```python
import torch

def _softmax(x, axis=-1):
    return torch.softmax(x, dim=axis)
def _gelu(x):
    return torch.nn.functional.gelu(x, approximate="tanh")
def _silu(x):
    return torch.nn.functional.silu(x)
def _sigmoid(x):
    return torch.sigmoid(x)
def _layernorm(x, axis=-1, eps=1e-5):
    m = x.mean(dim=axis, keepdim=True)
    v = x.var(dim=axis, keepdim=True, unbiased=False)
    return (x - m) / torch.sqrt(v + eps)
def _scatter_add(tgt, idx, src, axis=0):
    return tgt.clone().index_add_(axis, idx, src)
def _segment_sum(src, seg, n):
    out = torch.zeros((n,) + src.shape[1:], dtype=src.dtype)
    return out.index_add_(0, seg, src)
def _pad(x, pw):
    flat = tuple(v for pair in reversed(pw) for v in pair)
    return torch.nn.functional.pad(x, flat)

kernel_name = 'standalone__detection_seg_mask2former__vision'

def setup_inputs():

    _w = (lambda a: (lambda t: t.to(torch.bfloat16) if t.is_floating_point() else t)(torch.as_tensor(a)))
    H = W = 256
    C = 384
    Hc, Wc = H // 2, W // 2
    nh = 4
    Nq = 16
    sc = C ** -0.5
    return {
        "q": _w((lambda *s: torch.randn(*s, dtype=torch.bfloat16) * 0.2)(1, Nq, C)),
        "f_hi": _w((lambda *s: torch.randn(*s, dtype=torch.bfloat16) * 0.2)(1, H, W, C)),
        "f_lo": _w((lambda *s: torch.randn(*s, dtype=torch.bfloat16) * 0.4)(1, Hc, Wc, C)),
        "w_lat": _w((lambda *s: torch.randn(*s, dtype=torch.bfloat16) * 0.4)(C, C) * sc),
        "w_q": _w((lambda *s: torch.randn(*s, dtype=torch.bfloat16) * 3.2)(nh, C, C // nh) * sc),
        "w_k": _w((lambda *s: torch.randn(*s, dtype=torch.bfloat16) * 3.2)(nh, C, C // nh) * sc),
        "w_v": _w((lambda *s: torch.randn(*s, dtype=torch.bfloat16) * 3.2)(nh, C, C // nh) * sc),
        "w_o": _w((lambda *s: torch.randn(*s, dtype=torch.bfloat16) * 3.2)(C, C) * sc),
        "w_m": _w((lambda *s: torch.randn(*s, dtype=torch.bfloat16) * 1.6)(C, C) * sc),
    }

def reference(q, f_hi, f_lo, w_lat, w_q, w_k, w_v, w_o, w_m):
    B, Nq, C = q.shape
    _, H, W, _ = f_hi.shape
    nh = w_q.shape[0]
    dh = C // nh
    up = (lambda x, n, axis: torch.repeat_interleave(x, n, dim=axis))((lambda x, n, axis: torch.repeat_interleave(x, n, dim=axis))(f_lo, 2, axis=1), 2, axis=2)
    feat = f_hi + up @ w_lat
    feat = _layernorm(feat, axis=-1)
    kv = feat.reshape(B, H * W, C)
    m_embed = q @ w_m
    mask_bias = torch.einsum('bqc,bkc->bqk', m_embed, kv) * (C ** -0.5)
    Q = torch.einsum('bqc,hcd->bhqd', q, w_q)
    K = torch.einsum('bkc,hcd->bhkd', kv, w_k)
    V = torch.einsum('bkc,hcd->bhkd', kv, w_v)
    logits = torch.einsum('bhqd,bhkd->bhqk', Q, K) * (dh ** -0.5)
    logits = logits + mask_bias[:, None, :, :]
    attn = _softmax(logits, axis=-1)
    ctx = torch.einsum('bhqk,bhkd->bqhd', attn, V).reshape(B, Nq, C)
    return q + ctx @ w_o
```

```asm
; @launch grid=(256,1,1) block=(512,1,1) lds=163840
.amdgcn_target "amdgcn-amd-amdhsa--gfx950"
.text
.globl standalone__detection_seg_mask2former__vision_kernel
.p2align 8
.type standalone__detection_seg_mask2former__vision_kernel,@function
standalone__detection_seg_mask2former__vision_kernel:
s_getpc_b64 s[40:41]
s_load_dwordx16 s[64:79], s[0:1], 0
s_load_dwordx8 s[80:87], s[0:1], 64
s_lshr_b32 s42, s2, 3
s_and_b32 s43, s42, 15
s_lshl_b32 s43, s43, 13
s_min_u32 s43, s43, CODE_END-standalone__detection_seg_mask2former__vision_kernel-8192-64
v_lshl_add_u32 v28, v0, 4, s43
global_load_dwordx4 a[92:95], v28, s[40:41]
s_cmp_ge_u32 s2, 256
s_cbranch_scc1 K_end
v_lshrrev_b32 v2, 6, v0
v_and_b32 v0, 63, v0
v_readfirstlane_b32 s39, v2
v_lshlrev_b32 v1, 4, v0
v_and_b32 v56, 15, v0
v_lshrrev_b32 v57, 4, v0
s_and_b32 s3, s39, 3
s_movk_i32 s48, 768
s_mul_i32 s24, s3, 6144
s_lshr_b32 s57, s2, 4
s_lshl_b32 s57, s57, 3
s_and_b32 s44, s2, 7
s_or_b32 s57, s57, s44
s_and_b32 s45, s3, 1
s_mul_i32 s46, s45, 9
s_movk_i32 s47, 1366
v_mov_b32 v29, v0
v_mul_u32_u24 v30, s47, v29
v_lshrrev_b32 v30, 16, v30
v_mul_u32_u24 v31, 48, v30
v_sub_u32 v29, v29, v31
v_lshlrev_b32 v31, 1, v30
v_xor_b32 v31, s46, v31
v_xor_b32 v29, v29, v31
v_lshlrev_b32 v29, 4, v29
v_mul_u32_u24 v30, s48, v30
v_add_u32 v29, v29, v30
v_mov_b32 v36, v29
v_add_u32 v2, v30, v36
v_xor_b32 v29, 128, v29
v_add_u32 v39, 0, v29
v_add3_u32 v5, v30, v39, s48
v_add_u32 v5, 2304, v5
v_add_u32 v29, 64, v0
v_mul_u32_u24 v30, s47, v29
v_lshrrev_b32 v30, 16, v30
v_mul_u32_u24 v31, 48, v30
v_sub_u32 v29, v29, v31
v_lshlrev_b32 v31, 1, v30
v_xor_b32 v31, s46, v31
v_xor_b32 v29, v29, v31
v_lshlrev_b32 v29, 4, v29
v_mul_u32_u24 v30, s48, v30
v_add_u32 v29, v29, v30
v_subrev_u32 v37, 1024, v29
v_add_u32 v3, v30, v37
v_xor_b32 v29, 128, v29
v_add_u32 v40, 3072, v29
v_add3_u32 v6, v30, v40, s48
v_add_u32 v6, 2304, v6
v_add_u32 v29, 128, v0
v_mul_u32_u24 v30, s47, v29
v_lshrrev_b32 v30, 16, v30
v_mul_u32_u24 v31, 48, v30
v_sub_u32 v29, v29, v31
v_lshlrev_b32 v31, 1, v30
v_xor_b32 v31, s46, v31
v_xor_b32 v29, v29, v31
v_lshlrev_b32 v29, 4, v29
v_mul_u32_u24 v30, s48, v30
v_add_u32 v29, v29, v30
v_subrev_u32 v38, 2048, v29
v_add_u32 v4, v30, v38
v_xor_b32 v29, 128, v29
v_add_u32 v41, 2048, v29
v_add3_u32 v7, v30, v41, s48
v_add_u32 v7, 2304, v7
v_lshlrev_b32 v58, 1, v57
v_xor_b32 v58, v58, v56
v_lshlrev_b32 v58, 4, v58
v_mad_u32_u24 v32, v57, s48, v58
v_add_u32 v58, 4, v57
v_lshlrev_b32 v58, 1, v58
v_xor_b32 v58, v58, v56
v_lshlrev_b32 v58, 4, v58
v_mad_u32_u24 v33, v57, s48, v58
v_add_u32 v33, 2048, v33
v_lshlrev_b32 v58, 1, v57
v_xor_b32 v58, 9, v58
v_xor_b32 v58, v58, v56
v_lshlrev_b32 v58, 4, v58
v_mad_u32_u24 v34, v57, s48, v58
v_add_u32 v34, 4096, v34
v_add_u32 v58, 4, v57
v_lshlrev_b32 v58, 1, v58
v_xor_b32 v58, 9, v58
v_xor_b32 v58, v58, v56
v_lshlrev_b32 v58, 4, v58
v_mad_u32_u24 v35, v57, s48, v58
v_add_u32 v35, 6144, v35
s_mul_i32 s25, s2, 49152
s_lshl_b32 s44, s24, 1
s_add_u32 s25, s25, s44
s_lshr_b32 s26, s2, 1
s_mul_i32 s26, s26, 393216
s_and_b32 s27, s2, 1
s_mul_i32 s27, s27, 98304
s_add_u32 s26, s26, s27
s_mul_i32 s27, s45, 12288
s_add_u32 s26, s26, s27
s_lshr_b32 s27, s3, 1
s_mul_i32 s27, s27, 768
s_add_u32 s26, s26, s27
s_mul_i32 s27, s3, 73728
s_add_u32 s27, s27, 65536
s_lshl_b32 s45, s3, 12
s_lshr_b32 s43, s2, 4
s_lshl_b32 s43, s43, 2
s_add_u32 s43, s43, s3
s_mul_i32 s43, s43, 4608
s_waitcnt lgkmcnt(0)
s_mov_b32 s12, s66
s_mov_b32 s13, s67
s_mov_b32 s14, 50331648
s_mov_b32 s15, 0x20000
s_mov_b32 s16, s68
s_mov_b32 s17, s69
s_mov_b32 s18, 12582912
s_mov_b32 s19, 0x20000
s_mov_b32 s20, s70
s_mov_b32 s21, s71
s_mov_b32 s22, 294912
s_mov_b32 s23, 0x20000
s_mov_b32 s28, s86
s_mov_b32 s29, s87
s_mov_b32 s30, 4980736
s_mov_b32 s31, 0x20000
s_load_dword s38, s[86:87], 53248
s_mov_b32 s10, s78
s_mov_b32 s11, s79
s_cmp_ge_u32 s39, 4
s_cbranch_scc1 H_B
s_mov_b32 s97, 4980736
s_mov_b32 s96, 0
s_bitcmp1_b32 s2, 3
s_cbranch_scc0 H_none
s_cmp_ge_u32 s57, 120
s_cbranch_scc1 H_none2
s_cmp_ge_u32 s57, 96
s_cbranch_scc1 H_v
H_a:
s_mov_b32 s4, s64
s_mov_b32 s5, s65
s_mov_b32 s6, 12288
s_mov_b32 s7, 0x20000
s_mov_b32 s8, s72
s_mov_b32 s9, s73
s_mov_b32 s10, 294912
s_mov_b32 s11, 0x20000
s_mov_b32 s92, s74
s_mov_b32 s93, s75
s_mov_b32 s94, 294912
s_mov_b32 s95, 0x20000
s_mov_b32 s88, s80
s_mov_b32 s89, s81
s_mov_b32 s90, 294912
s_mov_b32 s91, 0x20000
s_bfe_u32 s40, s57, 0x20001
s_and_b32 s41, s57, 1
s_mul_i32 s41, s41, 12
s_lshr_b32 s44, s57, 3
s_add_u32 s41, s41, s44
s_mul_i32 s44, s40, 73728
s_mul_i32 s50, s41, 3072
s_add_u32 s50, s50, s44
s_min_u32 s51, s3, 2
s_lshl_b32 s51, s51, 10
s_add_u32 s50, s50, s51
s_add_u32 m0, s51, 159744
s_nop 0
buffer_load_dwordx4 v1, s[92:95], s50 offen lds
s_mul_i32 s99, s3, 3072
s_add_u32 s99, s99, 147456
s_mov_b32 m0, s99
s_mul_i32 s50, s3, 192
s_movk_i32 s51, 5462
v_add_u32 v64, 0, v0
v_mul_u32_u24 v65, s51, v64
v_lshrrev_b32 v65, 16, v65
v_mul_u32_u24 v65, 576, v65
v_add_u32 v66, v65, v1
buffer_load_dwordx4 v66, s[4:7], s50 offen offset:0 lds
v_add_u32 v64, 64, v0
v_mul_u32_u24 v65, s51, v64
v_lshrrev_b32 v65, 16, v65
v_mul_u32_u24 v65, 576, v65
v_add_u32 v67, v65, v1
buffer_load_dwordx4 v67, s[4:7], s50 offen offset:1024 lds
v_add_u32 v64, 128, v0
v_mul_u32_u24 v65, s51, v64
v_lshrrev_b32 v65, 16, v65
v_mul_u32_u24 v65, 576, v65
v_add_u32 v68, v65, v1
buffer_load_dwordx4 v68, s[4:7], s50 offen offset:2048 lds
s_mul_i32 s98, s3, 18432
s_add_u32 s44, s44, s98
s_add_u32 s98, s98, 73728
v_mul_u32_u24 v69, 3072, v57
v_lshl_add_u32 v69, v56, 1, v69
s_mul_i32 s59, s3, 73728
s_lshl_b32 s50, s41, 5
s_add_u32 s59, s59, s50
s_add_u32 s50, s44, 0
s_add_u32 m0, s98, 0
s_nop 0
buffer_load_dwordx4 v1, s[8:11], s50 offen offset:0 lds
buffer_load_dwordx4 v1, s[8:11], s50 offen offset:1024 lds
buffer_load_dwordx4 v1, s[8:11], s50 offen offset:2048 lds
buffer_load_dwordx4 v1, s[8:11], s50 offen offset:3072 lds
s_add_u32 m0, s98, 4096
s_add_u32 s50, s50, 4096
buffer_load_dwordx4 v1, s[8:11], s50 offen offset:0 lds
buffer_load_dwordx4 v1, s[8:11], s50 offen offset:1024 lds
v_lshrrev_b32 v70, 1, v57
v_lshlrev_b32 v70, 8, v70
v_lshl_add_u32 v70, v56, 4, v70
v_and_b32 v71, 1, v57
v_lshl_add_u32 v70, v71, 3, v70
v_mul_u32_u24 v67, 192, v56
v_lshl_add_u32 v68, v57, 3, v67
v_add_u32 v68, s99, v68
v_lshl_add_u32 v67, v57, 4, v67
v_add_u32 v71, 159744, v67
v_add_u32 v66, s98, v67
v_add_u32 v67, s99, v1
v_lshrrev_b32 v59, 3, v56
v_mul_u32_u24 v59, 9, v59
v_and_b32 v58, 7, v56
v_lshlrev_b32 v58, 1, v58
v_xor_b32 v58, v58, v59
v_xor_b32 v59, v57, v58
v_lshlrev_b32 v59, 4, v59
v_mad_u32_u24 v8, v56, s48, v59
s_lshl_b32 s50, s3, 6
v_xor_b32 v8, s50, v8
v_xor_b32 v9, 64, v8
v_xor_b32 v10, 128, v8
v_xor_b32 v11, 192, v8
v_and_b32 v59, 3, v0
v_lshl_add_u32 v59, v57, 2, v59
v_mul_u32_u24 v18, 80, v59
v_bfe_u32 v59, v0, 2, 1
v_lshl_add_u32 v12, v59, 3, v18
v_add_u32 v12, 147456, v12
s_lshl_b32 s50, s3, 10
s_add_u32 s50, s50, 150016
v_add_u32 v13, s50, v1
v_mov_b32 v16, 0
s_lshl_b32 s50, s3, 12
s_add_u32 s50, s50, 360448
v_min_u32 v14, 29, v0
v_lshl_add_u32 v14, v14, 7, s50
s_mov_b32 s53, 0x3b2aaaab
s_mov_b32 s54, 0x3727c5ac
s_mov_b32 s55, 0x4e800000
s_add_u32 s50, s44, 6144
s_add_u32 m0, s98, 6144
s_nop 0
buffer_load_dwordx4 v1, s[8:11], s50 offen offset:0 lds
buffer_load_dwordx4 v1, s[8:11], s50 offen offset:1024 lds
buffer_load_dwordx4 v1, s[8:11], s50 offen offset:2048 lds
buffer_load_dwordx4 v1, s[8:11], s50 offen offset:3072 lds
s_add_u32 m0, s98, 10240
s_add_u32 s50, s50, 4096
buffer_load_dwordx4 v1, s[8:11], s50 offen offset:0 lds
buffer_load_dwordx4 v1, s[8:11], s50 offen offset:1024 lds
s_add_u32 s50, s44, 12288
s_add_u32 m0, s98, 12288
s_nop 0
buffer_load_dwordx4 v1, s[8:11], s50 offen offset:0 lds
buffer_load_dwordx4 v1, s[8:11], s50 offen offset:1024 lds
buffer_load_dwordx4 v1, s[8:11], s50 offen offset:2048 lds
buffer_load_dwordx4 v1, s[8:11], s50 offen offset:3072 lds
s_add_u32 m0, s98, 16384
s_add_u32 s50, s50, 4096
buffer_load_dwordx4 v1, s[8:11], s50 offen offset:0 lds
buffer_load_dwordx4 v1, s[8:11], s50 offen offset:1024 lds
buffer_load_ushort v72, v69, s[88:91], s59 offen offset:0
buffer_load_ushort v73, v69, s[88:91], s59 offen offset:768
buffer_load_ushort v74, v69, s[88:91], s59 offen offset:1536
buffer_load_ushort v75, v69, s[88:91], s59 offen offset:2304
s_add_u32 s59, s59, 12288
buffer_load_ushort v76, v69, s[88:91], s59 offen offset:0
buffer_load_ushort v77, v69, s[88:91], s59 offen offset:768
buffer_load_ushort v78, v69, s[88:91], s59 offen offset:1536
buffer_load_ushort v79, v69, s[88:91], s59 offen offset:2304
s_add_u32 s59, s59, 12288
buffer_load_ushort v80, v69, s[88:91], s59 offen offset:0
buffer_load_ushort v81, v69, s[88:91], s59 offen offset:768
buffer_load_ushort v82, v69, s[88:91], s59 offen offset:1536
buffer_load_ushort v83, v69, s[88:91], s59 offen offset:2304
s_add_u32 s59, s59, 12288
buffer_load_ushort v84, v69, s[88:91], s59 offen offset:0
buffer_load_ushort v85, v69, s[88:91], s59 offen offset:768
buffer_load_ushort v86, v69, s[88:91], s59 offen offset:1536
buffer_load_ushort v87, v69, s[88:91], s59 offen offset:2304
s_add_u32 s59, s59, 12288
buffer_load_ushort v88, v69, s[88:91], s59 offen offset:0
buffer_load_ushort v89, v69, s[88:91], s59 offen offset:768
buffer_load_ushort v90, v69, s[88:91], s59 offen offset:1536
buffer_load_ushort v91, v69, s[88:91], s59 offen offset:2304
s_add_u32 s59, s59, 12288
buffer_load_ushort v92, v69, s[88:91], s59 offen offset:0
buffer_load_ushort v93, v69, s[88:91], s59 offen offset:768
buffer_load_ushort v94, v69, s[88:91], s59 offen offset:1536
buffer_load_ushort v95, v69, s[88:91], s59 offen offset:2304
v_mov_b32 v64, -1
v_lshlrev_b32 v65, 2, v0
s_lshl_b32 s44, s57, 10
s_lshl_b32 s50, s3, 8
s_add_u32 s44, s44, s50
s_add_u32 s44, s44, 393216
buffer_store_dword v64, v65, s[28:31], s44 offen sc0 sc1
s_add_u32 s49, s25, 0
s_add_u32 m0, s45, 0
s_nop 0
buffer_load_dwordx4 v32, s[16:19], s49 offen offset:0 nt lds
buffer_load_dwordx4 v33, s[16:19], s49 offen offset:1024 nt lds
buffer_load_dwordx4 v34, s[16:19], s49 offen offset:2048 nt lds
buffer_load_dwordx4 v35, s[16:19], s49 offen offset:3072 nt lds
s_add_u32 s49, s24, 0
s_add_u32 m0, s24, 49152
s_nop 0
buffer_load_dwordx4 v36, s[20:23], s49 offen offset:0 lds
buffer_load_dwordx4 v37, s[20:23], s49 offen offset:1024 lds
buffer_load_dwordx4 v38, s[20:23], s49 offen offset:2048 lds
buffer_load_dwordx4 v39, s[20:23], s49 offen offset:3072 lds
s_add_u32 m0, s24, 53248
s_nop 0
buffer_load_dwordx4 v40, s[20:23], s49 offen offset:0 lds
buffer_load_dwordx4 v41, s[20:23], s49 offen offset:1024 lds
s_waitcnt vmcnt(35)
s_barrier
ds_read_b128 v[44:47], v71 offset:0
ds_read_b128 v[48:51], v71 offset:64
ds_read_b128 v[52:55], v71 offset:128
ds_read_b128 a[0:3], v66 offset:0
ds_read_b128 a[4:7], v66 offset:64
ds_read_b128 a[8:11], v66 offset:128
ds_read_b128 a[12:15], v66 offset:3072
ds_read_b128 a[16:19], v66 offset:3136
ds_read_b128 a[20:23], v66 offset:3200
ds_read_b128 a[24:27], v66 offset:6144
ds_read_b128 a[28:31], v66 offset:6208
ds_read_b128 a[32:35], v66 offset:6272
ds_read_b128 a[36:39], v66 offset:9216
ds_read_b128 a[40:43], v66 offset:9280
ds_read_b128 a[44:47], v66 offset:9344
ds_read_b128 a[48:51], v66 offset:12288
ds_read_b128 a[52:55], v66 offset:12352
ds_read_b128 a[56:59], v66 offset:12416
ds_read_b128 a[60:63], v66 offset:15360
ds_read_b128 a[64:67], v66 offset:15424
ds_read_b128 a[68:71], v66 offset:15488
ds_read_b64 a[72:73], v68 offset:0
ds_read_b64 a[74:75], v68 offset:32
ds_read_b64 a[76:77], v68 offset:64
ds_read_b64 a[78:79], v68 offset:96
ds_read_b64 a[80:81], v68 offset:128
ds_read_b64 a[82:83], v68 offset:160
s_add_u32 s49, s25, 256
s_add_u32 m0, s45, 16384
s_nop 0
buffer_load_dwordx4 v32, s[16:19], s49 offen offset:0 nt lds
buffer_load_dwordx4 v33, s[16:19], s49 offen offset:1024 nt lds
buffer_load_dwordx4 v34, s[16:19], s49 offen offset:2048 nt lds
buffer_load_dwordx4 v35, s[16:19], s49 offen offset:3072 nt lds
s_waitcnt lgkmcnt(0)
s_barrier
v_mfma_f32_16x16x32_bf16 v[96:99], a[0:3], v[44:47], 0
s_mov_b32 s50, 0x3e16c740
s_waitcnt vmcnt(37)
v_lshl_or_b32 v132, v73, 16, v72
s_waitcnt vmcnt(35)
v_lshl_or_b32 v133, v75, 16, v74
v_mfma_f32_16x16x32_bf16 v[100:103], a[12:15], v[44:47], 0
s_mov_b32 s51, 0x3d96c740
s_waitcnt vmcnt(33)
v_lshl_or_b32 v134, v77, 16, v76
s_waitcnt vmcnt(31)
v_lshl_or_b32 v135, v79, 16, v78
v_mfma_f32_16x16x32_bf16 v[96:99], a[4:7], v[48:51], v[96:99]
s_waitcnt vmcnt(29)
v_lshl_or_b32 v136, v81, 16, v80
s_waitcnt vmcnt(27)
v_lshl_or_b32 v137, v83, 16, v82
v_mfma_f32_16x16x32_bf16 v[100:103], a[16:19], v[48:51], v[100:103]
s_waitcnt vmcnt(25)
v_lshl_or_b32 v138, v85, 16, v84
s_waitcnt vmcnt(23)
v_lshl_or_b32 v139, v87, 16, v86
v_mfma_f32_16x16x32_bf16 v[104:107], a[24:27], v[44:47], 0
s_waitcnt vmcnt(21)
v_lshl_or_b32 v140, v89, 16, v88
s_waitcnt vmcnt(19)
v_lshl_or_b32 v141, v91, 16, v90
v_mfma_f32_16x16x32_bf16 v[108:111], a[36:39], v[44:47], 0
s_waitcnt vmcnt(17)
v_lshl_or_b32 v142, v93, 16, v92
s_waitcnt vmcnt(15)
v_lshl_or_b32 v143, v95, 16, v94
v_mfma_f32_16x16x32_bf16 v[96:99], a[8:11], v[52:55], v[96:99]
v_mfma_f32_16x16x32_bf16 v[100:103], a[20:23], v[52:55], v[100:103]
v_mfma_f32_16x16x32_bf16 v[104:107], a[28:31], v[48:51], v[104:107]
s_nop 5
v_cvt_pk_bf16_f32 v120, v96, v97
v_mfma_f32_16x16x32_bf16 v[108:111], a[40:43], v[48:51], v[108:111]
v_cvt_pk_bf16_f32 v121, v98, v99
v_cvt_pk_bf16_f32 v122, v100, v101
v_mfma_f32_16x16x32_bf16 v[112:115], a[48:51], v[44:47], 0
v_cvt_pk_bf16_f32 v123, v102, v103
v_mfma_f32_16x16x32_bf16 v[116:119], a[60:63], v[44:47], 0
v_mfma_f32_16x16x32_bf16 v[104:107], a[32:35], v[52:55], v[104:107]
v_mfma_f32_16x16x32_bf16 v[108:111], a[44:47], v[52:55], v[108:111]
v_mfma_f32_16x16x32_bf16 v[112:115], a[52:55], v[48:51], v[112:115]
s_nop 5
v_cvt_pk_bf16_f32 v124, v104, v105
v_mfma_f32_16x16x32_bf16 v[116:119], a[64:67], v[48:51], v[116:119]
v_cvt_pk_bf16_f32 v125, v106, v107
v_cvt_pk_bf16_f32 v126, v108, v109
v_mfma_f32_16x16x32_bf16 v[112:115], a[56:59], v[52:55], v[112:115]
v_cvt_pk_bf16_f32 v127, v110, v111
v_mfma_f32_16x16x32_bf16 v[116:119], a[68:71], v[52:55], v[116:119]
v_mfma_f32_16x16x32_bf16 v[144:147], v[120:123], a[72:75], 0
s_nop 4
v_cvt_pk_bf16_f32 v128, v112, v113
v_mfma_f32_16x16x32_bf16 v[148:151], v[132:135], a[72:75], 0
v_cvt_pk_bf16_f32 v129, v114, v115
v_cvt_pk_bf16_f32 v130, v116, v117
v_mfma_f32_16x16x32_bf16 v[144:147], v[124:127], a[76:79], v[144:147]
v_cvt_pk_bf16_f32 v131, v118, v119
v_mfma_f32_16x16x32_bf16 v[148:151], v[136:139], a[76:79], v[148:151]
s_nop 0
v_mfma_f32_16x16x32_bf16 v[144:147], v[128:131], a[80:83], v[144:147]
v_mfma_f32_16x16x32_bf16 v[148:151], v[140:143], a[80:83], v[148:151]
s_nop 6
v_mul_f32 v144, s50, v144
v_mul_f32 v145, s50, v145
v_mul_f32 v146, s50, v146
v_mul_f32 v147, s50, v147
v_fma_f32 v144, s51, v148, v144
v_fma_f32 v145, s51, v149, v145
v_fma_f32 v146, s51, v150, v146
v_fma_f32 v147, s51, v151, v147
ds_write_b128 v67, v[144:147]
s_waitcnt lgkmcnt(0)
s_barrier
s_cmp_eq_u32 s3, 0
s_cbranch_scc0 H_a2
ds_read_b128 v[96:99], v67 offset:0
ds_read_b128 v[100:103], v67 offset:3072
ds_read_b128 v[104:107], v67 offset:6144
ds_read_b128 v[108:111], v67 offset:9216
s_waitcnt lgkmcnt(2)
v_add_f32 v96, v96, v100
s_waitcnt lgkmcnt(0)
v_add_f32 v104, v104, v108
v_add_f32 v96, v96, v104
v_add_f32 v97, v97, v101
v_add_f32 v105, v105, v109
v_add_f32 v97, v97, v105
v_add_f32 v98, v98, v102
v_add_f32 v106, v106, v110
v_add_f32 v98, v98, v106
v_add_f32 v99, v99, v103
v_add_f32 v107, v107, v111
v_add_f32 v99, v99, v107
v_cvt_pk_bf16_f32 v96, v96, v97
v_cvt_pk_bf16_f32 v97, v98, v99
s_mul_i32 s50, s40, 12288
s_lshl_b32 s51, s41, 9
s_add_u32 s50, s50, s51
buffer_store_dwordx2 v[96:97], v70, s[28:31], s50 offen sc0 sc1
H_a2:
s_add_u32 s49, s24, 24576
s_add_u32 m0, s24, 73728
s_nop 0
buffer_load_dwordx4 v36, s[20:23], s49 offen offset:0 lds
buffer_load_dwordx4 v37, s[20:23], s49 offen offset:1024 lds
buffer_load_dwordx4 v38, s[20:23], s49 offen offset:2048 lds
buffer_load_dwordx4 v39, s[20:23], s49 offen offset:3072 lds
s_add_u32 m0, s24, 77824
s_nop 0
buffer_load_dwordx4 v40, s[20:23], s49 offen offset:0 lds
buffer_load_dwordx4 v41, s[20:23], s49 offen offset:1024 lds
s_lshl_b32 s44, s40, 12
s_lshl_b32 s50, s41, 7
s_add_u32 s44, s44, s50
s_add_u32 s44, s44, 360448
s_cmp_eq_u32 s3, 0
s_cselect_b32 s97, s44, s97
s_cselect_b32 s96, 1, 0
s_branch J_Ab
H_v:
s_mov_b32 s8, s76
s_mov_b32 s9, s77
s_mov_b32 s10, 294912
s_mov_b32 s11, 0x20000
s_bfe_u32 s40, s57, 0x20001
s_and_b32 s41, s57, 1
s_mul_i32 s41, s41, 3
s_lshr_b32 s44, s57, 3
s_add_u32 s41, s41, s44
s_sub_u32 s41, s41, 12
v_mul_u32_u24 v69, 768, v57
v_lshl_add_u32 v69, v56, 1, v69
s_mul_i32 s50, s40, 73728
s_mul_i32 s51, s3, 18432
s_add_u32 s50, s50, s51
s_lshl_b32 s51, s41, 5
s_add_u32 s50, s50, s51
buffer_load_ushort v72, v69, s[8:11], s50 offen offset:0
buffer_load_ushort v73, v69, s[8:11], s50 offen offset:192
buffer_load_ushort v74, v69, s[8:11], s50 offen offset:384
buffer_load_ushort v75, v69, s[8:11], s50 offen offset:576
s_add_u32 s50, s50, 3072
buffer_load_ushort v76, v69, s[8:11], s50 offen offset:0
buffer_load_ushort v77, v69, s[8:11], s50 offen offset:192
buffer_load_ushort v78, v69, s[8:11], s50 offen offset:384
buffer_load_ushort v79, v69, s[8:11], s50 offen offset:576
s_add_u32 s50, s50, 3072
buffer_load_ushort v80, v69, s[8:11], s50 offen offset:0
buffer_load_ushort v81, v69, s[8:11], s50 offen offset:192
buffer_load_ushort v82, v69, s[8:11], s50 offen offset:384
buffer_load_ushort v83, v69, s[8:11], s50 offen offset:576
s_add_u32 s50, s50, 3072
buffer_load_ushort v84, v69, s[8:11], s50 offen offset:0
buffer_load_ushort v85, v69, s[8:11], s50 offen offset:192
buffer_load_ushort v86, v69, s[8:11], s50 offen offset:384
buffer_load_ushort v87, v69, s[8:11], s50 offen offset:576
s_add_u32 s50, s50, 3072
buffer_load_ushort v88, v69, s[8:11], s50 offen offset:0
buffer_load_ushort v89, v69, s[8:11], s50 offen offset:192
buffer_load_ushort v90, v69, s[8:11], s50 offen offset:384
buffer_load_ushort v91, v69, s[8:11], s50 offen offset:576
s_add_u32 s50, s50, 3072
buffer_load_ushort v92, v69, s[8:11], s50 offen offset:0
buffer_load_ushort v93, v69, s[8:11], s50 offen offset:192
buffer_load_ushort v94, v69, s[8:11], s50 offen offset:384
buffer_load_ushort v95, v69, s[8:11], s50 offen offset:576
s_add_u32 s50, s50, 3072
s_add_u32 s49, s25, 0
s_add_u32 m0, s45, 0
s_nop 0
buffer_load_dwordx4 v32, s[16:19], s49 offen offset:0 nt lds
buffer_load_dwordx4 v33, s[16:19], s49 offen offset:1024 nt lds
buffer_load_dwordx4 v34, s[16:19], s49 offen offset:2048 nt lds
buffer_load_dwordx4 v35, s[16:19], s49 offen offset:3072 nt lds
s_add_u32 s49, s24, 0
s_add_u32 m0, s24, 49152
s_nop 0
buffer_load_dwordx4 v36, s[20:23], s49 offen offset:0 lds
buffer_load_dwordx4 v37, s[20:23], s49 offen offset:1024 lds
buffer_load_dwordx4 v38, s[20:23], s49 offen offset:2048 lds
buffer_load_dwordx4 v39, s[20:23], s49 offen offset:3072 lds
s_add_u32 m0, s24, 53248
s_nop 0
buffer_load_dwordx4 v40, s[20:23], s49 offen offset:0 lds
buffer_load_dwordx4 v41, s[20:23], s49 offen offset:1024 lds
s_add_u32 s49, s25, 256
s_add_u32 m0, s45, 16384
s_nop 0
buffer_load_dwordx4 v32, s[16:19], s49 offen offset:0 nt lds
buffer_load_dwordx4 v33, s[16:19], s49 offen offset:1024 nt lds
buffer_load_dwordx4 v34, s[16:19], s49 offen offset:2048 nt lds
buffer_load_dwordx4 v35, s[16:19], s49 offen offset:3072 nt lds
v_lshrrev_b32 v59, 3, v56
v_mul_u32_u24 v59, 9, v59
v_and_b32 v58, 7, v56
v_lshlrev_b32 v58, 1, v58
v_xor_b32 v58, v58, v59
v_xor_b32 v59, v57, v58
v_lshlrev_b32 v59, 4, v59
v_mad_u32_u24 v8, v56, s48, v59
s_lshl_b32 s50, s3, 6
v_xor_b32 v8, s50, v8
v_xor_b32 v9, 64, v8
v_xor_b32 v10, 128, v8
v_xor_b32 v11, 192, v8
v_and_b32 v59, 3, v0
v_lshl_add_u32 v59, v57, 2, v59
v_mul_u32_u24 v18, 80, v59
v_bfe_u32 v59, v0, 2, 1
v_lshl_add_u32 v12, v59, 3, v18
v_add_u32 v12, 147456, v12
s_lshl_b32 s50, s3, 10
s_add_u32 s50, s50, 150016
v_add_u32 v13, s50, v1
v_mov_b32 v16, 0
s_lshl_b32 s50, s3, 12
s_add_u32 s50, s50, 360448
v_min_u32 v14, 29, v0
v_lshl_add_u32 v14, v14, 7, s50
s_mov_b32 s53, 0x3b2aaaab
s_mov_b32 s54, 0x3727c5ac
s_mov_b32 s55, 0x4e800000
s_waitcnt vmcnt(37)
v_lshlrev_b32 v72, 16, v72
s_waitcnt vmcnt(36)
v_lshlrev_b32 v73, 16, v73
s_waitcnt vmcnt(35)
v_lshlrev_b32 v74, 16, v74
s_waitcnt vmcnt(34)
v_lshlrev_b32 v75, 16, v75
s_waitcnt vmcnt(33)
v_lshlrev_b32 v76, 16, v76
s_waitcnt vmcnt(32)
v_lshlrev_b32 v77, 16, v77
s_waitcnt vmcnt(31)
v_lshlrev_b32 v78, 16, v78
s_waitcnt vmcnt(30)
v_lshlrev_b32 v79, 16, v79
s_waitcnt vmcnt(29)
v_lshlrev_b32 v80, 16, v80
s_waitcnt vmcnt(28)
v_lshlrev_b32 v81, 16, v81
s_waitcnt vmcnt(27)
v_lshlrev_b32 v82, 16, v82
s_waitcnt vmcnt(26)
v_lshlrev_b32 v83, 16, v83
s_waitcnt vmcnt(25)
v_lshlrev_b32 v84, 16, v84
s_waitcnt vmcnt(24)
v_lshlrev_b32 v85, 16, v85
s_waitcnt vmcnt(23)
v_lshlrev_b32 v86, 16, v86
s_waitcnt vmcnt(22)
v_lshlrev_b32 v87, 16, v87
s_waitcnt vmcnt(21)
v_lshlrev_b32 v88, 16, v88
s_waitcnt vmcnt(20)
v_lshlrev_b32 v89, 16, v89
s_waitcnt vmcnt(19)
v_lshlrev_b32 v90, 16, v90
s_waitcnt vmcnt(18)
v_lshlrev_b32 v91, 16, v91
s_waitcnt vmcnt(17)
v_lshlrev_b32 v92, 16, v92
s_waitcnt vmcnt(16)
v_lshlrev_b32 v93, 16, v93
s_waitcnt vmcnt(15)
v_lshlrev_b32 v94, 16, v94
s_waitcnt vmcnt(14)
v_lshlrev_b32 v95, 16, v95
v_add_f32 v96, v72, v73
v_add_f32 v97, v74, v75
v_add_f32 v98, v76, v77
v_add_f32 v99, v78, v79
v_add_f32 v100, v80, v81
v_add_f32 v101, v82, v83
v_add_f32 v102, v84, v85
v_add_f32 v103, v86, v87
v_add_f32 v104, v88, v89
v_add_f32 v105, v90, v91
v_add_f32 v106, v92, v93
v_add_f32 v107, v94, v95
v_add_f32 v96, v96, v97
v_add_f32 v96, v96, v98
v_add_f32 v96, v96, v99
v_add_f32 v96, v96, v100
v_add_f32 v96, v96, v101
v_add_f32 v96, v96, v102
v_add_f32 v96, v96, v103
v_add_f32 v96, v96, v104
v_add_f32 v96, v96, v105
v_add_f32 v96, v96, v106
v_add_f32 v96, v96, v107
v_mov_b32 v97, v96
s_nop 1
v_permlane32_swap_b32 v96, v97
v_add_f32 v96, v96, v97
v_mov_b32 v97, v96
s_nop 1
v_permlane16_swap_b32 v96, v97
v_add_f32 v96, v96, v97
s_lshl_b32 s44, s3, 2
s_add_u32 s44, s44, 147456
v_and_b32 v67, 15, v0
v_lshlrev_b32 v67, 4, v67
v_add_u32 v68, s44, v67
v_add_u32 v67, 147456, v67
ds_write_b32 v68, v96
s_waitcnt lgkmcnt(0)
s_barrier
ds_read_b128 v[100:103], v67
s_mov_b32 s44, 0x3b2aaaab
s_waitcnt lgkmcnt(0)
v_add_f32 v100, v100, v101
v_add_f32 v102, v102, v103
v_add_f32 v100, v100, v102
v_mul_f32 v100, s44, v100
v_sub_f32 v72, v72, v100
v_mov_b32 v101, v72
v_cvt_pk_bf16_f32 v72, v101, v101
v_and_b32 v72, 0xffff0000, v72
v_sub_f32 v101, v101, v72
v_sub_f32 v73, v73, v100
v_add_f32 v101, v73, v101
v_cvt_pk_bf16_f32 v73, v101, v101
v_and_b32 v73, 0xffff0000, v73
v_sub_f32 v101, v101, v73
v_sub_f32 v74, v74, v100
v_add_f32 v101, v74, v101
v_cvt_pk_bf16_f32 v74, v101, v101
v_and_b32 v74, 0xffff0000, v74
v_sub_f32 v101, v101, v74
v_sub_f32 v75, v75, v100
v_add_f32 v101, v75, v101
v_cvt_pk_bf16_f32 v75, v101, v101
v_and_b32 v75, 0xffff0000, v75
v_sub_f32 v101, v101, v75
v_sub_f32 v76, v76, v100
v_add_f32 v101, v76, v101
v_cvt_pk_bf16_f32 v76, v101, v101
v_and_b32 v76, 0xffff0000, v76
v_sub_f32 v101, v101, v76
v_sub_f32 v77, v77, v100
v_add_f32 v101, v77, v101
v_cvt_pk_bf16_f32 v77, v101, v101
v_and_b32 v77, 0xffff0000, v77
v_sub_f32 v101, v101, v77
v_sub_f32 v78, v78, v100
v_add_f32 v101, v78, v101
v_cvt_pk_bf16_f32 v78, v101, v101
v_and_b32 v78, 0xffff0000, v78
v_sub_f32 v101, v101, v78
v_sub_f32 v79, v79, v100
v_add_f32 v101, v79, v101
v_cvt_pk_bf16_f32 v79, v101, v101
v_and_b32 v79, 0xffff0000, v79
v_sub_f32 v101, v101, v79
v_sub_f32 v80, v80, v100
v_add_f32 v101, v80, v101
v_cvt_pk_bf16_f32 v80, v101, v101
v_and_b32 v80, 0xffff0000, v80
v_sub_f32 v101, v101, v80
v_sub_f32 v81, v81, v100
v_add_f32 v101, v81, v101
v_cvt_pk_bf16_f32 v81, v101, v101
v_and_b32 v81, 0xffff0000, v81
v_sub_f32 v101, v101, v81
v_sub_f32 v82, v82, v100
v_add_f32 v101, v82, v101
v_cvt_pk_bf16_f32 v82, v101, v101
v_and_b32 v82, 0xffff0000, v82
v_sub_f32 v101, v101, v82
v_sub_f32 v83, v83, v100
v_add_f32 v101, v83, v101
v_cvt_pk_bf16_f32 v83, v101, v101
v_and_b32 v83, 0xffff0000, v83
v_sub_f32 v101, v101, v83
v_sub_f32 v84, v84, v100
v_add_f32 v101, v84, v101
v_cvt_pk_bf16_f32 v84, v101, v101
v_and_b32 v84, 0xffff0000, v84
v_sub_f32 v101, v101, v84
v_sub_f32 v85, v85, v100
v_add_f32 v101, v85, v101
v_cvt_pk_bf16_f32 v85, v101, v101
v_and_b32 v85, 0xffff0000, v85
v_sub_f32 v101, v101, v85
v_sub_f32 v86, v86, v100
v_add_f32 v101, v86, v101
v_cvt_pk_bf16_f32 v86, v101, v101
v_and_b32 v86, 0xffff0000, v86
v_sub_f32 v101, v101, v86
v_sub_f32 v87, v87, v100
v_add_f32 v101, v87, v101
v_cvt_pk_bf16_f32 v87, v101, v101
v_and_b32 v87, 0xffff0000, v87
v_sub_f32 v101, v101, v87
v_sub_f32 v88, v88, v100
v_add_f32 v101, v88, v101
v_cvt_pk_bf16_f32 v88, v101, v101
v_and_b32 v88, 0xffff0000, v88
v_sub_f32 v101, v101, v88
v_sub_f32 v89, v89, v100
v_add_f32 v101, v89, v101
v_cvt_pk_bf16_f32 v89, v101, v101
v_and_b32 v89, 0xffff0000, v89
v_sub_f32 v101, v101, v89
v_sub_f32 v90, v90, v100
v_add_f32 v101, v90, v101
v_cvt_pk_bf16_f32 v90, v101, v101
v_and_b32 v90, 0xffff0000, v90
v_sub_f32 v101, v101, v90
v_sub_f32 v91, v91, v100
v_add_f32 v101, v91, v101
v_cvt_pk_bf16_f32 v91, v101, v101
v_and_b32 v91, 0xffff0000, v91
v_sub_f32 v101, v101, v91
v_sub_f32 v92, v92, v100
v_add_f32 v101, v92, v101
v_cvt_pk_bf16_f32 v92, v101, v101
v_and_b32 v92, 0xffff0000, v92
v_sub_f32 v101, v101, v92
v_sub_f32 v93, v93, v100
v_add_f32 v101, v93, v101
v_cvt_pk_bf16_f32 v93, v101, v101
v_and_b32 v93, 0xffff0000, v93
v_sub_f32 v101, v101, v93
v_sub_f32 v94, v94, v100
v_add_f32 v101, v94, v101
v_cvt_pk_bf16_f32 v94, v101, v101
v_and_b32 v94, 0xffff0000, v94
v_sub_f32 v101, v101, v94
v_sub_f32 v95, v95, v100
v_add_f32 v101, v95, v101
v_cvt_pk_bf16_f32 v95, v101, v101
v_and_b32 v95, 0xffff0000, v95
v_sub_f32 v101, v101, v95
v_add_f32 v101, v72, v101
v_cvt_pk_bf16_f32 v72, v101, v101
v_and_b32 v72, 0xffff0000, v72
v_sub_f32 v101, v101, v72
v_add_f32 v101, v73, v101
v_cvt_pk_bf16_f32 v73, v101, v101
v_and_b32 v73, 0xffff0000, v73
v_sub_f32 v101, v101, v73
v_add_f32 v101, v74, v101
v_cvt_pk_bf16_f32 v74, v101, v101
v_and_b32 v74, 0xffff0000, v74
v_sub_f32 v101, v101, v74
v_add_f32 v101, v75, v101
v_cvt_pk_bf16_f32 v75, v101, v101
v_and_b32 v75, 0xffff0000, v75
v_sub_f32 v101, v101, v75
v_add_f32 v101, v76, v101
v_cvt_pk_bf16_f32 v76, v101, v101
v_and_b32 v76, 0xffff0000, v76
v_sub_f32 v101, v101, v76
v_add_f32 v101, v77, v101
v_cvt_pk_bf16_f32 v77, v101, v101
v_and_b32 v77, 0xffff0000, v77
v_sub_f32 v101, v101, v77
v_add_f32 v101, v78, v101
v_cvt_pk_bf16_f32 v78, v101, v101
v_and_b32 v78, 0xffff0000, v78
v_sub_f32 v101, v101, v78
v_add_f32 v101, v79, v101
v_cvt_pk_bf16_f32 v79, v101, v101
v_and_b32 v79, 0xffff0000, v79
v_sub_f32 v101, v101, v79
v_add_f32 v101, v80, v101
v_cvt_pk_bf16_f32 v80, v101, v101
v_and_b32 v80, 0xffff0000, v80
v_sub_f32 v101, v101, v80
v_add_f32 v101, v81, v101
v_cvt_pk_bf16_f32 v81, v101, v101
v_and_b32 v81, 0xffff0000, v81
v_sub_f32 v101, v101, v81
v_add_f32 v101, v82, v101
v_cvt_pk_bf16_f32 v82, v101, v101
v_and_b32 v82, 0xffff0000, v82
v_sub_f32 v101, v101, v82
v_add_f32 v101, v83, v101
v_cvt_pk_bf16_f32 v83, v101, v101
v_and_b32 v83, 0xffff0000, v83
v_sub_f32 v101, v101, v83
v_add_f32 v101, v84, v101
v_cvt_pk_bf16_f32 v84, v101, v101
v_and_b32 v84, 0xffff0000, v84
v_sub_f32 v101, v101, v84
v_add_f32 v101, v85, v101
v_cvt_pk_bf16_f32 v85, v101, v101
v_and_b32 v85, 0xffff0000, v85
v_sub_f32 v101, v101, v85
v_add_f32 v101, v86, v101
v_cvt_pk_bf16_f32 v86, v101, v101
v_and_b32 v86, 0xffff0000, v86
v_sub_f32 v101, v101, v86
v_add_f32 v101, v87, v101
v_cvt_pk_bf16_f32 v87, v101, v101
v_and_b32 v87, 0xffff0000, v87
v_sub_f32 v101, v101, v87
v_add_f32 v101, v88, v101
v_cvt_pk_bf16_f32 v88, v101, v101
v_and_b32 v88, 0xffff0000, v88
v_sub_f32 v101, v101, v88
v_add_f32 v101, v89, v101
v_cvt_pk_bf16_f32 v89, v101, v101
v_and_b32 v89, 0xffff0000, v89
v_sub_f32 v101, v101, v89
v_add_f32 v101, v90, v101
v_cvt_pk_bf16_f32 v90, v101, v101
v_and_b32 v90, 0xffff0000, v90
v_sub_f32 v101, v101, v90
v_add_f32 v101, v91, v101
v_cvt_pk_bf16_f32 v91, v101, v101
v_and_b32 v91, 0xffff0000, v91
v_sub_f32 v101, v101, v91
v_add_f32 v101, v92, v101
v_cvt_pk_bf16_f32 v92, v101, v101
v_and_b32 v92, 0xffff0000, v92
v_sub_f32 v101, v101, v92
v_add_f32 v101, v93, v101
v_cvt_pk_bf16_f32 v93, v101, v101
v_and_b32 v93, 0xffff0000, v93
v_sub_f32 v101, v101, v93
v_add_f32 v101, v94, v101
v_cvt_pk_bf16_f32 v94, v101, v101
v_and_b32 v94, 0xffff0000, v94
v_sub_f32 v101, v101, v94
v_add_f32 v101, v95, v101
v_cvt_pk_bf16_f32 v95, v101, v101
v_and_b32 v95, 0xffff0000, v95
v_sub_f32 v101, v101, v95
v_cvt_pk_bf16_f32 v120, v72, v73
v_cvt_pk_bf16_f32 v121, v74, v75
v_cvt_pk_bf16_f32 v122, v76, v77
v_cvt_pk_bf16_f32 v123, v78, v79
v_cvt_pk_bf16_f32 v124, v80, v81
v_cvt_pk_bf16_f32 v125, v82, v83
v_cvt_pk_bf16_f32 v126, v84, v85
v_cvt_pk_bf16_f32 v127, v86, v87
v_cvt_pk_bf16_f32 v128, v88, v89
v_cvt_pk_bf16_f32 v129, v90, v91
v_cvt_pk_bf16_f32 v130, v92, v93
v_cvt_pk_bf16_f32 v131, v94, v95
s_mul_i32 s50, s40, 73728
s_mul_i32 s51, s3, 18432
s_add_u32 s50, s50, s51
s_lshl_b32 s51, s41, 10
s_add_u32 s50, s50, s51
s_add_u32 s50, s50, 65536
buffer_store_dwordx4 v[120:123], v1, s[28:31], s50 offen sc0 sc1
s_add_u32 s50, s50, 6144
buffer_store_dwordx4 v[124:127], v1, s[28:31], s50 offen sc0 sc1
s_add_u32 s50, s50, 6144
buffer_store_dwordx4 v[128:131], v1, s[28:31], s50 offen sc0 sc1
s_add_u32 s49, s24, 24576
s_add_u32 m0, s24, 73728
s_nop 0
buffer_load_dwordx4 v36, s[20:23], s49 offen offset:0 lds
buffer_load_dwordx4 v37, s[20:23], s49 offen offset:1024 lds
buffer_load_dwordx4 v38, s[20:23], s49 offen offset:2048 lds
buffer_load_dwordx4 v39, s[20:23], s49 offen offset:3072 lds
s_add_u32 m0, s24, 77824
s_nop 0
buffer_load_dwordx4 v40, s[20:23], s49 offen offset:0 lds
buffer_load_dwordx4 v41, s[20:23], s49 offen offset:1024 lds
s_lshl_b32 s44, s40, 12
s_lshl_b32 s50, s41, 7
s_add_u32 s44, s44, s50
s_add_u32 s44, s44, 363520
s_cmp_eq_u32 s3, 0
s_cselect_b32 s97, s44, s97
s_branch J_Ab
H_none:
s_add_u32 s49, s25, 0
s_add_u32 m0, s45, 0
s_nop 0
buffer_load_dwordx4 v32, s[16:19], s49 offen offset:0 nt lds
buffer_load_dwordx4 v33, s[16:19], s49 offen offset:1024 nt lds
buffer_load_dwordx4 v34, s[16:19], s49 offen offset:2048 nt lds
buffer_load_dwordx4 v35, s[16:19], s49 offen offset:3072 nt lds
s_lshr_b32 s50, s2, 4
s_lshl_b32 s50, s50, 2
s_add_u32 s50, s50, s3
s_bfe_u32 s51, s2, 0x20001
s_mul_i32 s51, s51, 73728
s_and_b32 s52, s2, 1
s_mul_i32 s44, s50, 1152
s_add_u32 s44, s44, s51
v_min_u32 v64, 8, v0
v_lshl_add_u32 v64, v64, 7, s44
global_load_dword a92, v64, s[72:73]
s_mul_i32 s59, s52, 384
s_add_u32 s59, s59, s43
v_min_u32 v65, 17, v0
v_mul_u32_u24 v66, 86, v65
v_lshrrev_b32 v66, 8, v66
v_mul_u32_u24 v66, 384, v66
v_lshl_add_u32 v65, v65, 7, v66
v_add_u32 v65, s59, v65
global_load_dword a92, v65, s[80:81]
s_mul_i32 s59, s50, 5
v_min_u32 v66, 4, v0
v_add_u32 v66, s59, v66
v_min_u32 v66, 287, v66
s_mul_i32 s59, s52, 36864
s_add_u32 s59, s59, s51
v_lshl_add_u32 v66, v66, 7, s59
global_load_dword a92, v66, s[74:75]
s_lshl_b32 s59, s50, 1
v_min_u32 v67, 1, v0
v_add_u32 v67, s59, v67
v_min_u32 v67, 95, v67
v_lshlrev_b32 v67, 7, v67
global_load_dword a92, v67, s[64:65]
global_load_dword a92, v64, s[76:77]
v_min_u32 v68, 35, v0
v_lshl_add_u32 v68, v68, 7, s43
global_load_dword a92, v68, s[70:71]
v_lshrrev_b32 v59, 3, v56
v_mul_u32_u24 v59, 9, v59
v_and_b32 v58, 7, v56
v_lshlrev_b32 v58, 1, v58
v_xor_b32 v58, v58, v59
v_xor_b32 v59, v57, v58
v_lshlrev_b32 v59, 4, v59
v_mad_u32_u24 v8, v56, s48, v59
s_lshl_b32 s50, s3, 6
v_xor_b32 v8, s50, v8
v_xor_b32 v9, 64, v8
v_xor_b32 v10, 128, v8
v_xor_b32 v11, 192, v8
v_and_b32 v59, 3, v0
v_lshl_add_u32 v59, v57, 2, v59
v_mul_u32_u24 v18, 80, v59
v_bfe_u32 v59, v0, 2, 1
v_lshl_add_u32 v12, v59, 3, v18
v_add_u32 v12, 147456, v12
s_lshl_b32 s50, s3, 10
s_add_u32 s50, s50, 150016
v_add_u32 v13, s50, v1
v_mov_b32 v16, 0
s_lshl_b32 s50, s3, 12
s_add_u32 s50, s50, 360448
v_min_u32 v14, 29, v0
v_lshl_add_u32 v14, v14, 7, s50
s_mov_b32 s53, 0x3b2aaaab
s_mov_b32 s54, 0x3727c5ac
s_mov_b32 s55, 0x4e800000
s_add_u32 s49, s24, 0
s_add_u32 m0, s24, 49152
s_nop 0
buffer_load_dwordx4 v36, s[20:23], s49 offen offset:0 lds
buffer_load_dwordx4 v37, s[20:23], s49 offen offset:1024 lds
buffer_load_dwordx4 v38, s[20:23], s49 offen offset:2048 lds
buffer_load_dwordx4 v39, s[20:23], s49 offen offset:3072 lds
s_add_u32 m0, s24, 53248
s_nop 0
buffer_load_dwordx4 v40, s[20:23], s49 offen offset:0 lds
buffer_load_dwordx4 v41, s[20:23], s49 offen offset:1024 lds
s_add_u32 s49, s24, 24576
s_add_u32 m0, s24, 73728
s_nop 0
buffer_load_dwordx4 v36, s[20:23], s49 offen offset:0 lds
buffer_load_dwordx4 v37, s[20:23], s49 offen offset:1024 lds
buffer_load_dwordx4 v38, s[20:23], s49 offen offset:2048 lds
buffer_load_dwordx4 v39, s[20:23], s49 offen offset:3072 lds
s_add_u32 m0, s24, 77824
s_nop 0
buffer_load_dwordx4 v40, s[20:23], s49 offen offset:0 lds
buffer_load_dwordx4 v41, s[20:23], s49 offen offset:1024 lds
s_add_u32 s49, s24, 49152
s_add_u32 m0, s24, 98304
s_nop 0
buffer_load_dwordx4 v36, s[20:23], s49 offen offset:0 lds
buffer_load_dwordx4 v37, s[20:23], s49 offen offset:1024 lds
buffer_load_dwordx4 v38, s[20:23], s49 offen offset:2048 lds
buffer_load_dwordx4 v39, s[20:23], s49 offen offset:3072 lds
s_add_u32 m0, s24, 102400
s_nop 0
buffer_load_dwordx4 v40, s[20:23], s49 offen offset:0 lds
buffer_load_dwordx4 v41, s[20:23], s49 offen offset:1024 lds
s_add_u32 s49, s25, 256
s_add_u32 m0, s45, 16384
s_nop 0
buffer_load_dwordx4 v32, s[16:19], s49 offen offset:0 nt lds
buffer_load_dwordx4 v33, s[16:19], s49 offen offset:1024 nt lds
buffer_load_dwordx4 v34, s[16:19], s49 offen offset:2048 nt lds
buffer_load_dwordx4 v35, s[16:19], s49 offen offset:3072 nt lds
s_branch J_Aa
H_none2:
s_add_u32 s49, s25, 0
s_add_u32 m0, s45, 0
s_nop 0
buffer_load_dwordx4 v32, s[16:19], s49 offen offset:0 nt lds
buffer_load_dwordx4 v33, s[16:19], s49 offen offset:1024 nt lds
buffer_load_dwordx4 v34, s[16:19], s49 offen offset:2048 nt lds
buffer_load_dwordx4 v35, s[16:19], s49 offen offset:3072 nt lds
v_lshrrev_b32 v59, 3, v56
v_mul_u32_u24 v59, 9, v59
v_and_b32 v58, 7, v56
v_lshlrev_b32 v58, 1, v58
v_xor_b32 v58, v58, v59
v_xor_b32 v59, v57, v58
v_lshlrev_b32 v59, 4, v59
v_mad_u32_u24 v8, v56, s48, v59
s_lshl_b32 s50, s3, 6
v_xor_b32 v8, s50, v8
v_xor_b32 v9, 64, v8
v_xor_b32 v10, 128, v8
v_xor_b32 v11, 192, v8
v_and_b32 v59, 3, v0
v_lshl_add_u32 v59, v57, 2, v59
v_mul_u32_u24 v18, 80, v59
v_bfe_u32 v59, v0, 2, 1
v_lshl_add_u32 v12, v59, 3, v18
v_add_u32 v12, 147456, v12
s_lshl_b32 s50, s3, 10
s_add_u32 s50, s50, 150016
v_add_u32 v13, s50, v1
v_mov_b32 v16, 0
s_lshl_b32 s50, s3, 12
s_add_u32 s50, s50, 360448
v_min_u32 v14, 29, v0
v_lshl_add_u32 v14, v14, 7, s50
s_mov_b32 s53, 0x3b2aaaab
s_mov_b32 s54, 0x3727c5ac
s_mov_b32 s55, 0x4e800000
s_add_u32 s49, s24, 0
s_add_u32 m0, s24, 49152
s_nop 0
buffer_load_dwordx4 v36, s[20:23], s49 offen offset:0 lds
buffer_load_dwordx4 v37, s[20:23], s49 offen offset:1024 lds
buffer_load_dwordx4 v38, s[20:23], s49 offen offset:2048 lds
buffer_load_dwordx4 v39, s[20:23], s49 offen offset:3072 lds
s_add_u32 m0, s24, 53248
s_nop 0
buffer_load_dwordx4 v40, s[20:23], s49 offen offset:0 lds
buffer_load_dwordx4 v41, s[20:23], s49 offen offset:1024 lds
s_add_u32 s49, s25, 256
s_add_u32 m0, s45, 16384
s_nop 0
buffer_load_dwordx4 v32, s[16:19], s49 offen offset:0 nt lds
buffer_load_dwordx4 v33, s[16:19], s49 offen offset:1024 nt lds
buffer_load_dwordx4 v34, s[16:19], s49 offen offset:2048 nt lds
buffer_load_dwordx4 v35, s[16:19], s49 offen offset:3072 nt lds
s_add_u32 s49, s24, 24576
s_add_u32 m0, s24, 73728
s_nop 0
buffer_load_dwordx4 v36, s[20:23], s49 offen offset:0 lds
buffer_load_dwordx4 v37, s[20:23], s49 offen offset:1024 lds
buffer_load_dwordx4 v38, s[20:23], s49 offen offset:2048 lds
buffer_load_dwordx4 v39, s[20:23], s49 offen offset:3072 lds
s_add_u32 m0, s24, 77824
s_nop 0
buffer_load_dwordx4 v40, s[20:23], s49 offen offset:0 lds
buffer_load_dwordx4 v41, s[20:23], s49 offen offset:1024 lds
s_branch J_Ab
H_B:
v_lshrrev_b32 v59, 3, v56
v_mul_u32_u24 v59, 9, v59
v_and_b32 v58, 7, v56
v_lshlrev_b32 v58, 1, v58
v_xor_b32 v58, v58, v59
v_xor_b32 v59, v57, v58
v_lshlrev_b32 v59, 4, v59
v_mad_u32_u24 v14, v56, s48, v59
s_lshl_b32 s50, s3, 6
v_xor_b32 v14, s50, v14
v_lshl_add_u32 v44, v56, 8, v59
v_xor_b32 v45, 64, v44
v_xor_b32 v46, 128, v44
v_xor_b32 v47, 192, v44
v_and_b32 v59, 1, v57
v_lshlrev_b32 v59, 3, v59
v_mad_u32_u24 v48, v56, s48, v59
v_mov_b32 v49, v58
v_lshrrev_b32 v50, 1, v57
v_lshrrev_b32 v59, 2, v56
v_cmp_eq_u32 vcc, v59, v57
s_lshl_b32 s50, s3, 4
v_mov_b32 v59, s50
v_cndmask_b32 v59, 64, v59, vcc
v_mul_u32_u24 v21, 80, v56
v_add_u32 v21, v21, v59
v_add_u32 v21, 147456, v21
v_add_u32 v20, 150016, v1
v_mov_b32 v22, 162816
v_and_b32 v59, 3, v0
v_cmp_eq_u32 s[32:33], 1, v59
v_cmp_eq_u32 s[34:35], 2, v59
v_cmp_eq_u32 s[36:37], 3, v59
v_bfe_u32 v61, v0, 1, 1
v_and_b32 v62, 1, v0
v_lshlrev_b32 v62, 3, v62
s_mul_i32 s50, s3, 12
v_lshrrev_b32 v60, 2, v56
v_lshl_add_u32 v60, v57, 2, v60
v_and_b32 v63, 15, v60
v_lshrrev_b32 v59, 3, v63
v_mul_u32_u24 v59, 9, v59
v_and_b32 v58, 7, v63
v_lshlrev_b32 v58, 1, v58
v_xor_b32 v58, v58, v59
v_mad_u32_u24 v63, v60, s48, v62
v_add_u32 v59, s50, v61
v_xor_b32 v59, v59, v58
v_lshl_add_u32 v8, v59, 4, v63
v_add3_u32 v59, s50, v61, 2
v_xor_b32 v59, v59, v58
v_lshl_add_u32 v9, v59, 4, v63
v_add3_u32 v59, s50, v61, 4
v_xor_b32 v59, v59, v58
v_lshl_add_u32 v10, v59, 4, v63
v_add3_u32 v59, s50, v61, 6
v_xor_b32 v59, v59, v58
v_lshl_add_u32 v11, v59, 4, v63
v_add3_u32 v59, s50, v61, 8
v_xor_b32 v59, v59, v58
v_lshl_add_u32 v12, v59, 4, v63
v_add3_u32 v59, s50, v61, 10
v_xor_b32 v59, v59, v58
v_lshl_add_u32 v13, v59, 4, v63
v_lshrrev_b32 v60, 2, v56
v_lshl_add_u32 v60, v57, 3, v60
v_and_b32 v63, 15, v60
v_lshrrev_b32 v59, 3, v63
v_mul_u32_u24 v59, 9, v59
v_and_b32 v58, 7, v63
v_lshlrev_b32 v58, 1, v58
v_xor_b32 v58, v58, v59
v_mad_u32_u24 v63, v60, s48, v62
v_add_u32 v63, 49152, v63
v_add_u32 v59, s50, v61
v_xor_b32 v59, v59, v58
v_lshl_add_u32 v24, v59, 4, v63
v_add3_u32 v59, s50, v61, 2
v_xor_b32 v59, v59, v58
v_lshl_add_u32 v26, v59, 4, v63
v_add3_u32 v59, s50, v61, 4
v_xor_b32 v59, v59, v58
v_lshl_add_u32 v28, v59, 4, v63
v_add3_u32 v59, s50, v61, 6
v_xor_b32 v59, v59, v58
v_lshl_add_u32 v30, v59, 4, v63
v_add3_u32 v59, s50, v61, 8
v_xor_b32 v59, v59, v58
v_lshl_add_u32 v32, v59, 4, v63
v_add3_u32 v59, s50, v61, 10
v_xor_b32 v59, v59, v58
v_lshl_add_u32 v34, v59, 4, v63
v_lshrrev_b32 v60, 2, v56
v_lshl_add_u32 v60, v57, 3, v60
v_add_u32 v60, 4, v60
v_and_b32 v63, 15, v60
v_lshrrev_b32 v59, 3, v63
v_mul_u32_u24 v59, 9, v59
v_and_b32 v58, 7, v63
v_lshlrev_b32 v58, 1, v58
v_xor_b32 v58, v58, v59
v_mad_u32_u24 v63, v60, s48, v62
v_add_u32 v63, 49152, v63
v_add_u32 v59, s50, v61
v_xor_b32 v59, v59, v58
v_lshl_add_u32 v25, v59, 4, v63
v_add3_u32 v59, s50, v61, 2
v_xor_b32 v59, v59, v58
v_lshl_add_u32 v27, v59, 4, v63
v_add3_u32 v59, s50, v61, 4
v_xor_b32 v59, v59, v58
v_lshl_add_u32 v29, v59, 4, v63
v_add3_u32 v59, s50, v61, 6
v_xor_b32 v59, v59, v58
v_lshl_add_u32 v31, v59, 4, v63
v_add3_u32 v59, s50, v61, 8
v_xor_b32 v59, v59, v58
v_lshl_add_u32 v33, v59, 4, v63
v_add3_u32 v59, s50, v61, 10
v_xor_b32 v59, v59, v58
v_lshl_add_u32 v35, v59, 4, v63
s_mov_b32 s50, 0x3f803f80
s_mov_b32 s56, 0x00800080
v_accvgpr_write_b32 a0, s50
v_accvgpr_write_b32 a1, s50
v_accvgpr_write_b32 a2, s50
v_accvgpr_write_b32 a3, s50
s_mov_b32 s16, s78
s_mov_b32 s17, s79
s_mov_b32 s18, 294912
s_mov_b32 s19, 0x20000
s_bitcmp1_b32 s2, 3
s_cbranch_scc0 J_Ba
s_cmp_ge_u32 s57, 120
s_cbranch_scc1 J_Bb
s_barrier
s_cmp_ge_u32 s57, 96
s_cbranch_scc1 J_Bb
s_barrier
s_barrier
s_branch J_Bb
J_Ba:
s_waitcnt vmcnt(0) lgkmcnt(0)
s_add_u32 s38, s38, 1
s_barrier
s_mul_i32 s50, s3, 12
v_add3_u32 v52, s50, v50, 0
v_xor_b32 v52, v52, v49
v_lshl_add_u32 v52, v52, 4, v48
v_add3_u32 v53, s50, v50, 2
v_xor_b32 v53, v53, v49
v_lshl_add_u32 v53, v53, 4, v48
v_add3_u32 v54, s50, v50, 4
v_xor_b32 v54, v54, v49
v_lshl_add_u32 v54, v54, 4, v48
v_add3_u32 v55, s50, v50, 6
v_xor_b32 v55, v55, v49
v_lshl_add_u32 v55, v55, 4, v48
v_add3_u32 v56, s50, v50, 8
v_xor_b32 v56, v56, v49
v_lshl_add_u32 v56, v56, 4, v48
v_add3_u32 v57, s50, v50, 10
v_xor_b32 v57, v57, v49
v_lshl_add_u32 v57, v57, 4, v48
v_mov_b32 v62, 0
s_lshl_b32 s50, s3, 2
v_add_u32 v63, s50, v22
s_add_u32 s49, s26, 221184
s_add_u32 m0, s24, 122880
ds_read_b128 a[16:19], v44 offset:0
v_min_u32 v23, 35, v0
v_lshlrev_b32 v23, 7, v23
s_mul_i32 s50, s3, 3072
ds_read_b128 a[20:23], v44 offset:4096
ds_read_b128 a[24:27], v44 offset:8192
ds_read_b128 a[28:31], v44 offset:12288
ds_read_b64_tr_b16 a[48:49], v24 offset:0
ds_read_b64_tr_b16 a[50:51], v25 offset:0
ds_read_b64_tr_b16 a[52:53], v26 offset:0
ds_read_b64_tr_b16 a[54:55], v27 offset:0
ds_read_b64_tr_b16 a[56:57], v28 offset:0
ds_read_b64_tr_b16 a[58:59], v29 offset:0
ds_read_b64_tr_b16 a[60:61], v30 offset:0
ds_read_b64_tr_b16 a[62:63], v31 offset:0
ds_read_b64_tr_b16 a[64:65], v32 offset:0
s_waitcnt lgkmcnt(7)
v_mfma_f32_16x16x32_bf16 v[64:67], a[48:51], a[16:19], 0
ds_read_b64_tr_b16 a[66:67], v33 offset:0
ds_read_b64_tr_b16 a[68:69], v34 offset:0
v_mfma_f32_16x16x32_bf16 v[68:71], a[48:51], a[20:23], 0
ds_read_b64_tr_b16 a[70:71], v35 offset:0
v_mfma_f32_16x16x32_bf16 v[72:75], a[48:51], a[24:27], 0
v_mfma_f32_16x16x32_bf16 v[76:79], a[48:51], a[28:31], 0
s_waitcnt lgkmcnt(3)
v_mfma_f32_16x16x32_bf16 v[80:83], a[52:55], a[16:19], 0
v_mfma_f32_16x16x32_bf16 v[84:87], a[52:55], a[20:23], 0
s_waitcnt lgkmcnt(0)
s_barrier
v_mfma_f32_16x16x32_bf16 v[88:91], a[52:55], a[24:27], 0
v_mfma_f32_16x16x32_bf16 v[92:95], a[52:55], a[28:31], 0
ds_read_b128 a[32:35], v45 offset:0
v_mfma_f32_16x16x32_bf16 v[96:99], a[56:59], a[16:19], 0
ds_read_b128 a[36:39], v45 offset:4096
v_mfma_f32_16x16x32_bf16 v[100:103], a[56:59], a[20:23], 0
ds_read_b128 a[40:43], v45 offset:8192
v_mfma_f32_16x16x32_bf16 v[104:107], a[56:59], a[24:27], 0
ds_read_b128 a[44:47], v45 offset:12288
v_mfma_f32_16x16x32_bf16 v[108:111], a[56:59], a[28:31], 0
ds_read_b64_tr_b16 a[72:73], v24 offset:24576
v_mfma_f32_16x16x32_bf16 v[112:115], a[60:63], a[16:19], 0
ds_read_b64_tr_b16 a[74:75], v25 offset:24576
ds_read_b64_tr_b16 a[76:77], v26 offset:24576
v_mfma_f32_16x16x32_bf16 v[116:119], a[60:63], a[20:23], 0
ds_read_b64_tr_b16 a[78:79], v27 offset:24576
v_add_u32 v24, 0xc000, v24
v_mfma_f32_16x16x32_bf16 v[120:123], a[60:63], a[24:27], 0
ds_read_b64_tr_b16 a[80:81], v28 offset:24576
ds_read_b64_tr_b16 a[82:83], v29 offset:24576
v_mfma_f32_16x16x32_bf16 v[124:127], a[60:63], a[28:31], 0
ds_read_b64_tr_b16 a[84:85], v30 offset:24576
ds_read_b64_tr_b16 a[86:87], v31 offset:24576
v_mfma_f32_16x16x32_bf16 v[128:131], a[64:67], a[16:19], 0
ds_read_b64_tr_b16 a[88:89], v32 offset:24576
v_add_u32 v25, 0xc000, v25
v_mfma_f32_16x16x32_bf16 v[132:135], a[64:67], a[20:23], 0
ds_read_b64_tr_b16 a[90:91], v33 offset:24576
ds_read_b64_tr_b16 a[92:93], v34 offset:24576
v_mfma_f32_16x16x32_bf16 v[136:139], a[64:67], a[24:27], 0
ds_read_b64_tr_b16 a[94:95], v35 offset:24576
v_add_u32 v26, 0xc000, v26
v_mfma_f32_16x16x32_bf16 v[140:143], a[64:67], a[28:31], 0
v_add_u32 v27, 0xc000, v27
v_add_u32 v28, 0xc000, v28
v_mfma_f32_16x16x32_bf16 v[144:147], a[68:71], a[16:19], 0
v_add_u32 v29, 0xc000, v29
v_add_u32 v30, 0xc000, v30
v_mfma_f32_16x16x32_bf16 v[148:151], a[68:71], a[20:23], 0
v_add_u32 v31, 0xc000, v31
v_add_u32 v32, 0xc000, v32
v_mfma_f32_16x16x32_bf16 v[152:155], a[68:71], a[24:27], 0
v_add_u32 v33, 0xc000, v33
s_waitcnt lgkmcnt(0)
s_barrier
v_mfma_f32_16x16x32_bf16 v[156:159], a[68:71], a[28:31], 0
v_add_u32 v34, 0xc000, v34
v_add_u32 v35, 0xc000, v35
v_mfma_f32_16x16x32_bf16 v[64:67], a[72:75], a[32:35], v[64:67]
ds_read_b128 a[16:19], v46 offset:0
v_mfma_f32_16x16x32_bf16 v[68:71], a[72:75], a[36:39], v[68:71]
ds_read_b128 a[20:23], v46 offset:4096
v_mfma_f32_16x16x32_bf16 v[72:75], a[72:75], a[40:43], v[72:75]
ds_read_b128 a[24:27], v46 offset:8192
v_mfma_f32_16x16x32_bf16 v[76:79], a[72:75], a[44:47], v[76:79]
ds_read_b128 a[28:31], v46 offset:12288
v_mfma_f32_16x16x32_bf16 v[80:83], a[76:79], a[32:35], v[80:83]
ds_read_b64_tr_b16 a[48:49], v24 offset:0
v_mfma_f32_16x16x32_bf16 v[84:87], a[76:79], a[36:39], v[84:87]
ds_read_b64_tr_b16 a[50:51], v25 offset:0
ds_read_b64_tr_b16 a[52:53], v26 offset:0
v_mfma_f32_16x16x32_bf16 v[88:91], a[76:79], a[40:43], v[88:91]
ds_read_b64_tr_b16 a[54:55], v27 offset:0
v_mfma_f32_16x16x32_bf16 v[92:95], a[76:79], a[44:47], v[92:95]
ds_read_b64_tr_b16 a[56:57], v28 offset:0
ds_read_b64_tr_b16 a[58:59], v29 offset:0
v_mfma_f32_16x16x32_bf16 v[96:99], a[80:83], a[32:35], v[96:99]
ds_read_b64_tr_b16 a[60:61], v30 offset:0
ds_read_b64_tr_b16 a[62:63], v31 offset:0
v_mfma_f32_16x16x32_bf16 v[100:103], a[80:83], a[36:39], v[100:103]
ds_read_b64_tr_b16 a[64:65], v32 offset:0
v_mfma_f32_16x16x32_bf16 v[104:107], a[80:83], a[40:43], v[104:107]
ds_read_b64_tr_b16 a[66:67], v33 offset:0
ds_read_b64_tr_b16 a[68:69], v34 offset:0
v_mfma_f32_16x16x32_bf16 v[108:111], a[80:83], a[44:47], v[108:111]
ds_read_b64_tr_b16 a[70:71], v35 offset:0
v_mfma_f32_16x16x32_bf16 v[112:115], a[84:87], a[32:35], v[112:115]
v_mfma_f32_16x16x32_bf16 v[116:119], a[84:87], a[36:39], v[116:119]
v_mfma_f32_16x16x32_bf16 v[120:123], a[84:87], a[40:43], v[120:123]
v_mfma_f32_16x16x32_bf16 v[124:127], a[84:87], a[44:47], v[124:127]
s_waitcnt lgkmcnt(0)
s_barrier
v_mfma_f32_16x16x32_bf16 v[128:131], a[88:91], a[32:35], v[128:131]
v_mfma_f32_16x16x32_bf16 v[132:135], a[88:91], a[36:39], v[132:135]
ds_read_b64_tr_b16 a[72:73], v24 offset:24576
ds_read_b64_tr_b16 a[74:75], v25 offset:24576
ds_read_b64_tr_b16 a[76:77], v26 offset:24576
v_mfma_f32_16x16x32_bf16 v[136:139], a[88:91], a[40:43], v[136:139]
ds_read_b64_tr_b16 a[78:79], v27 offset:24576
v_add_u32 v24, 0xffff4000, v24
v_mfma_f32_16x16x32_bf16 v[140:143], a[88:91], a[44:47], v[140:143]
ds_read_b64_tr_b16 a[80:81], v28 offset:24576
ds_read_b64_tr_b16 a[82:83], v29 offset:24576
v_mfma_f32_16x16x32_bf16 v[144:147], a[92:95], a[32:35], v[144:147]
ds_read_b128 a[32:35], v47 offset:0
v_add_u32 v25, 0xffff4000, v25
v_mfma_f32_16x16x32_bf16 v[148:151], a[92:95], a[36:39], v[148:151]
ds_read_b128 a[36:39], v47 offset:4096
v_add_u32 v26, 0xffff4000, v26
v_mfma_f32_16x16x32_bf16 v[152:155], a[92:95], a[40:43], v[152:155]
ds_read_b128 a[40:43], v47 offset:8192
v_add_u32 v27, 0xffff4000, v27
v_mfma_f32_16x16x32_bf16 v[156:159], a[92:95], a[44:47], v[156:159]
ds_read_b128 a[44:47], v47 offset:12288
v_mfma_f32_16x16x32_bf16 v[64:67], a[48:51], a[16:19], v[64:67]
v_add_u32 v28, 0xffff4000, v28
v_add_u32 v29, 0xffff4000, v29
v_mfma_f32_16x16x32_bf16 v[68:71], a[48:51], a[20:23], v[68:71]
ds_read_b64_tr_b16 a[84:85], v30 offset:24576
ds_read_b64_tr_b16 a[86:87], v31 offset:24576
ds_read_b64_tr_b16 a[88:89], v32 offset:24576
v_mfma_f32_16x16x32_bf16 v[72:75], a[48:51], a[24:27], v[72:75]
ds_read_b64_tr_b16 a[90:91], v33 offset:24576
v_add_u32 v30, 0xffff4000, v30
v_mfma_f32_16x16x32_bf16 v[76:79], a[48:51], a[28:31], v[76:79]
ds_read_b64_tr_b16 a[92:93], v34 offset:24576
ds_read_b64_tr_b16 a[94:95], v35 offset:24576
v_mfma_f32_16x16x32_bf16 v[80:83], a[52:55], a[16:19], v[80:83]
v_add_u32 v31, 0xffff4000, v31
v_add_u32 v32, 0xffff4000, v32
v_mfma_f32_16x16x32_bf16 v[84:87], a[52:55], a[20:23], v[84:87]
v_add_u32 v33, 0xffff4000, v33
v_add_u32 v34, 0xffff4000, v34
v_mfma_f32_16x16x32_bf16 v[88:91], a[52:55], a[24:27], v[88:91]
v_add_u32 v35, 0xffff4000, v35
v_mfma_f32_16x16x32_bf16 v[92:95], a[52:55], a[28:31], v[92:95]
v_mfma_f32_16x16x32_bf16 v[96:99], a[56:59], a[16:19], v[96:99]
s_waitcnt lgkmcnt(0)
s_barrier
v_mfma_f32_16x16x32_bf16 v[100:103], a[56:59], a[20:23], v[100:103]
v_mfma_f32_16x16x32_bf16 v[104:107], a[56:59], a[24:27], v[104:107]
ds_read_b64_tr_b16 a[48:49], v24 offset:0
v_mfma_f32_16x16x32_bf16 v[108:111], a[56:59], a[28:31], v[108:111]
ds_read_b64_tr_b16 a[50:51], v25 offset:0
ds_read_b64_tr_b16 a[52:53], v26 offset:0
v_mfma_f32_16x16x32_bf16 v[112:115], a[60:63], a[16:19], v[112:115]
ds_read_b64_tr_b16 a[54:55], v27 offset:0
ds_read_b64_tr_b16 a[56:57], v28 offset:0
v_mfma_f32_16x16x32_bf16 v[116:119], a[60:63], a[20:23], v[116:119]
ds_read_b64_tr_b16 a[58:59], v29 offset:0
v_mfma_f32_16x16x32_bf16 v[120:123], a[60:63], a[24:27], v[120:123]
v_mfma_f32_16x16x32_bf16 v[124:127], a[60:63], a[28:31], v[124:127]
ds_read_b64_tr_b16 a[60:61], v30 offset:0
ds_read_b64_tr_b16 a[62:63], v31 offset:0
v_mfma_f32_16x16x32_bf16 v[128:131], a[64:67], a[16:19], v[128:131]
v_mfma_f32_16x16x32_bf16 v[132:135], a[64:67], a[20:23], v[132:135]
v_mfma_f32_16x16x32_bf16 v[136:139], a[64:67], a[24:27], v[136:139]
v_mfma_f32_16x16x32_bf16 v[140:143], a[64:67], a[28:31], v[140:143]
ds_read_b64_tr_b16 a[64:65], v32 offset:0
ds_read_b64_tr_b16 a[66:67], v33 offset:0
v_mfma_f32_16x16x32_bf16 v[144:147], a[68:71], a[16:19], v[144:147]
ds_read_b128 a[16:19], v44 offset:16384
v_mfma_f32_16x16x32_bf16 v[148:151], a[68:71], a[20:23], v[148:151]
ds_read_b128 a[20:23], v44 offset:20480
v_mfma_f32_16x16x32_bf16 v[152:155], a[68:71], a[24:27], v[152:155]
ds_read_b128 a[24:27], v44 offset:24576
v_mfma_f32_16x16x32_bf16 v[156:159], a[68:71], a[28:31], v[156:159]
ds_read_b128 a[28:31], v44 offset:28672
v_mfma_f32_16x16x32_bf16 v[64:67], a[72:75], a[32:35], v[64:67]
ds_read_b64_tr_b16 a[68:69], v34 offset:0
v_mfma_f32_16x16x32_bf16 v[68:71], a[72:75], a[36:39], v[68:71]
ds_read_b64_tr_b16 a[70:71], v35 offset:0
v_mfma_f32_16x16x32_bf16 v[72:75], a[72:75], a[40:43], v[72:75]
v_mfma_f32_16x16x32_bf16 v[76:79], a[72:75], a[44:47], v[76:79]
v_mfma_f32_16x16x32_bf16 v[80:83], a[76:79], a[32:35], v[80:83]
v_mfma_f32_16x16x32_bf16 v[84:87], a[76:79], a[36:39], v[84:87]
s_waitcnt lgkmcnt(0)
s_barrier
v_mfma_f32_16x16x32_bf16 v[88:91], a[76:79], a[40:43], v[88:91]
v_mfma_f32_16x16x32_bf16 v[92:95], a[76:79], a[44:47], v[92:95]
ds_read_b64_tr_b16 a[72:73], v24 offset:24576
v_mfma_f32_16x16x32_bf16 v[96:99], a[80:83], a[32:35], v[96:99]
ds_read_b64_tr_b16 a[74:75], v25 offset:24576
ds_read_b64_tr_b16 a[76:77], v26 offset:24576
v_mfma_f32_16x16x32_bf16 v[100:103], a[80:83], a[36:39], v[100:103]
ds_read_b64_tr_b16 a[78:79], v27 offset:24576
v_add_u32 v24, 0xc000, v24
v_mfma_f32_16x16x32_bf16 v[104:107], a[80:83], a[40:43], v[104:107]
v_add_u32 v25, 0xc000, v25
v_add_u32 v26, 0xc000, v26
v_mfma_f32_16x16x32_bf16 v[108:111], a[80:83], a[44:47], v[108:111]
ds_read_b64_tr_b16 a[80:81], v28 offset:24576
ds_read_b64_tr_b16 a[82:83], v29 offset:24576
v_mfma_f32_16x16x32_bf16 v[112:115], a[84:87], a[32:35], v[112:115]
v_add_u32 v27, 0xc000, v27
v_add_u32 v28, 0xc000, v28
v_mfma_f32_16x16x32_bf16 v[116:119], a[84:87], a[36:39], v[116:119]
v_add_u32 v29, 0xc000, v29
v_mfma_f32_16x16x32_bf16 v[120:123], a[84:87], a[40:43], v[120:123]
v_mfma_f32_16x16x32_bf16 v[124:127], a[84:87], a[44:47], v[124:127]
ds_read_b64_tr_b16 a[84:85], v30 offset:24576
ds_read_b64_tr_b16 a[86:87], v31 offset:24576
v_mfma_f32_16x16x32_bf16 v[128:131], a[88:91], a[32:35], v[128:131]
v_add_u32 v30, 0xc000, v30
v_add_u32 v31, 0xc000, v31
v_mfma_f32_16x16x32_bf16 v[132:135], a[88:91], a[36:39], v[132:135]
v_mfma_f32_16x16x32_bf16 v[136:139], a[88:91], a[40:43], v[136:139]
v_mfma_f32_16x16x32_bf16 v[140:143], a[88:91], a[44:47], v[140:143]
ds_read_b64_tr_b16 a[88:89], v32 offset:24576
ds_read_b64_tr_b16 a[90:91], v33 offset:24576
v_mfma_f32_16x16x32_bf16 v[144:147], a[92:95], a[32:35], v[144:147]
ds_read_b128 a[32:35], v45 offset:16384
v_add_u32 v32, 0xc000, v32
v_mfma_f32_16x16x32_bf16 v[148:151], a[92:95], a[36:39], v[148:151]
ds_read_b128 a[36:39], v45 offset:20480
v_add_u32 v33, 0xc000, v33
v_mfma_f32_16x16x32_bf16 v[152:155], a[92:95], a[40:43], v[152:155]
ds_read_b128 a[40:43], v45 offset:24576
v_mfma_f32_16x16x32_bf16 v[156:159], a[92:95], a[44:47], v[156:159]
ds_read_b128 a[44:47], v45 offset:28672
v_mfma_f32_16x16x32_bf16 v[64:67], a[48:51], a[16:19], v[64:67]
ds_read_b64_tr_b16 a[92:93], v34 offset:24576
v_mfma_f32_16x16x32_bf16 v[68:71], a[48:51], a[20:23], v[68:71]
ds_read_b64_tr_b16 a[94:95], v35 offset:24576
v_add_u32 v34, 0xc000, v34
v_mfma_f32_16x16x32_bf16 v[72:75], a[48:51], a[24:27], v[72:75]
v_add_u32 v35, 0xc000, v35
v_mfma_f32_16x16x32_bf16 v[76:79], a[48:51], a[28:31], v[76:79]
v_mfma_f32_16x16x32_bf16 v[80:83], a[52:55], a[16:19], v[80:83]
v_mfma_f32_16x16x32_bf16 v[84:87], a[52:55], a[20:23], v[84:87]
s_waitcnt lgkmcnt(0)
s_barrier
v_mfma_f32_16x16x32_bf16 v[88:91], a[52:55], a[24:27], v[88:91]
v_mfma_f32_16x16x32_bf16 v[92:95], a[52:55], a[28:31], v[92:95]
ds_read_b64_tr_b16 a[48:49], v24 offset:0
v_mfma_f32_16x16x32_bf16 v[96:99], a[56:59], a[16:19], v[96:99]
ds_read_b64_tr_b16 a[50:51], v25 offset:0
ds_read_b64_tr_b16 a[52:53], v26 offset:0
v_mfma_f32_16x16x32_bf16 v[100:103], a[56:59], a[20:23], v[100:103]
ds_read_b64_tr_b16 a[54:55], v27 offset:0
v_mfma_f32_16x16x32_bf16 v[104:107], a[56:59], a[24:27], v[104:107]
v_mfma_f32_16x16x32_bf16 v[108:111], a[56:59], a[28:31], v[108:111]
ds_read_b64_tr_b16 a[56:57], v28 offset:0
ds_read_b64_tr_b16 a[58:59], v29 offset:0
v_mfma_f32_16x16x32_bf16 v[112:115], a[60:63], a[16:19], v[112:115]
v_mfma_f32_16x16x32_bf16 v[116:119], a[60:63], a[20:23], v[116:119]
v_mfma_f32_16x16x32_bf16 v[120:123], a[60:63], a[24:27], v[120:123]
v_mfma_f32_16x16x32_bf16 v[124:127], a[60:63], a[28:31], v[124:127]
ds_read_b64_tr_b16 a[60:61], v30 offset:0
ds_read_b64_tr_b16 a[62:63], v31 offset:0
v_mfma_f32_16x16x32_bf16 v[128:131], a[64:67], a[16:19], v[128:131]
v_mfma_f32_16x16x32_bf16 v[132:135], a[64:67], a[20:23], v[132:135]
v_mfma_f32_16x16x32_bf16 v[136:139], a[64:67], a[24:27], v[136:139]
v_mfma_f32_16x16x32_bf16 v[140:143], a[64:67], a[28:31], v[140:143]
ds_read_b64_tr_b16 a[64:65], v32 offset:0
ds_read_b64_tr_b16 a[66:67], v33 offset:0
v_mfma_f32_16x16x32_bf16 v[144:147], a[68:71], a[16:19], v[144:147]
ds_read_b128 a[16:19], v46 offset:16384
v_mfma_f32_16x16x32_bf16 v[148:151], a[68:71], a[20:23], v[148:151]
ds_read_b128 a[20:23], v46 offset:20480
v_mfma_f32_16x16x32_bf16 v[152:155], a[68:71], a[24:27], v[152:155]
ds_read_b128 a[24:27], v46 offset:24576
v_mfma_f32_16x16x32_bf16 v[156:159], a[68:71], a[28:31], v[156:159]
ds_read_b128 a[28:31], v46 offset:28672
v_mfma_f32_16x16x32_bf16 v[64:67], a[72:75], a[32:35], v[64:67]
ds_read_b64_tr_b16 a[68:69], v34 offset:0
v_mfma_f32_16x16x32_bf16 v[68:71], a[72:75], a[36:39], v[68:71]
ds_read_b64_tr_b16 a[70:71], v35 offset:0
v_mfma_f32_16x16x32_bf16 v[72:75], a[72:75], a[40:43], v[72:75]
v_mfma_f32_16x16x32_bf16 v[76:79], a[72:75], a[44:47], v[76:79]
v_mfma_f32_16x16x32_bf16 v[80:83], a[76:79], a[32:35], v[80:83]
v_mfma_f32_16x16x32_bf16 v[84:87], a[76:79], a[36:39], v[84:87]
s_waitcnt lgkmcnt(0)
s_barrier
v_mfma_f32_16x16x32_bf16 v[88:91], a[76:79], a[40:43], v[88:91]
v_mfma_f32_16x16x32_bf16 v[92:95], a[76:79], a[44:47], v[92:95]
ds_read_b64_tr_b16 a[72:73], v24 offset:24576
v_mfma_f32_16x16x32_bf16 v[96:99], a[80:83], a[32:35], v[96:99]
ds_read_b64_tr_b16 a[74:75], v25 offset:24576
ds_read_b64_tr_b16 a[76:77], v26 offset:24576
v_mfma_f32_16x16x32_bf16 v[100:103], a[80:83], a[36:39], v[100:103]
ds_read_b64_tr_b16 a[78:79], v27 offset:24576
v_add_u32 v24, 0xffff4000, v24
v_mfma_f32_16x16x32_bf16 v[104:107], a[80:83], a[40:43], v[104:107]
v_add_u32 v25, 0xffff4000, v25
v_add_u32 v26, 0xffff4000, v26
v_mfma_f32_16x16x32_bf16 v[108:111], a[80:83], a[44:47], v[108:111]
ds_read_b64_tr_b16 a[80:81], v28 offset:24576
ds_read_b64_tr_b16 a[82:83], v29 offset:24576
v_mfma_f32_16x16x32_bf16 v[112:115], a[84:87], a[32:35], v[112:115]
v_add_u32 v27, 0xffff4000, v27
v_add_u32 v28, 0xffff4000, v28
v_mfma_f32_16x16x32_bf16 v[116:119], a[84:87], a[36:39], v[116:119]
v_add_u32 v29, 0xffff4000, v29
v_mfma_f32_16x16x32_bf16 v[120:123], a[84:87], a[40:43], v[120:123]
v_mfma_f32_16x16x32_bf16 v[124:127], a[84:87], a[44:47], v[124:127]
ds_read_b64_tr_b16 a[84:85], v30 offset:24576
ds_read_b64_tr_b16 a[86:87], v31 offset:24576
v_mfma_f32_16x16x32_bf16 v[128:131], a[88:91], a[32:35], v[128:131]
v_add_u32 v30, 0xffff4000, v30
v_add_u32 v31, 0xffff4000, v31
v_mfma_f32_16x16x32_bf16 v[132:135], a[88:91], a[36:39], v[132:135]
v_mfma_f32_16x16x32_bf16 v[136:139], a[88:91], a[40:43], v[136:139]
v_mfma_f32_16x16x32_bf16 v[140:143], a[88:91], a[44:47], v[140:143]
ds_read_b64_tr_b16 a[88:89], v32 offset:24576
ds_read_b64_tr_b16 a[90:91], v33 offset:24576
v_mfma_f32_16x16x32_bf16 v[144:147], a[92:95], a[32:35], v[144:147]
ds_read_b128 a[32:35], v47 offset:16384
v_add_u32 v32, 0xffff4000, v32
v_mfma_f32_16x16x32_bf16 v[148:151], a[92:95], a[36:39], v[148:151]
ds_read_b128 a[36:39], v47 offset:20480
v_add_u32 v33, 0xffff4000, v33
v_mfma_f32_16x16x32_bf16 v[152:155], a[92:95], a[40:43], v[152:155]
ds_read_b128 a[40:43], v47 offset:24576
v_mfma_f32_16x16x32_bf16 v[156:159], a[92:95], a[44:47], v[156:159]
ds_read_b128 a[44:47], v47 offset:28672
v_mfma_f32_16x16x32_bf16 v[64:67], a[48:51], a[16:19], v[64:67]
ds_read_b64_tr_b16 a[92:93], v34 offset:24576
v_mfma_f32_16x16x32_bf16 v[68:71], a[48:51], a[20:23], v[68:71]
ds_read_b64_tr_b16 a[94:95], v35 offset:24576
v_add_u32 v34, 0xffff4000, v34
v_mfma_f32_16x16x32_bf16 v[72:75], a[48:51], a[24:27], v[72:75]
v_add_u32 v35, 0xffff4000, v35
v_mfma_f32_16x16x32_bf16 v[76:79], a[48:51], a[28:31], v[76:79]
v_mfma_f32_16x16x32_bf16 v[80:83], a[52:55], a[16:19], v[80:83]
v_mfma_f32_16x16x32_bf16 v[84:87], a[52:55], a[20:23], v[84:87]
s_waitcnt lgkmcnt(0)
s_barrier
v_mfma_f32_16x16x32_bf16 v[88:91], a[52:55], a[24:27], v[88:91]
v_mfma_f32_16x16x32_bf16 v[92:95], a[52:55], a[28:31], v[92:95]
ds_read_b64_tr_b16 a[48:49], v24 offset:0
v_mfma_f32_16x16x32_bf16 v[96:99], a[56:59], a[16:19], v[96:99]
ds_read_b64_tr_b16 a[50:51], v25 offset:0
ds_read_b64_tr_b16 a[52:53], v26 offset:0
v_mfma_f32_16x16x32_bf16 v[100:103], a[56:59], a[20:23], v[100:103]
ds_read_b64_tr_b16 a[54:55], v27 offset:0
v_mfma_f32_16x16x32_bf16 v[104:107], a[56:59], a[24:27], v[104:107]
v_mfma_f32_16x16x32_bf16 v[108:111], a[56:59], a[28:31], v[108:111]
ds_read_b64_tr_b16 a[56:57], v28 offset:0
ds_read_b64_tr_b16 a[58:59], v29 offset:0
v_mfma_f32_16x16x32_bf16 v[112:115], a[60:63], a[16:19], v[112:115]
v_mfma_f32_16x16x32_bf16 v[116:119], a[60:63], a[20:23], v[116:119]
v_mfma_f32_16x16x32_bf16 v[120:123], a[60:63], a[24:27], v[120:123]
v_mfma_f32_16x16x32_bf16 v[124:127], a[60:63], a[28:31], v[124:127]
ds_read_b64_tr_b16 a[60:61], v30 offset:0
ds_read_b64_tr_b16 a[62:63], v31 offset:0
v_mfma_f32_16x16x32_bf16 v[128:131], a[64:67], a[16:19], v[128:131]
v_mfma_f32_16x16x32_bf16 v[132:135], a[64:67], a[20:23], v[132:135]
v_mfma_f32_16x16x32_bf16 v[136:139], a[64:67], a[24:27], v[136:139]
v_mfma_f32_16x16x32_bf16 v[140:143], a[64:67], a[28:31], v[140:143]
ds_read_b64_tr_b16 a[64:65], v32 offset:0
ds_read_b64_tr_b16 a[66:67], v33 offset:0
v_mfma_f32_16x16x32_bf16 v[144:147], a[68:71], a[16:19], v[144:147]
ds_read_b128 a[16:19], v44 offset:32768
v_mfma_f32_16x16x32_bf16 v[148:151], a[68:71], a[20:23], v[148:151]
ds_read_b128 a[20:23], v44 offset:36864
v_mfma_f32_16x16x32_bf16 v[152:155], a[68:71], a[24:27], v[152:155]
ds_read_b128 a[24:27], v44 offset:40960
v_mfma_f32_16x16x32_bf16 v[156:159], a[68:71], a[28:31], v[156:159]
ds_read_b128 a[28:31], v44 offset:45056
v_mfma_f32_16x16x32_bf16 v[64:67], a[72:75], a[32:35], v[64:67]
ds_read_b64_tr_b16 a[68:69], v34 offset:0
v_mfma_f32_16x16x32_bf16 v[68:71], a[72:75], a[36:39], v[68:71]
ds_read_b64_tr_b16 a[70:71], v35 offset:0
v_mfma_f32_16x16x32_bf16 v[72:75], a[72:75], a[40:43], v[72:75]
v_mfma_f32_16x16x32_bf16 v[76:79], a[72:75], a[44:47], v[76:79]
v_mfma_f32_16x16x32_bf16 v[80:83], a[76:79], a[32:35], v[80:83]
v_mfma_f32_16x16x32_bf16 v[84:87], a[76:79], a[36:39], v[84:87]
s_waitcnt lgkmcnt(0)
s_barrier
v_mfma_f32_16x16x32_bf16 v[88:91], a[76:79], a[40:43], v[88:91]
v_mfma_f32_16x16x32_bf16 v[92:95], a[76:79], a[44:47], v[92:95]
ds_read_b64_tr_b16 a[72:73], v24 offset:24576
v_mfma_f32_16x16x32_bf16 v[96:99], a[80:83], a[32:35], v[96:99]
ds_read_b64_tr_b16 a[74:75], v25 offset:24576
ds_read_b64_tr_b16 a[76:77], v26 offset:24576
v_mfma_f32_16x16x32_bf16 v[100:103], a[80:83], a[36:39], v[100:103]
ds_read_b64_tr_b16 a[78:79], v27 offset:24576
v_add_u32 v24, 0xc000, v24
v_mfma_f32_16x16x32_bf16 v[104:107], a[80:83], a[40:43], v[104:107]
v_add_u32 v25, 0xc000, v25
v_add_u32 v26, 0xc000, v26
v_mfma_f32_16x16x32_bf16 v[108:111], a[80:83], a[44:47], v[108:111]
ds_read_b64_tr_b16 a[80:81], v28 offset:24576
ds_read_b64_tr_b16 a[82:83], v29 offset:24576
v_mfma_f32_16x16x32_bf16 v[112:115], a[84:87], a[32:35], v[112:115]
v_add_u32 v27, 0xc000, v27
v_add_u32 v28, 0xc000, v28
v_mfma_f32_16x16x32_bf16 v[116:119], a[84:87], a[36:39], v[116:119]
v_add_u32 v29, 0xc000, v29
v_mfma_f32_16x16x32_bf16 v[120:123], a[84:87], a[40:43], v[120:123]
v_mfma_f32_16x16x32_bf16 v[124:127], a[84:87], a[44:47], v[124:127]
ds_read_b64_tr_b16 a[84:85], v30 offset:24576
ds_read_b64_tr_b16 a[86:87], v31 offset:24576
v_mfma_f32_16x16x32_bf16 v[128:131], a[88:91], a[32:35], v[128:131]
v_add_u32 v30, 0xc000, v30
v_add_u32 v31, 0xc000, v31
v_mfma_f32_16x16x32_bf16 v[132:135], a[88:91], a[36:39], v[132:135]
v_mfma_f32_16x16x32_bf16 v[136:139], a[88:91], a[40:43], v[136:139]
v_mfma_f32_16x16x32_bf16 v[140:143], a[88:91], a[44:47], v[140:143]
ds_read_b64_tr_b16 a[88:89], v32 offset:24576
ds_read_b64_tr_b16 a[90:91], v33 offset:24576
v_mfma_f32_16x16x32_bf16 v[144:147], a[92:95], a[32:35], v[144:147]
ds_read_b128 a[32:35], v45 offset:32768
v_add_u32 v32, 0xc000, v32
v_mfma_f32_16x16x32_bf16 v[148:151], a[92:95], a[36:39], v[148:151]
ds_read_b128 a[36:39], v45 offset:36864
v_add_u32 v33, 0xc000, v33
v_mfma_f32_16x16x32_bf16 v[152:155], a[92:95], a[40:43], v[152:155]
ds_read_b128 a[40:43], v45 offset:40960
v_mfma_f32_16x16x32_bf16 v[156:159], a[92:95], a[44:47], v[156:159]
ds_read_b128 a[44:47], v45 offset:45056
v_mfma_f32_16x16x32_bf16 v[64:67], a[48:51], a[16:19], v[64:67]
ds_read_b64_tr_b16 a[92:93], v34 offset:24576
v_mfma_f32_16x16x32_bf16 v[68:71], a[48:51], a[20:23], v[68:71]
ds_read_b64_tr_b16 a[94:95], v35 offset:24576
v_add_u32 v34, 0xc000, v34
v_mfma_f32_16x16x32_bf16 v[72:75], a[48:51], a[24:27], v[72:75]
v_add_u32 v35, 0xc000, v35
v_mfma_f32_16x16x32_bf16 v[76:79], a[48:51], a[28:31], v[76:79]
v_mfma_f32_16x16x32_bf16 v[80:83], a[52:55], a[16:19], v[80:83]
v_mfma_f32_16x16x32_bf16 v[84:87], a[52:55], a[20:23], v[84:87]
s_waitcnt lgkmcnt(0)
s_barrier
v_mfma_f32_16x16x32_bf16 v[88:91], a[52:55], a[24:27], v[88:91]
v_mfma_f32_16x16x32_bf16 v[92:95], a[52:55], a[28:31], v[92:95]
ds_read_b64_tr_b16 a[48:49], v24 offset:0
v_mfma_f32_16x16x32_bf16 v[96:99], a[56:59], a[16:19], v[96:99]
ds_read_b64_tr_b16 a[50:51], v25 offset:0
ds_read_b64_tr_b16 a[52:53], v26 offset:0
v_mfma_f32_16x16x32_bf16 v[100:103], a[56:59], a[20:23], v[100:103]
ds_read_b64_tr_b16 a[54:55], v27 offset:0
v_mfma_f32_16x16x32_bf16 v[104:107], a[56:59], a[24:27], v[104:107]
v_mfma_f32_16x16x32_bf16 v[108:111], a[56:59], a[28:31], v[108:111]
ds_read_b64_tr_b16 a[56:57], v28 offset:0
ds_read_b64_tr_b16 a[58:59], v29 offset:0
v_mfma_f32_16x16x32_bf16 v[112:115], a[60:63], a[16:19], v[112:115]
v_mfma_f32_16x16x32_bf16 v[116:119], a[60:63], a[20:23], v[116:119]
v_mfma_f32_16x16x32_bf16 v[120:123], a[60:63], a[24:27], v[120:123]
v_mfma_f32_16x16x32_bf16 v[124:127], a[60:63], a[28:31], v[124:127]
ds_read_b64_tr_b16 a[60:61], v30 offset:0
ds_read_b64_tr_b16 a[62:63], v31 offset:0
v_mfma_f32_16x16x32_bf16 v[128:131], a[64:67], a[16:19], v[128:131]
v_mfma_f32_16x16x32_bf16 v[132:135], a[64:67], a[20:23], v[132:135]
v_mfma_f32_16x16x32_bf16 v[136:139], a[64:67], a[24:27], v[136:139]
v_mfma_f32_16x16x32_bf16 v[140:143], a[64:67], a[28:31], v[140:143]
ds_read_b64_tr_b16 a[64:65], v32 offset:0
ds_read_b64_tr_b16 a[66:67], v33 offset:0
v_mfma_f32_16x16x32_bf16 v[144:147], a[68:71], a[16:19], v[144:147]
ds_read_b128 a[16:19], v46 offset:32768
v_mfma_f32_16x16x32_bf16 v[148:151], a[68:71], a[20:23], v[148:151]
ds_read_b128 a[20:23], v46 offset:36864
v_mfma_f32_16x16x32_bf16 v[152:155], a[68:71], a[24:27], v[152:155]
ds_read_b128 a[24:27], v46 offset:40960
v_mfma_f32_16x16x32_bf16 v[156:159], a[68:71], a[28:31], v[156:159]
ds_read_b128 a[28:31], v46 offset:45056
v_mfma_f32_16x16x32_bf16 v[64:67], a[72:75], a[32:35], v[64:67]
ds_read_b64_tr_b16 a[68:69], v34 offset:0
v_mfma_f32_16x16x32_bf16 v[68:71], a[72:75], a[36:39], v[68:71]
ds_read_b64_tr_b16 a[70:71], v35 offset:0
v_mfma_f32_16x16x32_bf16 v[72:75], a[72:75], a[40:43], v[72:75]
v_mfma_f32_16x16x32_bf16 v[76:79], a[72:75], a[44:47], v[76:79]
v_mfma_f32_16x16x32_bf16 v[80:83], a[76:79], a[32:35], v[80:83]
v_mfma_f32_16x16x32_bf16 v[84:87], a[76:79], a[36:39], v[84:87]
s_waitcnt lgkmcnt(0)
s_barrier
v_mfma_f32_16x16x32_bf16 v[88:91], a[76:79], a[40:43], v[88:91]
v_mfma_f32_16x16x32_bf16 v[92:95], a[76:79], a[44:47], v[92:95]
ds_read_b64_tr_b16 a[72:73], v24 offset:24576
ds_read_b64_tr_b16 a[74:75], v25 offset:24576
ds_read_b64_tr_b16 a[76:77], v26 offset:24576
v_mfma_f32_16x16x32_bf16 v[96:99], a[80:83], a[32:35], v[96:99]
ds_read_b64_tr_b16 a[78:79], v27 offset:24576
v_mfma_f32_16x16x32_bf16 v[100:103], a[80:83], a[36:39], v[100:103]
v_mfma_f32_16x16x32_bf16 v[104:107], a[80:83], a[40:43], v[104:107]
v_mfma_f32_16x16x32_bf16 v[108:111], a[80:83], a[44:47], v[108:111]
ds_read_b64_tr_b16 a[80:81], v28 offset:24576
ds_read_b64_tr_b16 a[82:83], v29 offset:24576
v_mfma_f32_16x16x32_bf16 v[112:115], a[84:87], a[32:35], v[112:115]
v_mfma_f32_16x16x32_bf16 v[116:119], a[84:87], a[36:39], v[116:119]
v_mfma_f32_16x16x32_bf16 v[120:123], a[84:87], a[40:43], v[120:123]
v_mfma_f32_16x16x32_bf16 v[124:127], a[84:87], a[44:47], v[124:127]
ds_read_b64_tr_b16 a[84:85], v30 offset:24576
ds_read_b64_tr_b16 a[86:87], v31 offset:24576
v_mfma_f32_16x16x32_bf16 v[128:131], a[88:91], a[32:35], v[128:131]
v_mfma_f32_16x16x32_bf16 v[132:135], a[88:91], a[36:39], v[132:135]
v_mfma_f32_16x16x32_bf16 v[136:139], a[88:91], a[40:43], v[136:139]
v_mfma_f32_16x16x32_bf16 v[140:143], a[88:91], a[44:47], v[140:143]
ds_read_b64_tr_b16 a[88:89], v32 offset:24576
ds_read_b64_tr_b16 a[90:91], v33 offset:24576
v_mfma_f32_16x16x32_bf16 v[144:147], a[92:95], a[32:35], v[144:147]
ds_read_b128 a[32:35], v47 offset:32768
v_mfma_f32_16x16x32_bf16 v[148:151], a[92:95], a[36:39], v[148:151]
ds_read_b128 a[36:39], v47 offset:36864
v_mfma_f32_16x16x32_bf16 v[152:155], a[92:95], a[40:43], v[152:155]
ds_read_b128 a[40:43], v47 offset:40960
v_mfma_f32_16x16x32_bf16 v[156:159], a[92:95], a[44:47], v[156:159]
ds_read_b64_tr_b16 a[92:93], v34 offset:24576
v_mfma_f32_16x16x32_bf16 v[64:67], a[48:51], a[16:19], v[64:67]
ds_read_b64_tr_b16 a[94:95], v35 offset:24576
ds_read_b128 a[44:47], v47 offset:45056
v_mfma_f32_16x16x32_bf16 v[80:83], a[52:55], a[16:19], v[80:83]
v_mfma_f32_16x16x32_bf16 v[96:99], a[56:59], a[16:19], v[96:99]
v_mfma_f32_16x16x32_bf16 v[112:115], a[60:63], a[16:19], v[112:115]
v_mfma_f32_16x16x32_bf16 v[128:131], a[64:67], a[16:19], v[128:131]
v_mfma_f32_16x16x32_bf16 v[144:147], a[68:71], a[16:19], v[144:147]
s_waitcnt lgkmcnt(0)
s_barrier
v_mfma_f32_16x16x32_bf16 v[64:67], a[72:75], a[32:35], v[64:67]
v_mfma_f32_16x16x32_bf16 v[80:83], a[76:79], a[32:35], v[80:83]
ds_write2_b32 v63, v62, v62 offset0:0 offset1:4
v_mfma_f32_16x16x32_bf16 v[96:99], a[80:83], a[32:35], v[96:99]
s_nop 4
v_cvt_pk_bf16_f32 v16, v64, v65
v_mfma_f32_16x16x32_bf16 v[112:115], a[84:87], a[32:35], v[112:115]
v_cvt_pk_bf16_f32 v17, v66, v67
v_cvt_pk_bf16_f32 v18, v80, v81
v_mfma_f32_16x16x32_bf16 v[128:131], a[88:91], a[32:35], v[128:131]
ds_write_b64 v52, v[16:17] offset:0
v_cvt_pk_bf16_f32 v19, v82, v83
v_mfma_f32_16x16x32_bf16 v[144:147], a[92:95], a[32:35], v[144:147]
ds_write_b64 v53, v[18:19] offset:0
v_cvt_pk_bf16_f32 v36, v96, v97
v_mfma_f32_16x16x32_bf16 v[68:71], a[48:51], a[20:23], v[68:71]
v_cvt_pk_bf16_f32 v37, v98, v99
v_cvt_pk_bf16_f32 v38, v112, v113
v_mfma_f32_16x16x32_bf16 v[84:87], a[52:55], a[20:23], v[84:87]
ds_write_b64 v54, v[36:37] offset:0
v_cvt_pk_bf16_f32 v39, v114, v115
v_mfma_f32_16x16x32_bf16 v[100:103], a[56:59], a[20:23], v[100:103]
ds_write_b64 v55, v[38:39] offset:0
v_mfma_f32_16x16x32_bf16 v[116:119], a[60:63], a[20:23], v[116:119]
v_cvt_pk_bf16_f32 v58, v128, v129
v_cvt_pk_bf16_f32 v59, v130, v131
v_mfma_f32_16x16x32_bf16 v[132:135], a[64:67], a[20:23], v[132:135]
ds_write_b64 v56, v[58:59] offset:0
v_cvt_pk_bf16_f32 v60, v144, v145
v_mfma_f32_16x16x32_bf16 v[148:151], a[68:71], a[20:23], v[148:151]
v_cvt_pk_bf16_f32 v61, v146, v147
v_mfma_f32_16x16x32_bf16 v[68:71], a[72:75], a[36:39], v[68:71]
ds_write_b64 v57, v[60:61] offset:0
v_mfma_f32_16x16x32_bf16 v[84:87], a[76:79], a[36:39], v[84:87]
v_mfma_f32_16x16x32_bf16 v[100:103], a[80:83], a[36:39], v[100:103]
s_nop 4
v_cvt_pk_bf16_f32 v16, v68, v69
v_mfma_f32_16x16x32_bf16 v[116:119], a[84:87], a[36:39], v[116:119]
v_cvt_pk_bf16_f32 v17, v70, v71
v_cvt_pk_bf16_f32 v18, v84, v85
v_mfma_f32_16x16x32_bf16 v[132:135], a[88:91], a[36:39], v[132:135]
ds_write_b64 v52, v[16:17] offset:12288
v_cvt_pk_bf16_f32 v19, v86, v87
v_mfma_f32_16x16x32_bf16 v[148:151], a[92:95], a[36:39], v[148:151]
ds_write_b64 v53, v[18:19] offset:12288
v_cvt_pk_bf16_f32 v36, v100, v101
v_mfma_f32_16x16x32_bf16 v[72:75], a[48:51], a[24:27], v[72:75]
v_cvt_pk_bf16_f32 v37, v102, v103
v_cvt_pk_bf16_f32 v38, v116, v117
v_mfma_f32_16x16x32_bf16 v[88:91], a[52:55], a[24:27], v[88:91]
ds_write_b64 v54, v[36:37] offset:12288
v_cvt_pk_bf16_f32 v39, v118, v119
v_mfma_f32_16x16x32_bf16 v[104:107], a[56:59], a[24:27], v[104:107]
ds_write_b64 v55, v[38:39] offset:12288
v_mfma_f32_16x16x32_bf16 v[120:123], a[60:63], a[24:27], v[120:123]
v_cvt_pk_bf16_f32 v58, v132, v133
v_cvt_pk_bf16_f32 v59, v134, v135
v_mfma_f32_16x16x32_bf16 v[136:139], a[64:67], a[24:27], v[136:139]
ds_write_b64 v56, v[58:59] offset:12288
v_cvt_pk_bf16_f32 v60, v148, v149
v_mfma_f32_16x16x32_bf16 v[152:155], a[68:71], a[24:27], v[152:155]
v_cvt_pk_bf16_f32 v61, v150, v151
v_mfma_f32_16x16x32_bf16 v[72:75], a[72:75], a[40:43], v[72:75]
ds_write_b64 v57, v[60:61] offset:12288
v_mfma_f32_16x16x32_bf16 v[88:91], a[76:79], a[40:43], v[88:91]
v_mfma_f32_16x16x32_bf16 v[104:107], a[80:83], a[40:43], v[104:107]
s_nop 4
v_cvt_pk_bf16_f32 v16, v72, v73
v_mfma_f32_16x16x32_bf16 v[120:123], a[84:87], a[40:43], v[120:123]
v_cvt_pk_bf16_f32 v17, v74, v75
v_cvt_pk_bf16_f32 v18, v88, v89
v_mfma_f32_16x16x32_bf16 v[136:139], a[88:91], a[40:43], v[136:139]
ds_write_b64 v52, v[16:17] offset:24576
v_cvt_pk_bf16_f32 v19, v90, v91
v_mfma_f32_16x16x32_bf16 v[152:155], a[92:95], a[40:43], v[152:155]
ds_write_b64 v53, v[18:19] offset:24576
v_cvt_pk_bf16_f32 v36, v104, v105
v_mfma_f32_16x16x32_bf16 v[76:79], a[48:51], a[28:31], v[76:79]
v_cvt_pk_bf16_f32 v37, v106, v107
v_cvt_pk_bf16_f32 v38, v120, v121
v_mfma_f32_16x16x32_bf16 v[92:95], a[52:55], a[28:31], v[92:95]
ds_write_b64 v54, v[36:37] offset:24576
v_cvt_pk_bf16_f32 v39, v122, v123
v_mfma_f32_16x16x32_bf16 v[108:111], a[56:59], a[28:31], v[108:111]
ds_write_b64 v55, v[38:39] offset:24576
v_mfma_f32_16x16x32_bf16 v[124:127], a[60:63], a[28:31], v[124:127]
v_cvt_pk_bf16_f32 v58, v136, v137
v_cvt_pk_bf16_f32 v59, v138, v139
v_mfma_f32_16x16x32_bf16 v[140:143], a[64:67], a[28:31], v[140:143]
ds_write_b64 v56, v[58:59] offset:24576
v_cvt_pk_bf16_f32 v60, v152, v153
v_mfma_f32_16x16x32_bf16 v[156:159], a[68:71], a[28:31], v[156:159]
v_cvt_pk_bf16_f32 v61, v154, v155
v_mfma_f32_16x16x32_bf16 v[76:79], a[72:75], a[44:47], v[76:79]
ds_write_b64 v57, v[60:61] offset:24576
v_mfma_f32_16x16x32_bf16 v[92:95], a[76:79], a[44:47], v[92:95]
v_mfma_f32_16x16x32_bf16 v[108:111], a[80:83], a[44:47], v[108:111]
s_nop 4
v_cvt_pk_bf16_f32 v16, v76, v77
v_mfma_f32_16x16x32_bf16 v[124:127], a[84:87], a[44:47], v[124:127]
v_cvt_pk_bf16_f32 v17, v78, v79
v_cvt_pk_bf16_f32 v18, v92, v93
v_mfma_f32_16x16x32_bf16 v[140:143], a[88:91], a[44:47], v[140:143]
ds_write_b64 v52, v[16:17] offset:36864
v_cvt_pk_bf16_f32 v19, v94, v95
v_mfma_f32_16x16x32_bf16 v[156:159], a[92:95], a[44:47], v[156:159]
ds_write_b64 v53, v[18:19] offset:36864
v_cvt_pk_bf16_f32 v36, v108, v109
v_cvt_pk_bf16_f32 v37, v110, v111
v_cvt_pk_bf16_f32 v38, v124, v125
v_cvt_pk_bf16_f32 v39, v126, v127
v_cvt_pk_bf16_f32 v58, v140, v141
v_cvt_pk_bf16_f32 v59, v142, v143
ds_write_b64 v54, v[36:37] offset:36864
v_cvt_pk_bf16_f32 v60, v156, v157
v_cvt_pk_bf16_f32 v61, v158, v159
ds_write_b64 v55, v[38:39] offset:36864
ds_write_b64 v56, v[58:59] offset:36864
ds_write_b64 v57, v[60:61] offset:36864
s_waitcnt lgkmcnt(0)
s_barrier
ds_read_b128 v[40:43], v14 offset:0
ds_read_b128 v[44:47], v14 offset:256
ds_read_b128 v[52:55], v14 offset:12288
ds_read_b128 v[48:51], v14 offset:512
ds_read_b128 v[56:59], v14 offset:12544
s_waitcnt lgkmcnt(4)
v_mfma_f32_16x16x32_bf16 v[24:27], v[40:43], v[40:43], 0
ds_read_b128 v[60:63], v14 offset:12800
v_add_u32 v14, 0xc000, v14
v_mfma_f32_16x16x32_bf16 v[32:35], v[40:43], a[0:3], 0
s_waitcnt lgkmcnt(1)
ds_read_b128 a[4:7], v14 offset:0
v_mfma_f32_16x16x32_bf16 v[24:27], v[44:47], v[44:47], v[24:27]
v_add_u32 v40, s56, v40
v_add_u32 v41, s56, v41
v_mfma_f32_16x16x32_bf16 v[28:31], v[52:55], v[52:55], 0
ds_read_b128 a[8:11], v14 offset:12288
v_add_u32 v42, s56, v42
v_mfma_f32_16x16x32_bf16 v[36:39], v[52:55], a[0:3], 0
ds_read_b128 a[12:15], v14 offset:256
v_add_u32 v52, s56, v52
v_mfma_f32_16x16x32_bf16 v[32:35], v[44:47], a[0:3], v[32:35]
ds_read_b128 a[16:19], v14 offset:12544
v_add_u32 v53, s56, v53
v_mfma_f32_16x16x32_bf16 v[24:27], v[48:51], v[48:51], v[24:27]
ds_read_b128 a[20:23], v14 offset:512
v_add_u32 v54, s56, v54
v_mfma_f32_16x16x32_bf16 v[32:35], v[48:51], a[0:3], v[32:35]
ds_read_b128 a[24:27], v14 offset:12800
v_add_u32 v43, s56, v43
v_mfma_f32_16x16x32_bf16 v[28:31], v[56:59], v[56:59], v[28:31]
v_add_u32 v44, s56, v44
s_nop 0
v_cndmask_b32 v16, v24, v25, s[32:33]
v_mfma_f32_16x16x32_bf16 v[36:39], v[56:59], a[0:3], v[36:39]
s_waitcnt lgkmcnt(5)
v_cndmask_b32 v16, v16, v26, s[34:35]
v_cndmask_b32 v16, v16, v27, s[36:37]
v_mfma_f32_16x16x32_bf16 v[28:31], v[60:63], v[60:63], v[28:31]
v_cndmask_b32 v17, v32, v33, s[32:33]
v_cndmask_b32 v17, v17, v34, s[34:35]
v_mfma_f32_16x16x32_bf16 v[36:39], v[60:63], a[0:3], v[36:39]
v_cndmask_b32 v17, v17, v35, s[36:37]
v_add_u32 v45, s56, v45
v_add_u32 v46, s56, v46
v_add_u32 v47, s56, v47
v_add_u32 v48, s56, v48
v_cndmask_b32 v18, v28, v29, s[32:33]
v_cndmask_b32 v18, v18, v30, s[34:35]
v_cndmask_b32 v18, v18, v31, s[36:37]
v_add_u32 v49, s56, v49
v_cndmask_b32 v19, v36, v37, s[32:33]
v_cndmask_b32 v19, v19, v38, s[34:35]
v_cndmask_b32 v19, v19, v39, s[36:37]
v_add_u32 v50, s56, v50
v_add_u32 v55, s56, v55
v_add_u32 v51, s56, v51
v_mfma_f32_16x16x32_bf16 v[24:27], a[4:7], a[4:7], 0
ds_write_b128 v21, v[16:19] offset:10752
v_add_u32 v56, s56, v56
v_mfma_f32_16x16x32_bf16 v[32:35], a[4:7], a[0:3], 0
v_add_u32 v57, s56, v57
v_add_u32 v58, s56, v58
v_mfma_f32_16x16x32_bf16 v[24:27], a[4:7], v[40:43], v[24:27]
s_waitcnt lgkmcnt(1)
v_add_u32 v59, s56, v59
v_add_u32 v60, s56, v60
v_mfma_f32_16x16x32_bf16 v[28:31], a[8:11], a[8:11], 0
v_add_u32 v61, s56, v61
v_add_u32 v62, s56, v62
v_mfma_f32_16x16x32_bf16 v[36:39], a[8:11], a[0:3], 0
v_add_u32 v63, s56, v63
v_mfma_f32_16x16x32_bf16 v[28:31], a[8:11], v[40:43], v[28:31]
v_mfma_f32_16x16x32_bf16 v[24:27], a[12:15], a[12:15], v[24:27]
v_mfma_f32_16x16x32_bf16 v[32:35], a[12:15], a[0:3], v[32:35]
v_mfma_f32_16x16x32_bf16 v[24:27], a[12:15], v[44:47], v[24:27]
v_mfma_f32_16x16x32_bf16 v[28:31], a[16:19], a[16:19], v[28:31]
v_mfma_f32_16x16x32_bf16 v[36:39], a[16:19], a[0:3], v[36:39]
v_mfma_f32_16x16x32_bf16 v[28:31], a[16:19], v[44:47], v[28:31]
v_mfma_f32_16x16x32_bf16 v[24:27], a[20:23], a[20:23], v[24:27]
v_mfma_f32_16x16x32_bf16 v[32:35], a[20:23], a[0:3], v[32:35]
v_mfma_f32_16x16x32_bf16 v[24:27], a[20:23], v[48:51], v[24:27]
v_mfma_f32_16x16x32_bf16 v[28:31], a[24:27], a[24:27], v[28:31]
s_nop 5
v_cndmask_b32 v17, v32, v33, s[32:33]
v_mfma_f32_16x16x32_bf16 v[36:39], a[24:27], a[0:3], v[36:39]
v_cndmask_b32 v17, v17, v34, s[34:35]
v_cndmask_b32 v16, v24, v25, s[32:33]
v_mfma_f32_16x16x32_bf16 v[28:31], a[24:27], v[48:51], v[28:31]
v_cndmask_b32 v16, v16, v26, s[34:35]
v_cndmask_b32 v16, v16, v27, s[36:37]
v_cndmask_b32 v17, v17, v35, s[36:37]
s_nop 1
v_cndmask_b32 v19, v36, v37, s[32:33]
v_cndmask_b32 v19, v19, v38, s[34:35]
v_cndmask_b32 v19, v19, v39, s[36:37]
v_cndmask_b32 v18, v28, v29, s[32:33]
v_cndmask_b32 v18, v18, v30, s[34:35]
v_cndmask_b32 v18, v18, v31, s[36:37]
ds_write_b128 v21, v[16:19] offset:0
s_waitcnt lgkmcnt(0)
s_barrier
ds_read_b128 a[28:31], v14 offset:24576
buffer_load_dwordx4 v2, s[12:15], s49 offen offset:0 nt lds
ds_read_b128 a[8:11], v14 offset:24832
ds_read_b128 a[16:19], v14 offset:25088
ds_read_b128 a[4:7], v14 offset:36864
ds_read_b128 a[12:15], v14 offset:37120
buffer_load_dwordx4 v3, s[12:15], s49 offen offset:1024 nt lds
s_waitcnt lgkmcnt(4)
v_mfma_f32_16x16x32_bf16 v[24:27], a[28:31], a[28:31], 0
ds_read_b128 a[20:23], v14 offset:37376
v_add_u32 v14, 0xffff4000, v14
v_mfma_f32_16x16x32_bf16 v[24:27], a[28:31], v[40:43], v[24:27]
s_waitcnt lgkmcnt(1)
ds_read_b128 a[24:27], v14 offset:24576
v_mfma_f32_16x16x32_bf16 v[24:27], a[8:11], a[8:11], v[24:27]
ds_read_b64_tr_b16 a[48:49], v8 offset:0
v_mfma_f32_16x16x32_bf16 v[24:27], a[8:11], v[44:47], v[24:27]
ds_read_b64_tr_b16 a[50:51], v8 offset:12288
buffer_load_dwordx4 v4, s[12:15], s49 offen offset:2048 nt lds
ds_read_b64_tr_b16 a[52:53], v9 offset:0
v_mfma_f32_16x16x32_bf16 v[24:27], a[16:19], a[16:19], v[24:27]
ds_read_b64_tr_b16 a[54:55], v9 offset:12288
v_mfma_f32_16x16x32_bf16 v[32:35], a[28:31], a[0:3], 0
ds_read_b128 a[28:31], v14 offset:24832
v_mfma_f32_16x16x32_bf16 v[24:27], a[16:19], v[48:51], v[24:27]
ds_read_b64_tr_b16 a[56:57], v10 offset:0
ds_read_b64_tr_b16 a[58:59], v10 offset:12288
v_mfma_f32_16x16x32_bf16 v[32:35], a[8:11], a[0:3], v[32:35]
ds_read_b128 a[8:11], v14 offset:36864
buffer_load_dwordx4 v5, s[12:15], s49 offen offset:3072 nt lds
v_mfma_f32_16x16x32_bf16 v[32:35], a[16:19], a[0:3], v[32:35]
s_add_u32 m0, s24, 126976
ds_read_b128 a[16:19], v14 offset:37376
v_cndmask_b32 v16, v24, v25, s[32:33]
v_mfma_f32_16x16x32_bf16 v[28:31], a[4:7], a[4:7], 0
s_waitcnt lgkmcnt(7)
s_add_u32 s52, s43, 65536
ds_read_b64_tr_b16 a[60:61], v11 offset:0
v_cndmask_b32 v16, v16, v26, s[34:35]
v_cndmask_b32 v16, v16, v27, s[36:37]
v_mfma_f32_16x16x32_bf16 v[24:27], a[24:27], a[24:27], 0
ds_read_b64_tr_b16 a[62:63], v11 offset:12288
ds_read_b64_tr_b16 a[64:65], v12 offset:0
ds_read_b64_tr_b16 a[66:67], v12 offset:12288
buffer_load_dwordx4 v6, s[12:15], s49 offen offset:0 nt lds
ds_read_b64_tr_b16 a[68:69], v13 offset:0
v_mfma_f32_16x16x32_bf16 v[36:39], a[4:7], a[0:3], 0
ds_read_b64_tr_b16 a[70:71], v13 offset:12288
v_cndmask_b32 v17, v32, v33, s[32:33]
v_mfma_f32_16x16x32_bf16 v[28:31], a[4:7], v[40:43], v[28:31]
ds_read_b128 a[4:7], v14 offset:25088
v_cndmask_b32 v17, v17, v34, s[34:35]
v_cndmask_b32 v17, v17, v35, s[36:37]
v_mfma_f32_16x16x32_bf16 v[32:35], a[24:27], a[0:3], 0
s_waitcnt lgkmcnt(7)
ds_read_b64_tr_b16 a[72:73], v8 offset:24576
ds_read_b64_tr_b16 a[74:75], v8 offset:36864
buffer_load_dwordx4 v7, s[12:15], s49 offen offset:1024 nt lds
ds_read_b64_tr_b16 a[76:77], v9 offset:24576
ds_read_b64_tr_b16 a[78:79], v9 offset:36864
v_mfma_f32_16x16x32_bf16 v[24:27], a[28:31], a[28:31], v[24:27]
s_add_u32 s49, s26, 49152
ds_read_b64_tr_b16 a[80:81], v10 offset:24576
s_add_u32 m0, s24, 0
ds_read_b64_tr_b16 a[82:83], v10 offset:36864
v_mfma_f32_16x16x32_bf16 v[28:31], a[12:15], a[12:15], v[28:31]
ds_read_b64_tr_b16 a[84:85], v11 offset:24576
v_add_u32 v8, 0xc000, v8
v_mfma_f32_16x16x32_bf16 v[32:35], a[28:31], a[0:3], v[32:35]
ds_read_b64_tr_b16 a[86:87], v11 offset:36864
buffer_load_dword v23, v23, s[28:31], s52 offen
ds_read_b64_tr_b16 a[88:89], v12 offset:24576
ds_read_b64_tr_b16 a[90:91], v12 offset:36864
v_mfma_f32_16x16x32_bf16 v[28:31], a[12:15], v[44:47], v[28:31]
ds_read_b64_tr_b16 a[92:93], v13 offset:24576
ds_read_b64_tr_b16 a[94:95], v13 offset:36864
v_mfma_f32_16x16x32_bf16 v[28:31], a[20:23], a[20:23], v[28:31]
s_waitcnt lgkmcnt(10)
v_add_u32 v9, 0xc000, v9
v_add_u32 v10, 0xc000, v10
v_mfma_f32_16x16x32_bf16 v[24:27], a[4:7], a[4:7], v[24:27]
v_add_u32 v11, 0xc000, v11
v_add_u32 v12, 0xc000, v12
v_mfma_f32_16x16x32_bf16 v[28:31], a[20:23], v[48:51], v[28:31]
v_add_u32 v13, 0xc000, v13
s_waitcnt vmcnt(0)
v_min_u32 v23, 35, v0
v_mfma_f32_16x16x32_bf16 v[36:39], a[12:15], a[0:3], v[36:39]
ds_read_b128 a[12:15], v14 offset:37120
v_add_u32 v14, 0x18000, v14
v_mfma_f32_16x16x32_bf16 v[32:35], a[4:7], a[0:3], v[32:35]
v_lshl_add_u32 v23, v23, 7, s43
v_cndmask_b32 v18, v28, v29, s[32:33]
v_mfma_f32_16x16x32_bf16 v[36:39], a[20:23], a[0:3], v[36:39]
v_cndmask_b32 v18, v18, v30, s[34:35]
v_cndmask_b32 v18, v18, v31, s[36:37]
v_mfma_f32_16x16x32_bf16 v[28:31], a[8:11], a[8:11], 0
s_nop 4
v_cndmask_b32 v19, v36, v37, s[32:33]
v_cndmask_b32 v19, v19, v38, s[34:35]
v_cndmask_b32 v19, v19, v39, s[36:37]
v_mfma_f32_16x16x32_bf16 v[36:39], a[8:11], a[0:3], 0
ds_write_b128 v21, v[16:19] offset:1280
v_cndmask_b32 v16, v24, v25, s[32:33]
s_waitcnt lgkmcnt(1)
v_mfma_f32_16x16x32_bf16 v[28:31], a[12:15], a[12:15], v[28:31]
v_cndmask_b32 v16, v16, v26, s[34:35]
v_cndmask_b32 v16, v16, v27, s[36:37]
v_mfma_f32_16x16x32_bf16 v[36:39], a[12:15], a[0:3], v[36:39]
v_cndmask_b32 v17, v32, v33, s[32:33]
v_cndmask_b32 v17, v17, v34, s[34:35]
v_mfma_f32_16x16x32_bf16 v[28:31], a[16:19], a[16:19], v[28:31]
v_cndmask_b32 v17, v17, v35, s[36:37]
v_mfma_f32_16x16x32_bf16 v[36:39], a[16:19], a[0:3], v[36:39]
s_nop 5
v_cndmask_b32 v18, v28, v29, s[32:33]
v_cndmask_b32 v18, v18, v30, s[34:35]
v_cndmask_b32 v18, v18, v31, s[36:37]
v_cndmask_b32 v19, v36, v37, s[32:33]
v_cndmask_b32 v19, v19, v38, s[34:35]
v_cndmask_b32 v19, v19, v39, s[36:37]
ds_write_b128 v21, v[16:19] offset:12032
s_waitcnt lgkmcnt(0)
s_barrier
ds_read_b128 a[20:23], v14 offset:0
buffer_load_dwordx4 v2, s[12:15], s49 offen offset:0 nt lds
ds_read_b128 a[24:27], v14 offset:12288
ds_read_b128 a[32:35], v20 offset:0
ds_read_b128 a[36:39], v20 offset:1024
ds_read_b128 a[28:31], v14 offset:256
buffer_load_dwordx4 v3, s[12:15], s49 offen offset:1024 nt lds
s_waitcnt lgkmcnt(4)
v_mfma_f32_16x16x32_bf16 v[24:27], a[20:23], a[20:23], 0
ds_read_b128 a[40:43], v20 offset:2048
v_mfma_f32_16x16x32_bf16 v[32:35], a[20:23], a[0:3], 0
ds_read_b128 a[44:47], v20 offset:3072
v_mfma_f32_16x16x32_bf16 v[24:27], a[20:23], v[52:55], v[24:27]
s_waitcnt lgkmcnt(2)
ds_read_b128 a[4:7], v14 offset:12544
v_mfma_f32_16x16x32_bf16 v[28:31], a[24:27], a[24:27], 0
buffer_load_dwordx4 v4, s[12:15], s49 offen offset:2048 nt lds
ds_read_b64_tr_b16 a[16:17], v8 offset:0
v_mfma_f32_16x16x32_bf16 v[36:39], a[24:27], a[0:3], 0
ds_read_b64_tr_b16 a[18:19], v8 offset:12288
ds_read_b128 a[8:11], v14 offset:512
v_mfma_f32_16x16x32_bf16 v[28:31], a[24:27], v[52:55], v[28:31]
ds_read_b128 a[12:15], v14 offset:12800
v_mfma_f32_16x16x32_bf16 v[24:27], a[28:31], a[28:31], v[24:27]
v_add_u32 v14, 0xfffe8000, v14
v_mfma_f32_16x16x32_bf16 v[32:35], a[28:31], a[0:3], v[32:35]
ds_read_b64_tr_b16 a[20:21], v9 offset:0
ds_read_b64_tr_b16 a[22:23], v9 offset:12288
ds_read_b64_tr_b16 a[24:25], v10 offset:0
buffer_load_dwordx4 v5, s[12:15], s49 offen offset:3072 nt lds
ds_read_b64_tr_b16 a[26:27], v10 offset:12288
v_mfma_f32_16x16x32_bf16 v[24:27], a[28:31], v[56:59], v[24:27]
s_waitcnt lgkmcnt(8)
s_add_u32 m0, s24, 4096
ds_read_b64_tr_b16 a[28:29], v11 offset:0
v_mfma_f32_16x16x32_bf16 v[28:31], a[4:7], a[4:7], v[28:31]
ds_read_b64_tr_b16 a[30:31], v11 offset:12288
ds_read_b128 v[40:43], v14 offset:24576
v_mfma_f32_16x16x32_bf16 v[36:39], a[4:7], a[0:3], v[36:39]
ds_read_b128 v[44:47], v14 offset:24832
v_mfma_f32_16x16x32_bf16 v[28:31], a[4:7], v[56:59], v[28:31]
s_waitcnt lgkmcnt(8)
buffer_load_dwordx4 v6, s[12:15], s49 offen offset:0 nt lds
ds_read_b64_tr_b16 a[4:5], v12 offset:0
v_mfma_f32_16x16x32_bf16 v[64:67], a[16:19], a[32:35], 0
ds_read_b64_tr_b16 a[6:7], v12 offset:12288
v_mfma_f32_16x16x32_bf16 v[68:71], a[16:19], a[36:39], 0
ds_read_b128 v[48:51], v14 offset:25088
v_add_u32 v14, 0x18000, v14
v_mfma_f32_16x16x32_bf16 v[24:27], a[8:11], a[8:11], v[24:27]
s_waitcnt lgkmcnt(4)
v_add_u32 v40, s56, v40
v_mfma_f32_16x16x32_bf16 v[72:75], a[16:19], a[40:43], 0
buffer_load_dwordx4 v7, s[12:15], s49 offen offset:1024 nt lds
v_add_u32 v41, s56, v41
v_mfma_f32_16x16x32_bf16 v[32:35], a[8:11], a[0:3], v[32:35]
s_add_u32 s49, s26, 245760
v_add_u32 v42, s56, v42
v_add_u32 v43, s56, v43
v_mfma_f32_16x16x32_bf16 v[76:79], a[16:19], a[44:47], 0
s_waitcnt lgkmcnt(1)
s_add_u32 m0, s24, 49152
v_add_u32 v44, s56, v44
v_add_u32 v45, s56, v45
v_mfma_f32_16x16x32_bf16 v[24:27], a[8:11], v[60:63], v[24:27]
ds_read_b64_tr_b16 a[8:9], v13 offset:0
ds_read_b64_tr_b16 a[10:11], v13 offset:12288
v_mfma_f32_16x16x32_bf16 v[28:31], a[12:15], a[12:15], v[28:31]
v_cndmask_b32 v17, v32, v33, s[32:33]
v_cndmask_b32 v17, v17, v34, s[34:35]
v_mfma_f32_16x16x32_bf16 v[80:83], a[20:23], a[32:35], 0
v_cndmask_b32 v17, v17, v35, s[36:37]
s_nop 0
v_cndmask_b32 v16, v24, v25, s[32:33]
v_mfma_f32_16x16x32_bf16 v[36:39], a[12:15], a[0:3], v[36:39]
v_cndmask_b32 v16, v16, v26, s[34:35]
v_cndmask_b32 v16, v16, v27, s[36:37]
v_mfma_f32_16x16x32_bf16 v[28:31], a[12:15], v[60:63], v[28:31]
v_add_u32 v46, s56, v46
v_add_u32 v47, s56, v47
v_mfma_f32_16x16x32_bf16 v[84:87], a[20:23], a[36:39], 0
s_waitcnt lgkmcnt(2)
v_add_u32 v48, s56, v48
v_cndmask_b32 v19, v36, v37, s[32:33]
v_mfma_f32_16x16x32_bf16 v[88:91], a[20:23], a[40:43], 0
v_cndmask_b32 v19, v19, v38, s[34:35]
v_cndmask_b32 v18, v28, v29, s[32:33]
v_mfma_f32_16x16x32_bf16 v[92:95], a[20:23], a[44:47], 0
v_cndmask_b32 v18, v18, v30, s[34:35]
v_cndmask_b32 v18, v18, v31, s[36:37]
v_mfma_f32_16x16x32_bf16 v[96:99], a[24:27], a[32:35], 0
v_cndmask_b32 v19, v19, v39, s[36:37]
v_add_u32 v49, s56, v49
v_mfma_f32_16x16x32_bf16 v[100:103], a[24:27], a[36:39], 0
ds_write_b128 v21, v[16:19] offset:0
v_add_u32 v50, s56, v50
v_mfma_f32_16x16x32_bf16 v[104:107], a[24:27], a[40:43], 0
v_add_u32 v51, s56, v51
v_mfma_f32_16x16x32_bf16 v[108:111], a[24:27], a[44:47], 0
v_mfma_f32_16x16x32_bf16 v[112:115], a[28:31], a[32:35], 0
v_mfma_f32_16x16x32_bf16 v[116:119], a[28:31], a[36:39], 0
v_mfma_f32_16x16x32_bf16 v[120:123], a[28:31], a[40:43], 0
v_mfma_f32_16x16x32_bf16 v[124:127], a[28:31], a[44:47], 0
s_waitcnt lgkmcnt(0)
s_barrier
ds_read_b128 v[16:19], v22 offset:16
buffer_load_dwordx4 v2, s[12:15], s49 offen offset:0 nt lds
ds_read_b128 a[12:15], v14 offset:24576
v_mfma_f32_16x16x32_bf16 v[128:131], a[4:7], a[32:35], 0
ds_read_b128 a[16:19], v14 offset:36864
v_mfma_f32_16x16x32_bf16 v[132:135], a[4:7], a[36:39], 0
ds_read_b128 a[20:23], v14 offset:24832
v_mfma_f32_16x16x32_bf16 v[136:139], a[4:7], a[40:43], 0
ds_read_b128 a[24:27], v14 offset:37120
buffer_load_dwordx4 v3, s[12:15], s49 offen offset:1024 nt lds
s_waitcnt lgkmcnt(4)
v_max3_u32 v15, v16, v17, v18
v_mfma_f32_16x16x32_bf16 v[140:143], a[4:7], a[44:47], 0
s_waitcnt lgkmcnt(3)
ds_read_b128 a[28:31], v14 offset:25088
v_max_u32 v15, v15, v19
v_mfma_f32_16x16x32_bf16 v[24:27], a[12:15], a[12:15], 0
ds_read_b128 a[4:7], v14 offset:37376
v_cmp_eq_u32 vcc, 2, v15
v_mfma_f32_16x16x32_bf16 v[144:147], a[8:11], a[32:35], 0
ds_read_b128 a[32:35], v20 offset:4096
v_add_u32 v14, 0xfffe8000, v14
v_mfma_f32_16x16x32_bf16 v[32:35], a[12:15], a[0:3], 0
buffer_load_dwordx4 v4, s[12:15], s49 offen offset:2048 nt lds
v_mfma_f32_16x16x32_bf16 v[148:151], a[8:11], a[36:39], 0
ds_read_b128 a[36:39], v20 offset:5120
v_mfma_f32_16x16x32_bf16 v[152:155], a[8:11], a[40:43], 0
ds_read_b128 a[40:43], v20 offset:6144
v_mfma_f32_16x16x32_bf16 v[156:159], a[8:11], a[44:47], 0
ds_read_b128 a[44:47], v20 offset:7168
v_mfma_f32_16x16x32_bf16 v[24:27], a[12:15], v[52:55], v[24:27]
s_waitcnt lgkmcnt(5)
ds_read_b64_tr_b16 a[8:9], v8 offset:24576
ds_read_b64_tr_b16 a[10:11], v8 offset:36864
buffer_load_dwordx4 v5, s[12:15], s49 offen offset:3072 nt lds
ds_read_b64_tr_b16 a[12:13], v9 offset:24576
v_mfma_f32_16x16x32_bf16 v[28:31], a[16:19], a[16:19], 0
s_cbranch_vccnz RESC1a
C_R1a:
ds_read_b64_tr_b16 a[14:15], v9 offset:36864
v_mfma_f32_16x16x32_bf16 v[36:39], a[16:19], a[0:3], 0
s_add_u32 m0, s24, 53248
v_add_u32 v8, 0xc000, v8
v_add_u32 v9, 0xc000, v9
v_mfma_f32_16x16x32_bf16 v[28:31], a[16:19], v[52:55], v[28:31]
ds_read_b64_tr_b16 a[16:17], v10 offset:24576
ds_read_b64_tr_b16 a[18:19], v10 offset:36864
v_mfma_f32_16x16x32_bf16 v[24:27], a[20:23], a[20:23], v[24:27]
buffer_load_dwordx4 v6, s[12:15], s49 offen offset:0 nt lds
v_add_u32 v10, 0xc000, v10
v_mfma_f32_16x16x32_bf16 v[32:35], a[20:23], a[0:3], v[32:35]
v_mfma_f32_16x16x32_bf16 v[24:27], a[20:23], v[56:59], v[24:27]
ds_read_b64_tr_b16 a[20:21], v11 offset:24576
ds_read_b64_tr_b16 a[22:23], v11 offset:36864
v_mfma_f32_16x16x32_bf16 v[28:31], a[24:27], a[24:27], v[28:31]
s_waitcnt lgkmcnt(5)
v_add_u32 v11, 0xc000, v11
v_mfma_f32_16x16x32_bf16 v[64:67], a[8:11], a[32:35], v[64:67]
buffer_load_dwordx4 v7, s[12:15], s49 offen offset:1024 nt lds
s_add_u32 s49, s26, 73728
v_mfma_f32_16x16x32_bf16 v[36:39], a[24:27], a[0:3], v[36:39]
s_add_u32 m0, s24, 73728
v_mfma_f32_16x16x32_bf16 v[28:31], a[24:27], v[56:59], v[28:31]
ds_read_b64_tr_b16 a[24:25], v12 offset:24576
ds_read_b64_tr_b16 a[26:27], v12 offset:36864
v_mfma_f32_16x16x32_bf16 v[68:71], a[8:11], a[36:39], v[68:71]
v_add_u32 v12, 0xc000, v12
v_mfma_f32_16x16x32_bf16 v[24:27], a[28:31], a[28:31], v[24:27]
v_mfma_f32_16x16x32_bf16 v[72:75], a[8:11], a[40:43], v[72:75]
v_mfma_f32_16x16x32_bf16 v[32:35], a[28:31], a[0:3], v[32:35]
v_mfma_f32_16x16x32_bf16 v[24:27], a[28:31], v[60:63], v[24:27]
ds_read_b64_tr_b16 a[28:29], v13 offset:24576
ds_read_b64_tr_b16 a[30:31], v13 offset:36864
v_mfma_f32_16x16x32_bf16 v[76:79], a[8:11], a[44:47], v[76:79]
v_add_u32 v13, 0xc000, v13
s_nop 2
v_cndmask_b32 v17, v32, v33, s[32:33]
v_mfma_f32_16x16x32_bf16 v[28:31], a[4:7], a[4:7], v[28:31]
v_cndmask_b32 v17, v17, v34, s[34:35]
v_cndmask_b32 v16, v24, v25, s[32:33]
v_mfma_f32_16x16x32_bf16 v[36:39], a[4:7], a[0:3], v[36:39]
v_cndmask_b32 v16, v16, v26, s[34:35]
v_cndmask_b32 v16, v16, v27, s[36:37]
v_mfma_f32_16x16x32_bf16 v[28:31], a[4:7], v[60:63], v[28:31]
s_waitcnt lgkmcnt(2)
v_cndmask_b32 v17, v17, v35, s[36:37]
v_mfma_f32_16x16x32_bf16 v[80:83], a[12:15], a[32:35], v[80:83]
s_nop 1
v_cndmask_b32 v19, v36, v37, s[32:33]
v_mfma_f32_16x16x32_bf16 v[84:87], a[12:15], a[36:39], v[84:87]
v_cndmask_b32 v19, v19, v38, s[34:35]
v_cndmask_b32 v18, v28, v29, s[32:33]
v_mfma_f32_16x16x32_bf16 v[88:91], a[12:15], a[40:43], v[88:91]
v_cndmask_b32 v18, v18, v30, s[34:35]
v_cndmask_b32 v18, v18, v31, s[36:37]
v_mfma_f32_16x16x32_bf16 v[92:95], a[12:15], a[44:47], v[92:95]
v_cndmask_b32 v19, v19, v39, s[36:37]
v_mfma_f32_16x16x32_bf16 v[96:99], a[16:19], a[32:35], v[96:99]
ds_write_b128 v21, v[16:19] offset:1280
v_mfma_f32_16x16x32_bf16 v[100:103], a[16:19], a[36:39], v[100:103]
v_mfma_f32_16x16x32_bf16 v[104:107], a[16:19], a[40:43], v[104:107]
v_mfma_f32_16x16x32_bf16 v[108:111], a[16:19], a[44:47], v[108:111]
v_mfma_f32_16x16x32_bf16 v[112:115], a[20:23], a[32:35], v[112:115]
v_mfma_f32_16x16x32_bf16 v[116:119], a[20:23], a[36:39], v[116:119]
v_mfma_f32_16x16x32_bf16 v[120:123], a[20:23], a[40:43], v[120:123]
v_mfma_f32_16x16x32_bf16 v[124:127], a[20:23], a[44:47], v[124:127]
s_waitcnt vmcnt(6) lgkmcnt(0)
s_barrier
ds_read_b128 v[16:19], v22 offset:0
buffer_load_dwordx4 v2, s[12:15], s49 offen offset:0 nt lds
ds_read_b128 a[4:7], v14 offset:0
v_mfma_f32_16x16x32_bf16 v[128:131], a[24:27], a[32:35], v[128:131]
ds_read_b128 a[8:11], v14 offset:12288
v_mfma_f32_16x16x32_bf16 v[132:135], a[24:27], a[36:39], v[132:135]
ds_read_b128 a[12:15], v14 offset:256
v_mfma_f32_16x16x32_bf16 v[136:139], a[24:27], a[40:43], v[136:139]
ds_read_b128 a[16:19], v14 offset:12544
buffer_load_dwordx4 v3, s[12:15], s49 offen offset:1024 nt lds
s_waitcnt lgkmcnt(4)
v_max3_u32 v15, v16, v17, v18
v_mfma_f32_16x16x32_bf16 v[140:143], a[24:27], a[44:47], v[140:143]
s_waitcnt lgkmcnt(3)
ds_read_b128 a[20:23], v14 offset:512
v_max_u32 v15, v15, v19
v_mfma_f32_16x16x32_bf16 v[24:27], a[4:7], a[4:7], 0
ds_read_b128 a[24:27], v14 offset:12800
v_cmp_eq_u32 vcc, 3, v15
v_mfma_f32_16x16x32_bf16 v[144:147], a[28:31], a[32:35], v[144:147]
ds_read_b128 a[32:35], v20 offset:0
v_mfma_f32_16x16x32_bf16 v[32:35], a[4:7], a[0:3], 0
buffer_load_dwordx4 v4, s[12:15], s49 offen offset:2048 nt lds
ds_read_b128 v[52:55], v14 offset:36864
v_mfma_f32_16x16x32_bf16 v[148:151], a[28:31], a[36:39], v[148:151]
ds_read_b128 a[36:39], v20 offset:1024
v_mfma_f32_16x16x32_bf16 v[152:155], a[28:31], a[40:43], v[152:155]
ds_read_b128 a[40:43], v20 offset:2048
v_mfma_f32_16x16x32_bf16 v[156:159], a[28:31], a[44:47], v[156:159]
ds_read_b128 a[44:47], v20 offset:3072
v_mfma_f32_16x16x32_bf16 v[24:27], a[4:7], v[40:43], v[24:27]
s_waitcnt lgkmcnt(6)
buffer_load_dwordx4 v5, s[12:15], s49 offen offset:3072 nt lds
ds_read_b64_tr_b16 a[28:29], v8 offset:0
v_mfma_f32_16x16x32_bf16 v[28:31], a[8:11], a[8:11], 0
s_cbranch_vccnz RESC2a
C_R2a:
ds_read_b64_tr_b16 a[30:31], v8 offset:12288
ds_read_b64_tr_b16 a[4:5], v9 offset:0
v_mfma_f32_16x16x32_bf16 v[36:39], a[8:11], a[0:3], 0
s_add_u32 m0, s24, 77824
ds_read_b64_tr_b16 a[6:7], v9 offset:12288
ds_read_b128 v[56:59], v14 offset:37120
v_mfma_f32_16x16x32_bf16 v[28:31], a[8:11], v[40:43], v[28:31]
s_waitcnt lgkmcnt(7)
v_add_u32 v52, s56, v52
v_add_u32 v53, s56, v53
v_mfma_f32_16x16x32_bf16 v[24:27], a[12:15], a[12:15], v[24:27]
ds_read_b64_tr_b16 a[8:9], v10 offset:0
ds_read_b64_tr_b16 a[10:11], v10 offset:12288
buffer_load_dwordx4 v6, s[12:15], s49 offen offset:0 nt lds
ds_read_b128 v[60:63], v14 offset:37376
v_mfma_f32_16x16x32_bf16 v[32:35], a[12:15], a[0:3], v[32:35]
v_add_u32 v54, s56, v54
v_add_u32 v55, s56, v55
v_mfma_f32_16x16x32_bf16 v[24:27], a[12:15], v[44:47], v[24:27]
ds_read_b64_tr_b16 a[12:13], v11 offset:0
ds_read_b64_tr_b16 a[14:15], v11 offset:12288
v_mfma_f32_16x16x32_bf16 v[28:31], a[16:19], a[16:19], v[28:31]
s_waitcnt lgkmcnt(5)
v_add_u32 v56, s56, v56
v_add_u32 v57, s56, v57
v_mfma_f32_16x16x32_bf16 v[36:39], a[16:19], a[0:3], v[36:39]
buffer_load_dwordx4 v7, s[12:15], s49 offen offset:1024 nt lds
v_add_u32 v58, s56, v58
v_mfma_f32_16x16x32_bf16 v[28:31], a[16:19], v[44:47], v[28:31]
s_add_u32 s49, s26, 270336
ds_read_b64_tr_b16 a[16:17], v12 offset:0
ds_read_b64_tr_b16 a[18:19], v12 offset:12288
v_mfma_f32_16x16x32_bf16 v[64:67], a[28:31], a[32:35], v[64:67]
s_waitcnt lgkmcnt(4)
s_add_u32 m0, s24, 98304
v_add_u32 v59, s56, v59
v_add_u32 v60, s56, v60
v_mfma_f32_16x16x32_bf16 v[68:71], a[28:31], a[36:39], v[68:71]
v_add_u32 v61, s56, v61
v_add_u32 v62, s56, v62
v_mfma_f32_16x16x32_bf16 v[24:27], a[20:23], a[20:23], v[24:27]
global_load_dword v23, v23, s[10:11]
v_add_u32 v63, s56, v63
v_mfma_f32_16x16x32_bf16 v[72:75], a[28:31], a[40:43], v[72:75]
v_add_u32 v14, 0xc000, v14
v_mfma_f32_16x16x32_bf16 v[32:35], a[20:23], a[0:3], v[32:35]
v_mfma_f32_16x16x32_bf16 v[76:79], a[28:31], a[44:47], v[76:79]
v_mfma_f32_16x16x32_bf16 v[24:27], a[20:23], v[48:51], v[24:27]
ds_read_b64_tr_b16 a[20:21], v13 offset:0
ds_read_b64_tr_b16 a[22:23], v13 offset:12288
v_mfma_f32_16x16x32_bf16 v[28:31], a[24:27], a[24:27], v[28:31]
s_nop 2
v_cndmask_b32 v17, v32, v33, s[32:33]
v_cndmask_b32 v17, v17, v34, s[34:35]
v_mfma_f32_16x16x32_bf16 v[36:39], a[24:27], a[0:3], v[36:39]
v_cndmask_b32 v17, v17, v35, s[36:37]
v_cndmask_b32 v16, v24, v25, s[32:33]
v_mfma_f32_16x16x32_bf16 v[80:83], a[4:7], a[32:35], v[80:83]
v_cndmask_b32 v16, v16, v26, s[34:35]
v_cndmask_b32 v16, v16, v27, s[36:37]
v_mfma_f32_16x16x32_bf16 v[28:31], a[24:27], v[48:51], v[28:31]
s_nop 1
v_cndmask_b32 v19, v36, v37, s[32:33]
v_mfma_f32_16x16x32_bf16 v[84:87], a[4:7], a[36:39], v[84:87]
v_cndmask_b32 v19, v19, v38, s[34:35]
v_cndmask_b32 v19, v19, v39, s[36:37]
v_mfma_f32_16x16x32_bf16 v[88:91], a[4:7], a[40:43], v[88:91]
s_nop 0
v_cndmask_b32 v18, v28, v29, s[32:33]
v_mfma_f32_16x16x32_bf16 v[92:95], a[4:7], a[44:47], v[92:95]
v_cndmask_b32 v18, v18, v30, s[34:35]
v_cndmask_b32 v18, v18, v31, s[36:37]
v_mfma_f32_16x16x32_bf16 v[96:99], a[8:11], a[32:35], v[96:99]
ds_write_b128 v21, v[16:19] offset:0
v_mfma_f32_16x16x32_bf16 v[100:103], a[8:11], a[36:39], v[100:103]
v_mfma_f32_16x16x32_bf16 v[104:107], a[8:11], a[40:43], v[104:107]
v_mfma_f32_16x16x32_bf16 v[108:111], a[8:11], a[44:47], v[108:111]
s_waitcnt lgkmcnt(1)
v_mfma_f32_16x16x32_bf16 v[112:115], a[12:15], a[32:35], v[112:115]
v_mfma_f32_16x16x32_bf16 v[116:119], a[12:15], a[36:39], v[116:119]
v_mfma_f32_16x16x32_bf16 v[120:123], a[12:15], a[40:43], v[120:123]
v_mfma_f32_16x16x32_bf16 v[124:127], a[12:15], a[44:47], v[124:127]
s_waitcnt vmcnt(7) lgkmcnt(0)
s_barrier
ds_read_b128 v[16:19], v22 offset:16
buffer_load_dwordx4 v2, s[12:15], s49 offen offset:0 nt lds
ds_read_b128 a[24:27], v14 offset:0
v_mfma_f32_16x16x32_bf16 v[128:131], a[16:19], a[32:35], v[128:131]
ds_read_b128 a[28:31], v14 offset:12288
v_mfma_f32_16x16x32_bf16 v[132:135], a[16:19], a[36:39], v[132:135]
ds_read_b128 a[4:7], v14 offset:256
v_mfma_f32_16x16x32_bf16 v[136:139], a[16:19], a[40:43], v[136:139]
ds_read_b128 a[8:11], v14 offset:12544
buffer_load_dwordx4 v3, s[12:15], s49 offen offset:1024 nt lds
s_waitcnt lgkmcnt(4)
v_max3_u32 v15, v16, v17, v18
v_mfma_f32_16x16x32_bf16 v[140:143], a[16:19], a[44:47], v[140:143]
s_waitcnt lgkmcnt(3)
ds_read_b128 a[12:15], v14 offset:512
v_max_u32 v15, v15, v19
v_mfma_f32_16x16x32_bf16 v[24:27], a[24:27], a[24:27], 0
ds_read_b128 a[16:19], v14 offset:12800
v_cmp_eq_u32 vcc, 4, v15
v_mfma_f32_16x16x32_bf16 v[144:147], a[20:23], a[32:35], v[144:147]
ds_read_b128 a[32:35], v20 offset:4096
v_mfma_f32_16x16x32_bf16 v[148:151], a[20:23], a[36:39], v[148:151]
ds_read_b128 a[36:39], v20 offset:5120
buffer_load_dwordx4 v4, s[12:15], s49 offen offset:2048 nt lds
v_mfma_f32_16x16x32_bf16 v[152:155], a[20:23], a[40:43], v[152:155]
ds_read_b128 a[40:43], v20 offset:6144
v_mfma_f32_16x16x32_bf16 v[156:159], a[20:23], a[44:47], v[156:159]
ds_read_b64_tr_b16 a[20:21], v8 offset:24576
v_mfma_f32_16x16x32_bf16 v[32:35], a[24:27], a[0:3], 0
ds_read_b64_tr_b16 a[22:23], v8 offset:36864
v_add_u32 v8, 0xfffe8000, v8
v_mfma_f32_16x16x32_bf16 v[24:27], a[24:27], v[40:43], v[24:27]
s_waitcnt lgkmcnt(6)
ds_read_b128 a[44:47], v20 offset:7168
buffer_load_dwordx4 v5, s[12:15], s49 offen offset:3072 nt lds
ds_read_b64_tr_b16 a[24:25], v9 offset:24576
v_mfma_f32_16x16x32_bf16 v[28:31], a[28:31], a[28:31], 0
s_cbranch_vccnz RESC3a
C_R3a:
ds_read_b64_tr_b16 a[26:27], v9 offset:36864
v_mfma_f32_16x16x32_bf16 v[36:39], a[28:31], a[0:3], 0
s_add_u32 m0, s24, 102400
v_add_u32 v9, 0xfffe8000, v9
s_add_u32 s52, s27, 6144
v_mfma_f32_16x16x32_bf16 v[28:31], a[28:31], v[40:43], v[28:31]
s_waitcnt lgkmcnt(3)
ds_read_b64_tr_b16 a[28:29], v10 offset:24576
ds_read_b64_tr_b16 a[30:31], v10 offset:36864
v_mfma_f32_16x16x32_bf16 v[64:67], a[20:23], a[32:35], v[64:67]
buffer_load_dwordx4 v6, s[12:15], s49 offen offset:0 nt lds
v_add_u32 v10, 0xfffe8000, v10
v_mfma_f32_16x16x32_bf16 v[24:27], a[4:7], a[4:7], v[24:27]
v_mfma_f32_16x16x32_bf16 v[68:71], a[20:23], a[36:39], v[68:71]
v_mfma_f32_16x16x32_bf16 v[32:35], a[4:7], a[0:3], v[32:35]
v_mfma_f32_16x16x32_bf16 v[72:75], a[20:23], a[40:43], v[72:75]
buffer_load_dwordx4 v7, s[12:15], s49 offen offset:1024 nt lds
s_add_u32 m0, s24, 24576
v_mfma_f32_16x16x32_bf16 v[24:27], a[4:7], v[44:47], v[24:27]
s_waitcnt lgkmcnt(2)
ds_read_b64_tr_b16 a[4:5], v11 offset:24576
ds_read_b64_tr_b16 a[6:7], v11 offset:36864
v_mfma_f32_16x16x32_bf16 v[76:79], a[20:23], a[44:47], v[76:79]
v_add_u32 v11, 0xfffe8000, v11
v_mfma_f32_16x16x32_bf16 v[28:31], a[8:11], a[8:11], v[28:31]
v_mfma_f32_16x16x32_bf16 v[80:83], a[24:27], a[32:35], v[80:83]
buffer_load_dwordx4 v1, s[28:31], s52 offen offset:0 sc1 lds
v_mfma_f32_16x16x32_bf16 v[36:39], a[8:11], a[0:3], v[36:39]
v_mfma_f32_16x16x32_bf16 v[84:87], a[24:27], a[36:39], v[84:87]
v_mfma_f32_16x16x32_bf16 v[28:31], a[8:11], v[44:47], v[28:31]
ds_read_b64_tr_b16 a[8:9], v12 offset:24576
ds_read_b64_tr_b16 a[10:11], v12 offset:36864
v_mfma_f32_16x16x32_bf16 v[88:91], a[24:27], a[40:43], v[88:91]
buffer_load_dwordx4 v1, s[28:31], s52 offen offset:1024 sc1 lds
v_add_u32 v12, 0xfffe8000, v12
v_mfma_f32_16x16x32_bf16 v[92:95], a[24:27], a[44:47], v[92:95]
v_mfma_f32_16x16x32_bf16 v[24:27], a[12:15], a[12:15], v[24:27]
v_mfma_f32_16x16x32_bf16 v[32:35], a[12:15], a[0:3], v[32:35]
v_mfma_f32_16x16x32_bf16 v[24:27], a[12:15], v[48:51], v[24:27]
s_waitcnt lgkmcnt(2)
ds_read_b64_tr_b16 a[12:13], v13 offset:24576
ds_read_b64_tr_b16 a[14:15], v13 offset:36864
buffer_load_dwordx4 v1, s[28:31], s52 offen offset:2048 sc1 lds
v_mfma_f32_16x16x32_bf16 v[96:99], a[28:31], a[32:35], v[96:99]
s_nop 1
v_cndmask_b32 v17, v32, v33, s[32:33]
v_cndmask_b32 v17, v17, v34, s[34:35]
v_mfma_f32_16x16x32_bf16 v[100:103], a[28:31], a[36:39], v[100:103]
v_cndmask_b32 v16, v24, v25, s[32:33]
v_cndmask_b32 v16, v16, v26, s[34:35]
v_mfma_f32_16x16x32_bf16 v[28:31], a[16:19], a[16:19], v[28:31]
v_cndmask_b32 v16, v16, v27, s[36:37]
v_cndmask_b32 v17, v17, v35, s[36:37]
v_mfma_f32_16x16x32_bf16 v[104:107], a[28:31], a[40:43], v[104:107]
v_add_u32 v13, 0xfffe8000, v13
v_mfma_f32_16x16x32_bf16 v[36:39], a[16:19], a[0:3], v[36:39]
buffer_load_dwordx4 v1, s[28:31], s52 offen offset:3072 sc1 lds
s_add_u32 s52, s52, 4096
v_mfma_f32_16x16x32_bf16 v[108:111], a[28:31], a[44:47], v[108:111]
s_add_u32 m0, s24, 28672
v_mfma_f32_16x16x32_bf16 v[28:31], a[16:19], v[48:51], v[28:31]
s_nop 2
v_cndmask_b32 v19, v36, v37, s[32:33]
v_mfma_f32_16x16x32_bf16 v[112:115], a[4:7], a[32:35], v[112:115]
v_cndmask_b32 v19, v19, v38, s[34:35]
v_cndmask_b32 v19, v19, v39, s[36:37]
v_mfma_f32_16x16x32_bf16 v[116:119], a[4:7], a[36:39], v[116:119]
buffer_load_dwordx4 v1, s[28:31], s52 offen offset:0 sc1 lds
v_cndmask_b32 v18, v28, v29, s[32:33]
v_mfma_f32_16x16x32_bf16 v[120:123], a[4:7], a[40:43], v[120:123]
v_cndmask_b32 v18, v18, v30, s[34:35]
v_cndmask_b32 v18, v18, v31, s[36:37]
v_mfma_f32_16x16x32_bf16 v[124:127], a[4:7], a[44:47], v[124:127]
s_waitcnt lgkmcnt(0)
ds_write_b128 v21, v[16:19] offset:1280
v_mfma_f32_16x16x32_bf16 v[128:131], a[8:11], a[32:35], v[128:131]
v_mfma_f32_16x16x32_bf16 v[132:135], a[8:11], a[36:39], v[132:135]
buffer_load_dwordx4 v1, s[28:31], s52 offen offset:1024 sc1 lds
s_add_u32 s52, s27, 24576
v_mfma_f32_16x16x32_bf16 v[136:139], a[8:11], a[40:43], v[136:139]
s_add_u32 m0, s24, 122880
v_mfma_f32_16x16x32_bf16 v[140:143], a[8:11], a[44:47], v[140:143]
v_mfma_f32_16x16x32_bf16 v[144:147], a[12:15], a[32:35], v[144:147]
ds_read_b128 a[32:35], v20 offset:8192
v_mfma_f32_16x16x32_bf16 v[148:151], a[12:15], a[36:39], v[148:151]
ds_read_b128 a[36:39], v20 offset:9216
v_mfma_f32_16x16x32_bf16 v[152:155], a[12:15], a[40:43], v[152:155]
ds_read_b128 a[40:43], v20 offset:10240
v_mfma_f32_16x16x32_bf16 v[156:159], a[12:15], a[44:47], v[156:159]
ds_read_b128 a[44:47], v20 offset:11264
s_waitcnt lgkmcnt(3)
v_mfma_f32_16x16x32_bf16 v[64:67], a[48:51], a[32:35], v[64:67]
v_mfma_f32_16x16x32_bf16 v[80:83], a[52:55], a[32:35], v[80:83]
s_waitcnt lgkmcnt(2)
v_mfma_f32_16x16x32_bf16 v[68:71], a[48:51], a[36:39], v[68:71]
s_waitcnt lgkmcnt(1)
v_mfma_f32_16x16x32_bf16 v[72:75], a[48:51], a[40:43], v[72:75]
s_waitcnt vmcnt(13) lgkmcnt(0)
s_barrier
v_mfma_f32_16x16x32_bf16 v[76:79], a[48:51], a[44:47], v[76:79]
v_mfma_f32_16x16x32_bf16 v[84:87], a[52:55], a[36:39], v[84:87]
ds_read_b128 a[16:19], v14 offset:24576
buffer_load_dwordx4 v1, s[28:31], s52 offen offset:0 sc1 lds
ds_read_b128 v[16:19], v22 offset:0
v_mfma_f32_16x16x32_bf16 v[88:91], a[52:55], a[40:43], v[88:91]
ds_read_b128 a[20:23], v14 offset:36864
v_mfma_f32_16x16x32_bf16 v[92:95], a[52:55], a[44:47], v[92:95]
ds_read_b128 a[24:27], v14 offset:24832
v_mfma_f32_16x16x32_bf16 v[96:99], a[56:59], a[32:35], v[96:99]
ds_read_b128 a[28:31], v14 offset:37120
buffer_load_dwordx4 v1, s[28:31], s52 offen offset:1024 sc1 lds
v_mfma_f32_16x16x32_bf16 v[100:103], a[56:59], a[36:39], v[100:103]
ds_read_b128 a[4:7], v14 offset:25088
v_mfma_f32_16x16x32_bf16 v[104:107], a[56:59], a[40:43], v[104:107]
ds_read_b128 a[8:11], v14 offset:37376
v_mfma_f32_16x16x32_bf16 v[108:111], a[56:59], a[44:47], v[108:111]
s_waitcnt lgkmcnt(5)
v_max3_u32 v15, v16, v17, v18
v_max_u32 v15, v15, v19
v_mfma_f32_16x16x32_bf16 v[112:115], a[60:63], a[32:35], v[112:115]
ds_read_b64_tr_b16 a[12:13], v8 offset:0
ds_read_b64_tr_b16 a[14:15], v8 offset:12288
buffer_load_dwordx4 v1, s[28:31], s52 offen offset:2048 sc1 lds
v_mfma_f32_16x16x32_bf16 v[116:119], a[60:63], a[36:39], v[116:119]
v_cmp_eq_u32 vcc, 5, v15
v_add_u32 v14, 0xc000, v14
v_mfma_f32_16x16x32_bf16 v[120:123], a[60:63], a[40:43], v[120:123]
v_add_u32 v8, 0xc000, v8
v_mfma_f32_16x16x32_bf16 v[124:127], a[60:63], a[44:47], v[124:127]
v_mfma_f32_16x16x32_bf16 v[128:131], a[64:67], a[32:35], v[128:131]
buffer_load_dwordx4 v1, s[28:31], s52 offen offset:3072 sc1 lds
v_mfma_f32_16x16x32_bf16 v[132:135], a[64:67], a[36:39], v[132:135]
s_add_u32 s52, s52, 4096
s_add_u32 m0, s24, 126976
v_mfma_f32_16x16x32_bf16 v[136:139], a[64:67], a[40:43], v[136:139]
v_mfma_f32_16x16x32_bf16 v[24:27], a[16:19], a[16:19], 0
v_mfma_f32_16x16x32_bf16 v[140:143], a[64:67], a[44:47], v[140:143]
buffer_load_dwordx4 v1, s[28:31], s52 offen offset:0 sc1 lds
v_mfma_f32_16x16x32_bf16 v[32:35], a[16:19], a[0:3], 0
v_mfma_f32_16x16x32_bf16 v[144:147], a[68:71], a[32:35], v[144:147]
ds_read_b128 a[32:35], v20 offset:0
v_mfma_f32_16x16x32_bf16 v[24:27], a[16:19], v[52:55], v[24:27]
ds_read_b64_tr_b16 a[16:17], v9 offset:0
ds_read_b64_tr_b16 a[18:19], v9 offset:12288
v_mfma_f32_16x16x32_bf16 v[148:151], a[68:71], a[36:39], v[148:151]
ds_read_b128 a[36:39], v20 offset:1024
buffer_load_dwordx4 v1, s[28:31], s52 offen offset:1024 sc1 lds
v_mfma_f32_16x16x32_bf16 v[152:155], a[68:71], a[40:43], v[152:155]
s_add_u32 s52, s27, 43008
ds_read_b128 a[40:43], v20 offset:2048
s_add_u32 m0, s24, 0
v_mfma_f32_16x16x32_bf16 v[156:159], a[68:71], a[44:47], v[156:159]
s_waitcnt lgkmcnt(5)
ds_read_b128 a[44:47], v20 offset:3072
v_add_u32 v9, 0xc000, v9
v_mfma_f32_16x16x32_bf16 v[28:31], a[20:23], a[20:23], 0
v_mfma_f32_16x16x32_bf16 v[36:39], a[20:23], a[0:3], 0
s_cbranch_vccnz RESC4a
C_R4a:
v_mfma_f32_16x16x32_bf16 v[28:31], a[20:23], v[52:55], v[28:31]
ds_read_b64_tr_b16 a[20:21], v10 offset:0
ds_read_b64_tr_b16 a[22:23], v10 offset:12288
v_mfma_f32_16x16x32_bf16 v[24:27], a[24:27], a[24:27], v[24:27]
v_add_u32 v10, 0xc000, v10
v_mfma_f32_16x16x32_bf16 v[32:35], a[24:27], a[0:3], v[32:35]
v_mfma_f32_16x16x32_bf16 v[24:27], a[24:27], v[56:59], v[24:27]
ds_read_b64_tr_b16 a[24:25], v11 offset:0
ds_read_b64_tr_b16 a[26:27], v11 offset:12288
v_mfma_f32_16x16x32_bf16 v[28:31], a[28:31], a[28:31], v[28:31]
v_add_u32 v11, 0xc000, v11
v_mfma_f32_16x16x32_bf16 v[36:39], a[28:31], a[0:3], v[36:39]
v_mfma_f32_16x16x32_bf16 v[28:31], a[28:31], v[56:59], v[28:31]
ds_read_b64_tr_b16 a[28:29], v12 offset:0
ds_read_b64_tr_b16 a[30:31], v12 offset:12288
v_mfma_f32_16x16x32_bf16 v[24:27], a[4:7], a[4:7], v[24:27]
v_add_u32 v12, 0xc000, v12
v_mfma_f32_16x16x32_bf16 v[32:35], a[4:7], a[0:3], v[32:35]
v_mfma_f32_16x16x32_bf16 v[24:27], a[4:7], v[60:63], v[24:27]
ds_read_b64_tr_b16 a[4:5], v13 offset:0
ds_read_b64_tr_b16 a[6:7], v13 offset:12288
v_mfma_f32_16x16x32_bf16 v[28:31], a[8:11], a[8:11], v[28:31]
s_waitcnt lgkmcnt(4)
v_add_u32 v13, 0xc000, v13
s_nop 1
v_cndmask_b32 v17, v32, v33, s[32:33]
v_mfma_f32_16x16x32_bf16 v[64:67], a[12:15], a[32:35], v[64:67]
v_cndmask_b32 v17, v17, v34, s[34:35]
v_cndmask_b32 v16, v24, v25, s[32:33]
v_mfma_f32_16x16x32_bf16 v[36:39], a[8:11], a[0:3], v[36:39]
v_cndmask_b32 v16, v16, v26, s[34:35]
v_cndmask_b32 v16, v16, v27, s[36:37]
v_mfma_f32_16x16x32_bf16 v[28:31], a[8:11], v[60:63], v[28:31]
v_cndmask_b32 v17, v17, v35, s[36:37]
v_mfma_f32_16x16x32_bf16 v[68:71], a[12:15], a[36:39], v[68:71]
s_nop 2
v_cndmask_b32 v19, v36, v37, s[32:33]
v_mfma_f32_16x16x32_bf16 v[72:75], a[12:15], a[40:43], v[72:75]
v_cndmask_b32 v19, v19, v38, s[34:35]
v_cndmask_b32 v18, v28, v29, s[32:33]
v_mfma_f32_16x16x32_bf16 v[76:79], a[12:15], a[44:47], v[76:79]
v_cndmask_b32 v18, v18, v30, s[34:35]
v_cndmask_b32 v18, v18, v31, s[36:37]
v_mfma_f32_16x16x32_bf16 v[80:83], a[16:19], a[32:35], v[80:83]
v_cndmask_b32 v19, v19, v39, s[36:37]
v_mfma_f32_16x16x32_bf16 v[84:87], a[16:19], a[36:39], v[84:87]
ds_write_b128 v21, v[16:19] offset:0
v_mfma_f32_16x16x32_bf16 v[88:91], a[16:19], a[40:43], v[88:91]
v_mfma_f32_16x16x32_bf16 v[92:95], a[16:19], a[44:47], v[92:95]
v_mfma_f32_16x16x32_bf16 v[96:99], a[20:23], a[32:35], v[96:99]
v_mfma_f32_16x16x32_bf16 v[100:103], a[20:23], a[36:39], v[100:103]
v_mfma_f32_16x16x32_bf16 v[104:107], a[20:23], a[40:43], v[104:107]
v_mfma_f32_16x16x32_bf16 v[108:111], a[20:23], a[44:47], v[108:111]
v_mfma_f32_16x16x32_bf16 v[112:115], a[24:27], a[32:35], v[112:115]
s_waitcnt vmcnt(12) lgkmcnt(0)
s_barrier
v_mfma_f32_16x16x32_bf16 v[116:119], a[24:27], a[36:39], v[116:119]
v_mfma_f32_16x16x32_bf16 v[120:123], a[24:27], a[40:43], v[120:123]
ds_read_b128 v[16:19], v22 offset:16
buffer_load_dwordx4 v1, s[28:31], s52 offen offset:0 sc1 lds
ds_read_b128 a[8:11], v14 offset:0
v_mfma_f32_16x16x32_bf16 v[124:127], a[24:27], a[44:47], v[124:127]
ds_read_b128 a[12:15], v14 offset:12288
v_mfma_f32_16x16x32_bf16 v[128:131], a[28:31], a[32:35], v[128:131]
ds_read_b128 a[16:19], v14 offset:256
v_mfma_f32_16x16x32_bf16 v[132:135], a[28:31], a[36:39], v[132:135]
ds_read_b128 a[20:23], v14 offset:12544
buffer_load_dwordx4 v1, s[28:31], s52 offen offset:1024 sc1 lds
v_mfma_f32_16x16x32_bf16 v[136:139], a[28:31], a[40:43], v[136:139]
ds_read_b128 a[24:27], v14 offset:512
s_waitcnt lgkmcnt(5)
v_max3_u32 v15, v16, v17, v18
v_mfma_f32_16x16x32_bf16 v[140:143], a[28:31], a[44:47], v[140:143]
s_waitcnt lgkmcnt(4)
ds_read_b128 a[28:31], v14 offset:12800
v_mfma_f32_16x16x32_bf16 v[24:27], a[8:11], a[8:11], 0
v_max_u32 v15, v15, v19
v_cmp_eq_u32 vcc, 6, v15
v_mfma_f32_16x16x32_bf16 v[144:147], a[4:7], a[32:35], v[144:147]
ds_read_b128 a[32:35], v20 offset:4096
buffer_load_dwordx4 v1, s[28:31], s52 offen offset:2048 sc1 lds
v_mfma_f32_16x16x32_bf16 v[32:35], a[8:11], a[0:3], 0
v_mfma_f32_16x16x32_bf16 v[148:151], a[4:7], a[36:39], v[148:151]
ds_read_b128 a[36:39], v20 offset:5120
v_mfma_f32_16x16x32_bf16 v[152:155], a[4:7], a[40:43], v[152:155]
ds_read_b128 a[40:43], v20 offset:6144
v_mfma_f32_16x16x32_bf16 v[156:159], a[4:7], a[44:47], v[156:159]
ds_read_b128 a[44:47], v20 offset:7168
buffer_load_dwordx4 v1, s[28:31], s52 offen offset:3072 sc1 lds
v_mfma_f32_16x16x32_bf16 v[24:27], a[8:11], v[52:55], v[24:27]
s_waitcnt lgkmcnt(4)
s_add_u32 s52, s52, 4096
ds_read_b64_tr_b16 a[4:5], v8 offset:0
ds_read_b64_tr_b16 a[6:7], v8 offset:12288
v_mfma_f32_16x16x32_bf16 v[28:31], a[12:15], a[12:15], 0
s_cbranch_vccnz RESC5a
C_R5a:
ds_read_b64_tr_b16 a[8:9], v9 offset:0
ds_read_b64_tr_b16 a[10:11], v9 offset:12288
v_mfma_f32_16x16x32_bf16 v[36:39], a[12:15], a[0:3], 0
s_add_u32 m0, s24, 4096
s_add_u32 s50, s50, 49152
buffer_load_dwordx4 v1, s[28:31], s52 offen offset:0 sc1 lds
v_mfma_f32_16x16x32_bf16 v[28:31], a[12:15], v[52:55], v[28:31]
ds_read_b64_tr_b16 a[12:13], v10 offset:0
ds_read_b64_tr_b16 a[14:15], v10 offset:12288
v_mfma_f32_16x16x32_bf16 v[24:27], a[16:19], a[16:19], v[24:27]
v_add_u32 v14, s50, v1
v_mfma_f32_16x16x32_bf16 v[32:35], a[16:19], a[0:3], v[32:35]
v_mfma_f32_16x16x32_bf16 v[24:27], a[16:19], v[56:59], v[24:27]
ds_read_b64_tr_b16 a[16:17], v11 offset:0
ds_read_b64_tr_b16 a[18:19], v11 offset:12288
buffer_load_dwordx4 v1, s[28:31], s52 offen offset:1024 sc1 lds
v_mfma_f32_16x16x32_bf16 v[28:31], a[20:23], a[20:23], v[28:31]
v_mfma_f32_16x16x32_bf16 v[36:39], a[20:23], a[0:3], v[36:39]
v_mfma_f32_16x16x32_bf16 v[28:31], a[20:23], v[56:59], v[28:31]
ds_read_b64_tr_b16 a[20:21], v12 offset:0
ds_read_b64_tr_b16 a[22:23], v12 offset:12288
v_mfma_f32_16x16x32_bf16 v[24:27], a[24:27], a[24:27], v[24:27]
v_mfma_f32_16x16x32_bf16 v[32:35], a[24:27], a[0:3], v[32:35]
v_mfma_f32_16x16x32_bf16 v[24:27], a[24:27], v[60:63], v[24:27]
ds_read_b64_tr_b16 a[24:25], v13 offset:0
ds_read_b64_tr_b16 a[26:27], v13 offset:12288
v_mfma_f32_16x16x32_bf16 v[28:31], a[28:31], a[28:31], v[28:31]
s_waitcnt lgkmcnt(4)
s_nop 2
v_cndmask_b32 v17, v32, v33, s[32:33]
v_mfma_f32_16x16x32_bf16 v[64:67], a[4:7], a[32:35], v[64:67]
v_cndmask_b32 v17, v17, v34, s[34:35]
v_cndmask_b32 v16, v24, v25, s[32:33]
v_mfma_f32_16x16x32_bf16 v[36:39], a[28:31], a[0:3], v[36:39]
v_cndmask_b32 v16, v16, v26, s[34:35]
v_cndmask_b32 v16, v16, v27, s[36:37]
v_mfma_f32_16x16x32_bf16 v[68:71], a[4:7], a[36:39], v[68:71]
v_cndmask_b32 v17, v17, v35, s[36:37]
v_mfma_f32_16x16x32_bf16 v[28:31], a[28:31], v[60:63], v[28:31]
s_nop 2
v_cndmask_b32 v19, v36, v37, s[32:33]
v_mfma_f32_16x16x32_bf16 v[72:75], a[4:7], a[40:43], v[72:75]
v_cndmask_b32 v19, v19, v38, s[34:35]
v_cndmask_b32 v19, v19, v39, s[36:37]
v_mfma_f32_16x16x32_bf16 v[76:79], a[4:7], a[44:47], v[76:79]
v_cndmask_b32 v18, v28, v29, s[32:33]
v_mfma_f32_16x16x32_bf16 v[80:83], a[8:11], a[32:35], v[80:83]
v_cndmask_b32 v18, v18, v30, s[34:35]
v_cndmask_b32 v18, v18, v31, s[36:37]
v_mfma_f32_16x16x32_bf16 v[84:87], a[8:11], a[36:39], v[84:87]
ds_write_b128 v21, v[16:19] offset:1280
v_mfma_f32_16x16x32_bf16 v[88:91], a[8:11], a[40:43], v[88:91]
v_mfma_f32_16x16x32_bf16 v[92:95], a[8:11], a[44:47], v[92:95]
v_mfma_f32_16x16x32_bf16 v[96:99], a[12:15], a[32:35], v[96:99]
v_mfma_f32_16x16x32_bf16 v[100:103], a[12:15], a[36:39], v[100:103]
v_mfma_f32_16x16x32_bf16 v[104:107], a[12:15], a[40:43], v[104:107]
v_mfma_f32_16x16x32_bf16 v[108:111], a[12:15], a[44:47], v[108:111]
v_mfma_f32_16x16x32_bf16 v[112:115], a[16:19], a[32:35], v[112:115]
s_waitcnt lgkmcnt(0)
s_barrier
v_mfma_f32_16x16x32_bf16 v[116:119], a[16:19], a[36:39], v[116:119]
v_mfma_f32_16x16x32_bf16 v[120:123], a[16:19], a[40:43], v[120:123]
ds_read_b128 v[16:19], v22 offset:0
v_mfma_f32_16x16x32_bf16 v[124:127], a[16:19], a[44:47], v[124:127]
ds_read_b64_tr_b16 a[28:29], v8 offset:24576
ds_read_b64_tr_b16 a[30:31], v8 offset:36864
v_mfma_f32_16x16x32_bf16 v[128:131], a[20:23], a[32:35], v[128:131]
ds_read_b64_tr_b16 a[4:5], v9 offset:24576
v_add_u32 v8, 0xc000, v8
v_mfma_f32_16x16x32_bf16 v[132:135], a[20:23], a[36:39], v[132:135]
ds_read_b64_tr_b16 a[6:7], v9 offset:36864
ds_read_b64_tr_b16 a[8:9], v10 offset:24576
v_mfma_f32_16x16x32_bf16 v[136:139], a[20:23], a[40:43], v[136:139]
ds_read_b64_tr_b16 a[10:11], v10 offset:36864
ds_read_b64_tr_b16 a[12:13], v11 offset:24576
s_waitcnt lgkmcnt(7)
v_max3_u32 v15, v16, v17, v18
v_mfma_f32_16x16x32_bf16 v[140:143], a[20:23], a[44:47], v[140:143]
ds_read_b64_tr_b16 a[14:15], v11 offset:36864
ds_read_b64_tr_b16 a[16:17], v12 offset:24576
v_mfma_f32_16x16x32_bf16 v[144:147], a[24:27], a[32:35], v[144:147]
ds_read_b128 a[32:35], v20 offset:0
v_max_u32 v15, v15, v19
v_mfma_f32_16x16x32_bf16 v[148:151], a[24:27], a[36:39], v[148:151]
ds_read_b128 a[36:39], v20 offset:1024
v_cmp_eq_u32 vcc, 7, v15
v_mfma_f32_16x16x32_bf16 v[152:155], a[24:27], a[40:43], v[152:155]
ds_read_b128 a[40:43], v20 offset:2048
v_mfma_f32_16x16x32_bf16 v[156:159], a[24:27], a[44:47], v[156:159]
v_add_u32 v9, 0xc000, v9
v_add_u32 v10, 0xc000, v10
v_add_u32 v11, 0xc000, v11
ds_read_b128 a[44:47], v20 offset:3072
ds_read_b64_tr_b16 a[18:19], v12 offset:36864
v_add_u32 v12, 0xc000, v12
s_cbranch_vccnz RESC6a
C_R6a:
ds_read_b64_tr_b16 a[20:21], v13 offset:24576
ds_read_b64_tr_b16 a[22:23], v13 offset:36864
s_waitcnt lgkmcnt(6)
v_mfma_f32_16x16x32_bf16 v[64:67], a[28:31], a[32:35], v[64:67]
s_waitcnt lgkmcnt(5)
v_add_u32 v13, 0xc000, v13
v_mfma_f32_16x16x32_bf16 v[68:71], a[28:31], a[36:39], v[68:71]
s_waitcnt lgkmcnt(4)
v_mfma_f32_16x16x32_bf16 v[72:75], a[28:31], a[40:43], v[72:75]
s_waitcnt lgkmcnt(3)
v_mfma_f32_16x16x32_bf16 v[76:79], a[28:31], a[44:47], v[76:79]
v_mfma_f32_16x16x32_bf16 v[80:83], a[4:7], a[32:35], v[80:83]
s_waitcnt lgkmcnt(0)
s_barrier
s_setprio 2
v_mfma_f32_16x16x32_bf16 v[84:87], a[4:7], a[36:39], v[84:87]
v_mfma_f32_16x16x32_bf16 v[88:91], a[4:7], a[40:43], v[88:91]
ds_read_b128 v[16:19], v22 offset:16
v_mfma_f32_16x16x32_bf16 v[92:95], a[4:7], a[44:47], v[92:95]
ds_read_b64_tr_b16 a[24:25], v8 offset:0
ds_read_b64_tr_b16 a[26:27], v8 offset:12288
v_mfma_f32_16x16x32_bf16 v[96:99], a[8:11], a[32:35], v[96:99]
ds_read_b128 v[40:43], v20 offset:8192
v_mfma_f32_16x16x32_bf16 v[100:103], a[8:11], a[36:39], v[100:103]
ds_read_b128 v[44:47], v20 offset:9216
v_mfma_f32_16x16x32_bf16 v[104:107], a[8:11], a[40:43], v[104:107]
ds_read_b128 v[48:51], v20 offset:10240
v_mfma_f32_16x16x32_bf16 v[108:111], a[8:11], a[44:47], v[108:111]
s_waitcnt lgkmcnt(5)
v_max3_u32 v15, v16, v17, v18
v_max_u32 v15, v15, v19
v_mfma_f32_16x16x32_bf16 v[112:115], a[12:15], a[32:35], v[112:115]
ds_read_b64_tr_b16 a[28:29], v9 offset:0
ds_read_b64_tr_b16 a[30:31], v9 offset:12288
ds_read_b128 v[52:55], v20 offset:11264
v_mfma_f32_16x16x32_bf16 v[116:119], a[12:15], a[36:39], v[116:119]
v_cmp_eq_u32 vcc, 8, v15
v_mfma_f32_16x16x32_bf16 v[120:123], a[12:15], a[40:43], v[120:123]
ds_read_b64_tr_b16 a[4:5], v10 offset:0
ds_read_b64_tr_b16 a[6:7], v10 offset:12288
ds_read_b64_tr_b16 a[8:9], v11 offset:0
v_mfma_f32_16x16x32_bf16 v[124:127], a[12:15], a[44:47], v[124:127]
ds_read_b64_tr_b16 a[10:11], v11 offset:12288
v_mfma_f32_16x16x32_bf16 v[128:131], a[16:19], a[32:35], v[128:131]
ds_read_b64_tr_b16 a[12:13], v12 offset:0
ds_read_b64_tr_b16 a[14:15], v12 offset:12288
v_mfma_f32_16x16x32_bf16 v[132:135], a[16:19], a[36:39], v[132:135]
v_mfma_f32_16x16x32_bf16 v[136:139], a[16:19], a[40:43], v[136:139]
v_mfma_f32_16x16x32_bf16 v[140:143], a[16:19], a[44:47], v[140:143]
ds_read_b64_tr_b16 a[16:17], v13 offset:0
ds_read_b64_tr_b16 a[18:19], v13 offset:12288
v_mfma_f32_16x16x32_bf16 v[144:147], a[20:23], a[32:35], v[144:147]
ds_read_b128 a[32:35], v20 offset:4096
v_mfma_f32_16x16x32_bf16 v[148:151], a[20:23], a[36:39], v[148:151]
ds_read_b128 a[36:39], v20 offset:5120
v_mfma_f32_16x16x32_bf16 v[152:155], a[20:23], a[40:43], v[152:155]
ds_read_b128 a[40:43], v20 offset:6144
v_mfma_f32_16x16x32_bf16 v[156:159], a[20:23], a[44:47], v[156:159]
ds_read_b128 a[44:47], v20 offset:7168
s_cbranch_vccnz RESC7a
C_R7a:
s_waitcnt lgkmcnt(3)
v_mfma_f32_16x16x32_bf16 v[64:67], a[24:27], a[32:35], v[64:67]
s_waitcnt lgkmcnt(2)
v_mfma_f32_16x16x32_bf16 v[68:71], a[24:27], a[36:39], v[68:71]
v_mfma_f32_16x16x32_bf16 v[64:67], a[72:75], v[40:43], v[64:67]
s_waitcnt lgkmcnt(1)
v_mfma_f32_16x16x32_bf16 v[72:75], a[24:27], a[40:43], v[72:75]
v_mfma_f32_16x16x32_bf16 v[68:71], a[72:75], v[44:47], v[68:71]
s_waitcnt lgkmcnt(0)
s_nop 3
v_cvt_pk_bf16_f32 v24, v64, v65
v_mfma_f32_16x16x32_bf16 v[76:79], a[24:27], a[44:47], v[76:79]
v_cvt_pk_bf16_f32 v25, v66, v67
v_mfma_f32_16x16x32_bf16 v[72:75], a[72:75], v[48:51], v[72:75]
v_cvt_pk_bf16_f32 v28, v68, v69
v_mfma_f32_16x16x32_bf16 v[80:83], a[28:31], a[32:35], v[80:83]
v_cvt_pk_bf16_f32 v29, v70, v71
v_mfma_f32_16x16x32_bf16 v[76:79], a[72:75], v[52:55], v[76:79]
s_nop 3
v_cvt_pk_bf16_f32 v32, v72, v73
v_mfma_f32_16x16x32_bf16 v[80:83], a[76:79], v[40:43], v[80:83]
v_cvt_pk_bf16_f32 v33, v74, v75
v_mfma_f32_16x16x32_bf16 v[84:87], a[28:31], a[36:39], v[84:87]
v_cvt_pk_bf16_f32 v36, v76, v77
v_mfma_f32_16x16x32_bf16 v[88:91], a[28:31], a[40:43], v[88:91]
v_cvt_pk_bf16_f32 v37, v78, v79
s_nop 2
v_cvt_pk_bf16_f32 v26, v80, v81
v_mfma_f32_16x16x32_bf16 v[84:87], a[76:79], v[44:47], v[84:87]
v_cvt_pk_bf16_f32 v27, v82, v83
v_mfma_f32_16x16x32_bf16 v[92:95], a[28:31], a[44:47], v[92:95]
ds_write_b128 v14, v[24:27] offset:0
v_mfma_f32_16x16x32_bf16 v[88:91], a[76:79], v[48:51], v[88:91]
s_nop 3
v_cvt_pk_bf16_f32 v30, v84, v85
v_mfma_f32_16x16x32_bf16 v[92:95], a[76:79], v[52:55], v[92:95]
v_cvt_pk_bf16_f32 v31, v86, v87
v_mfma_f32_16x16x32_bf16 v[96:99], a[4:7], a[32:35], v[96:99]
ds_write_b128 v14, v[28:31] offset:12288
v_cvt_pk_bf16_f32 v34, v88, v89
v_cvt_pk_bf16_f32 v35, v90, v91
v_mfma_f32_16x16x32_bf16 v[100:103], a[4:7], a[36:39], v[100:103]
s_nop 1
v_cvt_pk_bf16_f32 v38, v92, v93
v_cvt_pk_bf16_f32 v39, v94, v95
v_mfma_f32_16x16x32_bf16 v[96:99], a[80:83], v[40:43], v[96:99]
v_mfma_f32_16x16x32_bf16 v[104:107], a[4:7], a[40:43], v[104:107]
v_mfma_f32_16x16x32_bf16 v[100:103], a[80:83], v[44:47], v[100:103]
ds_write_b128 v14, v[32:35] offset:24576
s_nop 4
v_cvt_pk_bf16_f32 v24, v96, v97
v_mfma_f32_16x16x32_bf16 v[108:111], a[4:7], a[44:47], v[108:111]
v_cvt_pk_bf16_f32 v25, v98, v99
v_mfma_f32_16x16x32_bf16 v[104:107], a[80:83], v[48:51], v[104:107]
v_cvt_pk_bf16_f32 v28, v100, v101
v_mfma_f32_16x16x32_bf16 v[112:115], a[8:11], a[32:35], v[112:115]
v_cvt_pk_bf16_f32 v29, v102, v103
v_mfma_f32_16x16x32_bf16 v[108:111], a[80:83], v[52:55], v[108:111]
ds_write_b128 v14, v[36:39] offset:36864
s_nop 2
v_cvt_pk_bf16_f32 v32, v104, v105
v_mfma_f32_16x16x32_bf16 v[112:115], a[84:87], v[40:43], v[112:115]
v_cvt_pk_bf16_f32 v33, v106, v107
v_mfma_f32_16x16x32_bf16 v[116:119], a[8:11], a[36:39], v[116:119]
v_cvt_pk_bf16_f32 v36, v108, v109
v_mfma_f32_16x16x32_bf16 v[120:123], a[8:11], a[40:43], v[120:123]
v_cvt_pk_bf16_f32 v37, v110, v111
s_nop 2
v_cvt_pk_bf16_f32 v26, v112, v113
v_mfma_f32_16x16x32_bf16 v[116:119], a[84:87], v[44:47], v[116:119]
v_cvt_pk_bf16_f32 v27, v114, v115
v_mfma_f32_16x16x32_bf16 v[124:127], a[8:11], a[44:47], v[124:127]
v_mfma_f32_16x16x32_bf16 v[120:123], a[84:87], v[48:51], v[120:123]
s_nop 4
v_cvt_pk_bf16_f32 v30, v116, v117
v_mfma_f32_16x16x32_bf16 v[124:127], a[84:87], v[52:55], v[124:127]
v_cvt_pk_bf16_f32 v31, v118, v119
s_waitcnt vmcnt(0) lgkmcnt(0)
s_barrier
v_cvt_pk_bf16_f32 v34, v120, v121
v_cvt_pk_bf16_f32 v35, v122, v123
v_mfma_f32_16x16x32_bf16 v[128:131], a[12:15], a[32:35], v[128:131]
s_nop 1
v_cvt_pk_bf16_f32 v38, v124, v125
v_cvt_pk_bf16_f32 v39, v126, v127
v_mfma_f32_16x16x32_bf16 v[132:135], a[12:15], a[36:39], v[132:135]
ds_write_b128 v14, v[24:27] offset:1024
v_mfma_f32_16x16x32_bf16 v[128:131], a[88:91], v[40:43], v[128:131]
v_mfma_f32_16x16x32_bf16 v[136:139], a[12:15], a[40:43], v[136:139]
v_mfma_f32_16x16x32_bf16 v[132:135], a[88:91], v[44:47], v[132:135]
ds_write_b128 v14, v[28:31] offset:13312
v_mfma_f32_16x16x32_bf16 v[140:143], a[12:15], a[44:47], v[140:143]
s_nop 3
v_cvt_pk_bf16_f32 v24, v128, v129
v_cvt_pk_bf16_f32 v25, v130, v131
v_mfma_f32_16x16x32_bf16 v[136:139], a[88:91], v[48:51], v[136:139]
v_cvt_pk_bf16_f32 v28, v132, v133
v_mfma_f32_16x16x32_bf16 v[144:147], a[16:19], a[32:35], v[144:147]
v_cvt_pk_bf16_f32 v29, v134, v135
v_mfma_f32_16x16x32_bf16 v[140:143], a[88:91], v[52:55], v[140:143]
ds_write_b128 v14, v[32:35] offset:25600
v_mfma_f32_16x16x32_bf16 v[144:147], a[92:95], v[40:43], v[144:147]
s_nop 1
v_cvt_pk_bf16_f32 v32, v136, v137
v_cvt_pk_bf16_f32 v33, v138, v139
v_mfma_f32_16x16x32_bf16 v[148:151], a[16:19], a[36:39], v[148:151]
v_mfma_f32_16x16x32_bf16 v[152:155], a[16:19], a[40:43], v[152:155]
s_nop 1
v_cvt_pk_bf16_f32 v26, v144, v145
v_mfma_f32_16x16x32_bf16 v[148:151], a[92:95], v[44:47], v[148:151]
ds_write_b128 v14, v[36:39] offset:37888
v_cvt_pk_bf16_f32 v27, v146, v147
v_mfma_f32_16x16x32_bf16 v[156:159], a[16:19], a[44:47], v[156:159]
v_cvt_pk_bf16_f32 v36, v140, v141
v_cvt_pk_bf16_f32 v37, v142, v143
v_mfma_f32_16x16x32_bf16 v[152:155], a[92:95], v[48:51], v[152:155]
s_nop 1
v_cvt_pk_bf16_f32 v30, v148, v149
v_mfma_f32_16x16x32_bf16 v[156:159], a[92:95], v[52:55], v[156:159]
v_cvt_pk_bf16_f32 v31, v150, v151
s_nop 2
v_cvt_pk_bf16_f32 v34, v152, v153
v_cvt_pk_bf16_f32 v35, v154, v155
s_nop 1
v_cvt_pk_bf16_f32 v38, v156, v157
v_cvt_pk_bf16_f32 v39, v158, v159
s_waitcnt lgkmcnt(0)
s_barrier
ds_write_b128 v14, v[24:27] offset:2048
ds_write_b128 v14, v[28:31] offset:14336
ds_write_b128 v14, v[32:35] offset:26624
ds_write_b128 v14, v[36:39] offset:38912
s_waitcnt lgkmcnt(0)
s_barrier
s_branch T_red
J_Aa:
s_waitcnt lgkmcnt(0)
s_add_u32 s38, s38, 1
s_waitcnt vmcnt(16)
s_barrier
s_add_u32 s49, s24, 73728
s_add_u32 m0, s24, 122880
s_mul_i32 s50, s3, 12288
buffer_load_dwordx4 v36, s[20:23], s49 offen offset:0 lds
buffer_load_dwordx4 v37, s[20:23], s49 offen offset:1024 lds
buffer_load_dwordx4 v38, s[20:23], s49 offen offset:2048 lds
buffer_load_dwordx4 v39, s[20:23], s49 offen offset:3072 lds
s_add_u32 m0, s24, 126976
s_nop 0
buffer_load_dwordx4 v40, s[20:23], s49 offen offset:0 lds
buffer_load_dwordx4 v41, s[20:23], s49 offen offset:1024 lds
s_waitcnt vmcnt(16)
s_barrier
s_add_u32 s49, s24, 98304
s_add_u32 m0, s24, 49152
s_nop 0
buffer_load_dwordx4 v36, s[20:23], s49 offen offset:0 lds
buffer_load_dwordx4 v37, s[20:23], s49 offen offset:1024 lds
buffer_load_dwordx4 v38, s[20:23], s49 offen offset:2048 lds
buffer_load_dwordx4 v39, s[20:23], s49 offen offset:3072 lds
s_add_u32 m0, s24, 53248
s_nop 0
buffer_load_dwordx4 v40, s[20:23], s49 offen offset:0 lds
buffer_load_dwordx4 v41, s[20:23], s49 offen offset:1024 lds
s_waitcnt vmcnt(16)
s_barrier
s_add_u32 s49, s24, 122880
s_add_u32 m0, s24, 73728
s_nop 0
buffer_load_dwordx4 v36, s[20:23], s49 offen offset:0 lds
buffer_load_dwordx4 v37, s[20:23], s49 offen offset:1024 lds
buffer_load_dwordx4 v38, s[20:23], s49 offen offset:2048 lds
buffer_load_dwordx4 v39, s[20:23], s49 offen offset:3072 lds
s_add_u32 m0, s24, 77824
s_nop 0
buffer_load_dwordx4 v40, s[20:23], s49 offen offset:0 lds
buffer_load_dwordx4 v41, s[20:23], s49 offen offset:1024 lds
s_waitcnt vmcnt(12)
s_barrier
s_add_u32 s49, s24, 147456
s_add_u32 m0, s24, 98304
s_nop 0
buffer_load_dwordx4 v36, s[20:23], s49 offen offset:0 lds
buffer_load_dwordx4 v37, s[20:23], s49 offen offset:1024 lds
buffer_load_dwordx4 v38, s[20:23], s49 offen offset:2048 lds
buffer_load_dwordx4 v39, s[20:23], s49 offen offset:3072 lds
s_add_u32 m0, s24, 102400
s_nop 0
buffer_load_dwordx4 v40, s[20:23], s49 offen offset:0 lds
buffer_load_dwordx4 v41, s[20:23], s49 offen offset:1024 lds
s_add_u32 s49, s25, 512
s_add_u32 m0, s45, 32768
s_nop 0
buffer_load_dwordx4 v32, s[16:19], s49 offen offset:0 nt lds
buffer_load_dwordx4 v33, s[16:19], s49 offen offset:1024 nt lds
buffer_load_dwordx4 v34, s[16:19], s49 offen offset:2048 nt lds
buffer_load_dwordx4 v35, s[16:19], s49 offen offset:3072 nt lds
s_waitcnt vmcnt(16)
s_barrier
s_add_u32 s49, s24, 172032
s_add_u32 m0, s24, 122880
s_nop 0
buffer_load_dwordx4 v36, s[20:23], s49 offen offset:0 lds
buffer_load_dwordx4 v37, s[20:23], s49 offen offset:1024 lds
buffer_load_dwordx4 v38, s[20:23], s49 offen offset:2048 lds
buffer_load_dwordx4 v39, s[20:23], s49 offen offset:3072 lds
s_add_u32 m0, s24, 126976
s_nop 0
buffer_load_dwordx4 v40, s[20:23], s49 offen offset:0 lds
buffer_load_dwordx4 v41, s[20:23], s49 offen offset:1024 lds
s_waitcnt vmcnt(16)
s_barrier
s_add_u32 s49, s24, 196608
s_add_u32 m0, s24, 49152
s_nop 0
buffer_load_dwordx4 v36, s[20:23], s49 offen offset:0 lds
buffer_load_dwordx4 v37, s[20:23], s49 offen offset:1024 lds
buffer_load_dwordx4 v38, s[20:23], s49 offen offset:2048 lds
buffer_load_dwordx4 v39, s[20:23], s49 offen offset:3072 lds
s_add_u32 m0, s24, 53248
s_nop 0
buffer_load_dwordx4 v40, s[20:23], s49 offen offset:0 lds
buffer_load_dwordx4 v41, s[20:23], s49 offen offset:1024 lds
s_waitcnt vmcnt(16)
s_barrier
s_add_u32 s49, s24, 221184
s_add_u32 m0, s24, 73728
s_nop 0
buffer_load_dwordx4 v36, s[20:23], s49 offen offset:0 lds
buffer_load_dwordx4 v37, s[20:23], s49 offen offset:1024 lds
buffer_load_dwordx4 v38, s[20:23], s49 offen offset:2048 lds
buffer_load_dwordx4 v39, s[20:23], s49 offen offset:3072 lds
s_add_u32 m0, s24, 77824
s_nop 0
buffer_load_dwordx4 v40, s[20:23], s49 offen offset:0 lds
buffer_load_dwordx4 v41, s[20:23], s49 offen offset:1024 lds
s_waitcnt vmcnt(12)
s_barrier
s_add_u32 s49, s24, 245760
s_add_u32 m0, s24, 98304
s_nop 0
buffer_load_dwordx4 v36, s[20:23], s49 offen offset:0 lds
buffer_load_dwordx4 v37, s[20:23], s49 offen offset:1024 lds
buffer_load_dwordx4 v38, s[20:23], s49 offen offset:2048 lds
buffer_load_dwordx4 v39, s[20:23], s49 offen offset:3072 lds
s_add_u32 m0, s24, 102400
s_nop 0
buffer_load_dwordx4 v40, s[20:23], s49 offen offset:0 lds
buffer_load_dwordx4 v41, s[20:23], s49 offen offset:1024 lds
s_waitcnt vmcnt(12)
s_barrier
s_add_u32 s49, s24, 270336
s_add_u32 m0, s24, 122880
s_nop 0
buffer_load_dwordx4 v36, s[20:23], s49 offen offset:0 lds
buffer_load_dwordx4 v37, s[20:23], s49 offen offset:1024 lds
buffer_load_dwordx4 v38, s[20:23], s49 offen offset:2048 lds
buffer_load_dwordx4 v39, s[20:23], s49 offen offset:3072 lds
s_add_u32 m0, s24, 126976
s_nop 0
buffer_load_dwordx4 v40, s[20:23], s49 offen offset:0 lds
buffer_load_dwordx4 v41, s[20:23], s49 offen offset:1024 lds
s_add_u32 s49, s26, 0
s_add_u32 m0, s24, 49152
buffer_load_dword v19, v14, s[28:31], 0 offen sc1
s_waitcnt vmcnt(13)
s_barrier
buffer_load_dwordx4 v2, s[12:15], s49 offen offset:0 nt lds
buffer_load_dwordx4 v3, s[12:15], s49 offen offset:1024 nt lds
buffer_load_dwordx4 v4, s[12:15], s49 offen offset:2048 nt lds
buffer_load_dwordx4 v5, s[12:15], s49 offen offset:3072 nt lds
s_add_u32 m0, s24, 53248
s_nop 0
buffer_load_dwordx4 v6, s[12:15], s49 offen offset:0 nt lds
buffer_load_dwordx4 v7, s[12:15], s49 offen offset:1024 nt lds
s_waitcnt vmcnt(13)
s_barrier
s_waitcnt vmcnt(6)
v_cmp_ne_u32 vcc, s38, v19
s_nop 0
s_cbranch_vccnz POLLa
C_POLLa:
s_xor_b32 s51, s3, 0
s_lshl_b32 s51, s51, 10
s_add_u32 s51, s51, s50
buffer_load_dwordx4 a[0:3], v1, s[28:31], s51 offen sc1
s_add_u32 s51, s51, 4096
v_and_b32 v19, 4, v0
v_lshlrev_b32 v19, 1, v19
v_sub_u32 v19, v12, v19
v_add_u32 v19, 10752, v19
buffer_load_dwordx4 a[4:7], v1, s[28:31], s51 offen sc1
s_add_u32 s51, s51, 4096
buffer_load_dwordx4 a[8:11], v1, s[28:31], s51 offen sc1
s_xor_b32 s51, s3, 1
s_lshl_b32 s51, s51, 10
s_add_u32 s51, s51, s50
s_mul_i32 s50, s3, 12288
buffer_load_dwordx4 a[12:15], v1, s[28:31], s51 offen sc1
s_add_u32 s51, s51, 4096
buffer_load_dwordx4 a[16:19], v1, s[28:31], s51 offen sc1
s_add_u32 s51, s51, 4096
buffer_load_dwordx4 a[20:23], v1, s[28:31], s51 offen sc1
s_barrier
s_barrier
s_xor_b32 s51, s3, 2
s_lshl_b32 s51, s51, 10
s_add_u32 s51, s51, s50
s_mov_b32 s16, s10
s_mov_b32 s17, s11
buffer_load_dwordx4 a[24:27], v1, s[28:31], s51 offen sc1
s_add_u32 s51, s51, 4096
s_mov_b32 s18, 294912
buffer_load_dwordx4 a[28:31], v1, s[28:31], s51 offen sc1
s_add_u32 s51, s51, 4096
buffer_load_dwordx4 a[32:35], v1, s[28:31], s51 offen sc1
s_xor_b32 s51, s3, 3
s_lshl_b32 s51, s51, 10
s_add_u32 s51, s51, s50
s_mov_b32 s50, 0x3f803f80
v_mov_b32 v60, s50
v_mov_b32 v61, s50
v_mov_b32 v62, s50
v_mov_b32 v63, s50
s_mul_i32 s50, s3, 12288
buffer_load_dwordx4 a[36:39], v1, s[28:31], s51 offen sc1
s_add_u32 s51, s51, 4096
buffer_load_dwordx4 a[40:43], v1, s[28:31], s51 offen sc1
s_add_u32 s51, s51, 4096
s_add_u32 s49, s26, 196608
s_add_u32 m0, s24, 73728
s_waitcnt vmcnt(10)
v_mfma_f32_16x16x32_bf16 v[64:67], v[60:63], a[0:3], 0
buffer_load_dwordx4 a[44:47], v1, s[28:31], s51 offen sc1
s_waitcnt vmcnt(10)
v_mfma_f32_16x16x32_bf16 v[64:67], v[60:63], a[4:7], v[64:67]
buffer_load_dwordx4 v2, s[12:15], s49 offen offset:0 nt lds
s_waitcnt vmcnt(10)
v_mfma_f32_16x16x32_bf16 v[64:67], v[60:63], a[8:11], v[64:67]
buffer_load_dwordx4 v3, s[12:15], s49 offen offset:1024 nt lds
s_waitcnt vmcnt(10)
v_mfma_f32_16x16x32_bf16 v[64:67], v[60:63], a[12:15], v[64:67]
buffer_load_dwordx4 v4, s[12:15], s49 offen offset:2048 nt lds
s_waitcnt vmcnt(10)
v_mfma_f32_16x16x32_bf16 v[64:67], v[60:63], a[16:19], v[64:67]
buffer_load_dwordx4 v5, s[12:15], s49 offen offset:3072 nt lds
s_add_u32 m0, s24, 77824
s_waitcnt vmcnt(10)
v_mfma_f32_16x16x32_bf16 v[64:67], v[60:63], a[20:23], v[64:67]
buffer_load_dwordx4 v6, s[12:15], s49 offen offset:0 nt lds
s_waitcnt vmcnt(10)
v_mfma_f32_16x16x32_bf16 v[64:67], v[60:63], a[24:27], v[64:67]
buffer_load_dwordx4 v7, s[12:15], s49 offen offset:1024 nt lds
s_barrier
s_add_u32 s49, s26, 24576
s_add_u32 m0, s24, 98304
ds_read_b128 a[48:51], v8 offset:0
ds_read_b128 a[52:55], v8 offset:256
s_waitcnt vmcnt(10)
v_mfma_f32_16x16x32_bf16 v[64:67], v[60:63], a[28:31], v[64:67]
buffer_load_dwordx4 v2, s[12:15], s49 offen offset:0 nt lds
ds_read_b128 a[56:59], v8 offset:512
ds_read_b128 a[60:63], v9 offset:0
ds_read_b128 a[64:67], v9 offset:256
s_waitcnt lgkmcnt(4)
v_mfma_f32_16x16x32_bf16 v[52:55], a[48:51], a[0:3], 0
s_waitcnt lgkmcnt(3)
ds_read_b128 a[48:51], v9 offset:512
buffer_load_dwordx4 v3, s[12:15], s49 offen offset:1024 nt lds
v_mfma_f32_16x16x32_bf16 v[52:55], a[52:55], a[4:7], v[52:55]
ds_read_b128 a[52:55], v10 offset:0
s_waitcnt vmcnt(11)
v_mfma_f32_16x16x32_bf16 v[64:67], v[60:63], a[32:35], v[64:67]
s_waitcnt lgkmcnt(2)
v_mfma_f32_16x16x32_bf16 v[52:55], a[56:59], a[8:11], v[52:55]
ds_read_b128 a[56:59], v10 offset:256
v_mfma_f32_16x16x32_bf16 v[52:55], a[60:63], a[12:15], v[52:55]
ds_read_b128 a[60:63], v10 offset:512
buffer_load_dwordx4 v4, s[12:15], s49 offen offset:2048 nt lds
v_mfma_f32_16x16x32_bf16 v[52:55], a[64:67], a[16:19], v[52:55]
s_waitcnt lgkmcnt(3)
ds_read_b128 a[64:67], v11 offset:0
v_mfma_f32_16x16x32_bf16 v[52:55], a[48:51], a[20:23], v[52:55]
s_waitcnt lgkmcnt(3)
ds_read_b128 a[48:51], v11 offset:256
v_mfma_f32_16x16x32_bf16 v[52:55], a[52:55], a[24:27], v[52:55]
ds_read_b128 a[52:55], v11 offset:512
s_waitcnt lgkmcnt(4)
v_mfma_f32_16x16x32_bf16 v[52:55], a[56:59], a[28:31], v[52:55]
s_waitcnt lgkmcnt(3)
ds_read_b128 a[56:59], v8 offset:12288
buffer_load_dwordx4 v5, s[12:15], s49 offen offset:3072 nt lds
v_mfma_f32_16x16x32_bf16 v[52:55], a[60:63], a[32:35], v[52:55]
s_add_u32 m0, s24, 102400
ds_read_b128 a[60:63], v8 offset:12544
s_waitcnt vmcnt(12)
v_mfma_f32_16x16x32_bf16 v[64:67], v[60:63], a[36:39], v[64:67]
s_waitcnt lgkmcnt(3)
v_mfma_f32_16x16x32_bf16 v[52:55], a[64:67], a[36:39], v[52:55]
ds_read_b128 a[64:67], v8 offset:12800
v_add_u32 v8, 0xc000, v8
s_waitcnt vmcnt(11)
v_mfma_f32_16x16x32_bf16 v[52:55], a[48:51], a[40:43], v[52:55]
ds_read_b128 a[48:51], v9 offset:12288
buffer_load_dwordx4 v6, s[12:15], s49 offen offset:0 nt lds
s_waitcnt vmcnt(11) lgkmcnt(4)
v_mfma_f32_16x16x32_bf16 v[52:55], a[52:55], a[44:47], v[52:55]
s_waitcnt lgkmcnt(3)
ds_read_b128 a[52:55], v9 offset:12544
v_mfma_f32_16x16x32_bf16 v[56:59], a[56:59], a[0:3], 0
s_waitcnt lgkmcnt(3)
ds_read_b128 a[56:59], v9 offset:12800
v_add_u32 v9, 0xc000, v9
v_mfma_f32_16x16x32_bf16 v[56:59], a[60:63], a[4:7], v[56:59]
s_waitcnt lgkmcnt(3)
ds_read_b128 a[60:63], v10 offset:12288
v_mfma_f32_16x16x32_bf16 v[56:59], a[64:67], a[8:11], v[56:59]
ds_read_b128 a[64:67], v10 offset:12544
buffer_load_dwordx4 v7, s[12:15], s49 offen offset:1024 nt lds
s_waitcnt lgkmcnt(4)
v_mfma_f32_16x16x32_bf16 v[56:59], a[48:51], a[12:15], v[56:59]
s_waitcnt lgkmcnt(3)
ds_read_b128 a[48:51], v10 offset:12800
v_add_u32 v10, 0xc000, v10
v_mfma_f32_16x16x32_bf16 v[56:59], a[52:55], a[16:19], v[56:59]
ds_read_b128 a[52:55], v11 offset:12288
v_mfma_f32_16x16x32_bf16 v[64:67], v[60:63], a[40:43], v[64:67]
s_waitcnt lgkmcnt(4)
v_mfma_f32_16x16x32_bf16 v[56:59], a[56:59], a[20:23], v[56:59]
s_waitcnt lgkmcnt(3)
ds_read_b128 a[56:59], v11 offset:12544
v_mfma_f32_16x16x32_bf16 v[56:59], a[60:63], a[24:27], v[56:59]
s_waitcnt lgkmcnt(3)
ds_read_b128 a[60:63], v11 offset:12800
v_add_u32 v11, 0xc000, v11
v_mfma_f32_16x16x32_bf16 v[56:59], a[64:67], a[28:31], v[56:59]
s_waitcnt lgkmcnt(3)
ds_read_b128 a[64:67], v8 offset:0
v_mfma_f32_16x16x32_bf16 v[56:59], a[48:51], a[32:35], v[56:59]
s_waitcnt lgkmcnt(3)
ds_read_b128 a[48:51], v8 offset:12288
v_mfma_f32_16x16x32_bf16 v[56:59], a[52:55], a[36:39], v[56:59]
ds_read_b128 a[52:55], v8 offset:256
s_waitcnt lgkmcnt(4)
v_mfma_f32_16x16x32_bf16 v[56:59], a[56:59], a[40:43], v[56:59]
ds_read_b128 a[56:59], v8 offset:12544
v_mfma_f32_16x16x32_bf16 v[64:67], v[60:63], a[44:47], v[64:67]
s_waitcnt lgkmcnt(4)
v_mfma_f32_16x16x32_bf16 v[56:59], a[60:63], a[44:47], v[56:59]
s_waitcnt lgkmcnt(3)
ds_read_b128 a[60:63], v8 offset:512
v_mfma_f32_16x16x32_bf16 v[36:39], a[64:67], a[0:3], v[52:55]
s_waitcnt lgkmcnt(3)
ds_read_b128 a[64:67], v8 offset:12800
s_nop 0
v_sub_f32 v17, 0, v64
v_mfma_f32_16x16x32_bf16 v[40:43], a[48:51], a[0:3], v[52:55]
s_waitcnt lgkmcnt(3)
ds_read_b128 a[48:51], v9 offset:0
v_mfma_f32_16x16x32_bf16 v[36:39], a[52:55], a[4:7], v[36:39]
s_waitcnt lgkmcnt(3)
ds_read_b128 a[52:55], v9 offset:12288
v_mfma_f32_16x16x32_bf16 v[40:43], a[56:59], a[4:7], v[40:43]
ds_read_b128 a[56:59], v9 offset:256
s_waitcnt lgkmcnt(4)
v_mfma_f32_16x16x32_bf16 v[36:39], a[60:63], a[8:11], v[36:39]
s_waitcnt lgkmcnt(3)
ds_read_b128 a[60:63], v9 offset:12544
v_mfma_f32_16x16x32_bf16 v[40:43], a[64:67], a[8:11], v[40:43]
s_waitcnt lgkmcnt(3)
ds_read_b128 a[64:67], v9 offset:512
v_mfma_f32_16x16x32_bf16 v[36:39], a[48:51], a[12:15], v[36:39]
s_waitcnt lgkmcnt(3)
ds_read_b128 a[48:51], v9 offset:12800
v_mfma_f32_16x16x32_bf16 v[40:43], a[52:55], a[12:15], v[40:43]
s_waitcnt lgkmcnt(3)
ds_read_b128 a[52:55], v10 offset:0
v_mfma_f32_16x16x32_bf16 v[36:39], a[56:59], a[16:19], v[36:39]
ds_read_b128 a[56:59], v10 offset:12288
s_waitcnt lgkmcnt(4)
v_mfma_f32_16x16x32_bf16 v[40:43], a[60:63], a[16:19], v[40:43]
s_waitcnt lgkmcnt(3)
ds_read_b128 a[60:63], v10 offset:256
v_mfma_f32_16x16x32_bf16 v[36:39], a[64:67], a[20:23], v[36:39]
s_waitcnt lgkmcnt(3)
ds_read_b128 a[64:67], v10 offset:12544
v_mfma_f32_16x16x32_bf16 v[40:43], a[48:51], a[20:23], v[40:43]
s_waitcnt lgkmcnt(3)
ds_read_b128 a[48:51], v10 offset:512
v_mfma_f32_16x16x32_bf16 v[36:39], a[52:55], a[24:27], v[36:39]
s_waitcnt lgkmcnt(3)
ds_read_b128 a[52:55], v10 offset:12800
v_mfma_f32_16x16x32_bf16 v[40:43], a[56:59], a[24:27], v[40:43]
ds_read_b128 a[56:59], v11 offset:0
s_waitcnt lgkmcnt(4)
v_mfma_f32_16x16x32_bf16 v[36:39], a[60:63], a[28:31], v[36:39]
s_waitcnt lgkmcnt(3)
ds_read_b128 a[60:63], v11 offset:12288
v_mfma_f32_16x16x32_bf16 v[40:43], a[64:67], a[28:31], v[40:43]
s_waitcnt lgkmcnt(3)
ds_read_b128 a[64:67], v11 offset:256
v_mfma_f32_16x16x32_bf16 v[36:39], a[48:51], a[32:35], v[36:39]
s_waitcnt lgkmcnt(3)
ds_read_b128 a[48:51], v11 offset:12544
v_mfma_f32_16x16x32_bf16 v[40:43], a[52:55], a[32:35], v[40:43]
s_waitcnt lgkmcnt(3)
ds_read_b128 a[52:55], v11 offset:512
v_mfma_f32_16x16x32_bf16 v[36:39], a[56:59], a[36:39], v[36:39]
ds_read_b128 a[56:59], v11 offset:12800
s_waitcnt lgkmcnt(4)
v_mfma_f32_16x16x32_bf16 v[40:43], a[60:63], a[36:39], v[40:43]
s_waitcnt lgkmcnt(3)
v_mfma_f32_16x16x32_bf16 v[36:39], a[64:67], a[40:43], v[36:39]
s_waitcnt lgkmcnt(2)
v_mfma_f32_16x16x32_bf16 v[40:43], a[48:51], a[40:43], v[40:43]
s_waitcnt vmcnt(6) lgkmcnt(0)
s_barrier
ds_read_b128 a[60:63], v8 offset:24576
v_mfma_f32_16x16x32_bf16 v[36:39], a[52:55], a[44:47], v[36:39]
ds_read2_b64 v[76:79], v19 offset0:0 offset1:2
v_mfma_f32_16x16x32_bf16 v[40:43], a[56:59], a[44:47], v[40:43]
ds_read2_b64 v[80:83], v19 offset0:4 offset1:6
s_waitcnt lgkmcnt(2)
v_mfma_f32_16x16x32_bf16 v[44:47], a[60:63], a[0:3], v[52:55]
s_waitcnt lgkmcnt(1)
ds_read_b128 a[64:67], v8 offset:36864
ds_read2_b64 v[28:31], v12 offset0:0 offset1:2
v_add_f32 v76, v76, v78
v_add_f32 v77, v77, v79
ds_read_b128 a[48:51], v8 offset:24832
s_waitcnt lgkmcnt(3)
v_add_f32 v80, v80, v82
v_add_f32 v81, v81, v83
v_add_f32 v20, v76, v80
v_add_f32 v21, v77, v81
s_waitcnt lgkmcnt(2)
v_mfma_f32_16x16x32_bf16 v[48:51], a[64:67], a[0:3], v[52:55]
s_waitcnt lgkmcnt(1)
ds_read2_b64 v[32:35], v12 offset0:4 offset1:6
ds_read_b128 a[52:55], v8 offset:37120
v_add_f32 v28, v28, v30
v_add_f32 v29, v29, v31
v_add_f32 v28, v28, v20
v_add_f32 v29, v29, v21
s_waitcnt lgkmcnt(2)
v_mfma_f32_16x16x32_bf16 v[44:47], a[48:51], a[4:7], v[44:47]
ds_read_b128 a[56:59], v8 offset:25088
ds_read_b128 a[60:63], v8 offset:37376
v_add_u32 v8, 0xffff4000, v8
ds_read_b128 a[64:67], v9 offset:24576
s_waitcnt lgkmcnt(4)
v_add_f32 v32, v32, v34
v_add_f32 v33, v33, v35
v_add_f32 v28, v28, v32
v_add_f32 v29, v29, v33
s_waitcnt lgkmcnt(3)
v_mfma_f32_16x16x32_bf16 v[48:51], a[52:55], a[4:7], v[48:51]
s_waitcnt lgkmcnt(2)
ds_read_b128 a[48:51], v9 offset:36864
v_mul_f32 v29, s53, v29
v_mul_f32 v28, s53, v28
v_fma_f32 v28, -v29, v29, v28
v_max_f32 v28, 0, v28
v_mfma_f32_16x16x32_bf16 v[44:47], a[56:59], a[8:11], v[44:47]
ds_read_b128 a[52:55], v9 offset:24832
v_add_f32 v28, s54, v28
v_rsq_f32 v28, v28
v_fmac_f32_dpp v36, v29, v17 row_newbcast:0 row_mask:0xf bank_mask:0xf
v_fmac_f32_dpp v37, v29, v17 row_newbcast:1 row_mask:0xf bank_mask:0xf
v_fmac_f32_dpp v38, v29, v17 row_newbcast:2 row_mask:0xf bank_mask:0xf
s_waitcnt lgkmcnt(2)
v_mfma_f32_16x16x32_bf16 v[48:51], a[60:63], a[8:11], v[48:51]
ds_read_b128 a[56:59], v9 offset:37120
v_fmac_f32_dpp v39, v29, v17 row_newbcast:3 row_mask:0xf bank_mask:0xf
v_fmac_f32_dpp v40, v29, v17 row_newbcast:4 row_mask:0xf bank_mask:0xf
v_fmac_f32_dpp v41, v29, v17 row_newbcast:5 row_mask:0xf bank_mask:0xf
v_fmac_f32_dpp v42, v29, v17 row_newbcast:6 row_mask:0xf bank_mask:0xf
v_fmac_f32_dpp v43, v29, v17 row_newbcast:7 row_mask:0xf bank_mask:0xf
v_mfma_f32_16x16x32_bf16 v[44:47], a[64:67], a[12:15], v[44:47]
ds_read_b128 a[60:63], v9 offset:25088
v_mov_b32_dpp v84, v28 row_newbcast:0 row_mask:0xf bank_mask:0xf
v_mov_b32_dpp v85, v28 row_newbcast:1 row_mask:0xf bank_mask:0xf
v_mov_b32_dpp v86, v28 row_newbcast:2 row_mask:0xf bank_mask:0xf
v_mov_b32_dpp v87, v28 row_newbcast:3 row_mask:0xf bank_mask:0xf
v_mov_b32_dpp v88, v28 row_newbcast:4 row_mask:0xf bank_mask:0xf
s_waitcnt lgkmcnt(3)
v_mfma_f32_16x16x32_bf16 v[48:51], a[48:51], a[12:15], v[48:51]
ds_read_b128 a[64:67], v9 offset:37376
v_mov_b32_dpp v89, v28 row_newbcast:5 row_mask:0xf bank_mask:0xf
v_mov_b32_dpp v90, v28 row_newbcast:6 row_mask:0xf bank_mask:0xf
v_mov_b32_dpp v91, v28 row_newbcast:7 row_mask:0xf bank_mask:0xf
v_mul_f32 v36, v36, v84
v_mul_f32 v37, v37, v85
s_waitcnt lgkmcnt(3)
v_mfma_f32_16x16x32_bf16 v[44:47], a[52:55], a[16:19], v[44:47]
s_waitcnt lgkmcnt(2)
ds_read_b128 a[48:51], v10 offset:24576
v_mul_f32 v38, v38, v86
v_mul_f32 v39, v39, v87
v_mul_f32 v40, v40, v88
v_mul_f32 v41, v41, v89
v_mul_f32 v42, v42, v90
v_mfma_f32_16x16x32_bf16 v[48:51], a[56:59], a[16:19], v[48:51]
s_waitcnt lgkmcnt(2)
ds_read_b128 a[52:55], v10 offset:36864
v_mul_f32 v43, v43, v91
v_max3_f32 v30, v36, v37, v38
v_max3_f32 v31, v39, v40, v41
v_max3_f32 v30, v30, v42, v43
v_max_f32 v30, v30, v31
v_mfma_f32_16x16x32_bf16 v[44:47], a[60:63], a[20:23], v[44:47]
s_waitcnt lgkmcnt(2)
ds_read_b128 a[56:59], v10 offset:24832
v_mov_b32 v31, v30
v_mfma_f32_16x16x32_bf16 v[48:51], a[64:67], a[20:23], v[48:51]
ds_read_b128 a[60:63], v10 offset:37120
v_permlane32_swap_b32 v30, v31
v_max_f32 v30, v30, v31
v_mov_b32 v31, v30
s_waitcnt lgkmcnt(3)
v_mfma_f32_16x16x32_bf16 v[44:47], a[48:51], a[24:27], v[44:47]
ds_read_b128 a[64:67], v10 offset:25088
v_permlane16_swap_b32 v30, v31
v_max_f32 v30, v30, v31
v_sub_f32 v36, v36, v30
v_sub_f32 v37, v37, v30
v_sub_f32 v38, v38, v30
v_sub_f32 v39, v39, v30
v_sub_f32 v40, v40, v30
v_sub_f32 v41, v41, v30
v_sub_f32 v42, v42, v30
v_sub_f32 v43, v43, v30
v_sub_f32 v15, 0, v30
s_waitcnt lgkmcnt(2)
v_mfma_f32_16x16x32_bf16 v[48:51], a[52:55], a[24:27], v[48:51]
ds_read_b128 a[48:51], v10 offset:37376
v_exp_f32 v76, v36
v_exp_f32 v77, v37
v_exp_f32 v78, v38
v_exp_f32 v79, v39
v_mfma_f32_16x16x32_bf16 v[44:47], a[56:59], a[28:31], v[44:47]
s_waitcnt lgkmcnt(1)
ds_read_b128 a[52:55], v11 offset:24576
v_exp_f32 v80, v40
v_exp_f32 v81, v41
v_exp_f32 v82, v42
v_exp_f32 v83, v43
v_add_f32 v32, v76, v77
v_mfma_f32_16x16x32_bf16 v[48:51], a[60:63], a[28:31], v[48:51]
ds_read_b128 a[56:59], v11 offset:36864
v_add_f32 v33, v78, v79
v_add_f32 v34, v80, v81
v_add_f32 v35, v82, v83
v_add_f32 v32, v32, v33
v_add_f32 v34, v34, v35
v_mfma_f32_16x16x32_bf16 v[44:47], a[64:67], a[32:35], v[44:47]
s_waitcnt lgkmcnt(2)
ds_read_b128 a[60:63], v11 offset:24832
v_add_f32 v32, v32, v34
v_add_f32 v16, v16, v32
v_mul_f32 v84, v76, v84
v_mul_f32 v85, v77, v85
v_mul_f32 v86, v78, v86
v_mfma_f32_16x16x32_bf16 v[48:51], a[48:51], a[32:35], v[48:51]
s_waitcnt lgkmcnt(2)
ds_read_b128 a[64:67], v11 offset:37120
v_mul_f32 v87, v79, v87
v_mul_f32 v88, v80, v88
v_mul_f32 v89, v81, v89
v_mul_f32 v90, v82, v90
v_mul_f32 v91, v83, v91
v_mfma_f32_16x16x32_bf16 v[44:47], a[52:55], a[36:39], v[44:47]
s_waitcnt lgkmcnt(2)
ds_read_b128 a[48:51], v11 offset:25088
v_cvt_pk_bf16_f32 v60, v84, v85
v_cvt_pk_bf16_f32 v61, v86, v87
v_cvt_pk_bf16_f32 v62, v88, v89
v_cvt_pk_bf16_f32 v63, v90, v91
v_mfma_f32_16x16x32_bf16 v[48:51], a[56:59], a[36:39], v[48:51]
s_waitcnt lgkmcnt(2)
ds_write_b128 v13, v[60:63] offset:0
v_add_f32 v68, v84, v88
v_add_f32 v69, v85, v89
v_add_f32 v70, v86, v90
v_add_f32 v71, v87, v91
v_mfma_f32_16x16x32_bf16 v[44:47], a[60:63], a[40:43], v[44:47]
s_waitcnt lgkmcnt(2)
v_add_u32 v9, 0xffff4000, v9
v_add_u32 v10, 0xffff4000, v10
v_mfma_f32_16x16x32_bf16 v[48:51], a[64:67], a[40:43], v[48:51]
ds_read_b128 a[52:55], v11 offset:37376
v_add_u32 v11, 0xffff4000, v11
s_waitcnt vmcnt(0) lgkmcnt(0)
s_barrier
ds_read2_b64 v[28:31], v12 offset0:160 offset1:162
v_mfma_f32_16x16x32_bf16 v[44:47], a[48:51], a[44:47], v[44:47]
v_mfma_f32_16x16x32_bf16 v[48:51], a[52:55], a[44:47], v[48:51]
ds_read2_b64 v[32:35], v12 offset0:164 offset1:166
ds_read_b128 a[56:59], v8 offset:24576
ds_read_b128 a[60:63], v8 offset:24832
s_waitcnt lgkmcnt(3)
v_add_f32 v28, v28, v30
v_add_f32 v29, v29, v31
v_add_f32 v28, v28, v20
v_add_f32 v29, v29, v21
ds_read_b128 a[64:67], v8 offset:25088
v_add_u32 v8, 0x18000, v8
s_waitcnt lgkmcnt(3)
v_add_f32 v32, v32, v34
v_add_f32 v33, v33, v35
v_add_f32 v28, v28, v32
v_add_f32 v29, v29, v33
s_waitcnt lgkmcnt(1)
v_mfma_f32_16x16x32_bf16 v[52:55], a[56:59], a[0:3], 0
ds_read_b128 a[48:51], v9 offset:24576
v_mul_f32 v29, s53, v29
v_mul_f32 v28, s53, v28
v_fma_f32 v28, -v29, v29, v28
v_mfma_f32_16x16x32_bf16 v[52:55], a[60:63], a[4:7], v[52:55]
ds_read_b128 a[52:55], v9 offset:24832
v_max_f32 v28, 0, v28
v_add_f32 v28, s54, v28
s_waitcnt lgkmcnt(2)
v_mfma_f32_16x16x32_bf16 v[52:55], a[64:67], a[8:11], v[52:55]
ds_read_b128 a[56:59], v9 offset:25088
v_rsq_f32 v28, v28
v_fmac_f32_dpp v44, v29, v17 row_newbcast:0 row_mask:0xf bank_mask:0xf
v_fmac_f32_dpp v45, v29, v17 row_newbcast:1 row_mask:0xf bank_mask:0xf
v_fmac_f32_dpp v46, v29, v17 row_newbcast:2 row_mask:0xf bank_mask:0xf
v_fmac_f32_dpp v47, v29, v17 row_newbcast:3 row_mask:0xf bank_mask:0xf
s_waitcnt lgkmcnt(2)
v_mfma_f32_16x16x32_bf16 v[52:55], a[48:51], a[12:15], v[52:55]
ds_read_b128 a[60:63], v10 offset:24576
v_fmac_f32_dpp v48, v29, v17 row_newbcast:4 row_mask:0xf bank_mask:0xf
v_fmac_f32_dpp v49, v29, v17 row_newbcast:5 row_mask:0xf bank_mask:0xf
v_fmac_f32_dpp v50, v29, v17 row_newbcast:6 row_mask:0xf bank_mask:0xf
s_waitcnt lgkmcnt(2)
v_mfma_f32_16x16x32_bf16 v[52:55], a[52:55], a[16:19], v[52:55]
ds_read_b128 a[64:67], v10 offset:24832
v_fmac_f32_dpp v51, v29, v17 row_newbcast:7 row_mask:0xf bank_mask:0xf
v_mov_b32_dpp v84, v28 row_newbcast:0 row_mask:0xf bank_mask:0xf
s_waitcnt lgkmcnt(2)
v_mfma_f32_16x16x32_bf16 v[52:55], a[56:59], a[20:23], v[52:55]
ds_read_b128 a[48:51], v10 offset:25088
v_mov_b32_dpp v85, v28 row_newbcast:1 row_mask:0xf bank_mask:0xf
v_mov_b32_dpp v86, v28 row_newbcast:2 row_mask:0xf bank_mask:0xf
v_mov_b32_dpp v87, v28 row_newbcast:3 row_mask:0xf bank_mask:0xf
v_mov_b32_dpp v88, v28 row_newbcast:4 row_mask:0xf bank_mask:0xf
v_mov_b32_dpp v89, v28 row_newbcast:5 row_mask:0xf bank_mask:0xf
v_mov_b32_dpp v90, v28 row_newbcast:6 row_mask:0xf bank_mask:0xf
s_waitcnt lgkmcnt(2)
v_mfma_f32_16x16x32_bf16 v[52:55], a[60:63], a[24:27], v[52:55]
ds_read_b128 a[52:55], v11 offset:24576
v_mov_b32_dpp v91, v28 row_newbcast:7 row_mask:0xf bank_mask:0xf
v_fma_f32 v44, v44, v84, v15
v_fma_f32 v45, v45, v85, v15
s_waitcnt lgkmcnt(2)
v_mfma_f32_16x16x32_bf16 v[52:55], a[64:67], a[28:31], v[52:55]
ds_read_b128 a[56:59], v11 offset:24832
v_fma_f32 v46, v46, v86, v15
v_fma_f32 v47, v47, v87, v15
s_waitcnt lgkmcnt(2)
v_mfma_f32_16x16x32_bf16 v[52:55], a[48:51], a[32:35], v[52:55]
s_waitcnt lgkmcnt(1)
ds_read_b128 a[60:63], v11 offset:25088
v_fma_f32 v48, v48, v88, v15
v_fma_f32 v49, v49, v89, v15
v_fma_f32 v50, v50, v90, v15
v_fma_f32 v51, v51, v91, v15
v_exp_f32 v76, v44
v_mfma_f32_16x16x32_bf16 v[52:55], a[52:55], a[36:39], v[52:55]
s_waitcnt lgkmcnt(1)
ds_read_b128 a[64:67], v8 offset:0
v_exp_f32 v77, v45
v_add_u32 v9, 0x18000, v9
v_mfma_f32_16x16x32_bf16 v[52:55], a[56:59], a[40:43], v[52:55]
ds_read_b128 a[48:51], v8 offset:12288
v_exp_f32 v78, v46
s_waitcnt lgkmcnt(2)
v_mfma_f32_16x16x32_bf16 v[52:55], a[60:63], a[44:47], v[52:55]
s_waitcnt lgkmcnt(1)
ds_read_b128 a[52:55], v8 offset:256
v_add_u32 v10, 0x18000, v10
v_exp_f32 v79, v47
v_add_u32 v11, 0x18000, v11
v_exp_f32 v80, v48
v_exp_f32 v81, v49
v_exp_f32 v82, v50
v_mfma_f32_16x16x32_bf16 v[36:39], a[64:67], a[0:3], v[56:59]
s_waitcnt lgkmcnt(1)
ds_read_b128 a[56:59], v8 offset:12544
v_exp_f32 v83, v51
v_add_f32 v32, v76, v77
v_add_f32 v33, v78, v79
v_mfma_f32_16x16x32_bf16 v[40:43], a[48:51], a[0:3], v[56:59]
s_waitcnt lgkmcnt(1)
ds_read_b128 a[60:63], v8 offset:512
v_add_f32 v34, v80, v81
v_add_f32 v35, v82, v83
v_mfma_f32_16x16x32_bf16 v[36:39], a[52:55], a[4:7], v[36:39]
ds_read_b128 a[64:67], v8 offset:12800
v_add_f32 v32, v32, v33
v_add_f32 v34, v34, v35
v_add_f32 v32, v32, v34
v_cmp_nge_f32 vcc, s55, v32
s_nop 0
s_cbranch_vccnz RARE1a
C_1a:
ds_read_b128 a[48:51], v9 offset:0
s_waitcnt lgkmcnt(3)
v_mfma_f32_16x16x32_bf16 v[40:43], a[56:59], a[4:7], v[40:43]
s_waitcnt lgkmcnt(2)
ds_read_b128 a[52:55], v9 offset:12288
v_add_f32 v16, v16, v32
v_mfma_f32_16x16x32_bf16 v[36:39], a[60:63], a[8:11], v[36:39]
s_waitcnt lgkmcnt(2)
ds_read_b128 a[56:59], v9 offset:256
v_mul_f32 v84, v76, v84
v_mul_f32 v85, v77, v85
v_mfma_f32_16x16x32_bf16 v[40:43], a[64:67], a[8:11], v[40:43]
s_waitcnt lgkmcnt(2)
ds_read_b128 a[60:63], v9 offset:12544
v_mul_f32 v86, v78, v86
v_mul_f32 v87, v79, v87
v_mul_f32 v88, v80, v88
v_mul_f32 v89, v81, v89
v_mul_f32 v90, v82, v90
v_mfma_f32_16x16x32_bf16 v[36:39], a[48:51], a[12:15], v[36:39]
ds_read_b128 a[64:67], v9 offset:512
v_mul_f32 v91, v83, v91
s_waitcnt lgkmcnt(3)
v_mfma_f32_16x16x32_bf16 v[40:43], a[52:55], a[12:15], v[40:43]
s_waitcnt lgkmcnt(2)
ds_read_b128 a[48:51], v9 offset:12800
v_cvt_pk_bf16_f32 v60, v84, v85
v_cvt_pk_bf16_f32 v61, v86, v87
v_mfma_f32_16x16x32_bf16 v[36:39], a[56:59], a[16:19], v[36:39]
s_waitcnt lgkmcnt(2)
ds_read_b128 a[52:55], v10 offset:0
v_cvt_pk_bf16_f32 v62, v88, v89
v_cvt_pk_bf16_f32 v63, v90, v91
v_mfma_f32_16x16x32_bf16 v[40:43], a[60:63], a[16:19], v[40:43]
s_waitcnt lgkmcnt(2)
ds_read2_b64 v[76:79], v19 offset0:1 offset1:3
v_add_f32 v68, v68, v84
v_add_f32 v68, v68, v88
v_mfma_f32_16x16x32_bf16 v[36:39], a[64:67], a[20:23], v[36:39]
v_add_f32 v69, v69, v85
v_add_f32 v69, v69, v89
v_add_f32 v70, v70, v86
s_waitcnt lgkmcnt(2)
v_mfma_f32_16x16x32_bf16 v[40:43], a[48:51], a[20:23], v[40:43]
s_waitcnt lgkmcnt(1)
ds_read2_b64 v[80:83], v19 offset0:5 offset1:7
v_add_f32 v70, v70, v90
v_add_f32 v71, v71, v87
v_add_f32 v71, v71, v91
v_mfma_f32_16x16x32_bf16 v[36:39], a[52:55], a[24:27], v[36:39]
s_waitcnt lgkmcnt(1)
ds_write_b128 v13, v[60:63] offset:4096
v_add_f32 v76, v76, v78
v_add_f32 v77, v77, v79
ds_read_b128 a[56:59], v10 offset:12288
s_waitcnt lgkmcnt(2)
v_add_f32 v80, v80, v82
v_add_f32 v81, v81, v83
v_add_f32 v22, v76, v80
v_add_f32 v23, v77, v81
ds_read_b128 a[60:63], v10 offset:256
ds_read_b128 a[64:67], v10 offset:12544
ds_read_b128 a[48:51], v10 offset:512
ds_read2_b64 v[76:79], v19 offset0:160 offset1:162
s_waitcnt lgkmcnt(4)
v_mfma_f32_16x16x32_bf16 v[40:43], a[56:59], a[24:27], v[40:43]
s_waitcnt lgkmcnt(3)
v_mfma_f32_16x16x32_bf16 v[36:39], a[60:63], a[28:31], v[36:39]
s_waitcnt lgkmcnt(0)
ds_read2_b64 v[80:83], v19 offset0:164 offset1:166
v_mfma_f32_16x16x32_bf16 v[40:43], a[64:67], a[28:31], v[40:43]
v_mfma_f32_16x16x32_bf16 v[36:39], a[48:51], a[32:35], v[36:39]
ds_read_b128 a[52:55], v10 offset:12800
ds_read_b128 a[56:59], v11 offset:0
v_add_f32 v76, v76, v78
v_add_f32 v77, v77, v79
ds_read_b128 a[60:63], v11 offset:12288
ds_read_b128 a[64:67], v11 offset:256
s_waitcnt lgkmcnt(4)
v_add_f32 v80, v80, v82
v_add_f32 v81, v81, v83
v_add_f32 v24, v76, v80
v_add_f32 v25, v77, v81
s_waitcnt lgkmcnt(3)
v_mfma_f32_16x16x32_bf16 v[40:43], a[52:55], a[32:35], v[40:43]
s_waitcnt lgkmcnt(2)
ds_read_b128 a[48:51], v11 offset:12544
ds_read_b128 a[52:55], v11 offset:512
v_mfma_f32_16x16x32_bf16 v[36:39], a[56:59], a[36:39], v[36:39]
s_waitcnt lgkmcnt(2)
ds_read_b128 a[56:59], v11 offset:12800
v_mfma_f32_16x16x32_bf16 v[40:43], a[60:63], a[36:39], v[40:43]
v_mfma_f32_16x16x32_bf16 v[36:39], a[64:67], a[40:43], v[36:39]
s_waitcnt lgkmcnt(2)
v_mfma_f32_16x16x32_bf16 v[40:43], a[48:51], a[40:43], v[40:43]
s_waitcnt lgkmcnt(0)
s_barrier
ds_read2_b64 v[28:31], v12 offset0:0 offset1:2
v_mfma_f32_16x16x32_bf16 v[36:39], a[52:55], a[44:47], v[36:39]
v_mfma_f32_16x16x32_bf16 v[40:43], a[56:59], a[44:47], v[40:43]
ds_read2_b64 v[32:35], v12 offset0:4 offset1:6
ds_read_b128 a[60:63], v8 offset:24576
ds_read_b128 a[64:67], v8 offset:36864
s_waitcnt lgkmcnt(3)
v_add_f32 v28, v28, v30
v_add_f32 v29, v29, v31
v_add_f32 v28, v28, v22
v_add_f32 v29, v29, v23
ds_read_b128 a[48:51], v8 offset:24832
ds_read_b128 a[52:55], v8 offset:37120
s_waitcnt lgkmcnt(4)
v_add_f32 v32, v32, v34
v_add_f32 v33, v33, v35
v_add_f32 v28, v28, v32
v_add_f32 v29, v29, v33
s_waitcnt lgkmcnt(2)
v_mfma_f32_16x16x32_bf16 v[44:47], a[60:63], a[0:3], v[56:59]
ds_read_b128 a[56:59], v8 offset:25088
v_mul_f32 v29, s53, v29
v_mfma_f32_16x16x32_bf16 v[48:51], a[64:67], a[0:3], v[56:59]
ds_read_b128 a[60:63], v8 offset:37376
v_mul_f32 v28, s53, v28
v_fma_f32 v28, -v29, v29, v28
v_max_f32 v28, 0, v28
s_waitcnt lgkmcnt(3)
v_mfma_f32_16x16x32_bf16 v[44:47], a[48:51], a[4:7], v[44:47]
ds_read_b128 a[64:67], v9 offset:24576
v_add_f32 v28, s54, v28
v_rsq_f32 v28, v28
v_fmac_f32_dpp v36, v29, v17 row_newbcast:0 row_mask:0xf bank_mask:0xf
s_waitcnt lgkmcnt(3)
v_mfma_f32_16x16x32_bf16 v[48:51], a[52:55], a[4:7], v[48:51]
ds_read_b128 a[48:51], v9 offset:36864
v_fmac_f32_dpp v37, v29, v17 row_newbcast:1 row_mask:0xf bank_mask:0xf
v_fmac_f32_dpp v38, v29, v17 row_newbcast:2 row_mask:0xf bank_mask:0xf
v_fmac_f32_dpp v39, v29, v17 row_newbcast:3 row_mask:0xf bank_mask:0xf
v_fmac_f32_dpp v40, v29, v17 row_newbcast:4 row_mask:0xf bank_mask:0xf
s_waitcnt lgkmcnt(2)
v_mfma_f32_16x16x32_bf16 v[44:47], a[56:59], a[8:11], v[44:47]
ds_read_b128 a[52:55], v9 offset:24832
v_fmac_f32_dpp v41, v29, v17 row_newbcast:5 row_mask:0xf bank_mask:0xf
v_fmac_f32_dpp v42, v29, v17 row_newbcast:6 row_mask:0xf bank_mask:0xf
v_fmac_f32_dpp v43, v29, v17 row_newbcast:7 row_mask:0xf bank_mask:0xf
v_mov_b32_dpp v84, v28 row_newbcast:0 row_mask:0xf bank_mask:0xf
v_mfma_f32_16x16x32_bf16 v[48:51], a[60:63], a[8:11], v[48:51]
ds_read_b128 a[56:59], v9 offset:37120
v_mov_b32_dpp v85, v28 row_newbcast:1 row_mask:0xf bank_mask:0xf
v_mov_b32_dpp v86, v28 row_newbcast:2 row_mask:0xf bank_mask:0xf
v_mov_b32_dpp v87, v28 row_newbcast:3 row_mask:0xf bank_mask:0xf
v_mov_b32_dpp v88, v28 row_newbcast:4 row_mask:0xf bank_mask:0xf
s_waitcnt lgkmcnt(3)
v_mfma_f32_16x16x32_bf16 v[44:47], a[64:67], a[12:15], v[44:47]
ds_read_b128 a[60:63], v9 offset:25088
v_mov_b32_dpp v89, v28 row_newbcast:5 row_mask:0xf bank_mask:0xf
v_mov_b32_dpp v90, v28 row_newbcast:6 row_mask:0xf bank_mask:0xf
v_mov_b32_dpp v91, v28 row_newbcast:7 row_mask:0xf bank_mask:0xf
v_fma_f32 v36, v36, v84, v15
s_waitcnt lgkmcnt(3)
v_mfma_f32_16x16x32_bf16 v[48:51], a[48:51], a[12:15], v[48:51]
s_waitcnt lgkmcnt(2)
ds_read_b128 a[64:67], v9 offset:37376
v_fma_f32 v37, v37, v85, v15
v_fma_f32 v38, v38, v86, v15
v_fma_f32 v39, v39, v87, v15
v_fma_f32 v40, v40, v88, v15
v_mfma_f32_16x16x32_bf16 v[44:47], a[52:55], a[16:19], v[44:47]
s_waitcnt lgkmcnt(2)
ds_read_b128 a[48:51], v10 offset:24576
v_fma_f32 v41, v41, v89, v15
v_fma_f32 v42, v42, v90, v15
v_fma_f32 v43, v43, v91, v15
v_exp_f32 v76, v36
v_mfma_f32_16x16x32_bf16 v[48:51], a[56:59], a[16:19], v[48:51]
s_waitcnt lgkmcnt(2)
ds_read_b128 a[52:55], v10 offset:36864
v_exp_f32 v77, v37
v_exp_f32 v78, v38
v_exp_f32 v79, v39
v_mfma_f32_16x16x32_bf16 v[44:47], a[60:63], a[20:23], v[44:47]
s_waitcnt lgkmcnt(2)
ds_read_b128 a[56:59], v10 offset:24832
v_exp_f32 v80, v40
v_exp_f32 v81, v41
v_exp_f32 v82, v42
v_exp_f32 v83, v43
v_mfma_f32_16x16x32_bf16 v[48:51], a[64:67], a[20:23], v[48:51]
s_waitcnt lgkmcnt(2)
ds_read_b128 a[60:63], v10 offset:37120
v_add_f32 v32, v76, v77
v_add_f32 v33, v78, v79
v_add_f32 v34, v80, v81
v_add_f32 v35, v82, v83
v_mfma_f32_16x16x32_bf16 v[44:47], a[48:51], a[24:27], v[44:47]
s_waitcnt lgkmcnt(2)
ds_read_b128 a[64:67], v10 offset:25088
v_add_f32 v32, v32, v33
v_add_f32 v34, v34, v35
v_add_f32 v32, v32, v34
v_cmp_nge_f32 vcc, s55, v32
v_mfma_f32_16x16x32_bf16 v[48:51], a[52:55], a[24:27], v[48:51]
s_cbranch_vccnz RARE2a
C_2a:
ds_read_b128 a[48:51], v10 offset:37376
v_add_f32 v16, v16, v32
v_mul_f32 v84, v76, v84
v_mul_f32 v85, v77, v85
s_waitcnt lgkmcnt(3)
v_mfma_f32_16x16x32_bf16 v[44:47], a[56:59], a[28:31], v[44:47]
s_waitcnt lgkmcnt(2)
ds_read_b128 a[52:55], v11 offset:24576
v_mul_f32 v86, v78, v86
v_mul_f32 v87, v79, v87
v_mul_f32 v88, v80, v88
v_mul_f32 v89, v81, v89
v_mfma_f32_16x16x32_bf16 v[48:51], a[60:63], a[28:31], v[48:51]
s_waitcnt lgkmcnt(2)
ds_read2_b64 v[76:79], v19 offset0:161 offset1:163
v_mul_f32 v90, v82, v90
v_mul_f32 v91, v83, v91
v_cvt_pk_bf16_f32 v60, v84, v85
v_cvt_pk_bf16_f32 v61, v86, v87
v_mfma_f32_16x16x32_bf16 v[44:47], a[64:67], a[32:35], v[44:47]
s_waitcnt lgkmcnt(2)
ds_read2_b64 v[80:83], v19 offset0:165 offset1:167
v_cvt_pk_bf16_f32 v62, v88, v89
v_cvt_pk_bf16_f32 v63, v90, v91
v_add_f32 v72, v84, v88
v_mfma_f32_16x16x32_bf16 v[48:51], a[48:51], a[32:35], v[48:51]
s_waitcnt lgkmcnt(2)
v_add_f32 v73, v85, v89
v_add_f32 v74, v86, v90
v_add_f32 v75, v87, v91
v_mfma_f32_16x16x32_bf16 v[44:47], a[52:55], a[36:39], v[44:47]
s_waitcnt lgkmcnt(1)
ds_write_b128 v13, v[60:63] offset:0
v_add_u32 v8, 0xfffe8000, v8
v_add_u32 v9, 0xfffe8000, v9
v_add_u32 v10, 0xfffe8000, v10
v_add_f32 v76, v76, v78
v_add_f32 v77, v77, v79
ds_read_b128 a[56:59], v11 offset:36864
s_waitcnt lgkmcnt(2)
v_add_f32 v80, v80, v82
v_add_f32 v81, v81, v83
v_add_f32 v26, v76, v80
v_add_f32 v27, v77, v81
ds_read_b128 a[60:63], v11 offset:24832
ds_read_b128 a[64:67], v11 offset:37120
ds_read_b128 a[48:51], v11 offset:25088
ds_read_b128 a[52:55], v11 offset:37376
v_add_u32 v11, 0xfffe8000, v11
s_waitcnt lgkmcnt(4)
v_mfma_f32_16x16x32_bf16 v[48:51], a[56:59], a[36:39], v[48:51]
s_waitcnt lgkmcnt(3)
v_mfma_f32_16x16x32_bf16 v[44:47], a[60:63], a[40:43], v[44:47]
s_waitcnt lgkmcnt(0)
v_mfma_f32_16x16x32_bf16 v[48:51], a[64:67], a[40:43], v[48:51]
s_barrier
ds_read2_b64 v[28:31], v12 offset0:160 offset1:162
v_mfma_f32_16x16x32_bf16 v[44:47], a[48:51], a[44:47], v[44:47]
v_mfma_f32_16x16x32_bf16 v[48:51], a[52:55], a[44:47], v[48:51]
ds_read2_b64 v[32:35], v12 offset0:164 offset1:166
ds_read_b128 a[56:59], v8 offset:36864
ds_read_b128 a[60:63], v8 offset:37120
s_waitcnt lgkmcnt(3)
v_add_f32 v28, v28, v30
v_add_f32 v29, v29, v31
v_add_f32 v28, v28, v22
v_add_f32 v29, v29, v23
ds_read_b128 a[64:67], v8 offset:37376
ds_read_b128 a[48:51], v9 offset:36864
s_waitcnt lgkmcnt(4)
v_add_f32 v32, v32, v34
v_add_f32 v33, v33, v35
v_add_f32 v28, v28, v32
v_add_f32 v29, v29, v33
s_waitcnt lgkmcnt(2)
v_mfma_f32_16x16x32_bf16 v[56:59], a[56:59], a[0:3], 0
ds_read_b128 a[52:55], v9 offset:37120
v_mul_f32 v29, s53, v29
v_mul_f32 v28, s53, v28
v_mfma_f32_16x16x32_bf16 v[56:59], a[60:63], a[4:7], v[56:59]
ds_read_b128 a[56:59], v9 offset:37376
v_fma_f32 v28, -v29, v29, v28
v_max_f32 v28, 0, v28
s_waitcnt lgkmcnt(3)
v_mfma_f32_16x16x32_bf16 v[56:59], a[64:67], a[8:11], v[56:59]
ds_read_b128 a[60:63], v10 offset:36864
v_add_f32 v28, s54, v28
v_rsq_f32 v28, v28
v_fmac_f32_dpp v44, v29, v17 row_newbcast:0 row_mask:0xf bank_mask:0xf
s_waitcnt lgkmcnt(3)
v_mfma_f32_16x16x32_bf16 v[56:59], a[48:51], a[12:15], v[56:59]
ds_read_b128 a[64:67], v10 offset:37120
v_fmac_f32_dpp v45, v29, v17 row_newbcast:1 row_mask:0xf bank_mask:0xf
v_fmac_f32_dpp v46, v29, v17 row_newbcast:2 row_mask:0xf bank_mask:0xf
s_waitcnt lgkmcnt(3)
v_mfma_f32_16x16x32_bf16 v[56:59], a[52:55], a[16:19], v[56:59]
ds_read_b128 a[48:51], v10 offset:37376
v_fmac_f32_dpp v47, v29, v17 row_newbcast:3 row_mask:0xf bank_mask:0xf
v_fmac_f32_dpp v48, v29, v17 row_newbcast:4 row_mask:0xf bank_mask:0xf
v_fmac_f32_dpp v49, v29, v17 row_newbcast:5 row_mask:0xf bank_mask:0xf
s_waitcnt lgkmcnt(3)
v_mfma_f32_16x16x32_bf16 v[56:59], a[56:59], a[20:23], v[56:59]
ds_read_b128 a[52:55], v11 offset:36864
v_fmac_f32_dpp v50, v29, v17 row_newbcast:6 row_mask:0xf bank_mask:0xf
v_fmac_f32_dpp v51, v29, v17 row_newbcast:7 row_mask:0xf bank_mask:0xf
s_waitcnt lgkmcnt(3)
v_mfma_f32_16x16x32_bf16 v[56:59], a[60:63], a[24:27], v[56:59]
ds_read_b128 a[56:59], v11 offset:37120
v_mov_b32_dpp v84, v28 row_newbcast:0 row_mask:0xf bank_mask:0xf
v_mov_b32_dpp v85, v28 row_newbcast:1 row_mask:0xf bank_mask:0xf
v_mov_b32_dpp v86, v28 row_newbcast:2 row_mask:0xf bank_mask:0xf
s_waitcnt lgkmcnt(3)
v_mfma_f32_16x16x32_bf16 v[56:59], a[64:67], a[28:31], v[56:59]
ds_read_b128 a[60:63], v11 offset:37376
v_mov_b32_dpp v87, v28 row_newbcast:3 row_mask:0xf bank_mask:0xf
v_mov_b32_dpp v88, v28 row_newbcast:4 row_mask:0xf bank_mask:0xf
s_waitcnt lgkmcnt(3)
v_mfma_f32_16x16x32_bf16 v[56:59], a[48:51], a[32:35], v[56:59]
ds_read_b128 a[64:67], v8 offset:0
v_mov_b32_dpp v89, v28 row_newbcast:5 row_mask:0xf bank_mask:0xf
v_mov_b32_dpp v90, v28 row_newbcast:6 row_mask:0xf bank_mask:0xf
s_waitcnt lgkmcnt(3)
v_mfma_f32_16x16x32_bf16 v[56:59], a[52:55], a[36:39], v[56:59]
ds_read_b128 a[48:51], v8 offset:12288
v_mov_b32_dpp v91, v28 row_newbcast:7 row_mask:0xf bank_mask:0xf
v_fma_f32 v44, v44, v84, v15
v_fma_f32 v45, v45, v85, v15
s_waitcnt lgkmcnt(3)
v_mfma_f32_16x16x32_bf16 v[56:59], a[56:59], a[40:43], v[56:59]
s_waitcnt lgkmcnt(2)
ds_read_b128 a[52:55], v8 offset:256
v_fma_f32 v46, v46, v86, v15
v_fma_f32 v47, v47, v87, v15
v_mfma_f32_16x16x32_bf16 v[56:59], a[60:63], a[44:47], v[56:59]
s_waitcnt lgkmcnt(2)
ds_read_b128 a[56:59], v8 offset:12544
v_fma_f32 v48, v48, v88, v15
v_fma_f32 v49, v49, v89, v15
v_fma_f32 v50, v50, v90, v15
v_mfma_f32_16x16x32_bf16 v[36:39], a[64:67], a[0:3], v[52:55]
s_waitcnt lgkmcnt(2)
ds_read_b128 a[60:63], v8 offset:512
v_fma_f32 v51, v51, v91, v15
v_exp_f32 v76, v44
v_mfma_f32_16x16x32_bf16 v[40:43], a[48:51], a[0:3], v[52:55]
s_waitcnt lgkmcnt(2)
ds_read_b128 a[64:67], v8 offset:12800
v_exp_f32 v77, v45
v_exp_f32 v78, v46
v_exp_f32 v79, v47
v_mfma_f32_16x16x32_bf16 v[36:39], a[52:55], a[4:7], v[36:39]
s_waitcnt lgkmcnt(2)
ds_read_b128 a[48:51], v9 offset:0
v_exp_f32 v80, v48
v_exp_f32 v81, v49
v_mfma_f32_16x16x32_bf16 v[40:43], a[56:59], a[4:7], v[40:43]
s_waitcnt lgkmcnt(2)
ds_read_b128 a[52:55], v9 offset:12288
v_exp_f32 v82, v50
v_exp_f32 v83, v51
v_add_f32 v32, v76, v77
v_mfma_f32_16x16x32_bf16 v[36:39], a[60:63], a[8:11], v[36:39]
s_waitcnt lgkmcnt(2)
ds_read_b128 a[56:59], v9 offset:256
v_add_f32 v33, v78, v79
v_add_f32 v34, v80, v81
v_mfma_f32_16x16x32_bf16 v[40:43], a[64:67], a[8:11], v[40:43]
s_waitcnt lgkmcnt(2)
ds_read_b128 a[60:63], v9 offset:12544
v_add_f32 v35, v82, v83
v_add_f32 v32, v32, v33
v_add_f32 v34, v34, v35
v_mfma_f32_16x16x32_bf16 v[36:39], a[48:51], a[12:15], v[36:39]
s_waitcnt lgkmcnt(2)
ds_read_b128 a[64:67], v9 offset:512
v_add_f32 v32, v32, v34
v_cmp_nge_f32 vcc, s55, v32
v_mfma_f32_16x16x32_bf16 v[40:43], a[52:55], a[12:15], v[40:43]
s_cbranch_vccnz RARE3a
C_3a:
ds_read_b128 a[48:51], v9 offset:12800
v_add_f32 v16, v16, v32
s_waitcnt lgkmcnt(3)
v_mfma_f32_16x16x32_bf16 v[36:39], a[56:59], a[16:19], v[36:39]
s_waitcnt lgkmcnt(2)
s_add_u32 s52, s27, 0
ds_read_b128 a[52:55], v10 offset:0
v_mul_f32 v84, v76, v84
v_mul_f32 v85, v77, v85
v_mul_f32 v86, v78, v86
v_mfma_f32_16x16x32_bf16 v[40:43], a[60:63], a[16:19], v[40:43]
s_waitcnt lgkmcnt(2)
ds_read_b128 a[56:59], v10 offset:12288
v_mul_f32 v87, v79, v87
v_mul_f32 v88, v80, v88
v_mfma_f32_16x16x32_bf16 v[36:39], a[64:67], a[20:23], v[36:39]
s_waitcnt lgkmcnt(2)
ds_read_b128 a[60:63], v10 offset:256
v_mul_f32 v89, v81, v89
v_mul_f32 v90, v82, v90
v_mul_f32 v91, v83, v91
v_mfma_f32_16x16x32_bf16 v[40:43], a[48:51], a[20:23], v[40:43]
ds_read_b128 a[64:67], v10 offset:12544
v_cvt_pk_bf16_f32 v60, v84, v85
v_cvt_pk_bf16_f32 v61, v86, v87
s_waitcnt lgkmcnt(3)
v_mfma_f32_16x16x32_bf16 v[36:39], a[52:55], a[24:27], v[36:39]
s_waitcnt lgkmcnt(2)
ds_read_b128 a[48:51], v10 offset:512
v_cvt_pk_bf16_f32 v62, v88, v89
v_cvt_pk_bf16_f32 v63, v90, v91
v_mfma_f32_16x16x32_bf16 v[40:43], a[56:59], a[24:27], v[40:43]
s_waitcnt lgkmcnt(2)
ds_write_b128 v13, v[60:63] offset:4096
v_add_f32 v72, v72, v84
v_add_f32 v72, v72, v88
v_mfma_f32_16x16x32_bf16 v[36:39], a[60:63], a[28:31], v[36:39]
s_waitcnt lgkmcnt(2)
v_add_f32 v73, v73, v85
v_add_f32 v73, v73, v89
v_add_f32 v74, v74, v86
v_mfma_f32_16x16x32_bf16 v[40:43], a[64:67], a[28:31], v[40:43]
v_add_f32 v74, v74, v90
v_add_f32 v75, v75, v87
v_add_f32 v75, v75, v91
s_waitcnt lgkmcnt(1)
v_mfma_f32_16x16x32_bf16 v[36:39], a[48:51], a[32:35], v[36:39]
ds_read_b128 a[52:55], v10 offset:12800
v_cvt_pk_bf16_f32 v64, v68, v69
v_cvt_pk_bf16_f32 v65, v70, v71
v_cvt_pk_bf16_f32 v66, v72, v73
v_cvt_pk_bf16_f32 v67, v74, v75
v_add_u32 v8, 0xc000, v8
v_add_u32 v9, 0xc000, v9
v_add_u32 v10, 0xc000, v10
ds_read_b128 a[56:59], v11 offset:0
ds_read_b128 a[60:63], v11 offset:12288
ds_read_b128 a[64:67], v11 offset:256
s_waitcnt lgkmcnt(3)
v_mfma_f32_16x16x32_bf16 v[40:43], a[52:55], a[32:35], v[40:43]
s_waitcnt lgkmcnt(2)
ds_read_b128 a[48:51], v11 offset:12544
ds_write_b128 v13, v[64:67] offset:8192
v_mfma_f32_16x16x32_bf16 v[36:39], a[56:59], a[36:39], v[36:39]
s_waitcnt lgkmcnt(3)
v_mfma_f32_16x16x32_bf16 v[40:43], a[60:63], a[36:39], v[40:43]
s_waitcnt lgkmcnt(2)
v_mfma_f32_16x16x32_bf16 v[36:39], a[64:67], a[40:43], v[36:39]
ds_read_b128 a[52:55], v11 offset:512
s_waitcnt lgkmcnt(2)
v_mfma_f32_16x16x32_bf16 v[40:43], a[48:51], a[40:43], v[40:43]
ds_read_b128 a[56:59], v11 offset:12800
v_add_u32 v11, 0xc000, v11
s_waitcnt lgkmcnt(0)
s_barrier
buffer_load_dwordx4 v[92:95], v1, s[28:31], s52 offen offset:0 sc1
ds_read2_b64 v[28:31], v12 offset0:0 offset1:2
v_mfma_f32_16x16x32_bf16 v[36:39], a[52:55], a[44:47], v[36:39]
v_mfma_f32_16x16x32_bf16 v[40:43], a[56:59], a[44:47], v[40:43]
ds_read2_b64 v[32:35], v12 offset0:4 offset1:6
buffer_load_dwordx4 v[96:99], v1, s[28:31], s52 offen offset:1024 sc1
ds_read_b128 a[60:63], v8 offset:0
ds_read_b128 a[64:67], v8 offset:12288
s_waitcnt lgkmcnt(3)
v_add_f32 v28, v28, v30
v_add_f32 v29, v29, v31
v_add_f32 v28, v28, v24
v_add_f32 v29, v29, v25
ds_read_b128 a[48:51], v8 offset:256
buffer_load_dwordx4 v[100:103], v1, s[28:31], s52 offen offset:2048 sc1
ds_read_b128 a[52:55], v8 offset:12544
s_waitcnt lgkmcnt(4)
v_add_f32 v32, v32, v34
v_add_f32 v33, v33, v35
v_add_f32 v28, v28, v32
v_add_f32 v29, v29, v33
v_mul_f32 v29, s53, v29
s_waitcnt lgkmcnt(2)
v_mfma_f32_16x16x32_bf16 v[44:47], a[60:63], a[0:3], v[52:55]
ds_read_b128 a[56:59], v8 offset:512
v_mul_f32 v28, s53, v28
v_fma_f32 v28, -v29, v29, v28
v_max_f32 v28, 0, v28
v_mfma_f32_16x16x32_bf16 v[48:51], a[64:67], a[0:3], v[52:55]
ds_read_b128 a[60:63], v8 offset:12800
buffer_load_dwordx4 v[104:107], v1, s[28:31], s52 offen offset:3072 sc1
ds_read_b128 a[64:67], v9 offset:0
v_add_f32 v28, s54, v28
v_rsq_f32 v28, v28
v_fmac_f32_dpp v36, v29, v17 row_newbcast:0 row_mask:0xf bank_mask:0xf
v_fmac_f32_dpp v37, v29, v17 row_newbcast:1 row_mask:0xf bank_mask:0xf
s_waitcnt lgkmcnt(4)
v_mfma_f32_16x16x32_bf16 v[44:47], a[48:51], a[4:7], v[44:47]
s_add_u32 s52, s52, 4096
ds_read_b128 a[48:51], v9 offset:12288
v_fmac_f32_dpp v38, v29, v17 row_newbcast:2 row_mask:0xf bank_mask:0xf
v_fmac_f32_dpp v39, v29, v17 row_newbcast:3 row_mask:0xf bank_mask:0xf
v_fmac_f32_dpp v40, v29, v17 row_newbcast:4 row_mask:0xf bank_mask:0xf
s_waitcnt lgkmcnt(4)
v_mfma_f32_16x16x32_bf16 v[48:51], a[52:55], a[4:7], v[48:51]
ds_read_b128 a[52:55], v9 offset:256
buffer_load_dwordx4 v[108:111], v1, s[28:31], s52 offen offset:0 sc1
v_fmac_f32_dpp v41, v29, v17 row_newbcast:5 row_mask:0xf bank_mask:0xf
v_fmac_f32_dpp v42, v29, v17 row_newbcast:6 row_mask:0xf bank_mask:0xf
v_fmac_f32_dpp v43, v29, v17 row_newbcast:7 row_mask:0xf bank_mask:0xf
s_waitcnt lgkmcnt(4)
v_mfma_f32_16x16x32_bf16 v[44:47], a[56:59], a[8:11], v[44:47]
ds_read_b128 a[56:59], v9 offset:12544
v_mov_b32_dpp v84, v28 row_newbcast:0 row_mask:0xf bank_mask:0xf
v_mov_b32_dpp v85, v28 row_newbcast:1 row_mask:0xf bank_mask:0xf
v_mov_b32_dpp v86, v28 row_newbcast:2 row_mask:0xf bank_mask:0xf
s_waitcnt lgkmcnt(3)
v_mfma_f32_16x16x32_bf16 v[48:51], a[60:63], a[8:11], v[48:51]
ds_read_b128 a[60:63], v9 offset:512
v_mov_b32_dpp v87, v28 row_newbcast:3 row_mask:0xf bank_mask:0xf
v_mov_b32_dpp v88, v28 row_newbcast:4 row_mask:0xf bank_mask:0xf
v_mov_b32_dpp v89, v28 row_newbcast:5 row_mask:0xf bank_mask:0xf
v_mov_b32_dpp v90, v28 row_newbcast:6 row_mask:0xf bank_mask:0xf
v_mfma_f32_16x16x32_bf16 v[44:47], a[64:67], a[12:15], v[44:47]
ds_read_b128 a[64:67], v9 offset:12800
buffer_load_dwordx4 v[112:115], v1, s[28:31], s52 offen offset:1024 sc1
v_mov_b32_dpp v91, v28 row_newbcast:7 row_mask:0xf bank_mask:0xf
v_fma_f32 v36, v36, v84, v15
v_fma_f32 v37, v37, v85, v15
s_waitcnt lgkmcnt(3)
v_mfma_f32_16x16x32_bf16 v[48:51], a[48:51], a[12:15], v[48:51]
ds_read_b128 a[48:51], v10 offset:0
v_fma_f32 v38, v38, v86, v15
v_fma_f32 v39, v39, v87, v15
v_fma_f32 v40, v40, v88, v15
v_mfma_f32_16x16x32_bf16 v[44:47], a[52:55], a[16:19], v[44:47]
s_waitcnt lgkmcnt(3)
ds_read_b128 a[52:55], v10 offset:12288
v_fma_f32 v41, v41, v89, v15
v_fma_f32 v42, v42, v90, v15
v_fma_f32 v43, v43, v91, v15
v_mfma_f32_16x16x32_bf16 v[48:51], a[56:59], a[16:19], v[48:51]
s_waitcnt lgkmcnt(3)
ds_read_b128 a[56:59], v10 offset:256
v_exp_f32 v76, v36
v_exp_f32 v77, v37
v_exp_f32 v78, v38
v_exp_f32 v79, v39
v_mfma_f32_16x16x32_bf16 v[44:47], a[60:63], a[20:23], v[44:47]
s_waitcnt lgkmcnt(2)
ds_read_b128 a[60:63], v10 offset:12544
v_exp_f32 v80, v40
v_exp_f32 v81, v41
v_exp_f32 v82, v42
v_mfma_f32_16x16x32_bf16 v[48:51], a[64:67], a[20:23], v[48:51]
ds_read_b128 a[64:67], v10 offset:512
v_exp_f32 v83, v43
v_add_f32 v32, v76, v77
v_add_f32 v33, v78, v79
v_mfma_f32_16x16x32_bf16 v[44:47], a[48:51], a[24:27], v[44:47]
s_waitcnt lgkmcnt(2)
ds_read_b128 a[48:51], v10 offset:12800
v_add_f32 v34, v80, v81
v_add_f32 v35, v82, v83
v_add_f32 v32, v32, v33
v_mfma_f32_16x16x32_bf16 v[48:51], a[52:55], a[24:27], v[48:51]
ds_read_b128 a[52:55], v11 offset:0
v_add_f32 v34, v34, v35
v_add_f32 v32, v32, v34
v_cmp_nge_f32 vcc, s55, v32
s_nop 0
s_cbranch_vccnz RARE4a
C_4a:
v_mfma_f32_16x16x32_bf16 v[44:47], a[56:59], a[28:31], v[44:47]
s_waitcnt lgkmcnt(3)
s_add_u32 s52, s27, 18432
ds_read_b128 a[56:59], v11 offset:12288
v_add_f32 v16, v16, v32
v_mul_f32 v84, v76, v84
v_mul_f32 v85, v77, v85
v_mfma_f32_16x16x32_bf16 v[48:51], a[60:63], a[28:31], v[48:51]
s_waitcnt lgkmcnt(3)
ds_read_b128 a[60:63], v11 offset:256
v_mul_f32 v86, v78, v86
v_mul_f32 v87, v79, v87
v_mul_f32 v88, v80, v88
v_mfma_f32_16x16x32_bf16 v[44:47], a[64:67], a[32:35], v[44:47]
s_waitcnt lgkmcnt(3)
ds_read_b128 a[64:67], v11 offset:12544
v_mul_f32 v89, v81, v89
v_mul_f32 v90, v82, v90
v_mul_f32 v91, v83, v91
v_mfma_f32_16x16x32_bf16 v[48:51], a[48:51], a[32:35], v[48:51]
s_waitcnt lgkmcnt(3)
ds_read_b128 a[48:51], v11 offset:512
v_cvt_pk_bf16_f32 v60, v84, v85
v_cvt_pk_bf16_f32 v61, v86, v87
v_cvt_pk_bf16_f32 v62, v88, v89
v_cvt_pk_bf16_f32 v63, v90, v91
v_mfma_f32_16x16x32_bf16 v[44:47], a[52:55], a[36:39], v[44:47]
s_waitcnt lgkmcnt(3)
ds_write_b128 v13, v[60:63] offset:0
v_add_f32 v68, v84, v88
v_add_f32 v69, v85, v89
v_mfma_f32_16x16x32_bf16 v[48:51], a[56:59], a[36:39], v[48:51]
s_waitcnt lgkmcnt(3)
v_add_f32 v70, v86, v90
v_add_f32 v71, v87, v91
v_mfma_f32_16x16x32_bf16 v[44:47], a[60:63], a[40:43], v[44:47]
s_waitcnt lgkmcnt(2)
v_mfma_f32_16x16x32_bf16 v[48:51], a[64:67], a[40:43], v[48:51]
ds_read_b128 a[52:55], v11 offset:12800
s_waitcnt lgkmcnt(0)
s_barrier
buffer_load_dwordx4 v[116:119], v1, s[28:31], s52 offen offset:0 sc1
ds_read2_b64 v[28:31], v12 offset0:160 offset1:162
v_mfma_f32_16x16x32_bf16 v[44:47], a[48:51], a[44:47], v[44:47]
v_mfma_f32_16x16x32_bf16 v[48:51], a[52:55], a[44:47], v[48:51]
ds_read2_b64 v[32:35], v12 offset0:164 offset1:166
buffer_load_dwordx4 v[120:123], v1, s[28:31], s52 offen offset:1024 sc1
ds_read_b128 a[56:59], v8 offset:24576
ds_read_b128 a[60:63], v8 offset:36864
s_waitcnt lgkmcnt(3)
v_add_f32 v28, v28, v30
v_add_f32 v29, v29, v31
v_add_f32 v28, v28, v24
v_add_f32 v29, v29, v25
ds_read_b128 a[64:67], v8 offset:24832
buffer_load_dwordx4 v[124:127], v1, s[28:31], s52 offen offset:2048 sc1
ds_read_b128 a[48:51], v8 offset:37120
s_waitcnt lgkmcnt(4)
v_add_f32 v32, v32, v34
v_add_f32 v33, v33, v35
v_add_f32 v28, v28, v32
v_add_f32 v29, v29, v33
s_waitcnt lgkmcnt(2)
v_mfma_f32_16x16x32_bf16 v[36:39], a[56:59], a[0:3], v[56:59]
ds_read_b128 a[52:55], v8 offset:25088
v_mul_f32 v29, s53, v29
v_mfma_f32_16x16x32_bf16 v[40:43], a[60:63], a[0:3], v[56:59]
ds_read_b128 a[56:59], v8 offset:37376
v_mul_f32 v28, s53, v28
v_fma_f32 v28, -v29, v29, v28
v_max_f32 v28, 0, v28
s_waitcnt lgkmcnt(3)
v_mfma_f32_16x16x32_bf16 v[36:39], a[64:67], a[4:7], v[36:39]
s_waitcnt lgkmcnt(2)
buffer_load_dwordx4 v[128:131], v1, s[28:31], s52 offen offset:3072 sc1
ds_read_b128 a[60:63], v9 offset:24576
v_add_f32 v28, s54, v28
v_rsq_f32 v28, v28
v_mfma_f32_16x16x32_bf16 v[40:43], a[48:51], a[4:7], v[40:43]
s_add_u32 s52, s52, 4096
ds_read_b128 a[64:67], v9 offset:36864
v_fmac_f32_dpp v44, v29, v17 row_newbcast:0 row_mask:0xf bank_mask:0xf
v_fmac_f32_dpp v45, v29, v17 row_newbcast:1 row_mask:0xf bank_mask:0xf
v_fmac_f32_dpp v46, v29, v17 row_newbcast:2 row_mask:0xf bank_mask:0xf
v_fmac_f32_dpp v47, v29, v17 row_newbcast:3 row_mask:0xf bank_mask:0xf
s_waitcnt lgkmcnt(2)
v_mfma_f32_16x16x32_bf16 v[36:39], a[52:55], a[8:11], v[36:39]
ds_read_b128 a[48:51], v9 offset:24832
v_fmac_f32_dpp v48, v29, v17 row_newbcast:4 row_mask:0xf bank_mask:0xf
v_fmac_f32_dpp v49, v29, v17 row_newbcast:5 row_mask:0xf bank_mask:0xf
v_fmac_f32_dpp v50, v29, v17 row_newbcast:6 row_mask:0xf bank_mask:0xf
v_fmac_f32_dpp v51, v29, v17 row_newbcast:7 row_mask:0xf bank_mask:0xf
v_mfma_f32_16x16x32_bf16 v[40:43], a[56:59], a[8:11], v[40:43]
buffer_load_dwordx4 v[132:135], v1, s[28:31], s52 offen offset:0 sc1
ds_read_b128 a[52:55], v9 offset:37120
v_mov_b32_dpp v84, v28 row_newbcast:0 row_mask:0xf bank_mask:0xf
v_mov_b32_dpp v85, v28 row_newbcast:1 row_mask:0xf bank_mask:0xf
v_mov_b32_dpp v86, v28 row_newbcast:2 row_mask:0xf bank_mask:0xf
s_waitcnt lgkmcnt(3)
v_mfma_f32_16x16x32_bf16 v[36:39], a[60:63], a[12:15], v[36:39]
ds_read_b128 a[56:59], v9 offset:25088
v_mov_b32_dpp v87, v28 row_newbcast:3 row_mask:0xf bank_mask:0xf
v_mov_b32_dpp v88, v28 row_newbcast:4 row_mask:0xf bank_mask:0xf
v_mov_b32_dpp v89, v28 row_newbcast:5 row_mask:0xf bank_mask:0xf
v_mov_b32_dpp v90, v28 row_newbcast:6 row_mask:0xf bank_mask:0xf
s_waitcnt lgkmcnt(3)
v_mfma_f32_16x16x32_bf16 v[40:43], a[64:67], a[12:15], v[40:43]
ds_read_b128 a[60:63], v9 offset:37376
v_mov_b32_dpp v91, v28 row_newbcast:7 row_mask:0xf bank_mask:0xf
v_fma_f32 v44, v44, v84, v15
v_fma_f32 v45, v45, v85, v15
v_fma_f32 v46, v46, v86, v15
s_waitcnt lgkmcnt(3)
v_mfma_f32_16x16x32_bf16 v[36:39], a[48:51], a[16:19], v[36:39]
s_waitcnt lgkmcnt(2)
buffer_load_dwordx4 v[136:139], v1, s[28:31], s52 offen offset:1024 sc1
ds_read_b128 a[64:67], v10 offset:24576
v_fma_f32 v47, v47, v87, v15
v_fma_f32 v48, v48, v88, v15
s_add_u32 s52, s27, 36864
v_fma_f32 v49, v49, v89, v15
v_fma_f32 v50, v50, v90, v15
v_mfma_f32_16x16x32_bf16 v[40:43], a[52:55], a[16:19], v[40:43]
s_waitcnt lgkmcnt(2)
ds_read_b128 a[48:51], v10 offset:36864
v_fma_f32 v51, v51, v91, v15
v_exp_f32 v76, v44
v_exp_f32 v77, v45
v_mfma_f32_16x16x32_bf16 v[36:39], a[56:59], a[20:23], v[36:39]
s_waitcnt lgkmcnt(2)
buffer_load_dwordx4 a[68:71], v1, s[28:31], s52 offen offset:0 sc1
ds_read_b128 a[52:55], v10 offset:24832
v_exp_f32 v78, v46
v_exp_f32 v79, v47
v_exp_f32 v80, v48
v_exp_f32 v81, v49
v_mfma_f32_16x16x32_bf16 v[40:43], a[60:63], a[20:23], v[40:43]
s_waitcnt lgkmcnt(2)
ds_read_b128 a[56:59], v10 offset:37120
v_exp_f32 v82, v50
v_exp_f32 v83, v51
v_add_f32 v32, v76, v77
v_add_f32 v33, v78, v79
v_mfma_f32_16x16x32_bf16 v[36:39], a[64:67], a[24:27], v[36:39]
s_waitcnt lgkmcnt(2)
buffer_load_dwordx4 a[72:75], v1, s[28:31], s52 offen offset:1024 sc1
ds_read_b128 a[60:63], v10 offset:25088
v_add_f32 v34, v80, v81
v_add_f32 v35, v82, v83
v_add_f32 v32, v32, v33
v_add_f32 v34, v34, v35
v_mfma_f32_16x16x32_bf16 v[40:43], a[48:51], a[24:27], v[40:43]
s_waitcnt lgkmcnt(2)
ds_read_b128 a[64:67], v10 offset:37376
v_add_f32 v32, v32, v34
v_cmp_nge_f32 vcc, s55, v32
v_mfma_f32_16x16x32_bf16 v[36:39], a[52:55], a[28:31], v[36:39]
s_waitcnt lgkmcnt(2)
ds_read_b128 a[48:51], v11 offset:24576
v_add_u32 v8, 0xc000, v8
v_mfma_f32_16x16x32_bf16 v[40:43], a[56:59], a[28:31], v[40:43]
buffer_load_dwordx4 a[76:79], v1, s[28:31], s52 offen offset:2048 sc1
ds_read_b128 a[52:55], v11 offset:36864
s_waitcnt lgkmcnt(3)
v_mfma_f32_16x16x32_bf16 v[36:39], a[60:63], a[32:35], v[36:39]
s_waitcnt lgkmcnt(2)
ds_read_b128 a[56:59], v11 offset:24832
v_add_u32 v9, 0xc000, v9
v_add_u32 v10, 0xc000, v10
v_mfma_f32_16x16x32_bf16 v[40:43], a[64:67], a[32:35], v[40:43]
s_waitcnt lgkmcnt(2)
ds_read_b128 a[60:63], v11 offset:37120
ds_read_b128 a[64:67], v11 offset:25088
v_mfma_f32_16x16x32_bf16 v[36:39], a[48:51], a[36:39], v[36:39]
buffer_load_dwordx4 a[80:83], v1, s[28:31], s52 offen offset:3072 sc1
ds_read_b128 a[48:51], v11 offset:37376
s_add_u32 s52, s52, 4096
s_cbranch_vccnz RARE5a
C_5a:
v_add_f32 v16, v16, v32
v_mul_f32 v84, v76, v84
v_mul_f32 v85, v77, v85
v_mul_f32 v86, v78, v86
v_mul_f32 v87, v79, v87
v_mul_f32 v88, v80, v88
v_mul_f32 v89, v81, v89
v_mul_f32 v90, v82, v90
v_mul_f32 v91, v83, v91
v_cvt_pk_bf16_f32 v60, v84, v85
v_cvt_pk_bf16_f32 v61, v86, v87
v_cvt_pk_bf16_f32 v62, v88, v89
v_cvt_pk_bf16_f32 v63, v90, v91
v_add_f32 v68, v68, v84
v_add_f32 v68, v68, v88
v_add_f32 v69, v69, v85
v_add_f32 v69, v69, v89
v_add_f32 v70, v70, v86
s_waitcnt lgkmcnt(1)
v_mfma_f32_16x16x32_bf16 v[40:43], a[52:55], a[36:39], v[40:43]
buffer_load_dwordx4 a[84:87], v1, s[28:31], s52 offen offset:0 sc1
ds_write_b128 v13, v[60:63] offset:4096
v_add_f32 v70, v70, v90
v_add_f32 v71, v71, v87
v_add_f32 v71, v71, v91
v_mfma_f32_16x16x32_bf16 v[36:39], a[56:59], a[40:43], v[36:39]
v_add_u32 v11, 0xc000, v11
v_mfma_f32_16x16x32_bf16 v[40:43], a[60:63], a[40:43], v[40:43]
buffer_load_dwordx4 a[88:91], v1, s[28:31], s52 offen offset:1024 sc1
s_add_u32 s52, s27, 55296
s_waitcnt lgkmcnt(0)
s_barrier
buffer_load_dwordx4 v[140:143], v1, s[28:31], s52 offen offset:0 sc1
ds_read2_b64 v[28:31], v12 offset0:0 offset1:2
v_mfma_f32_16x16x32_bf16 v[36:39], a[64:67], a[44:47], v[36:39]
v_mfma_f32_16x16x32_bf16 v[40:43], a[48:51], a[44:47], v[40:43]
ds_read2_b64 v[32:35], v12 offset0:4 offset1:6
buffer_load_dwordx4 v[144:147], v1, s[28:31], s52 offen offset:1024 sc1
ds_read_b128 a[52:55], v8 offset:0
ds_read_b128 a[56:59], v8 offset:12288
s_waitcnt lgkmcnt(3)
v_add_f32 v28, v28, v30
v_add_f32 v29, v29, v31
v_add_f32 v28, v28, v26
v_add_f32 v29, v29, v27
ds_read_b128 a[60:63], v8 offset:256
buffer_load_dwordx4 v[148:151], v1, s[28:31], s52 offen offset:2048 sc1
ds_read_b128 a[64:67], v8 offset:12544
s_waitcnt lgkmcnt(4)
v_add_f32 v32, v32, v34
v_add_f32 v33, v33, v35
v_add_f32 v28, v28, v32
v_add_f32 v29, v29, v33
v_mul_f32 v29, s53, v29
s_waitcnt lgkmcnt(2)
v_mfma_f32_16x16x32_bf16 v[44:47], a[52:55], a[0:3], v[56:59]
ds_read_b128 a[48:51], v8 offset:512
v_mul_f32 v28, s53, v28
v_fma_f32 v28, -v29, v29, v28
v_max_f32 v28, 0, v28
v_mfma_f32_16x16x32_bf16 v[48:51], a[56:59], a[0:3], v[56:59]
ds_read_b128 a[52:55], v8 offset:12800
buffer_load_dwordx4 v[152:155], v1, s[28:31], s52 offen offset:3072 sc1
ds_read_b128 a[56:59], v9 offset:0
v_add_f32 v28, s54, v28
v_rsq_f32 v28, v28
v_fmac_f32_dpp v36, v29, v17 row_newbcast:0 row_mask:0xf bank_mask:0xf
v_fmac_f32_dpp v37, v29, v17 row_newbcast:1 row_mask:0xf bank_mask:0xf
s_waitcnt lgkmcnt(4)
v_mfma_f32_16x16x32_bf16 v[44:47], a[60:63], a[4:7], v[44:47]
s_add_u32 s52, s52, 4096
ds_read_b128 a[60:63], v9 offset:12288
v_fmac_f32_dpp v38, v29, v17 row_newbcast:2 row_mask:0xf bank_mask:0xf
v_fmac_f32_dpp v39, v29, v17 row_newbcast:3 row_mask:0xf bank_mask:0xf
v_fmac_f32_dpp v40, v29, v17 row_newbcast:4 row_mask:0xf bank_mask:0xf
s_waitcnt lgkmcnt(4)
v_mfma_f32_16x16x32_bf16 v[48:51], a[64:67], a[4:7], v[48:51]
ds_read_b128 a[64:67], v9 offset:256
buffer_load_dwordx4 v[156:159], v1, s[28:31], s52 offen offset:0 sc1
v_fmac_f32_dpp v41, v29, v17 row_newbcast:5 row_mask:0xf bank_mask:0xf
v_fmac_f32_dpp v42, v29, v17 row_newbcast:6 row_mask:0xf bank_mask:0xf
v_fmac_f32_dpp v43, v29, v17 row_newbcast:7 row_mask:0xf bank_mask:0xf
s_waitcnt lgkmcnt(4)
v_mfma_f32_16x16x32_bf16 v[44:47], a[48:51], a[8:11], v[44:47]
ds_read_b128 a[48:51], v9 offset:12544
v_mov_b32_dpp v84, v28 row_newbcast:0 row_mask:0xf bank_mask:0xf
v_mov_b32_dpp v85, v28 row_newbcast:1 row_mask:0xf bank_mask:0xf
v_mov_b32_dpp v86, v28 row_newbcast:2 row_mask:0xf bank_mask:0xf
s_waitcnt lgkmcnt(3)
v_mfma_f32_16x16x32_bf16 v[48:51], a[52:55], a[8:11], v[48:51]
ds_read_b128 a[52:55], v9 offset:512
v_mov_b32_dpp v87, v28 row_newbcast:3 row_mask:0xf bank_mask:0xf
v_mov_b32_dpp v88, v28 row_newbcast:4 row_mask:0xf bank_mask:0xf
v_mov_b32_dpp v89, v28 row_newbcast:5 row_mask:0xf bank_mask:0xf
v_mov_b32_dpp v90, v28 row_newbcast:6 row_mask:0xf bank_mask:0xf
v_mfma_f32_16x16x32_bf16 v[44:47], a[56:59], a[12:15], v[44:47]
ds_read_b128 a[56:59], v9 offset:12800
buffer_load_dwordx4 a[92:95], v1, s[28:31], s52 offen offset:1024 sc1
v_mov_b32_dpp v91, v28 row_newbcast:7 row_mask:0xf bank_mask:0xf
v_fma_f32 v36, v36, v84, v15
v_fma_f32 v37, v37, v85, v15
s_waitcnt lgkmcnt(3)
v_mfma_f32_16x16x32_bf16 v[48:51], a[60:63], a[12:15], v[48:51]
ds_read_b128 a[60:63], v10 offset:0
v_fma_f32 v38, v38, v86, v15
v_fma_f32 v39, v39, v87, v15
v_fma_f32 v40, v40, v88, v15
v_mfma_f32_16x16x32_bf16 v[44:47], a[64:67], a[16:19], v[44:47]
s_waitcnt lgkmcnt(3)
ds_read_b128 a[64:67], v10 offset:12288
v_fma_f32 v41, v41, v89, v15
v_fma_f32 v42, v42, v90, v15
v_fma_f32 v43, v43, v91, v15
v_mfma_f32_16x16x32_bf16 v[48:51], a[48:51], a[16:19], v[48:51]
s_waitcnt lgkmcnt(3)
ds_read_b128 a[48:51], v10 offset:256
v_exp_f32 v76, v36
v_exp_f32 v77, v37
v_exp_f32 v78, v38
v_exp_f32 v79, v39
v_mfma_f32_16x16x32_bf16 v[44:47], a[52:55], a[20:23], v[44:47]
s_waitcnt lgkmcnt(2)
ds_read_b128 a[52:55], v10 offset:12544
v_exp_f32 v80, v40
v_exp_f32 v81, v41
v_exp_f32 v82, v42
v_mfma_f32_16x16x32_bf16 v[48:51], a[56:59], a[20:23], v[48:51]
ds_read_b128 a[56:59], v10 offset:512
v_exp_f32 v83, v43
v_add_f32 v32, v76, v77
v_add_f32 v33, v78, v79
v_mfma_f32_16x16x32_bf16 v[44:47], a[60:63], a[24:27], v[44:47]
s_waitcnt lgkmcnt(2)
ds_read_b128 a[60:63], v10 offset:12800
v_add_f32 v34, v80, v81
v_add_f32 v35, v82, v83
v_add_f32 v32, v32, v33
v_mfma_f32_16x16x32_bf16 v[48:51], a[64:67], a[24:27], v[48:51]
ds_read_b128 a[64:67], v11 offset:0
v_add_f32 v34, v34, v35
v_add_f32 v32, v32, v34
v_cmp_nge_f32 vcc, s55, v32
s_nop 0
s_cbranch_vccnz RARE6a
C_6a:
v_mfma_f32_16x16x32_bf16 v[44:47], a[48:51], a[28:31], v[44:47]
s_waitcnt lgkmcnt(3)
s_add_u32 s52, s27, 61440
ds_read_b128 a[48:51], v11 offset:12288
v_add_f32 v16, v16, v32
v_mul_f32 v84, v76, v84
v_mul_f32 v85, v77, v85
v_mfma_f32_16x16x32_bf16 v[48:51], a[52:55], a[28:31], v[48:51]
s_waitcnt lgkmcnt(3)
ds_read_b128 a[52:55], v11 offset:256
v_mul_f32 v86, v78, v86
v_mul_f32 v87, v79, v87
v_mul_f32 v88, v80, v88
v_mfma_f32_16x16x32_bf16 v[44:47], a[56:59], a[32:35], v[44:47]
s_waitcnt lgkmcnt(3)
ds_read_b128 a[56:59], v11 offset:12544
v_mul_f32 v89, v81, v89
v_mul_f32 v90, v82, v90
v_mul_f32 v91, v83, v91
v_mfma_f32_16x16x32_bf16 v[48:51], a[60:63], a[32:35], v[48:51]
s_waitcnt lgkmcnt(3)
ds_read_b128 a[60:63], v11 offset:512
v_cvt_pk_bf16_f32 v60, v84, v85
v_cvt_pk_bf16_f32 v61, v86, v87
v_cvt_pk_bf16_f32 v62, v88, v89
v_cvt_pk_bf16_f32 v63, v90, v91
v_mfma_f32_16x16x32_bf16 v[44:47], a[64:67], a[36:39], v[44:47]
s_waitcnt lgkmcnt(3)
ds_write_b128 v13, v[60:63] offset:0
v_add_f32 v72, v84, v88
v_add_f32 v73, v85, v89
v_mfma_f32_16x16x32_bf16 v[48:51], a[48:51], a[36:39], v[48:51]
s_waitcnt lgkmcnt(3)
v_add_f32 v74, v86, v90
v_add_f32 v75, v87, v91
v_mfma_f32_16x16x32_bf16 v[44:47], a[52:55], a[40:43], v[44:47]
s_waitcnt lgkmcnt(2)
v_mfma_f32_16x16x32_bf16 v[48:51], a[56:59], a[40:43], v[48:51]
ds_read_b128 a[64:67], v11 offset:12800
s_waitcnt lgkmcnt(0)
s_barrier
buffer_load_dwordx4 a[0:3], v1, s[28:31], s52 offen offset:0 sc1
ds_read2_b64 v[28:31], v12 offset0:160 offset1:162
v_mfma_f32_16x16x32_bf16 v[44:47], a[60:63], a[44:47], v[44:47]
v_mfma_f32_16x16x32_bf16 v[48:51], a[64:67], a[44:47], v[48:51]
ds_read2_b64 v[32:35], v12 offset0:164 offset1:166
v_and_b32 v12, 15, v0
v_lshlrev_b32 v14, 4, v12
v_lshlrev_b32 v12, 8, v12
buffer_load_dwordx4 a[4:7], v1, s[28:31], s52 offen offset:1024 sc1
s_waitcnt lgkmcnt(1)
v_add_f32 v28, v28, v30
v_add_f32 v29, v29, v31
v_add_f32 v28, v28, v26
v_add_f32 v29, v29, v27
buffer_load_dwordx4 a[8:11], v1, s[28:31], s52 offen offset:2048 sc1
s_waitcnt lgkmcnt(0)
v_add_f32 v32, v32, v34
v_add_f32 v33, v33, v35
v_add_f32 v28, v28, v32
v_add_f32 v29, v29, v33
v_mul_f32 v29, s53, v29
v_mul_f32 v28, s53, v28
v_fma_f32 v28, -v29, v29, v28
v_max_f32 v28, 0, v28
v_add_f32 v28, s54, v28
v_rsq_f32 v28, v28
v_fmac_f32_dpp v44, v29, v17 row_newbcast:0 row_mask:0xf bank_mask:0xf
v_fmac_f32_dpp v45, v29, v17 row_newbcast:1 row_mask:0xf bank_mask:0xf
v_fmac_f32_dpp v46, v29, v17 row_newbcast:2 row_mask:0xf bank_mask:0xf
v_fmac_f32_dpp v47, v29, v17 row_newbcast:3 row_mask:0xf bank_mask:0xf
v_fmac_f32_dpp v48, v29, v17 row_newbcast:4 row_mask:0xf bank_mask:0xf
v_fmac_f32_dpp v49, v29, v17 row_newbcast:5 row_mask:0xf bank_mask:0xf
v_fmac_f32_dpp v50, v29, v17 row_newbcast:6 row_mask:0xf bank_mask:0xf
v_fmac_f32_dpp v51, v29, v17 row_newbcast:7 row_mask:0xf bank_mask:0xf
v_mov_b32_dpp v84, v28 row_newbcast:0 row_mask:0xf bank_mask:0xf
v_mov_b32_dpp v85, v28 row_newbcast:1 row_mask:0xf bank_mask:0xf
v_mov_b32_dpp v86, v28 row_newbcast:2 row_mask:0xf bank_mask:0xf
v_mov_b32_dpp v87, v28 row_newbcast:3 row_mask:0xf bank_mask:0xf
v_mov_b32_dpp v88, v28 row_newbcast:4 row_mask:0xf bank_mask:0xf
v_mov_b32_dpp v89, v28 row_newbcast:5 row_mask:0xf bank_mask:0xf
v_mov_b32_dpp v90, v28 row_newbcast:6 row_mask:0xf bank_mask:0xf
v_mov_b32_dpp v91, v28 row_newbcast:7 row_mask:0xf bank_mask:0xf
v_fma_f32 v44, v44, v84, v15
v_fma_f32 v45, v45, v85, v15
v_fma_f32 v46, v46, v86, v15
v_fma_f32 v47, v47, v87, v15
v_fma_f32 v48, v48, v88, v15
v_fma_f32 v49, v49, v89, v15
v_fma_f32 v50, v50, v90, v15
v_fma_f32 v51, v51, v91, v15
v_exp_f32 v76, v44
v_exp_f32 v77, v45
v_exp_f32 v78, v46
v_exp_f32 v79, v47
v_exp_f32 v80, v48
v_exp_f32 v81, v49
v_exp_f32 v82, v50
v_exp_f32 v83, v51
v_add_f32 v32, v76, v77
v_add_f32 v33, v78, v79
v_add_f32 v34, v80, v81
v_add_f32 v35, v82, v83
v_add_f32 v32, v32, v33
v_add_f32 v34, v34, v35
v_add_f32 v32, v32, v34
v_cmp_nge_f32 vcc, s55, v32
buffer_load_dwordx4 a[12:15], v1, s[28:31], s52 offen offset:3072 sc1
s_add_u32 s52, s52, 4096
s_cbranch_vccnz RARE7a
C_7a:
v_add_f32 v16, v16, v32
v_mul_f32 v84, v76, v84
v_mul_f32 v85, v77, v85
v_mul_f32 v86, v78, v86
v_mul_f32 v87, v79, v87
v_mul_f32 v88, v80, v88
v_mul_f32 v89, v81, v89
v_mul_f32 v90, v82, v90
v_mul_f32 v91, v83, v91
v_cvt_pk_bf16_f32 v60, v84, v85
v_cvt_pk_bf16_f32 v61, v86, v87
v_cvt_pk_bf16_f32 v62, v88, v89
v_cvt_pk_bf16_f32 v63, v90, v91
v_add_f32 v72, v72, v84
v_add_f32 v72, v72, v88
v_add_f32 v73, v73, v85
v_add_f32 v73, v73, v89
v_add_f32 v74, v74, v86
v_add_f32 v74, v74, v90
v_add_f32 v75, v75, v87
v_add_f32 v75, v75, v91
v_cvt_pk_bf16_f32 v64, v68, v69
v_cvt_pk_bf16_f32 v65, v70, v71
v_cvt_pk_bf16_f32 v66, v72, v73
v_cvt_pk_bf16_f32 v67, v74, v75
v_mov_b32 v28, v16
buffer_load_dwordx4 a[16:19], v1, s[28:31], s52 offen offset:0 sc1
ds_write_b128 v13, v[60:63] offset:4096
v_permlane32_swap_b32 v16, v28
v_add_f32 v16, v16, v28
v_mov_b32 v28, v16
s_nop 1
v_permlane16_swap_b32 v16, v28
v_add_f32 v16, v16, v28
ds_write_b128 v13, v[64:67] offset:8192
v_and_b32 v13, 48, v0
v_add_u32 v12, v12, v13
buffer_load_dwordx4 a[20:23], v1, s[28:31], s52 offen offset:1024 sc1
s_add_u32 s52, s27, 12288
s_waitcnt lgkmcnt(0)
s_barrier
buffer_load_dwordx4 a[24:27], v1, s[28:31], s52 offen offset:0 sc1
buffer_load_dwordx4 a[28:31], v1, s[28:31], s52 offen offset:1024 sc1
buffer_load_dwordx4 a[32:35], v1, s[28:31], s52 offen offset:2048 sc1
buffer_load_dwordx4 a[36:39], v1, s[28:31], s52 offen offset:3072 sc1
s_add_u32 s52, s52, 4096
buffer_load_dwordx4 a[40:43], v1, s[28:31], s52 offen offset:0 sc1
buffer_load_dwordx4 a[44:47], v1, s[28:31], s52 offen offset:1024 sc1
s_add_u32 s52, s27, 30720
buffer_load_dwordx4 a[48:51], v1, s[28:31], s52 offen offset:0 sc1
buffer_load_dwordx4 a[52:55], v1, s[28:31], s52 offen offset:1024 sc1
buffer_load_dwordx4 a[56:59], v1, s[28:31], s52 offen offset:2048 sc1
buffer_load_dwordx4 a[60:63], v1, s[28:31], s52 offen offset:3072 sc1
s_add_u32 s52, s52, 4096
buffer_load_dwordx4 a[64:67], v1, s[28:31], s52 offen offset:0 sc1
buffer_load_dwordx4 v[20:23], v1, s[28:31], s52 offen offset:1024 sc1
s_add_u32 s52, s27, 49152
buffer_load_dwordx4 v[68:71], v1, s[28:31], s52 offen offset:0 sc1
buffer_load_dwordx4 v[72:75], v1, s[28:31], s52 offen offset:1024 sc1
buffer_load_dwordx4 v[76:79], v1, s[28:31], s52 offen offset:2048 sc1
buffer_load_dwordx4 v[80:83], v1, s[28:31], s52 offen offset:3072 sc1
s_add_u32 s52, s52, 4096
s_add_u32 s50, s50, 49152
v_add_u32 v8, s50, v1
s_add_u32 s50, s24, 24576
v_add_u32 v9, s50, v1
s_add_u32 s50, s24, 122880
v_add_u32 v10, s50, v1
s_add_u32 s50, s24, 0
v_add_u32 v11, s50, v1
s_lshl_b32 s50, s2, 14
s_lshl_b32 s51, s3, 12
s_add_u32 s50, s50, s51
s_lshr_b32 s51, s50, 4
s_add_u32 s50, s50, 524288
s_add_u32 s51, s51, 4718592
buffer_load_dwordx4 v[84:87], v1, s[28:31], s52 offen offset:0 sc1
buffer_load_dwordx4 v[88:91], v1, s[28:31], s52 offen offset:1024 sc1
s_barrier
s_add_u32 s52, s27, 67584
ds_read_b128 v[28:31], v8 offset:0
ds_read_b128 v[32:35], v8 offset:3072
ds_read_b128 v[60:63], v8 offset:6144
ds_read_b128 v[64:67], v8 offset:9216
s_waitcnt vmcnt(42) lgkmcnt(3)
v_mfma_f32_16x16x32_bf16 v[36:39], v[92:95], v[28:31], 0
buffer_load_dwordx4 v[92:95], v1, s[28:31], s52 offen offset:0 sc1
v_mfma_f32_16x16x32_bf16 v[40:43], v[96:99], v[28:31], 0
v_mfma_f32_16x16x32_bf16 v[44:47], v[100:103], v[28:31], 0
v_mfma_f32_16x16x32_bf16 v[48:51], v[104:107], v[28:31], 0
v_mfma_f32_16x16x32_bf16 v[52:55], v[108:111], v[28:31], 0
buffer_load_dwordx4 v[96:99], v1, s[28:31], s52 offen offset:1024 sc1
v_mfma_f32_16x16x32_bf16 v[56:59], v[112:115], v[28:31], 0
s_waitcnt vmcnt(38) lgkmcnt(0)
v_mfma_f32_16x16x32_bf16 v[36:39], v[116:119], v[32:35], v[36:39]
ds_read_b128 v[116:119], v9 offset:0
v_mfma_f32_16x16x32_bf16 v[40:43], v[120:123], v[32:35], v[40:43]
ds_read_b128 v[120:123], v9 offset:1024
v_mfma_f32_16x16x32_bf16 v[44:47], v[124:127], v[32:35], v[44:47]
buffer_load_dwordx4 v[100:103], v1, s[28:31], s52 offen offset:2048 sc1
ds_read_b128 v[124:127], v9 offset:2048
v_mfma_f32_16x16x32_bf16 v[48:51], v[128:131], v[32:35], v[48:51]
ds_read_b128 v[128:131], v9 offset:3072
v_mfma_f32_16x16x32_bf16 v[52:55], v[132:135], v[32:35], v[52:55]
ds_read_b128 v[132:135], v9 offset:4096
v_mfma_f32_16x16x32_bf16 v[56:59], v[136:139], v[32:35], v[56:59]
ds_read_b128 v[136:139], v9 offset:5120
s_waitcnt vmcnt(33)
v_mfma_f32_16x16x32_bf16 v[36:39], a[68:71], v[60:63], v[36:39]
buffer_load_dwordx4 v[104:107], v1, s[28:31], s52 offen offset:3072 sc1
ds_read_b128 a[68:71], v10 offset:0
s_add_u32 s52, s52, 4096
v_mfma_f32_16x16x32_bf16 v[40:43], a[72:75], v[60:63], v[40:43]
ds_read_b128 a[72:75], v10 offset:1024
v_mfma_f32_16x16x32_bf16 v[44:47], a[76:79], v[60:63], v[44:47]
ds_read_b128 a[76:79], v10 offset:2048
v_mfma_f32_16x16x32_bf16 v[48:51], a[80:83], v[60:63], v[48:51]
ds_read_b128 a[80:83], v10 offset:3072
v_mfma_f32_16x16x32_bf16 v[52:55], a[84:87], v[60:63], v[52:55]
buffer_load_dwordx4 v[108:111], v1, s[28:31], s52 offen offset:0 sc1
ds_read_b128 a[84:87], v10 offset:4096
v_mfma_f32_16x16x32_bf16 v[56:59], a[88:91], v[60:63], v[56:59]
ds_read_b128 a[88:91], v10 offset:5120
s_waitcnt vmcnt(29)
v_mfma_f32_16x16x32_bf16 v[36:39], v[140:143], v[64:67], v[36:39]
ds_read_b128 v[140:143], v11 offset:0
v_mfma_f32_16x16x32_bf16 v[40:43], v[144:147], v[64:67], v[40:43]
ds_read_b128 v[144:147], v11 offset:1024
buffer_load_dwordx4 v[112:115], v1, s[28:31], s52 offen offset:1024 sc1
v_mfma_f32_16x16x32_bf16 v[44:47], v[148:151], v[64:67], v[44:47]
ds_read_b128 v[148:151], v11 offset:2048
v_mfma_f32_16x16x32_bf16 v[48:51], v[152:155], v[64:67], v[48:51]
s_barrier
ds_read_b128 v[152:155], v11 offset:3072
v_mfma_f32_16x16x32_bf16 v[52:55], v[156:159], v[64:67], v[52:55]
ds_read_b128 v[156:159], v11 offset:4096
v_mfma_f32_16x16x32_bf16 v[56:59], a[92:95], v[64:67], v[56:59]
ds_read_b128 a[92:95], v11 offset:5120
ds_read_b128 v[28:31], v8 offset:1024
ds_read_b128 v[32:35], v8 offset:4096
ds_read_b128 v[60:63], v8 offset:7168
ds_read_b128 v[64:67], v8 offset:10240
s_waitcnt lgkmcnt(3)
v_mfma_f32_16x16x32_bf16 v[36:39], v[116:119], v[28:31], v[36:39]
v_mfma_f32_16x16x32_bf16 v[40:43], v[120:123], v[28:31], v[40:43]
v_mfma_f32_16x16x32_bf16 v[44:47], v[124:127], v[28:31], v[44:47]
v_mfma_f32_16x16x32_bf16 v[48:51], v[128:131], v[28:31], v[48:51]
s_waitcnt lgkmcnt(0)
s_barrier
v_mfma_f32_16x16x32_bf16 v[52:55], v[132:135], v[28:31], v[52:55]
v_mfma_f32_16x16x32_bf16 v[56:59], v[136:139], v[28:31], v[56:59]
ds_read_b128 v[28:31], v8 offset:2048
v_mfma_f32_16x16x32_bf16 v[36:39], a[68:71], v[32:35], v[36:39]
v_mfma_f32_16x16x32_bf16 v[40:43], a[72:75], v[32:35], v[40:43]
v_mfma_f32_16x16x32_bf16 v[44:47], a[76:79], v[32:35], v[44:47]
v_mfma_f32_16x16x32_bf16 v[48:51], a[80:83], v[32:35], v[48:51]
v_mfma_f32_16x16x32_bf16 v[52:55], a[84:87], v[32:35], v[52:55]
v_mfma_f32_16x16x32_bf16 v[56:59], a[88:91], v[32:35], v[56:59]
ds_read_b128 v[32:35], v8 offset:5120
v_mfma_f32_16x16x32_bf16 v[36:39], v[140:143], v[60:63], v[36:39]
v_mov_b32 v143, s38
v_mfma_f32_16x16x32_bf16 v[40:43], v[144:147], v[60:63], v[40:43]
v_mov_b32 v147, s38
v_mfma_f32_16x16x32_bf16 v[44:47], v[148:151], v[60:63], v[44:47]
v_mov_b32 v151, s38
v_mfma_f32_16x16x32_bf16 v[48:51], v[152:155], v[60:63], v[48:51]
v_mov_b32 v155, s38
v_mfma_f32_16x16x32_bf16 v[52:55], v[156:159], v[60:63], v[52:55]
v_sub_f32 v156, 0, v15
v_mov_b32 v157, v16
v_mfma_f32_16x16x32_bf16 v[56:59], a[92:95], v[60:63], v[56:59]
ds_read_b128 v[60:63], v8 offset:8192
v_mov_b32 v158, s38
s_waitcnt vmcnt(24)
v_mfma_f32_16x16x32_bf16 v[36:39], a[0:3], v[64:67], v[36:39]
v_mov_b32 v159, s38
v_mfma_f32_16x16x32_bf16 v[40:43], a[4:7], v[64:67], v[40:43]
v_mfma_f32_16x16x32_bf16 v[44:47], a[8:11], v[64:67], v[44:47]
v_mfma_f32_16x16x32_bf16 v[48:51], a[12:15], v[64:67], v[48:51]
v_mfma_f32_16x16x32_bf16 v[52:55], a[16:19], v[64:67], v[52:55]
v_mfma_f32_16x16x32_bf16 v[56:59], a[20:23], v[64:67], v[56:59]
ds_read_b128 v[64:67], v8 offset:11264
s_waitcnt vmcnt(18) lgkmcnt(1)
v_mfma_f32_16x16x32_bf16 v[36:39], a[24:27], v[28:31], v[36:39]
v_mfma_f32_16x16x32_bf16 v[40:43], a[28:31], v[28:31], v[40:43]
s_waitcnt vmcnt(12)
v_mfma_f32_16x16x32_bf16 v[36:39], a[48:51], v[32:35], v[36:39]
v_mfma_f32_16x16x32_bf16 v[40:43], a[52:55], v[32:35], v[40:43]
s_waitcnt vmcnt(6)
v_mfma_f32_16x16x32_bf16 v[36:39], v[68:71], v[60:63], v[36:39]
v_mfma_f32_16x16x32_bf16 v[40:43], v[72:75], v[60:63], v[40:43]
s_waitcnt vmcnt(0) lgkmcnt(0)
v_mfma_f32_16x16x32_bf16 v[36:39], v[92:95], v[64:67], v[36:39]
v_mfma_f32_16x16x32_bf16 v[40:43], v[96:99], v[64:67], v[40:43]
v_mfma_f32_16x16x32_bf16 v[44:47], a[32:35], v[28:31], v[44:47]
s_nop 5
v_cvt_pk_bf16_f32 v140, v36, v37
v_mfma_f32_16x16x32_bf16 v[44:47], a[56:59], v[32:35], v[44:47]
v_cvt_pk_bf16_f32 v141, v38, v39
v_cvt_pk_bf16_f32 v142, v40, v41
v_mfma_f32_16x16x32_bf16 v[44:47], v[76:79], v[60:63], v[44:47]
buffer_store_dwordx4 v[140:143], v12, s[28:31], s50 offen offset:0 sc0 sc1
v_cvt_pk_bf16_f32 v144, v42, v43
v_mfma_f32_16x16x32_bf16 v[44:47], v[100:103], v[64:67], v[44:47]
v_mfma_f32_16x16x32_bf16 v[48:51], a[36:39], v[28:31], v[48:51]
v_mfma_f32_16x16x32_bf16 v[52:55], a[40:43], v[28:31], v[52:55]
s_nop 5
v_cvt_pk_bf16_f32 v145, v44, v45
v_mfma_f32_16x16x32_bf16 v[48:51], a[60:63], v[32:35], v[48:51]
v_cvt_pk_bf16_f32 v146, v46, v47
v_mfma_f32_16x16x32_bf16 v[52:55], a[64:67], v[32:35], v[52:55]
buffer_store_dwordx4 v[144:147], v12, s[28:31], s50 offen offset:64 sc0 sc1
v_mfma_f32_16x16x32_bf16 v[48:51], v[80:83], v[60:63], v[48:51]
v_mfma_f32_16x16x32_bf16 v[52:55], v[84:87], v[60:63], v[52:55]
v_mfma_f32_16x16x32_bf16 v[48:51], v[104:107], v[64:67], v[48:51]
v_mfma_f32_16x16x32_bf16 v[52:55], v[108:111], v[64:67], v[52:55]
v_mfma_f32_16x16x32_bf16 v[56:59], a[44:47], v[28:31], v[56:59]
s_nop 5
v_cvt_pk_bf16_f32 v148, v48, v49
v_mfma_f32_16x16x32_bf16 v[56:59], v[20:23], v[32:35], v[56:59]
v_cvt_pk_bf16_f32 v149, v50, v51
v_cvt_pk_bf16_f32 v150, v52, v53
v_mfma_f32_16x16x32_bf16 v[56:59], v[88:91], v[60:63], v[56:59]
buffer_store_dwordx4 v[148:151], v12, s[28:31], s50 offen offset:128 sc0 sc1
v_cvt_pk_bf16_f32 v152, v54, v55
v_mfma_f32_16x16x32_bf16 v[56:59], v[112:115], v[64:67], v[56:59]
s_nop 7
v_cvt_pk_bf16_f32 v153, v56, v57
v_cvt_pk_bf16_f32 v154, v58, v59
buffer_store_dwordx4 v[152:155], v12, s[28:31], s50 offen offset:192 sc0 sc1
buffer_store_dwordx4 v[156:159], v14, s[28:31], s51 offen sc0 sc1
s_branch T_red
J_Bb:
s_waitcnt vmcnt(0) lgkmcnt(0)
s_add_u32 s38, s38, 1
s_barrier
s_mul_i32 s50, s3, 12
v_add3_u32 v52, s50, v50, 0
v_xor_b32 v52, v52, v49
v_lshl_add_u32 v52, v52, 4, v48
v_add3_u32 v53, s50, v50, 2
v_xor_b32 v53, v53, v49
v_lshl_add_u32 v53, v53, 4, v48
v_add3_u32 v54, s50, v50, 4
v_xor_b32 v54, v54, v49
v_lshl_add_u32 v54, v54, 4, v48
v_add3_u32 v55, s50, v50, 6
v_xor_b32 v55, v55, v49
v_lshl_add_u32 v55, v55, 4, v48
v_add3_u32 v56, s50, v50, 8
v_xor_b32 v56, v56, v49
v_lshl_add_u32 v56, v56, 4, v48
v_add3_u32 v57, s50, v50, 10
v_xor_b32 v57, v57, v49
v_lshl_add_u32 v57, v57, 4, v48
v_mov_b32 v62, 0
s_lshl_b32 s50, s3, 2
v_add_u32 v63, s50, v22
s_add_u32 s49, s26, 221184
s_add_u32 m0, s24, 122880
ds_read_b128 a[16:19], v44 offset:0
s_mul_i32 s50, s3, 3072
ds_read_b128 a[20:23], v44 offset:4096
ds_read_b128 a[24:27], v44 offset:8192
ds_read_b128 a[28:31], v44 offset:12288
ds_read_b64_tr_b16 a[48:49], v24 offset:0
ds_read_b64_tr_b16 a[50:51], v25 offset:0
ds_read_b64_tr_b16 a[52:53], v26 offset:0
ds_read_b64_tr_b16 a[54:55], v27 offset:0
ds_read_b64_tr_b16 a[56:57], v28 offset:0
ds_read_b64_tr_b16 a[58:59], v29 offset:0
ds_read_b64_tr_b16 a[60:61], v30 offset:0
ds_read_b64_tr_b16 a[62:63], v31 offset:0
ds_read_b64_tr_b16 a[64:65], v32 offset:0
s_waitcnt lgkmcnt(7)
v_mfma_f32_16x16x32_bf16 v[64:67], a[48:51], a[16:19], 0
ds_read_b64_tr_b16 a[66:67], v33 offset:0
ds_read_b64_tr_b16 a[68:69], v34 offset:0
v_mfma_f32_16x16x32_bf16 v[68:71], a[48:51], a[20:23], 0
ds_read_b64_tr_b16 a[70:71], v35 offset:0
v_mfma_f32_16x16x32_bf16 v[72:75], a[48:51], a[24:27], 0
v_mfma_f32_16x16x32_bf16 v[76:79], a[48:51], a[28:31], 0
s_waitcnt lgkmcnt(3)
v_mfma_f32_16x16x32_bf16 v[80:83], a[52:55], a[16:19], 0
v_mfma_f32_16x16x32_bf16 v[84:87], a[52:55], a[20:23], 0
s_waitcnt lgkmcnt(0)
s_barrier
v_mfma_f32_16x16x32_bf16 v[88:91], a[52:55], a[24:27], 0
v_mfma_f32_16x16x32_bf16 v[92:95], a[52:55], a[28:31], 0
ds_read_b128 a[32:35], v45 offset:0
v_mfma_f32_16x16x32_bf16 v[96:99], a[56:59], a[16:19], 0
ds_read_b128 a[36:39], v45 offset:4096
v_mfma_f32_16x16x32_bf16 v[100:103], a[56:59], a[20:23], 0
ds_read_b128 a[40:43], v45 offset:8192
v_mfma_f32_16x16x32_bf16 v[104:107], a[56:59], a[24:27], 0
ds_read_b128 a[44:47], v45 offset:12288
v_mfma_f32_16x16x32_bf16 v[108:111], a[56:59], a[28:31], 0
ds_read_b64_tr_b16 a[72:73], v24 offset:24576
v_mfma_f32_16x16x32_bf16 v[112:115], a[60:63], a[16:19], 0
ds_read_b64_tr_b16 a[74:75], v25 offset:24576
ds_read_b64_tr_b16 a[76:77], v26 offset:24576
v_mfma_f32_16x16x32_bf16 v[116:119], a[60:63], a[20:23], 0
ds_read_b64_tr_b16 a[78:79], v27 offset:24576
v_add_u32 v24, 0xc000, v24
v_mfma_f32_16x16x32_bf16 v[120:123], a[60:63], a[24:27], 0
ds_read_b64_tr_b16 a[80:81], v28 offset:24576
ds_read_b64_tr_b16 a[82:83], v29 offset:24576
v_mfma_f32_16x16x32_bf16 v[124:127], a[60:63], a[28:31], 0
ds_read_b64_tr_b16 a[84:85], v30 offset:24576
ds_read_b64_tr_b16 a[86:87], v31 offset:24576
v_mfma_f32_16x16x32_bf16 v[128:131], a[64:67], a[16:19], 0
ds_read_b64_tr_b16 a[88:89], v32 offset:24576
v_add_u32 v25, 0xc000, v25
v_mfma_f32_16x16x32_bf16 v[132:135], a[64:67], a[20:23], 0
ds_read_b64_tr_b16 a[90:91], v33 offset:24576
ds_read_b64_tr_b16 a[92:93], v34 offset:24576
v_mfma_f32_16x16x32_bf16 v[136:139], a[64:67], a[24:27], 0
ds_read_b64_tr_b16 a[94:95], v35 offset:24576
v_add_u32 v26, 0xc000, v26
v_mfma_f32_16x16x32_bf16 v[140:143], a[64:67], a[28:31], 0
v_add_u32 v27, 0xc000, v27
v_add_u32 v28, 0xc000, v28
v_mfma_f32_16x16x32_bf16 v[144:147], a[68:71], a[16:19], 0
v_add_u32 v29, 0xc000, v29
v_add_u32 v30, 0xc000, v30
v_mfma_f32_16x16x32_bf16 v[148:151], a[68:71], a[20:23], 0
v_add_u32 v31, 0xc000, v31
v_add_u32 v32, 0xc000, v32
v_mfma_f32_16x16x32_bf16 v[152:155], a[68:71], a[24:27], 0
v_add_u32 v33, 0xc000, v33
s_waitcnt lgkmcnt(0)
s_barrier
v_mfma_f32_16x16x32_bf16 v[156:159], a[68:71], a[28:31], 0
v_add_u32 v34, 0xc000, v34
v_add_u32 v35, 0xc000, v35
v_mfma_f32_16x16x32_bf16 v[64:67], a[72:75], a[32:35], v[64:67]
ds_read_b128 a[16:19], v46 offset:0
v_mfma_f32_16x16x32_bf16 v[68:71], a[72:75], a[36:39], v[68:71]
ds_read_b128 a[20:23], v46 offset:4096
v_mfma_f32_16x16x32_bf16 v[72:75], a[72:75], a[40:43], v[72:75]
ds_read_b128 a[24:27], v46 offset:8192
v_mfma_f32_16x16x32_bf16 v[76:79], a[72:75], a[44:47], v[76:79]
ds_read_b128 a[28:31], v46 offset:12288
v_mfma_f32_16x16x32_bf16 v[80:83], a[76:79], a[32:35], v[80:83]
ds_read_b64_tr_b16 a[48:49], v24 offset:0
v_mfma_f32_16x16x32_bf16 v[84:87], a[76:79], a[36:39], v[84:87]
ds_read_b64_tr_b16 a[50:51], v25 offset:0
ds_read_b64_tr_b16 a[52:53], v26 offset:0
v_mfma_f32_16x16x32_bf16 v[88:91], a[76:79], a[40:43], v[88:91]
ds_read_b64_tr_b16 a[54:55], v27 offset:0
v_mfma_f32_16x16x32_bf16 v[92:95], a[76:79], a[44:47], v[92:95]
ds_read_b64_tr_b16 a[56:57], v28 offset:0
ds_read_b64_tr_b16 a[58:59], v29 offset:0
v_mfma_f32_16x16x32_bf16 v[96:99], a[80:83], a[32:35], v[96:99]
ds_read_b64_tr_b16 a[60:61], v30 offset:0
ds_read_b64_tr_b16 a[62:63], v31 offset:0
v_mfma_f32_16x16x32_bf16 v[100:103], a[80:83], a[36:39], v[100:103]
ds_read_b64_tr_b16 a[64:65], v32 offset:0
v_mfma_f32_16x16x32_bf16 v[104:107], a[80:83], a[40:43], v[104:107]
ds_read_b64_tr_b16 a[66:67], v33 offset:0
ds_read_b64_tr_b16 a[68:69], v34 offset:0
v_mfma_f32_16x16x32_bf16 v[108:111], a[80:83], a[44:47], v[108:111]
ds_read_b64_tr_b16 a[70:71], v35 offset:0
v_mfma_f32_16x16x32_bf16 v[112:115], a[84:87], a[32:35], v[112:115]
v_mfma_f32_16x16x32_bf16 v[116:119], a[84:87], a[36:39], v[116:119]
v_mfma_f32_16x16x32_bf16 v[120:123], a[84:87], a[40:43], v[120:123]
v_mfma_f32_16x16x32_bf16 v[124:127], a[84:87], a[44:47], v[124:127]
s_waitcnt lgkmcnt(0)
s_barrier
v_mfma_f32_16x16x32_bf16 v[128:131], a[88:91], a[32:35], v[128:131]
v_mfma_f32_16x16x32_bf16 v[132:135], a[88:91], a[36:39], v[132:135]
ds_read_b64_tr_b16 a[72:73], v24 offset:24576
ds_read_b64_tr_b16 a[74:75], v25 offset:24576
ds_read_b64_tr_b16 a[76:77], v26 offset:24576
v_mfma_f32_16x16x32_bf16 v[136:139], a[88:91], a[40:43], v[136:139]
ds_read_b64_tr_b16 a[78:79], v27 offset:24576
v_add_u32 v24, 0xffff4000, v24
v_mfma_f32_16x16x32_bf16 v[140:143], a[88:91], a[44:47], v[140:143]
ds_read_b64_tr_b16 a[80:81], v28 offset:24576
ds_read_b64_tr_b16 a[82:83], v29 offset:24576
v_mfma_f32_16x16x32_bf16 v[144:147], a[92:95], a[32:35], v[144:147]
ds_read_b128 a[32:35], v47 offset:0
v_add_u32 v25, 0xffff4000, v25
v_mfma_f32_16x16x32_bf16 v[148:151], a[92:95], a[36:39], v[148:151]
ds_read_b128 a[36:39], v47 offset:4096
v_add_u32 v26, 0xffff4000, v26
v_mfma_f32_16x16x32_bf16 v[152:155], a[92:95], a[40:43], v[152:155]
ds_read_b128 a[40:43], v47 offset:8192
v_add_u32 v27, 0xffff4000, v27
v_mfma_f32_16x16x32_bf16 v[156:159], a[92:95], a[44:47], v[156:159]
ds_read_b128 a[44:47], v47 offset:12288
v_mfma_f32_16x16x32_bf16 v[64:67], a[48:51], a[16:19], v[64:67]
v_add_u32 v28, 0xffff4000, v28
v_add_u32 v29, 0xffff4000, v29
v_mfma_f32_16x16x32_bf16 v[68:71], a[48:51], a[20:23], v[68:71]
ds_read_b64_tr_b16 a[84:85], v30 offset:24576
ds_read_b64_tr_b16 a[86:87], v31 offset:24576
ds_read_b64_tr_b16 a[88:89], v32 offset:24576
v_mfma_f32_16x16x32_bf16 v[72:75], a[48:51], a[24:27], v[72:75]
ds_read_b64_tr_b16 a[90:91], v33 offset:24576
v_add_u32 v30, 0xffff4000, v30
v_mfma_f32_16x16x32_bf16 v[76:79], a[48:51], a[28:31], v[76:79]
ds_read_b64_tr_b16 a[92:93], v34 offset:24576
ds_read_b64_tr_b16 a[94:95], v35 offset:24576
v_mfma_f32_16x16x32_bf16 v[80:83], a[52:55], a[16:19], v[80:83]
v_add_u32 v31, 0xffff4000, v31
v_add_u32 v32, 0xffff4000, v32
v_mfma_f32_16x16x32_bf16 v[84:87], a[52:55], a[20:23], v[84:87]
v_add_u32 v33, 0xffff4000, v33
v_add_u32 v34, 0xffff4000, v34
v_mfma_f32_16x16x32_bf16 v[88:91], a[52:55], a[24:27], v[88:91]
v_add_u32 v35, 0xffff4000, v35
v_mfma_f32_16x16x32_bf16 v[92:95], a[52:55], a[28:31], v[92:95]
v_mfma_f32_16x16x32_bf16 v[96:99], a[56:59], a[16:19], v[96:99]
s_waitcnt lgkmcnt(0)
s_barrier
v_mfma_f32_16x16x32_bf16 v[100:103], a[56:59], a[20:23], v[100:103]
v_mfma_f32_16x16x32_bf16 v[104:107], a[56:59], a[24:27], v[104:107]
ds_read_b64_tr_b16 a[48:49], v24 offset:0
v_mfma_f32_16x16x32_bf16 v[108:111], a[56:59], a[28:31], v[108:111]
ds_read_b64_tr_b16 a[50:51], v25 offset:0
ds_read_b64_tr_b16 a[52:53], v26 offset:0
v_mfma_f32_16x16x32_bf16 v[112:115], a[60:63], a[16:19], v[112:115]
ds_read_b64_tr_b16 a[54:55], v27 offset:0
ds_read_b64_tr_b16 a[56:57], v28 offset:0
v_mfma_f32_16x16x32_bf16 v[116:119], a[60:63], a[20:23], v[116:119]
ds_read_b64_tr_b16 a[58:59], v29 offset:0
v_mfma_f32_16x16x32_bf16 v[120:123], a[60:63], a[24:27], v[120:123]
v_mfma_f32_16x16x32_bf16 v[124:127], a[60:63], a[28:31], v[124:127]
ds_read_b64_tr_b16 a[60:61], v30 offset:0
ds_read_b64_tr_b16 a[62:63], v31 offset:0
v_mfma_f32_16x16x32_bf16 v[128:131], a[64:67], a[16:19], v[128:131]
v_mfma_f32_16x16x32_bf16 v[132:135], a[64:67], a[20:23], v[132:135]
v_mfma_f32_16x16x32_bf16 v[136:139], a[64:67], a[24:27], v[136:139]
v_mfma_f32_16x16x32_bf16 v[140:143], a[64:67], a[28:31], v[140:143]
ds_read_b64_tr_b16 a[64:65], v32 offset:0
ds_read_b64_tr_b16 a[66:67], v33 offset:0
v_mfma_f32_16x16x32_bf16 v[144:147], a[68:71], a[16:19], v[144:147]
ds_read_b128 a[16:19], v44 offset:16384
v_mfma_f32_16x16x32_bf16 v[148:151], a[68:71], a[20:23], v[148:151]
ds_read_b128 a[20:23], v44 offset:20480
v_mfma_f32_16x16x32_bf16 v[152:155], a[68:71], a[24:27], v[152:155]
ds_read_b128 a[24:27], v44 offset:24576
v_mfma_f32_16x16x32_bf16 v[156:159], a[68:71], a[28:31], v[156:159]
ds_read_b128 a[28:31], v44 offset:28672
v_mfma_f32_16x16x32_bf16 v[64:67], a[72:75], a[32:35], v[64:67]
ds_read_b64_tr_b16 a[68:69], v34 offset:0
v_mfma_f32_16x16x32_bf16 v[68:71], a[72:75], a[36:39], v[68:71]
ds_read_b64_tr_b16 a[70:71], v35 offset:0
v_mfma_f32_16x16x32_bf16 v[72:75], a[72:75], a[40:43], v[72:75]
v_mfma_f32_16x16x32_bf16 v[76:79], a[72:75], a[44:47], v[76:79]
v_mfma_f32_16x16x32_bf16 v[80:83], a[76:79], a[32:35], v[80:83]
v_mfma_f32_16x16x32_bf16 v[84:87], a[76:79], a[36:39], v[84:87]
s_waitcnt lgkmcnt(0)
s_barrier
v_mfma_f32_16x16x32_bf16 v[88:91], a[76:79], a[40:43], v[88:91]
v_mfma_f32_16x16x32_bf16 v[92:95], a[76:79], a[44:47], v[92:95]
ds_read_b64_tr_b16 a[72:73], v24 offset:24576
v_mfma_f32_16x16x32_bf16 v[96:99], a[80:83], a[32:35], v[96:99]
ds_read_b64_tr_b16 a[74:75], v25 offset:24576
ds_read_b64_tr_b16 a[76:77], v26 offset:24576
v_mfma_f32_16x16x32_bf16 v[100:103], a[80:83], a[36:39], v[100:103]
ds_read_b64_tr_b16 a[78:79], v27 offset:24576
v_add_u32 v24, 0xc000, v24
v_mfma_f32_16x16x32_bf16 v[104:107], a[80:83], a[40:43], v[104:107]
v_add_u32 v25, 0xc000, v25
v_add_u32 v26, 0xc000, v26
v_mfma_f32_16x16x32_bf16 v[108:111], a[80:83], a[44:47], v[108:111]
ds_read_b64_tr_b16 a[80:81], v28 offset:24576
ds_read_b64_tr_b16 a[82:83], v29 offset:24576
v_mfma_f32_16x16x32_bf16 v[112:115], a[84:87], a[32:35], v[112:115]
v_add_u32 v27, 0xc000, v27
v_add_u32 v28, 0xc000, v28
v_mfma_f32_16x16x32_bf16 v[116:119], a[84:87], a[36:39], v[116:119]
v_add_u32 v29, 0xc000, v29
v_mfma_f32_16x16x32_bf16 v[120:123], a[84:87], a[40:43], v[120:123]
v_mfma_f32_16x16x32_bf16 v[124:127], a[84:87], a[44:47], v[124:127]
ds_read_b64_tr_b16 a[84:85], v30 offset:24576
ds_read_b64_tr_b16 a[86:87], v31 offset:24576
v_mfma_f32_16x16x32_bf16 v[128:131], a[88:91], a[32:35], v[128:131]
v_add_u32 v30, 0xc000, v30
v_add_u32 v31, 0xc000, v31
v_mfma_f32_16x16x32_bf16 v[132:135], a[88:91], a[36:39], v[132:135]
v_mfma_f32_16x16x32_bf16 v[136:139], a[88:91], a[40:43], v[136:139]
v_mfma_f32_16x16x32_bf16 v[140:143], a[88:91], a[44:47], v[140:143]
ds_read_b64_tr_b16 a[88:89], v32 offset:24576
ds_read_b64_tr_b16 a[90:91], v33 offset:24576
v_mfma_f32_16x16x32_bf16 v[144:147], a[92:95], a[32:35], v[144:147]
ds_read_b128 a[32:35], v45 offset:16384
v_add_u32 v32, 0xc000, v32
v_mfma_f32_16x16x32_bf16 v[148:151], a[92:95], a[36:39], v[148:151]
ds_read_b128 a[36:39], v45 offset:20480
v_add_u32 v33, 0xc000, v33
v_mfma_f32_16x16x32_bf16 v[152:155], a[92:95], a[40:43], v[152:155]
ds_read_b128 a[40:43], v45 offset:24576
v_mfma_f32_16x16x32_bf16 v[156:159], a[92:95], a[44:47], v[156:159]
ds_read_b128 a[44:47], v45 offset:28672
v_mfma_f32_16x16x32_bf16 v[64:67], a[48:51], a[16:19], v[64:67]
ds_read_b64_tr_b16 a[92:93], v34 offset:24576
v_mfma_f32_16x16x32_bf16 v[68:71], a[48:51], a[20:23], v[68:71]
ds_read_b64_tr_b16 a[94:95], v35 offset:24576
v_add_u32 v34, 0xc000, v34
v_mfma_f32_16x16x32_bf16 v[72:75], a[48:51], a[24:27], v[72:75]
v_add_u32 v35, 0xc000, v35
v_mfma_f32_16x16x32_bf16 v[76:79], a[48:51], a[28:31], v[76:79]
v_mfma_f32_16x16x32_bf16 v[80:83], a[52:55], a[16:19], v[80:83]
v_mfma_f32_16x16x32_bf16 v[84:87], a[52:55], a[20:23], v[84:87]
s_waitcnt lgkmcnt(0)
s_barrier
v_mfma_f32_16x16x32_bf16 v[88:91], a[52:55], a[24:27], v[88:91]
v_mfma_f32_16x16x32_bf16 v[92:95], a[52:55], a[28:31], v[92:95]
ds_read_b64_tr_b16 a[48:49], v24 offset:0
v_mfma_f32_16x16x32_bf16 v[96:99], a[56:59], a[16:19], v[96:99]
ds_read_b64_tr_b16 a[50:51], v25 offset:0
ds_read_b64_tr_b16 a[52:53], v26 offset:0
v_mfma_f32_16x16x32_bf16 v[100:103], a[56:59], a[20:23], v[100:103]
ds_read_b64_tr_b16 a[54:55], v27 offset:0
v_mfma_f32_16x16x32_bf16 v[104:107], a[56:59], a[24:27], v[104:107]
v_mfma_f32_16x16x32_bf16 v[108:111], a[56:59], a[28:31], v[108:111]
ds_read_b64_tr_b16 a[56:57], v28 offset:0
ds_read_b64_tr_b16 a[58:59], v29 offset:0
v_mfma_f32_16x16x32_bf16 v[112:115], a[60:63], a[16:19], v[112:115]
v_mfma_f32_16x16x32_bf16 v[116:119], a[60:63], a[20:23], v[116:119]
v_mfma_f32_16x16x32_bf16 v[120:123], a[60:63], a[24:27], v[120:123]
v_mfma_f32_16x16x32_bf16 v[124:127], a[60:63], a[28:31], v[124:127]
ds_read_b64_tr_b16 a[60:61], v30 offset:0
ds_read_b64_tr_b16 a[62:63], v31 offset:0
v_mfma_f32_16x16x32_bf16 v[128:131], a[64:67], a[16:19], v[128:131]
v_mfma_f32_16x16x32_bf16 v[132:135], a[64:67], a[20:23], v[132:135]
v_mfma_f32_16x16x32_bf16 v[136:139], a[64:67], a[24:27], v[136:139]
v_mfma_f32_16x16x32_bf16 v[140:143], a[64:67], a[28:31], v[140:143]
ds_read_b64_tr_b16 a[64:65], v32 offset:0
ds_read_b64_tr_b16 a[66:67], v33 offset:0
v_mfma_f32_16x16x32_bf16 v[144:147], a[68:71], a[16:19], v[144:147]
ds_read_b128 a[16:19], v46 offset:16384
v_mfma_f32_16x16x32_bf16 v[148:151], a[68:71], a[20:23], v[148:151]
ds_read_b128 a[20:23], v46 offset:20480
v_mfma_f32_16x16x32_bf16 v[152:155], a[68:71], a[24:27], v[152:155]
ds_read_b128 a[24:27], v46 offset:24576
v_mfma_f32_16x16x32_bf16 v[156:159], a[68:71], a[28:31], v[156:159]
ds_read_b128 a[28:31], v46 offset:28672
v_mfma_f32_16x16x32_bf16 v[64:67], a[72:75], a[32:35], v[64:67]
ds_read_b64_tr_b16 a[68:69], v34 offset:0
v_mfma_f32_16x16x32_bf16 v[68:71], a[72:75], a[36:39], v[68:71]
ds_read_b64_tr_b16 a[70:71], v35 offset:0
v_mfma_f32_16x16x32_bf16 v[72:75], a[72:75], a[40:43], v[72:75]
v_mfma_f32_16x16x32_bf16 v[76:79], a[72:75], a[44:47], v[76:79]
v_mfma_f32_16x16x32_bf16 v[80:83], a[76:79], a[32:35], v[80:83]
v_mfma_f32_16x16x32_bf16 v[84:87], a[76:79], a[36:39], v[84:87]
s_waitcnt lgkmcnt(0)
s_barrier
v_mfma_f32_16x16x32_bf16 v[88:91], a[76:79], a[40:43], v[88:91]
v_mfma_f32_16x16x32_bf16 v[92:95], a[76:79], a[44:47], v[92:95]
ds_read_b64_tr_b16 a[72:73], v24 offset:24576
v_mfma_f32_16x16x32_bf16 v[96:99], a[80:83], a[32:35], v[96:99]
ds_read_b64_tr_b16 a[74:75], v25 offset:24576
ds_read_b64_tr_b16 a[76:77], v26 offset:24576
v_mfma_f32_16x16x32_bf16 v[100:103], a[80:83], a[36:39], v[100:103]
ds_read_b64_tr_b16 a[78:79], v27 offset:24576
v_add_u32 v24, 0xffff4000, v24
v_mfma_f32_16x16x32_bf16 v[104:107], a[80:83], a[40:43], v[104:107]
v_add_u32 v25, 0xffff4000, v25
v_add_u32 v26, 0xffff4000, v26
v_mfma_f32_16x16x32_bf16 v[108:111], a[80:83], a[44:47], v[108:111]
ds_read_b64_tr_b16 a[80:81], v28 offset:24576
ds_read_b64_tr_b16 a[82:83], v29 offset:24576
v_mfma_f32_16x16x32_bf16 v[112:115], a[84:87], a[32:35], v[112:115]
v_add_u32 v27, 0xffff4000, v27
v_add_u32 v28, 0xffff4000, v28
v_mfma_f32_16x16x32_bf16 v[116:119], a[84:87], a[36:39], v[116:119]
v_add_u32 v29, 0xffff4000, v29
v_mfma_f32_16x16x32_bf16 v[120:123], a[84:87], a[40:43], v[120:123]
v_mfma_f32_16x16x32_bf16 v[124:127], a[84:87], a[44:47], v[124:127]
ds_read_b64_tr_b16 a[84:85], v30 offset:24576
ds_read_b64_tr_b16 a[86:87], v31 offset:24576
v_mfma_f32_16x16x32_bf16 v[128:131], a[88:91], a[32:35], v[128:131]
v_add_u32 v30, 0xffff4000, v30
v_add_u32 v31, 0xffff4000, v31
v_mfma_f32_16x16x32_bf16 v[132:135], a[88:91], a[36:39], v[132:135]
v_mfma_f32_16x16x32_bf16 v[136:139], a[88:91], a[40:43], v[136:139]
v_mfma_f32_16x16x32_bf16 v[140:143], a[88:91], a[44:47], v[140:143]
ds_read_b64_tr_b16 a[88:89], v32 offset:24576
ds_read_b64_tr_b16 a[90:91], v33 offset:24576
v_mfma_f32_16x16x32_bf16 v[144:147], a[92:95], a[32:35], v[144:147]
ds_read_b128 a[32:35], v47 offset:16384
v_add_u32 v32, 0xffff4000, v32
v_mfma_f32_16x16x32_bf16 v[148:151], a[92:95], a[36:39], v[148:151]
ds_read_b128 a[36:39], v47 offset:20480
v_add_u32 v33, 0xffff4000, v33
v_mfma_f32_16x16x32_bf16 v[152:155], a[92:95], a[40:43], v[152:155]
ds_read_b128 a[40:43], v47 offset:24576
v_mfma_f32_16x16x32_bf16 v[156:159], a[92:95], a[44:47], v[156:159]
ds_read_b128 a[44:47], v47 offset:28672
v_mfma_f32_16x16x32_bf16 v[64:67], a[48:51], a[16:19], v[64:67]
ds_read_b64_tr_b16 a[92:93], v34 offset:24576
v_mfma_f32_16x16x32_bf16 v[68:71], a[48:51], a[20:23], v[68:71]
ds_read_b64_tr_b16 a[94:95], v35 offset:24576
v_add_u32 v34, 0xffff4000, v34
v_mfma_f32_16x16x32_bf16 v[72:75], a[48:51], a[24:27], v[72:75]
v_add_u32 v35, 0xffff4000, v35
v_mfma_f32_16x16x32_bf16 v[76:79], a[48:51], a[28:31], v[76:79]
v_mfma_f32_16x16x32_bf16 v[80:83], a[52:55], a[16:19], v[80:83]
v_mfma_f32_16x16x32_bf16 v[84:87], a[52:55], a[20:23], v[84:87]
s_waitcnt lgkmcnt(0)
s_barrier
v_mfma_f32_16x16x32_bf16 v[88:91], a[52:55], a[24:27], v[88:91]
v_mfma_f32_16x16x32_bf16 v[92:95], a[52:55], a[28:31], v[92:95]
ds_read_b64_tr_b16 a[48:49], v24 offset:0
v_mfma_f32_16x16x32_bf16 v[96:99], a[56:59], a[16:19], v[96:99]
ds_read_b64_tr_b16 a[50:51], v25 offset:0
ds_read_b64_tr_b16 a[52:53], v26 offset:0
v_mfma_f32_16x16x32_bf16 v[100:103], a[56:59], a[20:23], v[100:103]
ds_read_b64_tr_b16 a[54:55], v27 offset:0
v_mfma_f32_16x16x32_bf16 v[104:107], a[56:59], a[24:27], v[104:107]
v_mfma_f32_16x16x32_bf16 v[108:111], a[56:59], a[28:31], v[108:111]
ds_read_b64_tr_b16 a[56:57], v28 offset:0
ds_read_b64_tr_b16 a[58:59], v29 offset:0
v_mfma_f32_16x16x32_bf16 v[112:115], a[60:63], a[16:19], v[112:115]
v_mfma_f32_16x16x32_bf16 v[116:119], a[60:63], a[20:23], v[116:119]
v_mfma_f32_16x16x32_bf16 v[120:123], a[60:63], a[24:27], v[120:123]
v_mfma_f32_16x16x32_bf16 v[124:127], a[60:63], a[28:31], v[124:127]
ds_read_b64_tr_b16 a[60:61], v30 offset:0
ds_read_b64_tr_b16 a[62:63], v31 offset:0
v_mfma_f32_16x16x32_bf16 v[128:131], a[64:67], a[16:19], v[128:131]
v_mfma_f32_16x16x32_bf16 v[132:135], a[64:67], a[20:23], v[132:135]
v_mfma_f32_16x16x32_bf16 v[136:139], a[64:67], a[24:27], v[136:139]
v_mfma_f32_16x16x32_bf16 v[140:143], a[64:67], a[28:31], v[140:143]
ds_read_b64_tr_b16 a[64:65], v32 offset:0
ds_read_b64_tr_b16 a[66:67], v33 offset:0
v_mfma_f32_16x16x32_bf16 v[144:147], a[68:71], a[16:19], v[144:147]
ds_read_b128 a[16:19], v44 offset:32768
v_mfma_f32_16x16x32_bf16 v[148:151], a[68:71], a[20:23], v[148:151]
ds_read_b128 a[20:23], v44 offset:36864
v_mfma_f32_16x16x32_bf16 v[152:155], a[68:71], a[24:27], v[152:155]
ds_read_b128 a[24:27], v44 offset:40960
v_mfma_f32_16x16x32_bf16 v[156:159], a[68:71], a[28:31], v[156:159]
ds_read_b128 a[28:31], v44 offset:45056
v_mfma_f32_16x16x32_bf16 v[64:67], a[72:75], a[32:35], v[64:67]
ds_read_b64_tr_b16 a[68:69], v34 offset:0
v_mfma_f32_16x16x32_bf16 v[68:71], a[72:75], a[36:39], v[68:71]
ds_read_b64_tr_b16 a[70:71], v35 offset:0
v_mfma_f32_16x16x32_bf16 v[72:75], a[72:75], a[40:43], v[72:75]
v_mfma_f32_16x16x32_bf16 v[76:79], a[72:75], a[44:47], v[76:79]
v_mfma_f32_16x16x32_bf16 v[80:83], a[76:79], a[32:35], v[80:83]
v_mfma_f32_16x16x32_bf16 v[84:87], a[76:79], a[36:39], v[84:87]
s_waitcnt lgkmcnt(0)
s_barrier
v_mfma_f32_16x16x32_bf16 v[88:91], a[76:79], a[40:43], v[88:91]
v_mfma_f32_16x16x32_bf16 v[92:95], a[76:79], a[44:47], v[92:95]
ds_read_b64_tr_b16 a[72:73], v24 offset:24576
v_mfma_f32_16x16x32_bf16 v[96:99], a[80:83], a[32:35], v[96:99]
ds_read_b64_tr_b16 a[74:75], v25 offset:24576
ds_read_b64_tr_b16 a[76:77], v26 offset:24576
v_mfma_f32_16x16x32_bf16 v[100:103], a[80:83], a[36:39], v[100:103]
ds_read_b64_tr_b16 a[78:79], v27 offset:24576
v_add_u32 v24, 0xc000, v24
v_mfma_f32_16x16x32_bf16 v[104:107], a[80:83], a[40:43], v[104:107]
v_add_u32 v25, 0xc000, v25
v_add_u32 v26, 0xc000, v26
v_mfma_f32_16x16x32_bf16 v[108:111], a[80:83], a[44:47], v[108:111]
ds_read_b64_tr_b16 a[80:81], v28 offset:24576
ds_read_b64_tr_b16 a[82:83], v29 offset:24576
v_mfma_f32_16x16x32_bf16 v[112:115], a[84:87], a[32:35], v[112:115]
v_add_u32 v27, 0xc000, v27
v_add_u32 v28, 0xc000, v28
v_mfma_f32_16x16x32_bf16 v[116:119], a[84:87], a[36:39], v[116:119]
v_add_u32 v29, 0xc000, v29
v_mfma_f32_16x16x32_bf16 v[120:123], a[84:87], a[40:43], v[120:123]
v_mfma_f32_16x16x32_bf16 v[124:127], a[84:87], a[44:47], v[124:127]
ds_read_b64_tr_b16 a[84:85], v30 offset:24576
ds_read_b64_tr_b16 a[86:87], v31 offset:24576
v_mfma_f32_16x16x32_bf16 v[128:131], a[88:91], a[32:35], v[128:131]
v_add_u32 v30, 0xc000, v30
v_add_u32 v31, 0xc000, v31
v_mfma_f32_16x16x32_bf16 v[132:135], a[88:91], a[36:39], v[132:135]
v_mfma_f32_16x16x32_bf16 v[136:139], a[88:91], a[40:43], v[136:139]
v_mfma_f32_16x16x32_bf16 v[140:143], a[88:91], a[44:47], v[140:143]
ds_read_b64_tr_b16 a[88:89], v32 offset:24576
ds_read_b64_tr_b16 a[90:91], v33 offset:24576
v_mfma_f32_16x16x32_bf16 v[144:147], a[92:95], a[32:35], v[144:147]
ds_read_b128 a[32:35], v45 offset:32768
v_add_u32 v32, 0xc000, v32
v_mfma_f32_16x16x32_bf16 v[148:151], a[92:95], a[36:39], v[148:151]
ds_read_b128 a[36:39], v45 offset:36864
v_add_u32 v33, 0xc000, v33
v_mfma_f32_16x16x32_bf16 v[152:155], a[92:95], a[40:43], v[152:155]
ds_read_b128 a[40:43], v45 offset:40960
v_mfma_f32_16x16x32_bf16 v[156:159], a[92:95], a[44:47], v[156:159]
ds_read_b128 a[44:47], v45 offset:45056
v_mfma_f32_16x16x32_bf16 v[64:67], a[48:51], a[16:19], v[64:67]
ds_read_b64_tr_b16 a[92:93], v34 offset:24576
v_mfma_f32_16x16x32_bf16 v[68:71], a[48:51], a[20:23], v[68:71]
ds_read_b64_tr_b16 a[94:95], v35 offset:24576
v_add_u32 v34, 0xc000, v34
v_mfma_f32_16x16x32_bf16 v[72:75], a[48:51], a[24:27], v[72:75]
v_add_u32 v35, 0xc000, v35
v_mfma_f32_16x16x32_bf16 v[76:79], a[48:51], a[28:31], v[76:79]
v_mfma_f32_16x16x32_bf16 v[80:83], a[52:55], a[16:19], v[80:83]
v_mfma_f32_16x16x32_bf16 v[84:87], a[52:55], a[20:23], v[84:87]
s_waitcnt lgkmcnt(0)
s_barrier
v_mfma_f32_16x16x32_bf16 v[88:91], a[52:55], a[24:27], v[88:91]
v_mfma_f32_16x16x32_bf16 v[92:95], a[52:55], a[28:31], v[92:95]
ds_read_b64_tr_b16 a[48:49], v24 offset:0
v_mfma_f32_16x16x32_bf16 v[96:99], a[56:59], a[16:19], v[96:99]
ds_read_b64_tr_b16 a[50:51], v25 offset:0
ds_read_b64_tr_b16 a[52:53], v26 offset:0
v_mfma_f32_16x16x32_bf16 v[100:103], a[56:59], a[20:23], v[100:103]
ds_read_b64_tr_b16 a[54:55], v27 offset:0
v_mfma_f32_16x16x32_bf16 v[104:107], a[56:59], a[24:27], v[104:107]
v_mfma_f32_16x16x32_bf16 v[108:111], a[56:59], a[28:31], v[108:111]
ds_read_b64_tr_b16 a[56:57], v28 offset:0
ds_read_b64_tr_b16 a[58:59], v29 offset:0
v_mfma_f32_16x16x32_bf16 v[112:115], a[60:63], a[16:19], v[112:115]
v_mfma_f32_16x16x32_bf16 v[116:119], a[60:63], a[20:23], v[116:119]
v_mfma_f32_16x16x32_bf16 v[120:123], a[60:63], a[24:27], v[120:123]
v_mfma_f32_16x16x32_bf16 v[124:127], a[60:63], a[28:31], v[124:127]
ds_read_b64_tr_b16 a[60:61], v30 offset:0
ds_read_b64_tr_b16 a[62:63], v31 offset:0
v_mfma_f32_16x16x32_bf16 v[128:131], a[64:67], a[16:19], v[128:131]
v_mfma_f32_16x16x32_bf16 v[132:135], a[64:67], a[20:23], v[132:135]
v_mfma_f32_16x16x32_bf16 v[136:139], a[64:67], a[24:27], v[136:139]
v_mfma_f32_16x16x32_bf16 v[140:143], a[64:67], a[28:31], v[140:143]
ds_read_b64_tr_b16 a[64:65], v32 offset:0
ds_read_b64_tr_b16 a[66:67], v33 offset:0
v_mfma_f32_16x16x32_bf16 v[144:147], a[68:71], a[16:19], v[144:147]
ds_read_b128 a[16:19], v46 offset:32768
v_mfma_f32_16x16x32_bf16 v[148:151], a[68:71], a[20:23], v[148:151]
ds_read_b128 a[20:23], v46 offset:36864
v_mfma_f32_16x16x32_bf16 v[152:155], a[68:71], a[24:27], v[152:155]
ds_read_b128 a[24:27], v46 offset:40960
v_mfma_f32_16x16x32_bf16 v[156:159], a[68:71], a[28:31], v[156:159]
ds_read_b128 a[28:31], v46 offset:45056
v_mfma_f32_16x16x32_bf16 v[64:67], a[72:75], a[32:35], v[64:67]
ds_read_b64_tr_b16 a[68:69], v34 offset:0
v_mfma_f32_16x16x32_bf16 v[68:71], a[72:75], a[36:39], v[68:71]
ds_read_b64_tr_b16 a[70:71], v35 offset:0
v_mfma_f32_16x16x32_bf16 v[72:75], a[72:75], a[40:43], v[72:75]
v_mfma_f32_16x16x32_bf16 v[76:79], a[72:75], a[44:47], v[76:79]
v_mfma_f32_16x16x32_bf16 v[80:83], a[76:79], a[32:35], v[80:83]
v_mfma_f32_16x16x32_bf16 v[84:87], a[76:79], a[36:39], v[84:87]
s_waitcnt lgkmcnt(0)
s_barrier
v_mfma_f32_16x16x32_bf16 v[88:91], a[76:79], a[40:43], v[88:91]
v_mfma_f32_16x16x32_bf16 v[92:95], a[76:79], a[44:47], v[92:95]
ds_read_b64_tr_b16 a[72:73], v24 offset:24576
ds_read_b64_tr_b16 a[74:75], v25 offset:24576
ds_read_b64_tr_b16 a[76:77], v26 offset:24576
v_mfma_f32_16x16x32_bf16 v[96:99], a[80:83], a[32:35], v[96:99]
ds_read_b64_tr_b16 a[78:79], v27 offset:24576
v_mfma_f32_16x16x32_bf16 v[100:103], a[80:83], a[36:39], v[100:103]
v_mfma_f32_16x16x32_bf16 v[104:107], a[80:83], a[40:43], v[104:107]
v_mfma_f32_16x16x32_bf16 v[108:111], a[80:83], a[44:47], v[108:111]
ds_read_b64_tr_b16 a[80:81], v28 offset:24576
ds_read_b64_tr_b16 a[82:83], v29 offset:24576
v_mfma_f32_16x16x32_bf16 v[112:115], a[84:87], a[32:35], v[112:115]
v_mfma_f32_16x16x32_bf16 v[116:119], a[84:87], a[36:39], v[116:119]
v_mfma_f32_16x16x32_bf16 v[120:123], a[84:87], a[40:43], v[120:123]
v_mfma_f32_16x16x32_bf16 v[124:127], a[84:87], a[44:47], v[124:127]
ds_read_b64_tr_b16 a[84:85], v30 offset:24576
ds_read_b64_tr_b16 a[86:87], v31 offset:24576
v_mfma_f32_16x16x32_bf16 v[128:131], a[88:91], a[32:35], v[128:131]
v_mfma_f32_16x16x32_bf16 v[132:135], a[88:91], a[36:39], v[132:135]
v_mfma_f32_16x16x32_bf16 v[136:139], a[88:91], a[40:43], v[136:139]
v_mfma_f32_16x16x32_bf16 v[140:143], a[88:91], a[44:47], v[140:143]
ds_read_b64_tr_b16 a[88:89], v32 offset:24576
ds_read_b64_tr_b16 a[90:91], v33 offset:24576
v_mfma_f32_16x16x32_bf16 v[144:147], a[92:95], a[32:35], v[144:147]
ds_read_b128 a[32:35], v47 offset:32768
v_mfma_f32_16x16x32_bf16 v[148:151], a[92:95], a[36:39], v[148:151]
ds_read_b128 a[36:39], v47 offset:36864
v_mfma_f32_16x16x32_bf16 v[152:155], a[92:95], a[40:43], v[152:155]
ds_read_b128 a[40:43], v47 offset:40960
v_mfma_f32_16x16x32_bf16 v[156:159], a[92:95], a[44:47], v[156:159]
ds_read_b64_tr_b16 a[92:93], v34 offset:24576
v_mfma_f32_16x16x32_bf16 v[64:67], a[48:51], a[16:19], v[64:67]
ds_read_b64_tr_b16 a[94:95], v35 offset:24576
ds_read_b128 a[44:47], v47 offset:45056
v_mfma_f32_16x16x32_bf16 v[80:83], a[52:55], a[16:19], v[80:83]
v_mfma_f32_16x16x32_bf16 v[96:99], a[56:59], a[16:19], v[96:99]
v_mfma_f32_16x16x32_bf16 v[112:115], a[60:63], a[16:19], v[112:115]
v_mfma_f32_16x16x32_bf16 v[128:131], a[64:67], a[16:19], v[128:131]
v_mfma_f32_16x16x32_bf16 v[144:147], a[68:71], a[16:19], v[144:147]
s_waitcnt lgkmcnt(0)
s_barrier
v_mfma_f32_16x16x32_bf16 v[64:67], a[72:75], a[32:35], v[64:67]
v_mfma_f32_16x16x32_bf16 v[80:83], a[76:79], a[32:35], v[80:83]
ds_write2_b32 v63, v62, v62 offset0:0 offset1:4
v_mfma_f32_16x16x32_bf16 v[96:99], a[80:83], a[32:35], v[96:99]
s_nop 4
v_cvt_pk_bf16_f32 v16, v64, v65
v_mfma_f32_16x16x32_bf16 v[112:115], a[84:87], a[32:35], v[112:115]
v_cvt_pk_bf16_f32 v17, v66, v67
v_cvt_pk_bf16_f32 v18, v80, v81
v_mfma_f32_16x16x32_bf16 v[128:131], a[88:91], a[32:35], v[128:131]
ds_write_b64 v52, v[16:17] offset:0
v_cvt_pk_bf16_f32 v19, v82, v83
v_mfma_f32_16x16x32_bf16 v[144:147], a[92:95], a[32:35], v[144:147]
ds_write_b64 v53, v[18:19] offset:0
v_cvt_pk_bf16_f32 v36, v96, v97
v_mfma_f32_16x16x32_bf16 v[68:71], a[48:51], a[20:23], v[68:71]
v_cvt_pk_bf16_f32 v37, v98, v99
v_cvt_pk_bf16_f32 v38, v112, v113
v_mfma_f32_16x16x32_bf16 v[84:87], a[52:55], a[20:23], v[84:87]
ds_write_b64 v54, v[36:37] offset:0
v_cvt_pk_bf16_f32 v39, v114, v115
v_mfma_f32_16x16x32_bf16 v[100:103], a[56:59], a[20:23], v[100:103]
ds_write_b64 v55, v[38:39] offset:0
v_mfma_f32_16x16x32_bf16 v[116:119], a[60:63], a[20:23], v[116:119]
v_cvt_pk_bf16_f32 v58, v128, v129
v_cvt_pk_bf16_f32 v59, v130, v131
v_mfma_f32_16x16x32_bf16 v[132:135], a[64:67], a[20:23], v[132:135]
ds_write_b64 v56, v[58:59] offset:0
v_cvt_pk_bf16_f32 v60, v144, v145
v_mfma_f32_16x16x32_bf16 v[148:151], a[68:71], a[20:23], v[148:151]
v_cvt_pk_bf16_f32 v61, v146, v147
v_mfma_f32_16x16x32_bf16 v[68:71], a[72:75], a[36:39], v[68:71]
ds_write_b64 v57, v[60:61] offset:0
v_mfma_f32_16x16x32_bf16 v[84:87], a[76:79], a[36:39], v[84:87]
v_mfma_f32_16x16x32_bf16 v[100:103], a[80:83], a[36:39], v[100:103]
s_nop 4
v_cvt_pk_bf16_f32 v16, v68, v69
v_mfma_f32_16x16x32_bf16 v[116:119], a[84:87], a[36:39], v[116:119]
v_cvt_pk_bf16_f32 v17, v70, v71
v_cvt_pk_bf16_f32 v18, v84, v85
v_mfma_f32_16x16x32_bf16 v[132:135], a[88:91], a[36:39], v[132:135]
ds_write_b64 v52, v[16:17] offset:12288
v_cvt_pk_bf16_f32 v19, v86, v87
v_mfma_f32_16x16x32_bf16 v[148:151], a[92:95], a[36:39], v[148:151]
ds_write_b64 v53, v[18:19] offset:12288
v_cvt_pk_bf16_f32 v36, v100, v101
v_mfma_f32_16x16x32_bf16 v[72:75], a[48:51], a[24:27], v[72:75]
v_cvt_pk_bf16_f32 v37, v102, v103
v_cvt_pk_bf16_f32 v38, v116, v117
v_mfma_f32_16x16x32_bf16 v[88:91], a[52:55], a[24:27], v[88:91]
ds_write_b64 v54, v[36:37] offset:12288
v_cvt_pk_bf16_f32 v39, v118, v119
v_mfma_f32_16x16x32_bf16 v[104:107], a[56:59], a[24:27], v[104:107]
ds_write_b64 v55, v[38:39] offset:12288
v_mfma_f32_16x16x32_bf16 v[120:123], a[60:63], a[24:27], v[120:123]
v_cvt_pk_bf16_f32 v58, v132, v133
v_cvt_pk_bf16_f32 v59, v134, v135
v_mfma_f32_16x16x32_bf16 v[136:139], a[64:67], a[24:27], v[136:139]
ds_write_b64 v56, v[58:59] offset:12288
v_cvt_pk_bf16_f32 v60, v148, v149
v_mfma_f32_16x16x32_bf16 v[152:155], a[68:71], a[24:27], v[152:155]
v_cvt_pk_bf16_f32 v61, v150, v151
v_mfma_f32_16x16x32_bf16 v[72:75], a[72:75], a[40:43], v[72:75]
ds_write_b64 v57, v[60:61] offset:12288
v_mfma_f32_16x16x32_bf16 v[88:91], a[76:79], a[40:43], v[88:91]
v_mfma_f32_16x16x32_bf16 v[104:107], a[80:83], a[40:43], v[104:107]
s_nop 4
v_cvt_pk_bf16_f32 v16, v72, v73
v_mfma_f32_16x16x32_bf16 v[120:123], a[84:87], a[40:43], v[120:123]
v_cvt_pk_bf16_f32 v17, v74, v75
v_cvt_pk_bf16_f32 v18, v88, v89
v_mfma_f32_16x16x32_bf16 v[136:139], a[88:91], a[40:43], v[136:139]
ds_write_b64 v52, v[16:17] offset:24576
v_cvt_pk_bf16_f32 v19, v90, v91
v_mfma_f32_16x16x32_bf16 v[152:155], a[92:95], a[40:43], v[152:155]
ds_write_b64 v53, v[18:19] offset:24576
v_cvt_pk_bf16_f32 v36, v104, v105
v_mfma_f32_16x16x32_bf16 v[76:79], a[48:51], a[28:31], v[76:79]
v_cvt_pk_bf16_f32 v37, v106, v107
v_cvt_pk_bf16_f32 v38, v120, v121
v_mfma_f32_16x16x32_bf16 v[92:95], a[52:55], a[28:31], v[92:95]
ds_write_b64 v54, v[36:37] offset:24576
v_cvt_pk_bf16_f32 v39, v122, v123
v_mfma_f32_16x16x32_bf16 v[108:111], a[56:59], a[28:31], v[108:111]
ds_write_b64 v55, v[38:39] offset:24576
v_mfma_f32_16x16x32_bf16 v[124:127], a[60:63], a[28:31], v[124:127]
v_cvt_pk_bf16_f32 v58, v136, v137
v_cvt_pk_bf16_f32 v59, v138, v139
v_mfma_f32_16x16x32_bf16 v[140:143], a[64:67], a[28:31], v[140:143]
ds_write_b64 v56, v[58:59] offset:24576
v_cvt_pk_bf16_f32 v60, v152, v153
v_mfma_f32_16x16x32_bf16 v[156:159], a[68:71], a[28:31], v[156:159]
v_cvt_pk_bf16_f32 v61, v154, v155
v_mfma_f32_16x16x32_bf16 v[76:79], a[72:75], a[44:47], v[76:79]
ds_write_b64 v57, v[60:61] offset:24576
v_mfma_f32_16x16x32_bf16 v[92:95], a[76:79], a[44:47], v[92:95]
v_mfma_f32_16x16x32_bf16 v[108:111], a[80:83], a[44:47], v[108:111]
s_nop 4
v_cvt_pk_bf16_f32 v16, v76, v77
v_mfma_f32_16x16x32_bf16 v[124:127], a[84:87], a[44:47], v[124:127]
v_cvt_pk_bf16_f32 v17, v78, v79
v_cvt_pk_bf16_f32 v18, v92, v93
v_mfma_f32_16x16x32_bf16 v[140:143], a[88:91], a[44:47], v[140:143]
ds_write_b64 v52, v[16:17] offset:36864
v_cvt_pk_bf16_f32 v19, v94, v95
v_mfma_f32_16x16x32_bf16 v[156:159], a[92:95], a[44:47], v[156:159]
ds_write_b64 v53, v[18:19] offset:36864
v_cvt_pk_bf16_f32 v36, v108, v109
v_cvt_pk_bf16_f32 v37, v110, v111
v_cvt_pk_bf16_f32 v38, v124, v125
v_cvt_pk_bf16_f32 v39, v126, v127
v_cvt_pk_bf16_f32 v58, v140, v141
v_cvt_pk_bf16_f32 v59, v142, v143
ds_write_b64 v54, v[36:37] offset:36864
v_cvt_pk_bf16_f32 v60, v156, v157
v_cvt_pk_bf16_f32 v61, v158, v159
ds_write_b64 v55, v[38:39] offset:36864
ds_write_b64 v56, v[58:59] offset:36864
ds_write_b64 v57, v[60:61] offset:36864
s_waitcnt lgkmcnt(0)
s_barrier
ds_read_b128 v[40:43], v14 offset:0
ds_read_b128 v[44:47], v14 offset:256
ds_read_b128 v[52:55], v14 offset:12288
ds_read_b128 v[48:51], v14 offset:512
ds_read_b128 v[56:59], v14 offset:12544
s_waitcnt lgkmcnt(4)
v_mfma_f32_16x16x32_bf16 v[24:27], v[40:43], v[40:43], 0
ds_read_b128 v[60:63], v14 offset:12800
v_add_u32 v14, 0xc000, v14
v_mfma_f32_16x16x32_bf16 v[32:35], v[40:43], a[0:3], 0
s_waitcnt lgkmcnt(1)
ds_read_b128 a[4:7], v14 offset:0
v_mfma_f32_16x16x32_bf16 v[24:27], v[44:47], v[44:47], v[24:27]
v_add_u32 v40, s56, v40
v_add_u32 v41, s56, v41
v_mfma_f32_16x16x32_bf16 v[28:31], v[52:55], v[52:55], 0
ds_read_b128 a[8:11], v14 offset:12288
v_add_u32 v42, s56, v42
v_mfma_f32_16x16x32_bf16 v[36:39], v[52:55], a[0:3], 0
ds_read_b128 a[12:15], v14 offset:256
v_add_u32 v52, s56, v52
v_mfma_f32_16x16x32_bf16 v[32:35], v[44:47], a[0:3], v[32:35]
ds_read_b128 a[16:19], v14 offset:12544
v_add_u32 v53, s56, v53
v_mfma_f32_16x16x32_bf16 v[24:27], v[48:51], v[48:51], v[24:27]
ds_read_b128 a[20:23], v14 offset:512
v_add_u32 v54, s56, v54
v_mfma_f32_16x16x32_bf16 v[32:35], v[48:51], a[0:3], v[32:35]
ds_read_b128 a[24:27], v14 offset:12800
v_add_u32 v43, s56, v43
v_mfma_f32_16x16x32_bf16 v[28:31], v[56:59], v[56:59], v[28:31]
v_add_u32 v44, s56, v44
s_nop 0
v_cndmask_b32 v16, v24, v25, s[32:33]
v_mfma_f32_16x16x32_bf16 v[36:39], v[56:59], a[0:3], v[36:39]
s_waitcnt lgkmcnt(5)
v_cndmask_b32 v16, v16, v26, s[34:35]
v_cndmask_b32 v16, v16, v27, s[36:37]
v_mfma_f32_16x16x32_bf16 v[28:31], v[60:63], v[60:63], v[28:31]
v_cndmask_b32 v17, v32, v33, s[32:33]
v_cndmask_b32 v17, v17, v34, s[34:35]
v_mfma_f32_16x16x32_bf16 v[36:39], v[60:63], a[0:3], v[36:39]
v_cndmask_b32 v17, v17, v35, s[36:37]
v_add_u32 v45, s56, v45
v_add_u32 v46, s56, v46
v_add_u32 v47, s56, v47
v_add_u32 v48, s56, v48
v_cndmask_b32 v18, v28, v29, s[32:33]
v_cndmask_b32 v18, v18, v30, s[34:35]
v_cndmask_b32 v18, v18, v31, s[36:37]
v_add_u32 v49, s56, v49
v_cndmask_b32 v19, v36, v37, s[32:33]
v_cndmask_b32 v19, v19, v38, s[34:35]
v_cndmask_b32 v19, v19, v39, s[36:37]
v_add_u32 v50, s56, v50
v_add_u32 v55, s56, v55
v_add_u32 v51, s56, v51
v_mfma_f32_16x16x32_bf16 v[24:27], a[4:7], a[4:7], 0
ds_write_b128 v21, v[16:19] offset:10752
v_add_u32 v56, s56, v56
v_mfma_f32_16x16x32_bf16 v[32:35], a[4:7], a[0:3], 0
v_add_u32 v57, s56, v57
v_add_u32 v58, s56, v58
v_mfma_f32_16x16x32_bf16 v[24:27], a[4:7], v[40:43], v[24:27]
s_waitcnt lgkmcnt(1)
v_add_u32 v59, s56, v59
v_add_u32 v60, s56, v60
v_mfma_f32_16x16x32_bf16 v[28:31], a[8:11], a[8:11], 0
v_add_u32 v61, s56, v61
v_add_u32 v62, s56, v62
v_mfma_f32_16x16x32_bf16 v[36:39], a[8:11], a[0:3], 0
v_add_u32 v63, s56, v63
v_mfma_f32_16x16x32_bf16 v[28:31], a[8:11], v[40:43], v[28:31]
v_mfma_f32_16x16x32_bf16 v[24:27], a[12:15], a[12:15], v[24:27]
v_mfma_f32_16x16x32_bf16 v[32:35], a[12:15], a[0:3], v[32:35]
v_mfma_f32_16x16x32_bf16 v[24:27], a[12:15], v[44:47], v[24:27]
v_mfma_f32_16x16x32_bf16 v[28:31], a[16:19], a[16:19], v[28:31]
v_mfma_f32_16x16x32_bf16 v[36:39], a[16:19], a[0:3], v[36:39]
v_mfma_f32_16x16x32_bf16 v[28:31], a[16:19], v[44:47], v[28:31]
v_mfma_f32_16x16x32_bf16 v[24:27], a[20:23], a[20:23], v[24:27]
v_mfma_f32_16x16x32_bf16 v[32:35], a[20:23], a[0:3], v[32:35]
v_mfma_f32_16x16x32_bf16 v[24:27], a[20:23], v[48:51], v[24:27]
v_mfma_f32_16x16x32_bf16 v[28:31], a[24:27], a[24:27], v[28:31]
s_nop 5
v_cndmask_b32 v17, v32, v33, s[32:33]
v_mfma_f32_16x16x32_bf16 v[36:39], a[24:27], a[0:3], v[36:39]
v_cndmask_b32 v17, v17, v34, s[34:35]
v_cndmask_b32 v16, v24, v25, s[32:33]
v_mfma_f32_16x16x32_bf16 v[28:31], a[24:27], v[48:51], v[28:31]
v_cndmask_b32 v16, v16, v26, s[34:35]
v_cndmask_b32 v16, v16, v27, s[36:37]
v_cndmask_b32 v17, v17, v35, s[36:37]
s_nop 1
v_cndmask_b32 v19, v36, v37, s[32:33]
v_cndmask_b32 v19, v19, v38, s[34:35]
v_cndmask_b32 v19, v19, v39, s[36:37]
v_cndmask_b32 v18, v28, v29, s[32:33]
v_cndmask_b32 v18, v18, v30, s[34:35]
v_cndmask_b32 v18, v18, v31, s[36:37]
ds_write_b128 v21, v[16:19] offset:0
s_waitcnt lgkmcnt(0)
s_barrier
ds_read_b128 a[28:31], v14 offset:24576
buffer_load_dwordx4 v2, s[12:15], s49 offen offset:0 nt lds
ds_read_b128 a[8:11], v14 offset:24832
ds_read_b128 a[16:19], v14 offset:25088
ds_read_b128 a[4:7], v14 offset:36864
ds_read_b128 a[12:15], v14 offset:37120
buffer_load_dwordx4 v3, s[12:15], s49 offen offset:1024 nt lds
s_waitcnt lgkmcnt(4)
v_mfma_f32_16x16x32_bf16 v[24:27], a[28:31], a[28:31], 0
ds_read_b128 a[20:23], v14 offset:37376
v_add_u32 v14, 0xffff4000, v14
v_mfma_f32_16x16x32_bf16 v[24:27], a[28:31], v[40:43], v[24:27]
s_waitcnt lgkmcnt(1)
ds_read_b128 a[24:27], v14 offset:24576
v_mfma_f32_16x16x32_bf16 v[24:27], a[8:11], a[8:11], v[24:27]
ds_read_b64_tr_b16 a[48:49], v8 offset:0
v_mfma_f32_16x16x32_bf16 v[24:27], a[8:11], v[44:47], v[24:27]
ds_read_b64_tr_b16 a[50:51], v8 offset:12288
buffer_load_dwordx4 v4, s[12:15], s49 offen offset:2048 nt lds
ds_read_b64_tr_b16 a[52:53], v9 offset:0
v_mfma_f32_16x16x32_bf16 v[24:27], a[16:19], a[16:19], v[24:27]
ds_read_b64_tr_b16 a[54:55], v9 offset:12288
v_mfma_f32_16x16x32_bf16 v[32:35], a[28:31], a[0:3], 0
ds_read_b128 a[28:31], v14 offset:24832
v_mfma_f32_16x16x32_bf16 v[24:27], a[16:19], v[48:51], v[24:27]
ds_read_b64_tr_b16 a[56:57], v10 offset:0
ds_read_b64_tr_b16 a[58:59], v10 offset:12288
v_mfma_f32_16x16x32_bf16 v[32:35], a[8:11], a[0:3], v[32:35]
ds_read_b128 a[8:11], v14 offset:36864
buffer_load_dwordx4 v5, s[12:15], s49 offen offset:3072 nt lds
v_mfma_f32_16x16x32_bf16 v[32:35], a[16:19], a[0:3], v[32:35]
s_add_u32 m0, s24, 126976
ds_read_b128 a[16:19], v14 offset:37376
v_cndmask_b32 v16, v24, v25, s[32:33]
v_mfma_f32_16x16x32_bf16 v[28:31], a[4:7], a[4:7], 0
s_waitcnt lgkmcnt(7)
ds_read_b64_tr_b16 a[60:61], v11 offset:0
v_cndmask_b32 v16, v16, v26, s[34:35]
v_cndmask_b32 v16, v16, v27, s[36:37]
v_mfma_f32_16x16x32_bf16 v[24:27], a[24:27], a[24:27], 0
ds_read_b64_tr_b16 a[62:63], v11 offset:12288
ds_read_b64_tr_b16 a[64:65], v12 offset:0
ds_read_b64_tr_b16 a[66:67], v12 offset:12288
buffer_load_dwordx4 v6, s[12:15], s49 offen offset:0 nt lds
ds_read_b64_tr_b16 a[68:69], v13 offset:0
v_mfma_f32_16x16x32_bf16 v[36:39], a[4:7], a[0:3], 0
ds_read_b64_tr_b16 a[70:71], v13 offset:12288
v_cndmask_b32 v17, v32, v33, s[32:33]
v_mfma_f32_16x16x32_bf16 v[28:31], a[4:7], v[40:43], v[28:31]
ds_read_b128 a[4:7], v14 offset:25088
v_cndmask_b32 v17, v17, v34, s[34:35]
v_cndmask_b32 v17, v17, v35, s[36:37]
v_mfma_f32_16x16x32_bf16 v[32:35], a[24:27], a[0:3], 0
s_waitcnt lgkmcnt(7)
ds_read_b64_tr_b16 a[72:73], v8 offset:24576
ds_read_b64_tr_b16 a[74:75], v8 offset:36864
buffer_load_dwordx4 v7, s[12:15], s49 offen offset:1024 nt lds
ds_read_b64_tr_b16 a[76:77], v9 offset:24576
ds_read_b64_tr_b16 a[78:79], v9 offset:36864
v_mfma_f32_16x16x32_bf16 v[24:27], a[28:31], a[28:31], v[24:27]
s_add_u32 s49, s26, 49152
ds_read_b64_tr_b16 a[80:81], v10 offset:24576
s_add_u32 m0, s24, 0
ds_read_b64_tr_b16 a[82:83], v10 offset:36864
v_mfma_f32_16x16x32_bf16 v[28:31], a[12:15], a[12:15], v[28:31]
ds_read_b64_tr_b16 a[84:85], v11 offset:24576
v_add_u32 v8, 0xc000, v8
v_mfma_f32_16x16x32_bf16 v[32:35], a[28:31], a[0:3], v[32:35]
ds_read_b64_tr_b16 a[86:87], v11 offset:36864
ds_read_b64_tr_b16 a[88:89], v12 offset:24576
v_mfma_f32_16x16x32_bf16 v[28:31], a[12:15], v[44:47], v[28:31]
ds_read_b64_tr_b16 a[90:91], v12 offset:36864
ds_read_b64_tr_b16 a[92:93], v13 offset:24576
v_mfma_f32_16x16x32_bf16 v[28:31], a[20:23], a[20:23], v[28:31]
s_waitcnt lgkmcnt(10)
ds_read_b64_tr_b16 a[94:95], v13 offset:36864
v_add_u32 v9, 0xc000, v9
v_mfma_f32_16x16x32_bf16 v[24:27], a[4:7], a[4:7], v[24:27]
v_add_u32 v10, 0xc000, v10
v_add_u32 v11, 0xc000, v11
v_mfma_f32_16x16x32_bf16 v[28:31], a[20:23], v[48:51], v[28:31]
v_add_u32 v12, 0xc000, v12
v_add_u32 v13, 0xc000, v13
v_mfma_f32_16x16x32_bf16 v[36:39], a[12:15], a[0:3], v[36:39]
ds_read_b128 a[12:15], v14 offset:37120
v_add_u32 v14, 0x18000, v14
v_mfma_f32_16x16x32_bf16 v[32:35], a[4:7], a[0:3], v[32:35]
s_nop 1
v_cndmask_b32 v18, v28, v29, s[32:33]
v_mfma_f32_16x16x32_bf16 v[36:39], a[20:23], a[0:3], v[36:39]
v_cndmask_b32 v18, v18, v30, s[34:35]
v_cndmask_b32 v18, v18, v31, s[36:37]
v_mfma_f32_16x16x32_bf16 v[28:31], a[8:11], a[8:11], 0
s_nop 4
v_cndmask_b32 v19, v36, v37, s[32:33]
v_cndmask_b32 v19, v19, v38, s[34:35]
v_cndmask_b32 v19, v19, v39, s[36:37]
v_mfma_f32_16x16x32_bf16 v[36:39], a[8:11], a[0:3], 0
ds_write_b128 v21, v[16:19] offset:1280
v_cndmask_b32 v16, v24, v25, s[32:33]
s_waitcnt lgkmcnt(1)
v_mfma_f32_16x16x32_bf16 v[28:31], a[12:15], a[12:15], v[28:31]
v_cndmask_b32 v16, v16, v26, s[34:35]
v_cndmask_b32 v16, v16, v27, s[36:37]
v_mfma_f32_16x16x32_bf16 v[36:39], a[12:15], a[0:3], v[36:39]
v_cndmask_b32 v17, v32, v33, s[32:33]
v_cndmask_b32 v17, v17, v34, s[34:35]
v_mfma_f32_16x16x32_bf16 v[28:31], a[16:19], a[16:19], v[28:31]
v_cndmask_b32 v17, v17, v35, s[36:37]
v_mfma_f32_16x16x32_bf16 v[36:39], a[16:19], a[0:3], v[36:39]
s_nop 5
v_cndmask_b32 v18, v28, v29, s[32:33]
v_cndmask_b32 v18, v18, v30, s[34:35]
v_cndmask_b32 v18, v18, v31, s[36:37]
v_cndmask_b32 v19, v36, v37, s[32:33]
v_cndmask_b32 v19, v19, v38, s[34:35]
v_cndmask_b32 v19, v19, v39, s[36:37]
ds_write_b128 v21, v[16:19] offset:12032
s_waitcnt lgkmcnt(0)
s_barrier
ds_read_b128 a[20:23], v14 offset:0
buffer_load_dwordx4 v2, s[12:15], s49 offen offset:0 nt lds
ds_read_b128 a[24:27], v14 offset:12288
ds_read_b128 a[32:35], v20 offset:0
ds_read_b128 a[36:39], v20 offset:1024
ds_read_b128 a[28:31], v14 offset:256
buffer_load_dwordx4 v3, s[12:15], s49 offen offset:1024 nt lds
s_waitcnt lgkmcnt(4)
v_mfma_f32_16x16x32_bf16 v[24:27], a[20:23], a[20:23], 0
ds_read_b128 a[40:43], v20 offset:2048
v_mfma_f32_16x16x32_bf16 v[32:35], a[20:23], a[0:3], 0
ds_read_b128 a[44:47], v20 offset:3072
v_mfma_f32_16x16x32_bf16 v[24:27], a[20:23], v[52:55], v[24:27]
s_waitcnt lgkmcnt(2)
ds_read_b128 a[4:7], v14 offset:12544
v_mfma_f32_16x16x32_bf16 v[28:31], a[24:27], a[24:27], 0
buffer_load_dwordx4 v4, s[12:15], s49 offen offset:2048 nt lds
ds_read_b64_tr_b16 a[16:17], v8 offset:0
v_mfma_f32_16x16x32_bf16 v[36:39], a[24:27], a[0:3], 0
ds_read_b64_tr_b16 a[18:19], v8 offset:12288
ds_read_b128 a[8:11], v14 offset:512
v_mfma_f32_16x16x32_bf16 v[28:31], a[24:27], v[52:55], v[28:31]
ds_read_b128 a[12:15], v14 offset:12800
v_mfma_f32_16x16x32_bf16 v[24:27], a[28:31], a[28:31], v[24:27]
v_add_u32 v14, 0xfffe8000, v14
v_mfma_f32_16x16x32_bf16 v[32:35], a[28:31], a[0:3], v[32:35]
ds_read_b64_tr_b16 a[20:21], v9 offset:0
ds_read_b64_tr_b16 a[22:23], v9 offset:12288
ds_read_b64_tr_b16 a[24:25], v10 offset:0
buffer_load_dwordx4 v5, s[12:15], s49 offen offset:3072 nt lds
ds_read_b64_tr_b16 a[26:27], v10 offset:12288
v_mfma_f32_16x16x32_bf16 v[24:27], a[28:31], v[56:59], v[24:27]
s_waitcnt lgkmcnt(8)
s_add_u32 m0, s24, 4096
ds_read_b64_tr_b16 a[28:29], v11 offset:0
v_mfma_f32_16x16x32_bf16 v[28:31], a[4:7], a[4:7], v[28:31]
ds_read_b64_tr_b16 a[30:31], v11 offset:12288
ds_read_b128 v[40:43], v14 offset:24576
v_mfma_f32_16x16x32_bf16 v[36:39], a[4:7], a[0:3], v[36:39]
ds_read_b128 v[44:47], v14 offset:24832
v_mfma_f32_16x16x32_bf16 v[28:31], a[4:7], v[56:59], v[28:31]
s_waitcnt lgkmcnt(8)
buffer_load_dwordx4 v6, s[12:15], s49 offen offset:0 nt lds
ds_read_b64_tr_b16 a[4:5], v12 offset:0
v_mfma_f32_16x16x32_bf16 v[64:67], a[16:19], a[32:35], 0
ds_read_b64_tr_b16 a[6:7], v12 offset:12288
v_mfma_f32_16x16x32_bf16 v[68:71], a[16:19], a[36:39], 0
ds_read_b128 v[48:51], v14 offset:25088
v_add_u32 v14, 0x18000, v14
v_mfma_f32_16x16x32_bf16 v[24:27], a[8:11], a[8:11], v[24:27]
s_waitcnt lgkmcnt(4)
v_add_u32 v40, s56, v40
v_mfma_f32_16x16x32_bf16 v[72:75], a[16:19], a[40:43], 0
buffer_load_dwordx4 v7, s[12:15], s49 offen offset:1024 nt lds
v_add_u32 v41, s56, v41
v_mfma_f32_16x16x32_bf16 v[32:35], a[8:11], a[0:3], v[32:35]
s_add_u32 s49, s26, 245760
v_add_u32 v42, s56, v42
v_add_u32 v43, s56, v43
v_mfma_f32_16x16x32_bf16 v[76:79], a[16:19], a[44:47], 0
s_waitcnt lgkmcnt(1)
s_add_u32 m0, s24, 49152
v_add_u32 v44, s56, v44
v_add_u32 v45, s56, v45
v_mfma_f32_16x16x32_bf16 v[24:27], a[8:11], v[60:63], v[24:27]
ds_read_b64_tr_b16 a[8:9], v13 offset:0
ds_read_b64_tr_b16 a[10:11], v13 offset:12288
v_mfma_f32_16x16x32_bf16 v[28:31], a[12:15], a[12:15], v[28:31]
v_cndmask_b32 v17, v32, v33, s[32:33]
v_cndmask_b32 v17, v17, v34, s[34:35]
v_mfma_f32_16x16x32_bf16 v[80:83], a[20:23], a[32:35], 0
v_cndmask_b32 v17, v17, v35, s[36:37]
s_nop 0
v_cndmask_b32 v16, v24, v25, s[32:33]
v_mfma_f32_16x16x32_bf16 v[36:39], a[12:15], a[0:3], v[36:39]
v_cndmask_b32 v16, v16, v26, s[34:35]
v_cndmask_b32 v16, v16, v27, s[36:37]
v_mfma_f32_16x16x32_bf16 v[28:31], a[12:15], v[60:63], v[28:31]
v_add_u32 v46, s56, v46
v_add_u32 v47, s56, v47
v_mfma_f32_16x16x32_bf16 v[84:87], a[20:23], a[36:39], 0
s_waitcnt lgkmcnt(2)
v_add_u32 v48, s56, v48
v_cndmask_b32 v19, v36, v37, s[32:33]
v_mfma_f32_16x16x32_bf16 v[88:91], a[20:23], a[40:43], 0
v_cndmask_b32 v19, v19, v38, s[34:35]
v_cndmask_b32 v18, v28, v29, s[32:33]
v_mfma_f32_16x16x32_bf16 v[92:95], a[20:23], a[44:47], 0
v_cndmask_b32 v18, v18, v30, s[34:35]
v_cndmask_b32 v18, v18, v31, s[36:37]
v_mfma_f32_16x16x32_bf16 v[96:99], a[24:27], a[32:35], 0
v_cndmask_b32 v19, v19, v39, s[36:37]
v_add_u32 v49, s56, v49
v_mfma_f32_16x16x32_bf16 v[100:103], a[24:27], a[36:39], 0
ds_write_b128 v21, v[16:19] offset:0
v_add_u32 v50, s56, v50
v_mfma_f32_16x16x32_bf16 v[104:107], a[24:27], a[40:43], 0
v_add_u32 v51, s56, v51
v_mfma_f32_16x16x32_bf16 v[108:111], a[24:27], a[44:47], 0
v_mfma_f32_16x16x32_bf16 v[112:115], a[28:31], a[32:35], 0
v_mfma_f32_16x16x32_bf16 v[116:119], a[28:31], a[36:39], 0
v_mfma_f32_16x16x32_bf16 v[120:123], a[28:31], a[40:43], 0
v_mfma_f32_16x16x32_bf16 v[124:127], a[28:31], a[44:47], 0
s_waitcnt vmcnt(6) lgkmcnt(0)
s_barrier
ds_read_b128 v[16:19], v22 offset:16
buffer_load_dwordx4 v2, s[12:15], s49 offen offset:0 nt lds
ds_read_b128 a[12:15], v14 offset:24576
v_mfma_f32_16x16x32_bf16 v[128:131], a[4:7], a[32:35], 0
ds_read_b128 a[16:19], v14 offset:36864
v_mfma_f32_16x16x32_bf16 v[132:135], a[4:7], a[36:39], 0
ds_read_b128 a[20:23], v14 offset:24832
v_mfma_f32_16x16x32_bf16 v[136:139], a[4:7], a[40:43], 0
ds_read_b128 a[24:27], v14 offset:37120
buffer_load_dwordx4 v3, s[12:15], s49 offen offset:1024 nt lds
s_waitcnt lgkmcnt(4)
v_max3_u32 v15, v16, v17, v18
v_mfma_f32_16x16x32_bf16 v[140:143], a[4:7], a[44:47], 0
s_waitcnt lgkmcnt(3)
ds_read_b128 a[28:31], v14 offset:25088
v_max_u32 v15, v15, v19
v_mfma_f32_16x16x32_bf16 v[24:27], a[12:15], a[12:15], 0
ds_read_b128 a[4:7], v14 offset:37376
v_cmp_eq_u32 vcc, 2, v15
v_mfma_f32_16x16x32_bf16 v[144:147], a[8:11], a[32:35], 0
ds_read_b128 a[32:35], v20 offset:4096
v_add_u32 v14, 0xfffe8000, v14
v_mfma_f32_16x16x32_bf16 v[32:35], a[12:15], a[0:3], 0
buffer_load_dwordx4 v4, s[12:15], s49 offen offset:2048 nt lds
v_mfma_f32_16x16x32_bf16 v[148:151], a[8:11], a[36:39], 0
ds_read_b128 a[36:39], v20 offset:5120
v_mfma_f32_16x16x32_bf16 v[152:155], a[8:11], a[40:43], 0
ds_read_b128 a[40:43], v20 offset:6144
v_mfma_f32_16x16x32_bf16 v[156:159], a[8:11], a[44:47], 0
ds_read_b128 a[44:47], v20 offset:7168
v_mfma_f32_16x16x32_bf16 v[24:27], a[12:15], v[52:55], v[24:27]
s_waitcnt lgkmcnt(5)
ds_read_b64_tr_b16 a[8:9], v8 offset:24576
ds_read_b64_tr_b16 a[10:11], v8 offset:36864
buffer_load_dwordx4 v5, s[12:15], s49 offen offset:3072 nt lds
ds_read_b64_tr_b16 a[12:13], v9 offset:24576
v_mfma_f32_16x16x32_bf16 v[28:31], a[16:19], a[16:19], 0
s_cbranch_vccnz RESC1b
C_R1b:
ds_read_b64_tr_b16 a[14:15], v9 offset:36864
v_mfma_f32_16x16x32_bf16 v[36:39], a[16:19], a[0:3], 0
s_add_u32 m0, s24, 53248
v_add_u32 v8, 0xc000, v8
v_add_u32 v9, 0xc000, v9
v_mfma_f32_16x16x32_bf16 v[28:31], a[16:19], v[52:55], v[28:31]
ds_read_b64_tr_b16 a[16:17], v10 offset:24576
ds_read_b64_tr_b16 a[18:19], v10 offset:36864
v_mfma_f32_16x16x32_bf16 v[24:27], a[20:23], a[20:23], v[24:27]
buffer_load_dwordx4 v6, s[12:15], s49 offen offset:0 nt lds
v_add_u32 v10, 0xc000, v10
v_mfma_f32_16x16x32_bf16 v[32:35], a[20:23], a[0:3], v[32:35]
v_mfma_f32_16x16x32_bf16 v[24:27], a[20:23], v[56:59], v[24:27]
ds_read_b64_tr_b16 a[20:21], v11 offset:24576
ds_read_b64_tr_b16 a[22:23], v11 offset:36864
v_mfma_f32_16x16x32_bf16 v[28:31], a[24:27], a[24:27], v[28:31]
s_waitcnt lgkmcnt(5)
v_add_u32 v11, 0xc000, v11
v_mfma_f32_16x16x32_bf16 v[64:67], a[8:11], a[32:35], v[64:67]
buffer_load_dwordx4 v7, s[12:15], s49 offen offset:1024 nt lds
s_add_u32 s49, s26, 73728
v_mfma_f32_16x16x32_bf16 v[36:39], a[24:27], a[0:3], v[36:39]
s_add_u32 m0, s24, 73728
v_mfma_f32_16x16x32_bf16 v[28:31], a[24:27], v[56:59], v[28:31]
ds_read_b64_tr_b16 a[24:25], v12 offset:24576
ds_read_b64_tr_b16 a[26:27], v12 offset:36864
v_mfma_f32_16x16x32_bf16 v[68:71], a[8:11], a[36:39], v[68:71]
v_add_u32 v12, 0xc000, v12
v_mfma_f32_16x16x32_bf16 v[24:27], a[28:31], a[28:31], v[24:27]
v_mfma_f32_16x16x32_bf16 v[72:75], a[8:11], a[40:43], v[72:75]
v_mfma_f32_16x16x32_bf16 v[32:35], a[28:31], a[0:3], v[32:35]
v_mfma_f32_16x16x32_bf16 v[24:27], a[28:31], v[60:63], v[24:27]
ds_read_b64_tr_b16 a[28:29], v13 offset:24576
ds_read_b64_tr_b16 a[30:31], v13 offset:36864
v_mfma_f32_16x16x32_bf16 v[76:79], a[8:11], a[44:47], v[76:79]
v_add_u32 v13, 0xc000, v13
s_nop 2
v_cndmask_b32 v17, v32, v33, s[32:33]
v_mfma_f32_16x16x32_bf16 v[28:31], a[4:7], a[4:7], v[28:31]
v_cndmask_b32 v17, v17, v34, s[34:35]
v_cndmask_b32 v16, v24, v25, s[32:33]
v_mfma_f32_16x16x32_bf16 v[36:39], a[4:7], a[0:3], v[36:39]
v_cndmask_b32 v16, v16, v26, s[34:35]
v_cndmask_b32 v16, v16, v27, s[36:37]
v_mfma_f32_16x16x32_bf16 v[28:31], a[4:7], v[60:63], v[28:31]
s_waitcnt lgkmcnt(2)
v_cndmask_b32 v17, v17, v35, s[36:37]
v_mfma_f32_16x16x32_bf16 v[80:83], a[12:15], a[32:35], v[80:83]
s_nop 1
v_cndmask_b32 v19, v36, v37, s[32:33]
v_mfma_f32_16x16x32_bf16 v[84:87], a[12:15], a[36:39], v[84:87]
v_cndmask_b32 v19, v19, v38, s[34:35]
v_cndmask_b32 v18, v28, v29, s[32:33]
v_mfma_f32_16x16x32_bf16 v[88:91], a[12:15], a[40:43], v[88:91]
v_cndmask_b32 v18, v18, v30, s[34:35]
v_cndmask_b32 v18, v18, v31, s[36:37]
v_mfma_f32_16x16x32_bf16 v[92:95], a[12:15], a[44:47], v[92:95]
v_cndmask_b32 v19, v19, v39, s[36:37]
v_mfma_f32_16x16x32_bf16 v[96:99], a[16:19], a[32:35], v[96:99]
ds_write_b128 v21, v[16:19] offset:1280
v_mfma_f32_16x16x32_bf16 v[100:103], a[16:19], a[36:39], v[100:103]
v_mfma_f32_16x16x32_bf16 v[104:107], a[16:19], a[40:43], v[104:107]
v_mfma_f32_16x16x32_bf16 v[108:111], a[16:19], a[44:47], v[108:111]
v_mfma_f32_16x16x32_bf16 v[112:115], a[20:23], a[32:35], v[112:115]
v_mfma_f32_16x16x32_bf16 v[116:119], a[20:23], a[36:39], v[116:119]
v_mfma_f32_16x16x32_bf16 v[120:123], a[20:23], a[40:43], v[120:123]
v_mfma_f32_16x16x32_bf16 v[124:127], a[20:23], a[44:47], v[124:127]
s_waitcnt vmcnt(6) lgkmcnt(0)
s_barrier
ds_read_b128 v[16:19], v22 offset:0
buffer_load_dwordx4 v2, s[12:15], s49 offen offset:0 nt lds
ds_read_b128 a[4:7], v14 offset:0
v_mfma_f32_16x16x32_bf16 v[128:131], a[24:27], a[32:35], v[128:131]
ds_read_b128 a[8:11], v14 offset:12288
v_mfma_f32_16x16x32_bf16 v[132:135], a[24:27], a[36:39], v[132:135]
ds_read_b128 a[12:15], v14 offset:256
v_mfma_f32_16x16x32_bf16 v[136:139], a[24:27], a[40:43], v[136:139]
ds_read_b128 a[16:19], v14 offset:12544
buffer_load_dwordx4 v3, s[12:15], s49 offen offset:1024 nt lds
s_waitcnt lgkmcnt(4)
v_max3_u32 v15, v16, v17, v18
v_mfma_f32_16x16x32_bf16 v[140:143], a[24:27], a[44:47], v[140:143]
s_waitcnt lgkmcnt(3)
ds_read_b128 a[20:23], v14 offset:512
v_max_u32 v15, v15, v19
v_mfma_f32_16x16x32_bf16 v[24:27], a[4:7], a[4:7], 0
ds_read_b128 a[24:27], v14 offset:12800
v_cmp_eq_u32 vcc, 3, v15
v_mfma_f32_16x16x32_bf16 v[144:147], a[28:31], a[32:35], v[144:147]
ds_read_b128 a[32:35], v20 offset:0
v_mfma_f32_16x16x32_bf16 v[32:35], a[4:7], a[0:3], 0
buffer_load_dwordx4 v4, s[12:15], s49 offen offset:2048 nt lds
ds_read_b128 v[52:55], v14 offset:36864
v_mfma_f32_16x16x32_bf16 v[148:151], a[28:31], a[36:39], v[148:151]
ds_read_b128 a[36:39], v20 offset:1024
v_mfma_f32_16x16x32_bf16 v[152:155], a[28:31], a[40:43], v[152:155]
ds_read_b128 a[40:43], v20 offset:2048
v_mfma_f32_16x16x32_bf16 v[156:159], a[28:31], a[44:47], v[156:159]
ds_read_b128 a[44:47], v20 offset:3072
v_mfma_f32_16x16x32_bf16 v[24:27], a[4:7], v[40:43], v[24:27]
s_waitcnt lgkmcnt(6)
buffer_load_dwordx4 v5, s[12:15], s49 offen offset:3072 nt lds
ds_read_b64_tr_b16 a[28:29], v8 offset:0
v_mfma_f32_16x16x32_bf16 v[28:31], a[8:11], a[8:11], 0
s_cbranch_vccnz RESC2b
C_R2b:
ds_read_b64_tr_b16 a[30:31], v8 offset:12288
ds_read_b64_tr_b16 a[4:5], v9 offset:0
v_mfma_f32_16x16x32_bf16 v[36:39], a[8:11], a[0:3], 0
s_add_u32 m0, s24, 77824
ds_read_b64_tr_b16 a[6:7], v9 offset:12288
ds_read_b128 v[56:59], v14 offset:37120
v_mfma_f32_16x16x32_bf16 v[28:31], a[8:11], v[40:43], v[28:31]
s_waitcnt lgkmcnt(7)
v_add_u32 v52, s56, v52
v_add_u32 v53, s56, v53
v_mfma_f32_16x16x32_bf16 v[24:27], a[12:15], a[12:15], v[24:27]
ds_read_b64_tr_b16 a[8:9], v10 offset:0
ds_read_b64_tr_b16 a[10:11], v10 offset:12288
buffer_load_dwordx4 v6, s[12:15], s49 offen offset:0 nt lds
ds_read_b128 v[60:63], v14 offset:37376
v_mfma_f32_16x16x32_bf16 v[32:35], a[12:15], a[0:3], v[32:35]
v_add_u32 v54, s56, v54
v_add_u32 v55, s56, v55
v_mfma_f32_16x16x32_bf16 v[24:27], a[12:15], v[44:47], v[24:27]
ds_read_b64_tr_b16 a[12:13], v11 offset:0
ds_read_b64_tr_b16 a[14:15], v11 offset:12288
v_mfma_f32_16x16x32_bf16 v[28:31], a[16:19], a[16:19], v[28:31]
s_waitcnt lgkmcnt(5)
v_add_u32 v56, s56, v56
v_add_u32 v57, s56, v57
v_mfma_f32_16x16x32_bf16 v[36:39], a[16:19], a[0:3], v[36:39]
buffer_load_dwordx4 v7, s[12:15], s49 offen offset:1024 nt lds
v_add_u32 v58, s56, v58
v_mfma_f32_16x16x32_bf16 v[28:31], a[16:19], v[44:47], v[28:31]
s_add_u32 s49, s26, 270336
ds_read_b64_tr_b16 a[16:17], v12 offset:0
ds_read_b64_tr_b16 a[18:19], v12 offset:12288
v_mfma_f32_16x16x32_bf16 v[64:67], a[28:31], a[32:35], v[64:67]
s_waitcnt lgkmcnt(4)
s_add_u32 m0, s24, 98304
v_add_u32 v59, s56, v59
v_add_u32 v60, s56, v60
v_mfma_f32_16x16x32_bf16 v[68:71], a[28:31], a[36:39], v[68:71]
v_add_u32 v61, s56, v61
v_add_u32 v62, s56, v62
v_mfma_f32_16x16x32_bf16 v[24:27], a[20:23], a[20:23], v[24:27]
v_add_u32 v63, s56, v63
v_add_u32 v14, 0xc000, v14
v_mfma_f32_16x16x32_bf16 v[72:75], a[28:31], a[40:43], v[72:75]
v_mfma_f32_16x16x32_bf16 v[32:35], a[20:23], a[0:3], v[32:35]
v_mfma_f32_16x16x32_bf16 v[76:79], a[28:31], a[44:47], v[76:79]
v_mfma_f32_16x16x32_bf16 v[24:27], a[20:23], v[48:51], v[24:27]
ds_read_b64_tr_b16 a[20:21], v13 offset:0
ds_read_b64_tr_b16 a[22:23], v13 offset:12288
v_mfma_f32_16x16x32_bf16 v[28:31], a[24:27], a[24:27], v[28:31]
s_nop 2
v_cndmask_b32 v17, v32, v33, s[32:33]
v_cndmask_b32 v17, v17, v34, s[34:35]
v_mfma_f32_16x16x32_bf16 v[36:39], a[24:27], a[0:3], v[36:39]
v_cndmask_b32 v17, v17, v35, s[36:37]
v_cndmask_b32 v16, v24, v25, s[32:33]
v_mfma_f32_16x16x32_bf16 v[80:83], a[4:7], a[32:35], v[80:83]
v_cndmask_b32 v16, v16, v26, s[34:35]
v_cndmask_b32 v16, v16, v27, s[36:37]
v_mfma_f32_16x16x32_bf16 v[28:31], a[24:27], v[48:51], v[28:31]
s_nop 1
v_cndmask_b32 v19, v36, v37, s[32:33]
v_mfma_f32_16x16x32_bf16 v[84:87], a[4:7], a[36:39], v[84:87]
v_cndmask_b32 v19, v19, v38, s[34:35]
v_cndmask_b32 v19, v19, v39, s[36:37]
v_mfma_f32_16x16x32_bf16 v[88:91], a[4:7], a[40:43], v[88:91]
s_nop 0
v_cndmask_b32 v18, v28, v29, s[32:33]
v_mfma_f32_16x16x32_bf16 v[92:95], a[4:7], a[44:47], v[92:95]
v_cndmask_b32 v18, v18, v30, s[34:35]
v_cndmask_b32 v18, v18, v31, s[36:37]
v_mfma_f32_16x16x32_bf16 v[96:99], a[8:11], a[32:35], v[96:99]
ds_write_b128 v21, v[16:19] offset:0
v_mfma_f32_16x16x32_bf16 v[100:103], a[8:11], a[36:39], v[100:103]
v_mfma_f32_16x16x32_bf16 v[104:107], a[8:11], a[40:43], v[104:107]
v_mfma_f32_16x16x32_bf16 v[108:111], a[8:11], a[44:47], v[108:111]
s_waitcnt lgkmcnt(1)
v_mfma_f32_16x16x32_bf16 v[112:115], a[12:15], a[32:35], v[112:115]
v_mfma_f32_16x16x32_bf16 v[116:119], a[12:15], a[36:39], v[116:119]
v_mfma_f32_16x16x32_bf16 v[120:123], a[12:15], a[40:43], v[120:123]
v_mfma_f32_16x16x32_bf16 v[124:127], a[12:15], a[44:47], v[124:127]
s_waitcnt vmcnt(6) lgkmcnt(0)
s_barrier
ds_read_b128 v[16:19], v22 offset:16
buffer_load_dwordx4 v2, s[12:15], s49 offen offset:0 nt lds
ds_read_b128 a[24:27], v14 offset:0
v_mfma_f32_16x16x32_bf16 v[128:131], a[16:19], a[32:35], v[128:131]
ds_read_b128 a[28:31], v14 offset:12288
v_mfma_f32_16x16x32_bf16 v[132:135], a[16:19], a[36:39], v[132:135]
ds_read_b128 a[4:7], v14 offset:256
v_mfma_f32_16x16x32_bf16 v[136:139], a[16:19], a[40:43], v[136:139]
ds_read_b128 a[8:11], v14 offset:12544
buffer_load_dwordx4 v3, s[12:15], s49 offen offset:1024 nt lds
s_waitcnt lgkmcnt(4)
v_max3_u32 v15, v16, v17, v18
v_mfma_f32_16x16x32_bf16 v[140:143], a[16:19], a[44:47], v[140:143]
s_waitcnt lgkmcnt(3)
ds_read_b128 a[12:15], v14 offset:512
v_max_u32 v15, v15, v19
v_mfma_f32_16x16x32_bf16 v[24:27], a[24:27], a[24:27], 0
ds_read_b128 a[16:19], v14 offset:12800
v_cmp_eq_u32 vcc, 4, v15
v_mfma_f32_16x16x32_bf16 v[144:147], a[20:23], a[32:35], v[144:147]
ds_read_b128 a[32:35], v20 offset:4096
v_mfma_f32_16x16x32_bf16 v[148:151], a[20:23], a[36:39], v[148:151]
ds_read_b128 a[36:39], v20 offset:5120
buffer_load_dwordx4 v4, s[12:15], s49 offen offset:2048 nt lds
v_mfma_f32_16x16x32_bf16 v[152:155], a[20:23], a[40:43], v[152:155]
ds_read_b128 a[40:43], v20 offset:6144
v_mfma_f32_16x16x32_bf16 v[156:159], a[20:23], a[44:47], v[156:159]
ds_read_b64_tr_b16 a[20:21], v8 offset:24576
v_mfma_f32_16x16x32_bf16 v[32:35], a[24:27], a[0:3], 0
ds_read_b64_tr_b16 a[22:23], v8 offset:36864
v_add_u32 v8, 0xfffe8000, v8
v_mfma_f32_16x16x32_bf16 v[24:27], a[24:27], v[40:43], v[24:27]
s_waitcnt lgkmcnt(6)
ds_read_b128 a[44:47], v20 offset:7168
buffer_load_dwordx4 v5, s[12:15], s49 offen offset:3072 nt lds
ds_read_b64_tr_b16 a[24:25], v9 offset:24576
v_mfma_f32_16x16x32_bf16 v[28:31], a[28:31], a[28:31], 0
s_cbranch_vccnz RESC3b
C_R3b:
ds_read_b64_tr_b16 a[26:27], v9 offset:36864
v_mfma_f32_16x16x32_bf16 v[36:39], a[28:31], a[0:3], 0
s_add_u32 m0, s24, 102400
v_add_u32 v9, 0xfffe8000, v9
s_add_u32 s52, s27, 6144
v_mfma_f32_16x16x32_bf16 v[28:31], a[28:31], v[40:43], v[28:31]
s_waitcnt lgkmcnt(3)
ds_read_b64_tr_b16 a[28:29], v10 offset:24576
ds_read_b64_tr_b16 a[30:31], v10 offset:36864
v_mfma_f32_16x16x32_bf16 v[64:67], a[20:23], a[32:35], v[64:67]
buffer_load_dwordx4 v6, s[12:15], s49 offen offset:0 nt lds
v_add_u32 v10, 0xfffe8000, v10
v_mfma_f32_16x16x32_bf16 v[24:27], a[4:7], a[4:7], v[24:27]
v_mfma_f32_16x16x32_bf16 v[68:71], a[20:23], a[36:39], v[68:71]
v_mfma_f32_16x16x32_bf16 v[32:35], a[4:7], a[0:3], v[32:35]
v_mfma_f32_16x16x32_bf16 v[72:75], a[20:23], a[40:43], v[72:75]
buffer_load_dwordx4 v7, s[12:15], s49 offen offset:1024 nt lds
s_add_u32 m0, s24, 24576
v_mfma_f32_16x16x32_bf16 v[24:27], a[4:7], v[44:47], v[24:27]
s_waitcnt lgkmcnt(2)
ds_read_b64_tr_b16 a[4:5], v11 offset:24576
ds_read_b64_tr_b16 a[6:7], v11 offset:36864
v_mfma_f32_16x16x32_bf16 v[76:79], a[20:23], a[44:47], v[76:79]
v_add_u32 v11, 0xfffe8000, v11
v_mfma_f32_16x16x32_bf16 v[28:31], a[8:11], a[8:11], v[28:31]
v_mfma_f32_16x16x32_bf16 v[80:83], a[24:27], a[32:35], v[80:83]
buffer_load_dwordx4 v1, s[28:31], s52 offen offset:0 sc1 lds
v_mfma_f32_16x16x32_bf16 v[36:39], a[8:11], a[0:3], v[36:39]
v_mfma_f32_16x16x32_bf16 v[84:87], a[24:27], a[36:39], v[84:87]
v_mfma_f32_16x16x32_bf16 v[28:31], a[8:11], v[44:47], v[28:31]
ds_read_b64_tr_b16 a[8:9], v12 offset:24576
ds_read_b64_tr_b16 a[10:11], v12 offset:36864
v_mfma_f32_16x16x32_bf16 v[88:91], a[24:27], a[40:43], v[88:91]
buffer_load_dwordx4 v1, s[28:31], s52 offen offset:1024 sc1 lds
v_add_u32 v12, 0xfffe8000, v12
v_mfma_f32_16x16x32_bf16 v[92:95], a[24:27], a[44:47], v[92:95]
v_mfma_f32_16x16x32_bf16 v[24:27], a[12:15], a[12:15], v[24:27]
v_mfma_f32_16x16x32_bf16 v[32:35], a[12:15], a[0:3], v[32:35]
v_mfma_f32_16x16x32_bf16 v[24:27], a[12:15], v[48:51], v[24:27]
s_waitcnt lgkmcnt(2)
ds_read_b64_tr_b16 a[12:13], v13 offset:24576
ds_read_b64_tr_b16 a[14:15], v13 offset:36864
buffer_load_dwordx4 v1, s[28:31], s52 offen offset:2048 sc1 lds
v_mfma_f32_16x16x32_bf16 v[96:99], a[28:31], a[32:35], v[96:99]
s_nop 1
v_cndmask_b32 v17, v32, v33, s[32:33]
v_cndmask_b32 v17, v17, v34, s[34:35]
v_mfma_f32_16x16x32_bf16 v[100:103], a[28:31], a[36:39], v[100:103]
v_cndmask_b32 v16, v24, v25, s[32:33]
v_cndmask_b32 v16, v16, v26, s[34:35]
v_mfma_f32_16x16x32_bf16 v[28:31], a[16:19], a[16:19], v[28:31]
v_cndmask_b32 v16, v16, v27, s[36:37]
v_cndmask_b32 v17, v17, v35, s[36:37]
v_mfma_f32_16x16x32_bf16 v[104:107], a[28:31], a[40:43], v[104:107]
v_add_u32 v13, 0xfffe8000, v13
v_mfma_f32_16x16x32_bf16 v[36:39], a[16:19], a[0:3], v[36:39]
buffer_load_dwordx4 v1, s[28:31], s52 offen offset:3072 sc1 lds
s_add_u32 s52, s52, 4096
v_mfma_f32_16x16x32_bf16 v[108:111], a[28:31], a[44:47], v[108:111]
s_add_u32 m0, s24, 28672
v_mfma_f32_16x16x32_bf16 v[28:31], a[16:19], v[48:51], v[28:31]
s_nop 2
v_cndmask_b32 v19, v36, v37, s[32:33]
v_mfma_f32_16x16x32_bf16 v[112:115], a[4:7], a[32:35], v[112:115]
v_cndmask_b32 v19, v19, v38, s[34:35]
v_cndmask_b32 v19, v19, v39, s[36:37]
v_mfma_f32_16x16x32_bf16 v[116:119], a[4:7], a[36:39], v[116:119]
buffer_load_dwordx4 v1, s[28:31], s52 offen offset:0 sc1 lds
v_cndmask_b32 v18, v28, v29, s[32:33]
v_mfma_f32_16x16x32_bf16 v[120:123], a[4:7], a[40:43], v[120:123]
v_cndmask_b32 v18, v18, v30, s[34:35]
v_cndmask_b32 v18, v18, v31, s[36:37]
v_mfma_f32_16x16x32_bf16 v[124:127], a[4:7], a[44:47], v[124:127]
s_waitcnt lgkmcnt(0)
ds_write_b128 v21, v[16:19] offset:1280
v_mfma_f32_16x16x32_bf16 v[128:131], a[8:11], a[32:35], v[128:131]
v_mfma_f32_16x16x32_bf16 v[132:135], a[8:11], a[36:39], v[132:135]
buffer_load_dwordx4 v1, s[28:31], s52 offen offset:1024 sc1 lds
s_add_u32 s52, s27, 24576
v_mfma_f32_16x16x32_bf16 v[136:139], a[8:11], a[40:43], v[136:139]
s_add_u32 m0, s24, 122880
v_mfma_f32_16x16x32_bf16 v[140:143], a[8:11], a[44:47], v[140:143]
v_mfma_f32_16x16x32_bf16 v[144:147], a[12:15], a[32:35], v[144:147]
ds_read_b128 a[32:35], v20 offset:8192
v_mfma_f32_16x16x32_bf16 v[148:151], a[12:15], a[36:39], v[148:151]
ds_read_b128 a[36:39], v20 offset:9216
v_mfma_f32_16x16x32_bf16 v[152:155], a[12:15], a[40:43], v[152:155]
ds_read_b128 a[40:43], v20 offset:10240
v_mfma_f32_16x16x32_bf16 v[156:159], a[12:15], a[44:47], v[156:159]
ds_read_b128 a[44:47], v20 offset:11264
s_waitcnt lgkmcnt(3)
v_mfma_f32_16x16x32_bf16 v[64:67], a[48:51], a[32:35], v[64:67]
v_mfma_f32_16x16x32_bf16 v[80:83], a[52:55], a[32:35], v[80:83]
s_waitcnt lgkmcnt(2)
v_mfma_f32_16x16x32_bf16 v[68:71], a[48:51], a[36:39], v[68:71]
s_waitcnt lgkmcnt(1)
v_mfma_f32_16x16x32_bf16 v[72:75], a[48:51], a[40:43], v[72:75]
s_waitcnt vmcnt(12) lgkmcnt(0)
s_barrier
v_mfma_f32_16x16x32_bf16 v[76:79], a[48:51], a[44:47], v[76:79]
v_mfma_f32_16x16x32_bf16 v[84:87], a[52:55], a[36:39], v[84:87]
ds_read_b128 a[16:19], v14 offset:24576
buffer_load_dwordx4 v1, s[28:31], s52 offen offset:0 sc1 lds
ds_read_b128 v[16:19], v22 offset:0
v_mfma_f32_16x16x32_bf16 v[88:91], a[52:55], a[40:43], v[88:91]
ds_read_b128 a[20:23], v14 offset:36864
v_mfma_f32_16x16x32_bf16 v[92:95], a[52:55], a[44:47], v[92:95]
ds_read_b128 a[24:27], v14 offset:24832
v_mfma_f32_16x16x32_bf16 v[96:99], a[56:59], a[32:35], v[96:99]
ds_read_b128 a[28:31], v14 offset:37120
buffer_load_dwordx4 v1, s[28:31], s52 offen offset:1024 sc1 lds
v_mfma_f32_16x16x32_bf16 v[100:103], a[56:59], a[36:39], v[100:103]
ds_read_b128 a[4:7], v14 offset:25088
v_mfma_f32_16x16x32_bf16 v[104:107], a[56:59], a[40:43], v[104:107]
ds_read_b128 a[8:11], v14 offset:37376
v_mfma_f32_16x16x32_bf16 v[108:111], a[56:59], a[44:47], v[108:111]
s_waitcnt lgkmcnt(5)
v_max3_u32 v15, v16, v17, v18
v_max_u32 v15, v15, v19
v_mfma_f32_16x16x32_bf16 v[112:115], a[60:63], a[32:35], v[112:115]
ds_read_b64_tr_b16 a[12:13], v8 offset:0
ds_read_b64_tr_b16 a[14:15], v8 offset:12288
buffer_load_dwordx4 v1, s[28:31], s52 offen offset:2048 sc1 lds
v_mfma_f32_16x16x32_bf16 v[116:119], a[60:63], a[36:39], v[116:119]
v_cmp_eq_u32 vcc, 5, v15
v_add_u32 v14, 0xc000, v14
v_mfma_f32_16x16x32_bf16 v[120:123], a[60:63], a[40:43], v[120:123]
v_add_u32 v8, 0xc000, v8
v_mfma_f32_16x16x32_bf16 v[124:127], a[60:63], a[44:47], v[124:127]
v_mfma_f32_16x16x32_bf16 v[128:131], a[64:67], a[32:35], v[128:131]
buffer_load_dwordx4 v1, s[28:31], s52 offen offset:3072 sc1 lds
v_mfma_f32_16x16x32_bf16 v[132:135], a[64:67], a[36:39], v[132:135]
s_add_u32 s52, s52, 4096
s_add_u32 m0, s24, 126976
v_mfma_f32_16x16x32_bf16 v[136:139], a[64:67], a[40:43], v[136:139]
v_mfma_f32_16x16x32_bf16 v[24:27], a[16:19], a[16:19], 0
v_mfma_f32_16x16x32_bf16 v[140:143], a[64:67], a[44:47], v[140:143]
buffer_load_dwordx4 v1, s[28:31], s52 offen offset:0 sc1 lds
v_mfma_f32_16x16x32_bf16 v[32:35], a[16:19], a[0:3], 0
v_mfma_f32_16x16x32_bf16 v[144:147], a[68:71], a[32:35], v[144:147]
ds_read_b128 a[32:35], v20 offset:0
v_mfma_f32_16x16x32_bf16 v[24:27], a[16:19], v[52:55], v[24:27]
ds_read_b64_tr_b16 a[16:17], v9 offset:0
ds_read_b64_tr_b16 a[18:19], v9 offset:12288
v_mfma_f32_16x16x32_bf16 v[148:151], a[68:71], a[36:39], v[148:151]
ds_read_b128 a[36:39], v20 offset:1024
buffer_load_dwordx4 v1, s[28:31], s52 offen offset:1024 sc1 lds
v_mfma_f32_16x16x32_bf16 v[152:155], a[68:71], a[40:43], v[152:155]
s_add_u32 s52, s27, 43008
ds_read_b128 a[40:43], v20 offset:2048
s_add_u32 m0, s24, 0
v_mfma_f32_16x16x32_bf16 v[156:159], a[68:71], a[44:47], v[156:159]
s_waitcnt lgkmcnt(5)
ds_read_b128 a[44:47], v20 offset:3072
v_add_u32 v9, 0xc000, v9
v_mfma_f32_16x16x32_bf16 v[28:31], a[20:23], a[20:23], 0
v_mfma_f32_16x16x32_bf16 v[36:39], a[20:23], a[0:3], 0
s_cbranch_vccnz RESC4b
C_R4b:
v_mfma_f32_16x16x32_bf16 v[28:31], a[20:23], v[52:55], v[28:31]
ds_read_b64_tr_b16 a[20:21], v10 offset:0
ds_read_b64_tr_b16 a[22:23], v10 offset:12288
v_mfma_f32_16x16x32_bf16 v[24:27], a[24:27], a[24:27], v[24:27]
v_add_u32 v10, 0xc000, v10
v_mfma_f32_16x16x32_bf16 v[32:35], a[24:27], a[0:3], v[32:35]
v_mfma_f32_16x16x32_bf16 v[24:27], a[24:27], v[56:59], v[24:27]
ds_read_b64_tr_b16 a[24:25], v11 offset:0
ds_read_b64_tr_b16 a[26:27], v11 offset:12288
v_mfma_f32_16x16x32_bf16 v[28:31], a[28:31], a[28:31], v[28:31]
v_add_u32 v11, 0xc000, v11
v_mfma_f32_16x16x32_bf16 v[36:39], a[28:31], a[0:3], v[36:39]
v_mfma_f32_16x16x32_bf16 v[28:31], a[28:31], v[56:59], v[28:31]
ds_read_b64_tr_b16 a[28:29], v12 offset:0
ds_read_b64_tr_b16 a[30:31], v12 offset:12288
v_mfma_f32_16x16x32_bf16 v[24:27], a[4:7], a[4:7], v[24:27]
v_add_u32 v12, 0xc000, v12
v_mfma_f32_16x16x32_bf16 v[32:35], a[4:7], a[0:3], v[32:35]
v_mfma_f32_16x16x32_bf16 v[24:27], a[4:7], v[60:63], v[24:27]
ds_read_b64_tr_b16 a[4:5], v13 offset:0
ds_read_b64_tr_b16 a[6:7], v13 offset:12288
v_mfma_f32_16x16x32_bf16 v[28:31], a[8:11], a[8:11], v[28:31]
s_waitcnt lgkmcnt(4)
v_add_u32 v13, 0xc000, v13
s_nop 1
v_cndmask_b32 v17, v32, v33, s[32:33]
v_mfma_f32_16x16x32_bf16 v[64:67], a[12:15], a[32:35], v[64:67]
v_cndmask_b32 v17, v17, v34, s[34:35]
v_cndmask_b32 v16, v24, v25, s[32:33]
v_mfma_f32_16x16x32_bf16 v[36:39], a[8:11], a[0:3], v[36:39]
v_cndmask_b32 v16, v16, v26, s[34:35]
v_cndmask_b32 v16, v16, v27, s[36:37]
v_mfma_f32_16x16x32_bf16 v[28:31], a[8:11], v[60:63], v[28:31]
v_cndmask_b32 v17, v17, v35, s[36:37]
v_mfma_f32_16x16x32_bf16 v[68:71], a[12:15], a[36:39], v[68:71]
s_nop 2
v_cndmask_b32 v19, v36, v37, s[32:33]
v_mfma_f32_16x16x32_bf16 v[72:75], a[12:15], a[40:43], v[72:75]
v_cndmask_b32 v19, v19, v38, s[34:35]
v_cndmask_b32 v18, v28, v29, s[32:33]
v_mfma_f32_16x16x32_bf16 v[76:79], a[12:15], a[44:47], v[76:79]
v_cndmask_b32 v18, v18, v30, s[34:35]
v_cndmask_b32 v18, v18, v31, s[36:37]
v_mfma_f32_16x16x32_bf16 v[80:83], a[16:19], a[32:35], v[80:83]
v_cndmask_b32 v19, v19, v39, s[36:37]
v_mfma_f32_16x16x32_bf16 v[84:87], a[16:19], a[36:39], v[84:87]
ds_write_b128 v21, v[16:19] offset:0
v_mfma_f32_16x16x32_bf16 v[88:91], a[16:19], a[40:43], v[88:91]
v_mfma_f32_16x16x32_bf16 v[92:95], a[16:19], a[44:47], v[92:95]
v_mfma_f32_16x16x32_bf16 v[96:99], a[20:23], a[32:35], v[96:99]
v_mfma_f32_16x16x32_bf16 v[100:103], a[20:23], a[36:39], v[100:103]
v_mfma_f32_16x16x32_bf16 v[104:107], a[20:23], a[40:43], v[104:107]
v_mfma_f32_16x16x32_bf16 v[108:111], a[20:23], a[44:47], v[108:111]
v_mfma_f32_16x16x32_bf16 v[112:115], a[24:27], a[32:35], v[112:115]
s_waitcnt vmcnt(12) lgkmcnt(0)
s_barrier
v_mfma_f32_16x16x32_bf16 v[116:119], a[24:27], a[36:39], v[116:119]
v_mfma_f32_16x16x32_bf16 v[120:123], a[24:27], a[40:43], v[120:123]
ds_read_b128 v[16:19], v22 offset:16
buffer_load_dwordx4 v1, s[28:31], s52 offen offset:0 sc1 lds
ds_read_b128 a[8:11], v14 offset:0
v_mfma_f32_16x16x32_bf16 v[124:127], a[24:27], a[44:47], v[124:127]
ds_read_b128 a[12:15], v14 offset:12288
v_mfma_f32_16x16x32_bf16 v[128:131], a[28:31], a[32:35], v[128:131]
ds_read_b128 a[16:19], v14 offset:256
v_mfma_f32_16x16x32_bf16 v[132:135], a[28:31], a[36:39], v[132:135]
ds_read_b128 a[20:23], v14 offset:12544
buffer_load_dwordx4 v1, s[28:31], s52 offen offset:1024 sc1 lds
v_mfma_f32_16x16x32_bf16 v[136:139], a[28:31], a[40:43], v[136:139]
ds_read_b128 a[24:27], v14 offset:512
s_waitcnt lgkmcnt(5)
v_max3_u32 v15, v16, v17, v18
v_mfma_f32_16x16x32_bf16 v[140:143], a[28:31], a[44:47], v[140:143]
s_waitcnt lgkmcnt(4)
ds_read_b128 a[28:31], v14 offset:12800
v_mfma_f32_16x16x32_bf16 v[24:27], a[8:11], a[8:11], 0
v_max_u32 v15, v15, v19
v_cmp_eq_u32 vcc, 6, v15
v_mfma_f32_16x16x32_bf16 v[144:147], a[4:7], a[32:35], v[144:147]
ds_read_b128 a[32:35], v20 offset:4096
buffer_load_dwordx4 v1, s[28:31], s52 offen offset:2048 sc1 lds
v_mfma_f32_16x16x32_bf16 v[32:35], a[8:11], a[0:3], 0
v_mfma_f32_16x16x32_bf16 v[148:151], a[4:7], a[36:39], v[148:151]
ds_read_b128 a[36:39], v20 offset:5120
v_mfma_f32_16x16x32_bf16 v[152:155], a[4:7], a[40:43], v[152:155]
ds_read_b128 a[40:43], v20 offset:6144
v_mfma_f32_16x16x32_bf16 v[156:159], a[4:7], a[44:47], v[156:159]
ds_read_b128 a[44:47], v20 offset:7168
buffer_load_dwordx4 v1, s[28:31], s52 offen offset:3072 sc1 lds
v_mfma_f32_16x16x32_bf16 v[24:27], a[8:11], v[52:55], v[24:27]
s_waitcnt lgkmcnt(4)
s_add_u32 s52, s52, 4096
ds_read_b64_tr_b16 a[4:5], v8 offset:0
ds_read_b64_tr_b16 a[6:7], v8 offset:12288
v_mfma_f32_16x16x32_bf16 v[28:31], a[12:15], a[12:15], 0
s_cbranch_vccnz RESC5b
C_R5b:
ds_read_b64_tr_b16 a[8:9], v9 offset:0
ds_read_b64_tr_b16 a[10:11], v9 offset:12288
v_mfma_f32_16x16x32_bf16 v[36:39], a[12:15], a[0:3], 0
s_add_u32 m0, s24, 4096
s_add_u32 s50, s50, 49152
buffer_load_dwordx4 v1, s[28:31], s52 offen offset:0 sc1 lds
v_mfma_f32_16x16x32_bf16 v[28:31], a[12:15], v[52:55], v[28:31]
ds_read_b64_tr_b16 a[12:13], v10 offset:0
ds_read_b64_tr_b16 a[14:15], v10 offset:12288
v_mfma_f32_16x16x32_bf16 v[24:27], a[16:19], a[16:19], v[24:27]
v_add_u32 v14, s50, v1
v_mfma_f32_16x16x32_bf16 v[32:35], a[16:19], a[0:3], v[32:35]
v_mfma_f32_16x16x32_bf16 v[24:27], a[16:19], v[56:59], v[24:27]
ds_read_b64_tr_b16 a[16:17], v11 offset:0
ds_read_b64_tr_b16 a[18:19], v11 offset:12288
buffer_load_dwordx4 v1, s[28:31], s52 offen offset:1024 sc1 lds
v_mfma_f32_16x16x32_bf16 v[28:31], a[20:23], a[20:23], v[28:31]
v_mfma_f32_16x16x32_bf16 v[36:39], a[20:23], a[0:3], v[36:39]
v_mfma_f32_16x16x32_bf16 v[28:31], a[20:23], v[56:59], v[28:31]
ds_read_b64_tr_b16 a[20:21], v12 offset:0
ds_read_b64_tr_b16 a[22:23], v12 offset:12288
v_mfma_f32_16x16x32_bf16 v[24:27], a[24:27], a[24:27], v[24:27]
v_mfma_f32_16x16x32_bf16 v[32:35], a[24:27], a[0:3], v[32:35]
v_mfma_f32_16x16x32_bf16 v[24:27], a[24:27], v[60:63], v[24:27]
ds_read_b64_tr_b16 a[24:25], v13 offset:0
ds_read_b64_tr_b16 a[26:27], v13 offset:12288
v_mfma_f32_16x16x32_bf16 v[28:31], a[28:31], a[28:31], v[28:31]
s_waitcnt lgkmcnt(4)
s_nop 2
v_cndmask_b32 v17, v32, v33, s[32:33]
v_mfma_f32_16x16x32_bf16 v[64:67], a[4:7], a[32:35], v[64:67]
v_cndmask_b32 v17, v17, v34, s[34:35]
v_cndmask_b32 v16, v24, v25, s[32:33]
v_mfma_f32_16x16x32_bf16 v[36:39], a[28:31], a[0:3], v[36:39]
v_cndmask_b32 v16, v16, v26, s[34:35]
v_cndmask_b32 v16, v16, v27, s[36:37]
v_mfma_f32_16x16x32_bf16 v[68:71], a[4:7], a[36:39], v[68:71]
v_cndmask_b32 v17, v17, v35, s[36:37]
v_mfma_f32_16x16x32_bf16 v[28:31], a[28:31], v[60:63], v[28:31]
s_nop 2
v_cndmask_b32 v19, v36, v37, s[32:33]
v_mfma_f32_16x16x32_bf16 v[72:75], a[4:7], a[40:43], v[72:75]
v_cndmask_b32 v19, v19, v38, s[34:35]
v_cndmask_b32 v19, v19, v39, s[36:37]
v_mfma_f32_16x16x32_bf16 v[76:79], a[4:7], a[44:47], v[76:79]
v_cndmask_b32 v18, v28, v29, s[32:33]
v_mfma_f32_16x16x32_bf16 v[80:83], a[8:11], a[32:35], v[80:83]
v_cndmask_b32 v18, v18, v30, s[34:35]
v_cndmask_b32 v18, v18, v31, s[36:37]
v_mfma_f32_16x16x32_bf16 v[84:87], a[8:11], a[36:39], v[84:87]
ds_write_b128 v21, v[16:19] offset:1280
v_mfma_f32_16x16x32_bf16 v[88:91], a[8:11], a[40:43], v[88:91]
v_mfma_f32_16x16x32_bf16 v[92:95], a[8:11], a[44:47], v[92:95]
v_mfma_f32_16x16x32_bf16 v[96:99], a[12:15], a[32:35], v[96:99]
v_mfma_f32_16x16x32_bf16 v[100:103], a[12:15], a[36:39], v[100:103]
v_mfma_f32_16x16x32_bf16 v[104:107], a[12:15], a[40:43], v[104:107]
v_mfma_f32_16x16x32_bf16 v[108:111], a[12:15], a[44:47], v[108:111]
v_mfma_f32_16x16x32_bf16 v[112:115], a[16:19], a[32:35], v[112:115]
s_waitcnt lgkmcnt(0)
s_barrier
v_mfma_f32_16x16x32_bf16 v[116:119], a[16:19], a[36:39], v[116:119]
v_mfma_f32_16x16x32_bf16 v[120:123], a[16:19], a[40:43], v[120:123]
ds_read_b128 v[16:19], v22 offset:0
v_mfma_f32_16x16x32_bf16 v[124:127], a[16:19], a[44:47], v[124:127]
ds_read_b64_tr_b16 a[28:29], v8 offset:24576
ds_read_b64_tr_b16 a[30:31], v8 offset:36864
v_mfma_f32_16x16x32_bf16 v[128:131], a[20:23], a[32:35], v[128:131]
ds_read_b64_tr_b16 a[4:5], v9 offset:24576
v_add_u32 v8, 0xc000, v8
v_mfma_f32_16x16x32_bf16 v[132:135], a[20:23], a[36:39], v[132:135]
ds_read_b64_tr_b16 a[6:7], v9 offset:36864
ds_read_b64_tr_b16 a[8:9], v10 offset:24576
v_mfma_f32_16x16x32_bf16 v[136:139], a[20:23], a[40:43], v[136:139]
ds_read_b64_tr_b16 a[10:11], v10 offset:36864
ds_read_b64_tr_b16 a[12:13], v11 offset:24576
s_waitcnt lgkmcnt(7)
v_max3_u32 v15, v16, v17, v18
v_mfma_f32_16x16x32_bf16 v[140:143], a[20:23], a[44:47], v[140:143]
ds_read_b64_tr_b16 a[14:15], v11 offset:36864
ds_read_b64_tr_b16 a[16:17], v12 offset:24576
v_mfma_f32_16x16x32_bf16 v[144:147], a[24:27], a[32:35], v[144:147]
ds_read_b128 a[32:35], v20 offset:0
v_max_u32 v15, v15, v19
v_mfma_f32_16x16x32_bf16 v[148:151], a[24:27], a[36:39], v[148:151]
ds_read_b128 a[36:39], v20 offset:1024
v_cmp_eq_u32 vcc, 7, v15
v_mfma_f32_16x16x32_bf16 v[152:155], a[24:27], a[40:43], v[152:155]
ds_read_b128 a[40:43], v20 offset:2048
v_mfma_f32_16x16x32_bf16 v[156:159], a[24:27], a[44:47], v[156:159]
v_add_u32 v9, 0xc000, v9
v_add_u32 v10, 0xc000, v10
v_add_u32 v11, 0xc000, v11
ds_read_b128 a[44:47], v20 offset:3072
ds_read_b64_tr_b16 a[18:19], v12 offset:36864
v_add_u32 v12, 0xc000, v12
s_cbranch_vccnz RESC6b
C_R6b:
ds_read_b64_tr_b16 a[20:21], v13 offset:24576
ds_read_b64_tr_b16 a[22:23], v13 offset:36864
s_waitcnt lgkmcnt(6)
v_mfma_f32_16x16x32_bf16 v[64:67], a[28:31], a[32:35], v[64:67]
s_waitcnt lgkmcnt(5)
v_add_u32 v13, 0xc000, v13
v_mfma_f32_16x16x32_bf16 v[68:71], a[28:31], a[36:39], v[68:71]
s_waitcnt lgkmcnt(4)
v_mfma_f32_16x16x32_bf16 v[72:75], a[28:31], a[40:43], v[72:75]
s_waitcnt lgkmcnt(3)
v_mfma_f32_16x16x32_bf16 v[76:79], a[28:31], a[44:47], v[76:79]
v_mfma_f32_16x16x32_bf16 v[80:83], a[4:7], a[32:35], v[80:83]
s_waitcnt lgkmcnt(0)
s_barrier
s_setprio 2
v_mfma_f32_16x16x32_bf16 v[84:87], a[4:7], a[36:39], v[84:87]
v_mfma_f32_16x16x32_bf16 v[88:91], a[4:7], a[40:43], v[88:91]
ds_read_b128 v[16:19], v22 offset:16
v_mfma_f32_16x16x32_bf16 v[92:95], a[4:7], a[44:47], v[92:95]
ds_read_b64_tr_b16 a[24:25], v8 offset:0
ds_read_b64_tr_b16 a[26:27], v8 offset:12288
v_mfma_f32_16x16x32_bf16 v[96:99], a[8:11], a[32:35], v[96:99]
ds_read_b128 v[40:43], v20 offset:8192
v_mfma_f32_16x16x32_bf16 v[100:103], a[8:11], a[36:39], v[100:103]
ds_read_b128 v[44:47], v20 offset:9216
v_mfma_f32_16x16x32_bf16 v[104:107], a[8:11], a[40:43], v[104:107]
ds_read_b128 v[48:51], v20 offset:10240
v_mfma_f32_16x16x32_bf16 v[108:111], a[8:11], a[44:47], v[108:111]
s_waitcnt lgkmcnt(5)
v_max3_u32 v15, v16, v17, v18
v_max_u32 v15, v15, v19
v_mfma_f32_16x16x32_bf16 v[112:115], a[12:15], a[32:35], v[112:115]
ds_read_b64_tr_b16 a[28:29], v9 offset:0
ds_read_b64_tr_b16 a[30:31], v9 offset:12288
ds_read_b128 v[52:55], v20 offset:11264
v_mfma_f32_16x16x32_bf16 v[116:119], a[12:15], a[36:39], v[116:119]
v_cmp_eq_u32 vcc, 8, v15
v_mfma_f32_16x16x32_bf16 v[120:123], a[12:15], a[40:43], v[120:123]
ds_read_b64_tr_b16 a[4:5], v10 offset:0
ds_read_b64_tr_b16 a[6:7], v10 offset:12288
ds_read_b64_tr_b16 a[8:9], v11 offset:0
v_mfma_f32_16x16x32_bf16 v[124:127], a[12:15], a[44:47], v[124:127]
ds_read_b64_tr_b16 a[10:11], v11 offset:12288
v_mfma_f32_16x16x32_bf16 v[128:131], a[16:19], a[32:35], v[128:131]
ds_read_b64_tr_b16 a[12:13], v12 offset:0
ds_read_b64_tr_b16 a[14:15], v12 offset:12288
v_mfma_f32_16x16x32_bf16 v[132:135], a[16:19], a[36:39], v[132:135]
v_mfma_f32_16x16x32_bf16 v[136:139], a[16:19], a[40:43], v[136:139]
v_mfma_f32_16x16x32_bf16 v[140:143], a[16:19], a[44:47], v[140:143]
ds_read_b64_tr_b16 a[16:17], v13 offset:0
ds_read_b64_tr_b16 a[18:19], v13 offset:12288
v_mfma_f32_16x16x32_bf16 v[144:147], a[20:23], a[32:35], v[144:147]
ds_read_b128 a[32:35], v20 offset:4096
v_mfma_f32_16x16x32_bf16 v[148:151], a[20:23], a[36:39], v[148:151]
ds_read_b128 a[36:39], v20 offset:5120
v_mfma_f32_16x16x32_bf16 v[152:155], a[20:23], a[40:43], v[152:155]
ds_read_b128 a[40:43], v20 offset:6144
v_mfma_f32_16x16x32_bf16 v[156:159], a[20:23], a[44:47], v[156:159]
ds_read_b128 a[44:47], v20 offset:7168
s_cbranch_vccnz RESC7b
C_R7b:
s_waitcnt lgkmcnt(3)
v_mfma_f32_16x16x32_bf16 v[64:67], a[24:27], a[32:35], v[64:67]
s_waitcnt lgkmcnt(2)
v_mfma_f32_16x16x32_bf16 v[68:71], a[24:27], a[36:39], v[68:71]
v_mfma_f32_16x16x32_bf16 v[64:67], a[72:75], v[40:43], v[64:67]
s_waitcnt lgkmcnt(1)
v_mfma_f32_16x16x32_bf16 v[72:75], a[24:27], a[40:43], v[72:75]
v_mfma_f32_16x16x32_bf16 v[68:71], a[72:75], v[44:47], v[68:71]
s_waitcnt lgkmcnt(0)
s_nop 3
v_cvt_pk_bf16_f32 v24, v64, v65
v_mfma_f32_16x16x32_bf16 v[76:79], a[24:27], a[44:47], v[76:79]
v_cvt_pk_bf16_f32 v25, v66, v67
v_mfma_f32_16x16x32_bf16 v[72:75], a[72:75], v[48:51], v[72:75]
v_cvt_pk_bf16_f32 v28, v68, v69
v_mfma_f32_16x16x32_bf16 v[80:83], a[28:31], a[32:35], v[80:83]
v_cvt_pk_bf16_f32 v29, v70, v71
v_mfma_f32_16x16x32_bf16 v[76:79], a[72:75], v[52:55], v[76:79]
s_nop 3
v_cvt_pk_bf16_f32 v32, v72, v73
v_mfma_f32_16x16x32_bf16 v[80:83], a[76:79], v[40:43], v[80:83]
v_cvt_pk_bf16_f32 v33, v74, v75
v_mfma_f32_16x16x32_bf16 v[84:87], a[28:31], a[36:39], v[84:87]
v_cvt_pk_bf16_f32 v36, v76, v77
v_mfma_f32_16x16x32_bf16 v[88:91], a[28:31], a[40:43], v[88:91]
v_cvt_pk_bf16_f32 v37, v78, v79
s_nop 2
v_cvt_pk_bf16_f32 v26, v80, v81
v_mfma_f32_16x16x32_bf16 v[84:87], a[76:79], v[44:47], v[84:87]
v_cvt_pk_bf16_f32 v27, v82, v83
v_mfma_f32_16x16x32_bf16 v[92:95], a[28:31], a[44:47], v[92:95]
ds_write_b128 v14, v[24:27] offset:0
v_mfma_f32_16x16x32_bf16 v[88:91], a[76:79], v[48:51], v[88:91]
s_nop 3
v_cvt_pk_bf16_f32 v30, v84, v85
v_mfma_f32_16x16x32_bf16 v[92:95], a[76:79], v[52:55], v[92:95]
v_cvt_pk_bf16_f32 v31, v86, v87
v_mfma_f32_16x16x32_bf16 v[96:99], a[4:7], a[32:35], v[96:99]
ds_write_b128 v14, v[28:31] offset:12288
v_cvt_pk_bf16_f32 v34, v88, v89
v_cvt_pk_bf16_f32 v35, v90, v91
v_mfma_f32_16x16x32_bf16 v[100:103], a[4:7], a[36:39], v[100:103]
s_nop 1
v_cvt_pk_bf16_f32 v38, v92, v93
v_cvt_pk_bf16_f32 v39, v94, v95
v_mfma_f32_16x16x32_bf16 v[96:99], a[80:83], v[40:43], v[96:99]
v_mfma_f32_16x16x32_bf16 v[104:107], a[4:7], a[40:43], v[104:107]
v_mfma_f32_16x16x32_bf16 v[100:103], a[80:83], v[44:47], v[100:103]
ds_write_b128 v14, v[32:35] offset:24576
s_nop 4
v_cvt_pk_bf16_f32 v24, v96, v97
v_mfma_f32_16x16x32_bf16 v[108:111], a[4:7], a[44:47], v[108:111]
v_cvt_pk_bf16_f32 v25, v98, v99
v_mfma_f32_16x16x32_bf16 v[104:107], a[80:83], v[48:51], v[104:107]
v_cvt_pk_bf16_f32 v28, v100, v101
v_mfma_f32_16x16x32_bf16 v[112:115], a[8:11], a[32:35], v[112:115]
v_cvt_pk_bf16_f32 v29, v102, v103
v_mfma_f32_16x16x32_bf16 v[108:111], a[80:83], v[52:55], v[108:111]
ds_write_b128 v14, v[36:39] offset:36864
s_nop 2
v_cvt_pk_bf16_f32 v32, v104, v105
v_mfma_f32_16x16x32_bf16 v[112:115], a[84:87], v[40:43], v[112:115]
v_cvt_pk_bf16_f32 v33, v106, v107
v_mfma_f32_16x16x32_bf16 v[116:119], a[8:11], a[36:39], v[116:119]
v_cvt_pk_bf16_f32 v36, v108, v109
v_mfma_f32_16x16x32_bf16 v[120:123], a[8:11], a[40:43], v[120:123]
v_cvt_pk_bf16_f32 v37, v110, v111
s_nop 2
v_cvt_pk_bf16_f32 v26, v112, v113
v_mfma_f32_16x16x32_bf16 v[116:119], a[84:87], v[44:47], v[116:119]
v_cvt_pk_bf16_f32 v27, v114, v115
v_mfma_f32_16x16x32_bf16 v[124:127], a[8:11], a[44:47], v[124:127]
v_mfma_f32_16x16x32_bf16 v[120:123], a[84:87], v[48:51], v[120:123]
s_nop 4
v_cvt_pk_bf16_f32 v30, v116, v117
v_mfma_f32_16x16x32_bf16 v[124:127], a[84:87], v[52:55], v[124:127]
v_cvt_pk_bf16_f32 v31, v118, v119
s_waitcnt vmcnt(0) lgkmcnt(0)
s_barrier
v_cvt_pk_bf16_f32 v34, v120, v121
v_cvt_pk_bf16_f32 v35, v122, v123
v_mfma_f32_16x16x32_bf16 v[128:131], a[12:15], a[32:35], v[128:131]
s_nop 1
v_cvt_pk_bf16_f32 v38, v124, v125
v_cvt_pk_bf16_f32 v39, v126, v127
v_mfma_f32_16x16x32_bf16 v[132:135], a[12:15], a[36:39], v[132:135]
ds_write_b128 v14, v[24:27] offset:1024
v_mfma_f32_16x16x32_bf16 v[128:131], a[88:91], v[40:43], v[128:131]
v_mfma_f32_16x16x32_bf16 v[136:139], a[12:15], a[40:43], v[136:139]
v_mfma_f32_16x16x32_bf16 v[132:135], a[88:91], v[44:47], v[132:135]
ds_write_b128 v14, v[28:31] offset:13312
v_mfma_f32_16x16x32_bf16 v[140:143], a[12:15], a[44:47], v[140:143]
s_nop 3
v_cvt_pk_bf16_f32 v24, v128, v129
v_cvt_pk_bf16_f32 v25, v130, v131
v_mfma_f32_16x16x32_bf16 v[136:139], a[88:91], v[48:51], v[136:139]
v_cvt_pk_bf16_f32 v28, v132, v133
v_mfma_f32_16x16x32_bf16 v[144:147], a[16:19], a[32:35], v[144:147]
v_cvt_pk_bf16_f32 v29, v134, v135
v_mfma_f32_16x16x32_bf16 v[140:143], a[88:91], v[52:55], v[140:143]
ds_write_b128 v14, v[32:35] offset:25600
v_mfma_f32_16x16x32_bf16 v[144:147], a[92:95], v[40:43], v[144:147]
s_nop 1
v_cvt_pk_bf16_f32 v32, v136, v137
v_cvt_pk_bf16_f32 v33, v138, v139
v_mfma_f32_16x16x32_bf16 v[148:151], a[16:19], a[36:39], v[148:151]
v_mfma_f32_16x16x32_bf16 v[152:155], a[16:19], a[40:43], v[152:155]
s_nop 1
v_cvt_pk_bf16_f32 v26, v144, v145
v_mfma_f32_16x16x32_bf16 v[148:151], a[92:95], v[44:47], v[148:151]
ds_write_b128 v14, v[36:39] offset:37888
v_cvt_pk_bf16_f32 v27, v146, v147
v_mfma_f32_16x16x32_bf16 v[156:159], a[16:19], a[44:47], v[156:159]
v_cvt_pk_bf16_f32 v36, v140, v141
v_cvt_pk_bf16_f32 v37, v142, v143
v_mfma_f32_16x16x32_bf16 v[152:155], a[92:95], v[48:51], v[152:155]
s_nop 1
v_cvt_pk_bf16_f32 v30, v148, v149
v_mfma_f32_16x16x32_bf16 v[156:159], a[92:95], v[52:55], v[156:159]
v_cvt_pk_bf16_f32 v31, v150, v151
s_nop 2
v_cvt_pk_bf16_f32 v34, v152, v153
v_cvt_pk_bf16_f32 v35, v154, v155
s_nop 1
v_cvt_pk_bf16_f32 v38, v156, v157
v_cvt_pk_bf16_f32 v39, v158, v159
s_waitcnt lgkmcnt(0)
s_barrier
ds_write_b128 v14, v[24:27] offset:2048
ds_write_b128 v14, v[28:31] offset:14336
ds_write_b128 v14, v[32:35] offset:26624
ds_write_b128 v14, v[36:39] offset:38912
s_waitcnt lgkmcnt(0)
s_barrier
s_branch K_fin
J_Ab:
s_waitcnt lgkmcnt(0)
s_add_u32 s38, s38, 1
s_waitcnt vmcnt(10)
s_barrier
s_add_u32 s49, s24, 49152
s_add_u32 m0, s24, 98304
v_mov_b32 v28, 0
v_mov_b32 v29, s38
s_mul_i32 s50, s3, 12288
buffer_load_dwordx4 v36, s[20:23], s49 offen offset:0 lds
buffer_load_dwordx4 v37, s[20:23], s49 offen offset:1024 lds
buffer_load_dwordx4 v38, s[20:23], s49 offen offset:2048 lds
buffer_load_dwordx4 v39, s[20:23], s49 offen offset:3072 lds
s_add_u32 m0, s24, 102400
s_nop 0
buffer_load_dwordx4 v40, s[20:23], s49 offen offset:0 lds
buffer_load_dwordx4 v41, s[20:23], s49 offen offset:1024 lds
s_add_u32 s49, s24, 73728
s_add_u32 m0, s24, 122880
s_nop 0
buffer_load_dwordx4 v36, s[20:23], s49 offen offset:0 lds
buffer_load_dwordx4 v37, s[20:23], s49 offen offset:1024 lds
buffer_load_dwordx4 v38, s[20:23], s49 offen offset:2048 lds
buffer_load_dwordx4 v39, s[20:23], s49 offen offset:3072 lds
s_add_u32 m0, s24, 126976
s_nop 0
buffer_load_dwordx4 v40, s[20:23], s49 offen offset:0 lds
buffer_load_dwordx4 v41, s[20:23], s49 offen offset:1024 lds
s_waitcnt vmcnt(12)
s_barrier
s_mov_b64 exec, 1
s_add_u32 s49, s24, 98304
s_add_u32 m0, s24, 49152
buffer_store_dword v29, v28, s[28:31], s97 offen sc0 sc1
s_mov_b64 exec, -1
buffer_load_dwordx4 v36, s[20:23], s49 offen offset:0 lds
buffer_load_dwordx4 v37, s[20:23], s49 offen offset:1024 lds
buffer_load_dwordx4 v38, s[20:23], s49 offen offset:2048 lds
buffer_load_dwordx4 v39, s[20:23], s49 offen offset:3072 lds
s_add_u32 m0, s24, 53248
s_nop 0
buffer_load_dwordx4 v40, s[20:23], s49 offen offset:0 lds
buffer_load_dwordx4 v41, s[20:23], s49 offen offset:1024 lds
s_waitcnt vmcnt(13)
s_barrier
s_add_u32 s49, s24, 122880
s_add_u32 m0, s24, 73728
s_nop 0
buffer_load_dwordx4 v36, s[20:23], s49 offen offset:0 lds
buffer_load_dwordx4 v37, s[20:23], s49 offen offset:1024 lds
buffer_load_dwordx4 v38, s[20:23], s49 offen offset:2048 lds
buffer_load_dwordx4 v39, s[20:23], s49 offen offset:3072 lds
s_add_u32 m0, s24, 77824
s_nop 0
buffer_load_dwordx4 v40, s[20:23], s49 offen offset:0 lds
buffer_load_dwordx4 v41, s[20:23], s49 offen offset:1024 lds
s_waitcnt vmcnt(13)
s_barrier
s_add_u32 s49, s24, 147456
s_add_u32 m0, s24, 98304
s_nop 0
buffer_load_dwordx4 v36, s[20:23], s49 offen offset:0 lds
buffer_load_dwordx4 v37, s[20:23], s49 offen offset:1024 lds
buffer_load_dwordx4 v38, s[20:23], s49 offen offset:2048 lds
buffer_load_dwordx4 v39, s[20:23], s49 offen offset:3072 lds
s_add_u32 m0, s24, 102400
s_nop 0
buffer_load_dwordx4 v40, s[20:23], s49 offen offset:0 lds
buffer_load_dwordx4 v41, s[20:23], s49 offen offset:1024 lds
s_add_u32 s49, s25, 512
s_add_u32 m0, s45, 32768
s_nop 0
buffer_load_dwordx4 v32, s[16:19], s49 offen offset:0 nt lds
buffer_load_dwordx4 v33, s[16:19], s49 offen offset:1024 nt lds
buffer_load_dwordx4 v34, s[16:19], s49 offen offset:2048 nt lds
buffer_load_dwordx4 v35, s[16:19], s49 offen offset:3072 nt lds
s_waitcnt vmcnt(16)
s_barrier
s_add_u32 s49, s24, 172032
s_add_u32 m0, s24, 122880
s_nop 0
buffer_load_dwordx4 v36, s[20:23], s49 offen offset:0 lds
buffer_load_dwordx4 v37, s[20:23], s49 offen offset:1024 lds
buffer_load_dwordx4 v38, s[20:23], s49 offen offset:2048 lds
buffer_load_dwordx4 v39, s[20:23], s49 offen offset:3072 lds
s_add_u32 m0, s24, 126976
s_nop 0
buffer_load_dwordx4 v40, s[20:23], s49 offen offset:0 lds
buffer_load_dwordx4 v41, s[20:23], s49 offen offset:1024 lds
s_waitcnt vmcnt(16)
s_barrier
s_add_u32 s49, s24, 196608
s_add_u32 m0, s24, 49152
s_nop 0
buffer_load_dwordx4 v36, s[20:23], s49 offen offset:0 lds
buffer_load_dwordx4 v37, s[20:23], s49 offen offset:1024 lds
buffer_load_dwordx4 v38, s[20:23], s49 offen offset:2048 lds
buffer_load_dwordx4 v39, s[20:23], s49 offen offset:3072 lds
s_add_u32 m0, s24, 53248
s_nop 0
buffer_load_dwordx4 v40, s[20:23], s49 offen offset:0 lds
buffer_load_dwordx4 v41, s[20:23], s49 offen offset:1024 lds
s_waitcnt vmcnt(16)
s_barrier
s_add_u32 s49, s24, 221184
s_add_u32 m0, s24, 73728
s_nop 0
buffer_load_dwordx4 v36, s[20:23], s49 offen offset:0 lds
buffer_load_dwordx4 v37, s[20:23], s49 offen offset:1024 lds
buffer_load_dwordx4 v38, s[20:23], s49 offen offset:2048 lds
buffer_load_dwordx4 v39, s[20:23], s49 offen offset:3072 lds
s_add_u32 m0, s24, 77824
s_nop 0
buffer_load_dwordx4 v40, s[20:23], s49 offen offset:0 lds
buffer_load_dwordx4 v41, s[20:23], s49 offen offset:1024 lds
s_waitcnt vmcnt(12)
s_barrier
s_add_u32 s49, s24, 245760
s_add_u32 m0, s24, 98304
s_nop 0
buffer_load_dwordx4 v36, s[20:23], s49 offen offset:0 lds
buffer_load_dwordx4 v37, s[20:23], s49 offen offset:1024 lds
buffer_load_dwordx4 v38, s[20:23], s49 offen offset:2048 lds
buffer_load_dwordx4 v39, s[20:23], s49 offen offset:3072 lds
s_add_u32 m0, s24, 102400
s_nop 0
buffer_load_dwordx4 v40, s[20:23], s49 offen offset:0 lds
buffer_load_dwordx4 v41, s[20:23], s49 offen offset:1024 lds
s_waitcnt vmcnt(12)
s_barrier
s_add_u32 s49, s24, 270336
s_add_u32 m0, s24, 122880
s_nop 0
buffer_load_dwordx4 v36, s[20:23], s49 offen offset:0 lds
buffer_load_dwordx4 v37, s[20:23], s49 offen offset:1024 lds
buffer_load_dwordx4 v38, s[20:23], s49 offen offset:2048 lds
buffer_load_dwordx4 v39, s[20:23], s49 offen offset:3072 lds
s_add_u32 m0, s24, 126976
s_nop 0
buffer_load_dwordx4 v40, s[20:23], s49 offen offset:0 lds
buffer_load_dwordx4 v41, s[20:23], s49 offen offset:1024 lds
s_add_u32 s49, s26, 0
s_add_u32 m0, s24, 49152
buffer_load_dword v19, v14, s[28:31], 0 offen sc1
s_waitcnt vmcnt(13)
s_barrier
buffer_load_dwordx4 v2, s[12:15], s49 offen offset:0 nt lds
buffer_load_dwordx4 v3, s[12:15], s49 offen offset:1024 nt lds
buffer_load_dwordx4 v4, s[12:15], s49 offen offset:2048 nt lds
buffer_load_dwordx4 v5, s[12:15], s49 offen offset:3072 nt lds
s_add_u32 m0, s24, 53248
s_nop 0
buffer_load_dwordx4 v6, s[12:15], s49 offen offset:0 nt lds
buffer_load_dwordx4 v7, s[12:15], s49 offen offset:1024 nt lds
s_waitcnt vmcnt(13)
s_barrier
s_waitcnt vmcnt(6)
v_cmp_ne_u32 vcc, s38, v19
s_nop 0
s_cbranch_vccnz POLLb
C_POLLb:
s_xor_b32 s51, s3, 0
s_lshl_b32 s51, s51, 10
s_add_u32 s51, s51, s50
buffer_load_dwordx4 a[0:3], v1, s[28:31], s51 offen sc1
s_add_u32 s51, s51, 4096
v_and_b32 v19, 4, v0
v_lshlrev_b32 v19, 1, v19
v_sub_u32 v19, v12, v19
v_add_u32 v19, 10752, v19
buffer_load_dwordx4 a[4:7], v1, s[28:31], s51 offen sc1
s_add_u32 s51, s51, 4096
buffer_load_dwordx4 a[8:11], v1, s[28:31], s51 offen sc1
s_xor_b32 s51, s3, 1
s_lshl_b32 s51, s51, 10
s_add_u32 s51, s51, s50
s_mul_i32 s50, s3, 12288
buffer_load_dwordx4 a[12:15], v1, s[28:31], s51 offen sc1
s_add_u32 s51, s51, 4096
buffer_load_dwordx4 a[16:19], v1, s[28:31], s51 offen sc1
s_add_u32 s51, s51, 4096
buffer_load_dwordx4 a[20:23], v1, s[28:31], s51 offen sc1
s_barrier
s_barrier
s_xor_b32 s51, s3, 2
s_lshl_b32 s51, s51, 10
s_add_u32 s51, s51, s50
buffer_load_dwordx4 a[24:27], v1, s[28:31], s51 offen sc1
s_add_u32 s51, s51, 4096
buffer_load_dwordx4 a[28:31], v1, s[28:31], s51 offen sc1
s_add_u32 s51, s51, 4096
buffer_load_dwordx4 a[32:35], v1, s[28:31], s51 offen sc1
s_xor_b32 s51, s3, 3
s_lshl_b32 s51, s51, 10
s_add_u32 s51, s51, s50
s_mov_b32 s50, 0x3f803f80
v_mov_b32 v60, s50
v_mov_b32 v61, s50
v_mov_b32 v62, s50
v_mov_b32 v63, s50
s_mul_i32 s50, s3, 12288
buffer_load_dwordx4 a[36:39], v1, s[28:31], s51 offen sc1
s_add_u32 s51, s51, 4096
buffer_load_dwordx4 a[40:43], v1, s[28:31], s51 offen sc1
s_add_u32 s51, s51, 4096
s_add_u32 s49, s26, 196608
s_add_u32 m0, s24, 73728
s_waitcnt vmcnt(10)
v_mfma_f32_16x16x32_bf16 v[64:67], v[60:63], a[0:3], 0
buffer_load_dwordx4 a[44:47], v1, s[28:31], s51 offen sc1
s_waitcnt vmcnt(10)
v_mfma_f32_16x16x32_bf16 v[64:67], v[60:63], a[4:7], v[64:67]
buffer_load_dwordx4 v2, s[12:15], s49 offen offset:0 nt lds
s_waitcnt vmcnt(10)
v_mfma_f32_16x16x32_bf16 v[64:67], v[60:63], a[8:11], v[64:67]
buffer_load_dwordx4 v3, s[12:15], s49 offen offset:1024 nt lds
s_waitcnt vmcnt(10)
v_mfma_f32_16x16x32_bf16 v[64:67], v[60:63], a[12:15], v[64:67]
buffer_load_dwordx4 v4, s[12:15], s49 offen offset:2048 nt lds
s_waitcnt vmcnt(10)
v_mfma_f32_16x16x32_bf16 v[64:67], v[60:63], a[16:19], v[64:67]
buffer_load_dwordx4 v5, s[12:15], s49 offen offset:3072 nt lds
s_add_u32 m0, s24, 77824
s_waitcnt vmcnt(10)
v_mfma_f32_16x16x32_bf16 v[64:67], v[60:63], a[20:23], v[64:67]
buffer_load_dwordx4 v6, s[12:15], s49 offen offset:0 nt lds
s_waitcnt vmcnt(10)
v_mfma_f32_16x16x32_bf16 v[64:67], v[60:63], a[24:27], v[64:67]
buffer_load_dwordx4 v7, s[12:15], s49 offen offset:1024 nt lds
s_barrier
s_add_u32 s49, s26, 24576
s_add_u32 m0, s24, 98304
ds_read_b128 a[48:51], v8 offset:0
ds_read_b128 a[52:55], v8 offset:256
s_waitcnt vmcnt(10)
v_mfma_f32_16x16x32_bf16 v[64:67], v[60:63], a[28:31], v[64:67]
buffer_load_dwordx4 v2, s[12:15], s49 offen offset:0 nt lds
ds_read_b128 a[56:59], v8 offset:512
ds_read_b128 a[60:63], v9 offset:0
ds_read_b128 a[64:67], v9 offset:256
s_waitcnt lgkmcnt(4)
v_mfma_f32_16x16x32_bf16 v[52:55], a[48:51], a[0:3], 0
s_waitcnt lgkmcnt(3)
ds_read_b128 a[48:51], v9 offset:512
buffer_load_dwordx4 v3, s[12:15], s49 offen offset:1024 nt lds
v_mfma_f32_16x16x32_bf16 v[52:55], a[52:55], a[4:7], v[52:55]
ds_read_b128 a[52:55], v10 offset:0
s_waitcnt vmcnt(11)
v_mfma_f32_16x16x32_bf16 v[64:67], v[60:63], a[32:35], v[64:67]
s_waitcnt lgkmcnt(2)
v_mfma_f32_16x16x32_bf16 v[52:55], a[56:59], a[8:11], v[52:55]
ds_read_b128 a[56:59], v10 offset:256
v_mfma_f32_16x16x32_bf16 v[52:55], a[60:63], a[12:15], v[52:55]
ds_read_b128 a[60:63], v10 offset:512
buffer_load_dwordx4 v4, s[12:15], s49 offen offset:2048 nt lds
v_mfma_f32_16x16x32_bf16 v[52:55], a[64:67], a[16:19], v[52:55]
s_waitcnt lgkmcnt(3)
ds_read_b128 a[64:67], v11 offset:0
v_mfma_f32_16x16x32_bf16 v[52:55], a[48:51], a[20:23], v[52:55]
s_waitcnt lgkmcnt(3)
ds_read_b128 a[48:51], v11 offset:256
v_mfma_f32_16x16x32_bf16 v[52:55], a[52:55], a[24:27], v[52:55]
ds_read_b128 a[52:55], v11 offset:512
s_waitcnt lgkmcnt(4)
v_mfma_f32_16x16x32_bf16 v[52:55], a[56:59], a[28:31], v[52:55]
s_waitcnt lgkmcnt(3)
ds_read_b128 a[56:59], v8 offset:12288
buffer_load_dwordx4 v5, s[12:15], s49 offen offset:3072 nt lds
v_mfma_f32_16x16x32_bf16 v[52:55], a[60:63], a[32:35], v[52:55]
s_add_u32 m0, s24, 102400
ds_read_b128 a[60:63], v8 offset:12544
s_waitcnt vmcnt(12)
v_mfma_f32_16x16x32_bf16 v[64:67], v[60:63], a[36:39], v[64:67]
s_waitcnt lgkmcnt(3)
v_mfma_f32_16x16x32_bf16 v[52:55], a[64:67], a[36:39], v[52:55]
ds_read_b128 a[64:67], v8 offset:12800
v_add_u32 v8, 0xc000, v8
s_waitcnt vmcnt(11)
v_mfma_f32_16x16x32_bf16 v[52:55], a[48:51], a[40:43], v[52:55]
ds_read_b128 a[48:51], v9 offset:12288
buffer_load_dwordx4 v6, s[12:15], s49 offen offset:0 nt lds
s_waitcnt vmcnt(11) lgkmcnt(4)
v_mfma_f32_16x16x32_bf16 v[52:55], a[52:55], a[44:47], v[52:55]
s_waitcnt lgkmcnt(3)
ds_read_b128 a[52:55], v9 offset:12544
v_mfma_f32_16x16x32_bf16 v[56:59], a[56:59], a[0:3], 0
s_waitcnt lgkmcnt(3)
ds_read_b128 a[56:59], v9 offset:12800
v_add_u32 v9, 0xc000, v9
v_mfma_f32_16x16x32_bf16 v[56:59], a[60:63], a[4:7], v[56:59]
s_waitcnt lgkmcnt(3)
ds_read_b128 a[60:63], v10 offset:12288
v_mfma_f32_16x16x32_bf16 v[56:59], a[64:67], a[8:11], v[56:59]
ds_read_b128 a[64:67], v10 offset:12544
buffer_load_dwordx4 v7, s[12:15], s49 offen offset:1024 nt lds
s_waitcnt lgkmcnt(4)
v_mfma_f32_16x16x32_bf16 v[56:59], a[48:51], a[12:15], v[56:59]
s_waitcnt lgkmcnt(3)
ds_read_b128 a[48:51], v10 offset:12800
v_add_u32 v10, 0xc000, v10
v_mfma_f32_16x16x32_bf16 v[56:59], a[52:55], a[16:19], v[56:59]
ds_read_b128 a[52:55], v11 offset:12288
v_mfma_f32_16x16x32_bf16 v[64:67], v[60:63], a[40:43], v[64:67]
s_waitcnt lgkmcnt(4)
v_mfma_f32_16x16x32_bf16 v[56:59], a[56:59], a[20:23], v[56:59]
s_waitcnt lgkmcnt(3)
ds_read_b128 a[56:59], v11 offset:12544
v_mfma_f32_16x16x32_bf16 v[56:59], a[60:63], a[24:27], v[56:59]
s_waitcnt lgkmcnt(3)
ds_read_b128 a[60:63], v11 offset:12800
v_add_u32 v11, 0xc000, v11
v_mfma_f32_16x16x32_bf16 v[56:59], a[64:67], a[28:31], v[56:59]
s_waitcnt lgkmcnt(3)
ds_read_b128 a[64:67], v8 offset:0
v_mfma_f32_16x16x32_bf16 v[56:59], a[48:51], a[32:35], v[56:59]
s_waitcnt lgkmcnt(3)
ds_read_b128 a[48:51], v8 offset:12288
v_mfma_f32_16x16x32_bf16 v[56:59], a[52:55], a[36:39], v[56:59]
ds_read_b128 a[52:55], v8 offset:256
s_waitcnt lgkmcnt(4)
v_mfma_f32_16x16x32_bf16 v[56:59], a[56:59], a[40:43], v[56:59]
ds_read_b128 a[56:59], v8 offset:12544
v_mfma_f32_16x16x32_bf16 v[64:67], v[60:63], a[44:47], v[64:67]
s_waitcnt lgkmcnt(4)
v_mfma_f32_16x16x32_bf16 v[56:59], a[60:63], a[44:47], v[56:59]
s_waitcnt lgkmcnt(3)
ds_read_b128 a[60:63], v8 offset:512
v_mfma_f32_16x16x32_bf16 v[36:39], a[64:67], a[0:3], v[52:55]
s_waitcnt lgkmcnt(3)
ds_read_b128 a[64:67], v8 offset:12800
s_nop 0
v_sub_f32 v17, 0, v64
v_mfma_f32_16x16x32_bf16 v[40:43], a[48:51], a[0:3], v[52:55]
s_waitcnt lgkmcnt(3)
ds_read_b128 a[48:51], v9 offset:0
v_mfma_f32_16x16x32_bf16 v[36:39], a[52:55], a[4:7], v[36:39]
s_waitcnt lgkmcnt(3)
ds_read_b128 a[52:55], v9 offset:12288
v_mfma_f32_16x16x32_bf16 v[40:43], a[56:59], a[4:7], v[40:43]
ds_read_b128 a[56:59], v9 offset:256
s_waitcnt lgkmcnt(4)
v_mfma_f32_16x16x32_bf16 v[36:39], a[60:63], a[8:11], v[36:39]
s_waitcnt lgkmcnt(3)
ds_read_b128 a[60:63], v9 offset:12544
v_mfma_f32_16x16x32_bf16 v[40:43], a[64:67], a[8:11], v[40:43]
s_waitcnt lgkmcnt(3)
ds_read_b128 a[64:67], v9 offset:512
v_mfma_f32_16x16x32_bf16 v[36:39], a[48:51], a[12:15], v[36:39]
s_waitcnt lgkmcnt(3)
ds_read_b128 a[48:51], v9 offset:12800
v_mfma_f32_16x16x32_bf16 v[40:43], a[52:55], a[12:15], v[40:43]
s_waitcnt lgkmcnt(3)
ds_read_b128 a[52:55], v10 offset:0
v_mfma_f32_16x16x32_bf16 v[36:39], a[56:59], a[16:19], v[36:39]
ds_read_b128 a[56:59], v10 offset:12288
s_waitcnt lgkmcnt(4)
v_mfma_f32_16x16x32_bf16 v[40:43], a[60:63], a[16:19], v[40:43]
s_waitcnt lgkmcnt(3)
ds_read_b128 a[60:63], v10 offset:256
v_mfma_f32_16x16x32_bf16 v[36:39], a[64:67], a[20:23], v[36:39]
s_waitcnt lgkmcnt(3)
ds_read_b128 a[64:67], v10 offset:12544
v_mfma_f32_16x16x32_bf16 v[40:43], a[48:51], a[20:23], v[40:43]
s_waitcnt lgkmcnt(3)
ds_read_b128 a[48:51], v10 offset:512
v_mfma_f32_16x16x32_bf16 v[36:39], a[52:55], a[24:27], v[36:39]
s_waitcnt lgkmcnt(3)
ds_read_b128 a[52:55], v10 offset:12800
v_mfma_f32_16x16x32_bf16 v[40:43], a[56:59], a[24:27], v[40:43]
ds_read_b128 a[56:59], v11 offset:0
s_waitcnt lgkmcnt(4)
v_mfma_f32_16x16x32_bf16 v[36:39], a[60:63], a[28:31], v[36:39]
s_waitcnt lgkmcnt(3)
ds_read_b128 a[60:63], v11 offset:12288
v_mfma_f32_16x16x32_bf16 v[40:43], a[64:67], a[28:31], v[40:43]
s_waitcnt lgkmcnt(3)
ds_read_b128 a[64:67], v11 offset:256
v_mfma_f32_16x16x32_bf16 v[36:39], a[48:51], a[32:35], v[36:39]
s_waitcnt lgkmcnt(3)
ds_read_b128 a[48:51], v11 offset:12544
v_mfma_f32_16x16x32_bf16 v[40:43], a[52:55], a[32:35], v[40:43]
s_waitcnt lgkmcnt(3)
ds_read_b128 a[52:55], v11 offset:512
v_mfma_f32_16x16x32_bf16 v[36:39], a[56:59], a[36:39], v[36:39]
ds_read_b128 a[56:59], v11 offset:12800
s_waitcnt lgkmcnt(4)
v_mfma_f32_16x16x32_bf16 v[40:43], a[60:63], a[36:39], v[40:43]
s_waitcnt lgkmcnt(3)
v_mfma_f32_16x16x32_bf16 v[36:39], a[64:67], a[40:43], v[36:39]
s_waitcnt lgkmcnt(2)
v_mfma_f32_16x16x32_bf16 v[40:43], a[48:51], a[40:43], v[40:43]
s_waitcnt vmcnt(6) lgkmcnt(0)
s_barrier
ds_read_b128 a[60:63], v8 offset:24576
v_mfma_f32_16x16x32_bf16 v[36:39], a[52:55], a[44:47], v[36:39]
ds_read2_b64 v[76:79], v19 offset0:0 offset1:2
v_mfma_f32_16x16x32_bf16 v[40:43], a[56:59], a[44:47], v[40:43]
ds_read2_b64 v[80:83], v19 offset0:4 offset1:6
s_waitcnt lgkmcnt(2)
v_mfma_f32_16x16x32_bf16 v[44:47], a[60:63], a[0:3], v[52:55]
s_waitcnt lgkmcnt(1)
ds_read_b128 a[64:67], v8 offset:36864
ds_read2_b64 v[28:31], v12 offset0:0 offset1:2
v_add_f32 v76, v76, v78
v_add_f32 v77, v77, v79
ds_read_b128 a[48:51], v8 offset:24832
s_waitcnt lgkmcnt(3)
v_add_f32 v80, v80, v82
v_add_f32 v81, v81, v83
v_add_f32 v20, v76, v80
v_add_f32 v21, v77, v81
s_waitcnt lgkmcnt(2)
v_mfma_f32_16x16x32_bf16 v[48:51], a[64:67], a[0:3], v[52:55]
s_waitcnt lgkmcnt(1)
ds_read2_b64 v[32:35], v12 offset0:4 offset1:6
ds_read_b128 a[52:55], v8 offset:37120
v_add_f32 v28, v28, v30
v_add_f32 v29, v29, v31
v_add_f32 v28, v28, v20
v_add_f32 v29, v29, v21
s_waitcnt lgkmcnt(2)
v_mfma_f32_16x16x32_bf16 v[44:47], a[48:51], a[4:7], v[44:47]
ds_read_b128 a[56:59], v8 offset:25088
ds_read_b128 a[60:63], v8 offset:37376
v_add_u32 v8, 0xffff4000, v8
ds_read_b128 a[64:67], v9 offset:24576
s_waitcnt lgkmcnt(4)
v_add_f32 v32, v32, v34
v_add_f32 v33, v33, v35
v_add_f32 v28, v28, v32
v_add_f32 v29, v29, v33
s_waitcnt lgkmcnt(3)
v_mfma_f32_16x16x32_bf16 v[48:51], a[52:55], a[4:7], v[48:51]
s_waitcnt lgkmcnt(2)
ds_read_b128 a[48:51], v9 offset:36864
v_mul_f32 v29, s53, v29
v_mul_f32 v28, s53, v28
v_fma_f32 v28, -v29, v29, v28
v_max_f32 v28, 0, v28
v_mfma_f32_16x16x32_bf16 v[44:47], a[56:59], a[8:11], v[44:47]
ds_read_b128 a[52:55], v9 offset:24832
v_add_f32 v28, s54, v28
v_rsq_f32 v28, v28
v_fmac_f32_dpp v36, v29, v17 row_newbcast:0 row_mask:0xf bank_mask:0xf
v_fmac_f32_dpp v37, v29, v17 row_newbcast:1 row_mask:0xf bank_mask:0xf
v_fmac_f32_dpp v38, v29, v17 row_newbcast:2 row_mask:0xf bank_mask:0xf
s_waitcnt lgkmcnt(2)
v_mfma_f32_16x16x32_bf16 v[48:51], a[60:63], a[8:11], v[48:51]
ds_read_b128 a[56:59], v9 offset:37120
v_fmac_f32_dpp v39, v29, v17 row_newbcast:3 row_mask:0xf bank_mask:0xf
v_fmac_f32_dpp v40, v29, v17 row_newbcast:4 row_mask:0xf bank_mask:0xf
v_fmac_f32_dpp v41, v29, v17 row_newbcast:5 row_mask:0xf bank_mask:0xf
v_fmac_f32_dpp v42, v29, v17 row_newbcast:6 row_mask:0xf bank_mask:0xf
v_fmac_f32_dpp v43, v29, v17 row_newbcast:7 row_mask:0xf bank_mask:0xf
v_mfma_f32_16x16x32_bf16 v[44:47], a[64:67], a[12:15], v[44:47]
ds_read_b128 a[60:63], v9 offset:25088
v_mov_b32_dpp v84, v28 row_newbcast:0 row_mask:0xf bank_mask:0xf
v_mov_b32_dpp v85, v28 row_newbcast:1 row_mask:0xf bank_mask:0xf
v_mov_b32_dpp v86, v28 row_newbcast:2 row_mask:0xf bank_mask:0xf
v_mov_b32_dpp v87, v28 row_newbcast:3 row_mask:0xf bank_mask:0xf
v_mov_b32_dpp v88, v28 row_newbcast:4 row_mask:0xf bank_mask:0xf
s_waitcnt lgkmcnt(3)
v_mfma_f32_16x16x32_bf16 v[48:51], a[48:51], a[12:15], v[48:51]
ds_read_b128 a[64:67], v9 offset:37376
v_mov_b32_dpp v89, v28 row_newbcast:5 row_mask:0xf bank_mask:0xf
v_mov_b32_dpp v90, v28 row_newbcast:6 row_mask:0xf bank_mask:0xf
v_mov_b32_dpp v91, v28 row_newbcast:7 row_mask:0xf bank_mask:0xf
v_mul_f32 v36, v36, v84
v_mul_f32 v37, v37, v85
s_waitcnt lgkmcnt(3)
v_mfma_f32_16x16x32_bf16 v[44:47], a[52:55], a[16:19], v[44:47]
s_waitcnt lgkmcnt(2)
ds_read_b128 a[48:51], v10 offset:24576
v_mul_f32 v38, v38, v86
v_mul_f32 v39, v39, v87
v_mul_f32 v40, v40, v88
v_mul_f32 v41, v41, v89
v_mul_f32 v42, v42, v90
v_mfma_f32_16x16x32_bf16 v[48:51], a[56:59], a[16:19], v[48:51]
s_waitcnt lgkmcnt(2)
ds_read_b128 a[52:55], v10 offset:36864
v_mul_f32 v43, v43, v91
v_max3_f32 v30, v36, v37, v38
v_max3_f32 v31, v39, v40, v41
v_max3_f32 v30, v30, v42, v43
v_max_f32 v30, v30, v31
v_mfma_f32_16x16x32_bf16 v[44:47], a[60:63], a[20:23], v[44:47]
s_waitcnt lgkmcnt(2)
ds_read_b128 a[56:59], v10 offset:24832
v_mov_b32 v31, v30
v_mfma_f32_16x16x32_bf16 v[48:51], a[64:67], a[20:23], v[48:51]
ds_read_b128 a[60:63], v10 offset:37120
v_permlane32_swap_b32 v30, v31
v_max_f32 v30, v30, v31
v_mov_b32 v31, v30
s_waitcnt lgkmcnt(3)
v_mfma_f32_16x16x32_bf16 v[44:47], a[48:51], a[24:27], v[44:47]
ds_read_b128 a[64:67], v10 offset:25088
v_permlane16_swap_b32 v30, v31
v_max_f32 v30, v30, v31
v_sub_f32 v36, v36, v30
v_sub_f32 v37, v37, v30
v_sub_f32 v38, v38, v30
v_sub_f32 v39, v39, v30
v_sub_f32 v40, v40, v30
v_sub_f32 v41, v41, v30
v_sub_f32 v42, v42, v30
v_sub_f32 v43, v43, v30
v_sub_f32 v15, 0, v30
s_waitcnt lgkmcnt(2)
v_mfma_f32_16x16x32_bf16 v[48:51], a[52:55], a[24:27], v[48:51]
ds_read_b128 a[48:51], v10 offset:37376
v_exp_f32 v76, v36
v_exp_f32 v77, v37
v_exp_f32 v78, v38
v_exp_f32 v79, v39
v_mfma_f32_16x16x32_bf16 v[44:47], a[56:59], a[28:31], v[44:47]
s_waitcnt lgkmcnt(1)
ds_read_b128 a[52:55], v11 offset:24576
v_exp_f32 v80, v40
v_exp_f32 v81, v41
v_exp_f32 v82, v42
v_exp_f32 v83, v43
v_add_f32 v32, v76, v77
v_mfma_f32_16x16x32_bf16 v[48:51], a[60:63], a[28:31], v[48:51]
ds_read_b128 a[56:59], v11 offset:36864
v_add_f32 v33, v78, v79
v_add_f32 v34, v80, v81
v_add_f32 v35, v82, v83
v_add_f32 v32, v32, v33
v_add_f32 v34, v34, v35
v_mfma_f32_16x16x32_bf16 v[44:47], a[64:67], a[32:35], v[44:47]
s_waitcnt lgkmcnt(2)
ds_read_b128 a[60:63], v11 offset:24832
v_add_f32 v32, v32, v34
v_add_f32 v16, v16, v32
v_mul_f32 v84, v76, v84
v_mul_f32 v85, v77, v85
v_mul_f32 v86, v78, v86
v_mfma_f32_16x16x32_bf16 v[48:51], a[48:51], a[32:35], v[48:51]
s_waitcnt lgkmcnt(2)
ds_read_b128 a[64:67], v11 offset:37120
v_mul_f32 v87, v79, v87
v_mul_f32 v88, v80, v88
v_mul_f32 v89, v81, v89
v_mul_f32 v90, v82, v90
v_mul_f32 v91, v83, v91
v_mfma_f32_16x16x32_bf16 v[44:47], a[52:55], a[36:39], v[44:47]
s_waitcnt lgkmcnt(2)
ds_read_b128 a[48:51], v11 offset:25088
v_cvt_pk_bf16_f32 v60, v84, v85
v_cvt_pk_bf16_f32 v61, v86, v87
v_cvt_pk_bf16_f32 v62, v88, v89
v_cvt_pk_bf16_f32 v63, v90, v91
v_mfma_f32_16x16x32_bf16 v[48:51], a[56:59], a[36:39], v[48:51]
s_waitcnt lgkmcnt(2)
ds_write_b128 v13, v[60:63] offset:0
v_add_f32 v68, v84, v88
v_add_f32 v69, v85, v89
v_add_f32 v70, v86, v90
v_add_f32 v71, v87, v91
v_mfma_f32_16x16x32_bf16 v[44:47], a[60:63], a[40:43], v[44:47]
s_waitcnt lgkmcnt(2)
v_add_u32 v9, 0xffff4000, v9
v_add_u32 v10, 0xffff4000, v10
v_mfma_f32_16x16x32_bf16 v[48:51], a[64:67], a[40:43], v[48:51]
ds_read_b128 a[52:55], v11 offset:37376
v_add_u32 v11, 0xffff4000, v11
s_waitcnt vmcnt(0) lgkmcnt(0)
s_barrier
ds_read2_b64 v[28:31], v12 offset0:160 offset1:162
v_mfma_f32_16x16x32_bf16 v[44:47], a[48:51], a[44:47], v[44:47]
v_mfma_f32_16x16x32_bf16 v[48:51], a[52:55], a[44:47], v[48:51]
ds_read2_b64 v[32:35], v12 offset0:164 offset1:166
ds_read_b128 a[56:59], v8 offset:24576
ds_read_b128 a[60:63], v8 offset:24832
s_waitcnt lgkmcnt(3)
v_add_f32 v28, v28, v30
v_add_f32 v29, v29, v31
v_add_f32 v28, v28, v20
v_add_f32 v29, v29, v21
ds_read_b128 a[64:67], v8 offset:25088
v_add_u32 v8, 0x18000, v8
s_waitcnt lgkmcnt(3)
v_add_f32 v32, v32, v34
v_add_f32 v33, v33, v35
v_add_f32 v28, v28, v32
v_add_f32 v29, v29, v33
s_waitcnt lgkmcnt(1)
v_mfma_f32_16x16x32_bf16 v[52:55], a[56:59], a[0:3], 0
ds_read_b128 a[48:51], v9 offset:24576
v_mul_f32 v29, s53, v29
v_mul_f32 v28, s53, v28
v_fma_f32 v28, -v29, v29, v28
v_mfma_f32_16x16x32_bf16 v[52:55], a[60:63], a[4:7], v[52:55]
ds_read_b128 a[52:55], v9 offset:24832
v_max_f32 v28, 0, v28
v_add_f32 v28, s54, v28
s_waitcnt lgkmcnt(2)
v_mfma_f32_16x16x32_bf16 v[52:55], a[64:67], a[8:11], v[52:55]
ds_read_b128 a[56:59], v9 offset:25088
v_rsq_f32 v28, v28
v_fmac_f32_dpp v44, v29, v17 row_newbcast:0 row_mask:0xf bank_mask:0xf
v_fmac_f32_dpp v45, v29, v17 row_newbcast:1 row_mask:0xf bank_mask:0xf
v_fmac_f32_dpp v46, v29, v17 row_newbcast:2 row_mask:0xf bank_mask:0xf
v_fmac_f32_dpp v47, v29, v17 row_newbcast:3 row_mask:0xf bank_mask:0xf
s_waitcnt lgkmcnt(2)
v_mfma_f32_16x16x32_bf16 v[52:55], a[48:51], a[12:15], v[52:55]
ds_read_b128 a[60:63], v10 offset:24576
v_fmac_f32_dpp v48, v29, v17 row_newbcast:4 row_mask:0xf bank_mask:0xf
v_fmac_f32_dpp v49, v29, v17 row_newbcast:5 row_mask:0xf bank_mask:0xf
v_fmac_f32_dpp v50, v29, v17 row_newbcast:6 row_mask:0xf bank_mask:0xf
s_waitcnt lgkmcnt(2)
v_mfma_f32_16x16x32_bf16 v[52:55], a[52:55], a[16:19], v[52:55]
ds_read_b128 a[64:67], v10 offset:24832
v_fmac_f32_dpp v51, v29, v17 row_newbcast:7 row_mask:0xf bank_mask:0xf
v_mov_b32_dpp v84, v28 row_newbcast:0 row_mask:0xf bank_mask:0xf
s_waitcnt lgkmcnt(2)
v_mfma_f32_16x16x32_bf16 v[52:55], a[56:59], a[20:23], v[52:55]
ds_read_b128 a[48:51], v10 offset:25088
v_mov_b32_dpp v85, v28 row_newbcast:1 row_mask:0xf bank_mask:0xf
v_mov_b32_dpp v86, v28 row_newbcast:2 row_mask:0xf bank_mask:0xf
v_mov_b32_dpp v87, v28 row_newbcast:3 row_mask:0xf bank_mask:0xf
v_mov_b32_dpp v88, v28 row_newbcast:4 row_mask:0xf bank_mask:0xf
v_mov_b32_dpp v89, v28 row_newbcast:5 row_mask:0xf bank_mask:0xf
v_mov_b32_dpp v90, v28 row_newbcast:6 row_mask:0xf bank_mask:0xf
s_waitcnt lgkmcnt(2)
v_mfma_f32_16x16x32_bf16 v[52:55], a[60:63], a[24:27], v[52:55]
ds_read_b128 a[52:55], v11 offset:24576
v_mov_b32_dpp v91, v28 row_newbcast:7 row_mask:0xf bank_mask:0xf
v_fma_f32 v44, v44, v84, v15
v_fma_f32 v45, v45, v85, v15
s_waitcnt lgkmcnt(2)
v_mfma_f32_16x16x32_bf16 v[52:55], a[64:67], a[28:31], v[52:55]
ds_read_b128 a[56:59], v11 offset:24832
v_fma_f32 v46, v46, v86, v15
v_fma_f32 v47, v47, v87, v15
s_waitcnt lgkmcnt(2)
v_mfma_f32_16x16x32_bf16 v[52:55], a[48:51], a[32:35], v[52:55]
s_waitcnt lgkmcnt(1)
ds_read_b128 a[60:63], v11 offset:25088
v_fma_f32 v48, v48, v88, v15
v_fma_f32 v49, v49, v89, v15
v_fma_f32 v50, v50, v90, v15
v_fma_f32 v51, v51, v91, v15
v_exp_f32 v76, v44
v_mfma_f32_16x16x32_bf16 v[52:55], a[52:55], a[36:39], v[52:55]
s_waitcnt lgkmcnt(1)
ds_read_b128 a[64:67], v8 offset:0
v_exp_f32 v77, v45
v_add_u32 v9, 0x18000, v9
v_mfma_f32_16x16x32_bf16 v[52:55], a[56:59], a[40:43], v[52:55]
ds_read_b128 a[48:51], v8 offset:12288
v_exp_f32 v78, v46
s_waitcnt lgkmcnt(2)
v_mfma_f32_16x16x32_bf16 v[52:55], a[60:63], a[44:47], v[52:55]
s_waitcnt lgkmcnt(1)
ds_read_b128 a[52:55], v8 offset:256
v_add_u32 v10, 0x18000, v10
v_exp_f32 v79, v47
v_add_u32 v11, 0x18000, v11
v_exp_f32 v80, v48
v_exp_f32 v81, v49
v_exp_f32 v82, v50
v_mfma_f32_16x16x32_bf16 v[36:39], a[64:67], a[0:3], v[56:59]
s_waitcnt lgkmcnt(1)
ds_read_b128 a[56:59], v8 offset:12544
v_exp_f32 v83, v51
v_add_f32 v32, v76, v77
v_add_f32 v33, v78, v79
v_mfma_f32_16x16x32_bf16 v[40:43], a[48:51], a[0:3], v[56:59]
s_waitcnt lgkmcnt(1)
ds_read_b128 a[60:63], v8 offset:512
v_add_f32 v34, v80, v81
v_add_f32 v35, v82, v83
v_mfma_f32_16x16x32_bf16 v[36:39], a[52:55], a[4:7], v[36:39]
ds_read_b128 a[64:67], v8 offset:12800
v_add_f32 v32, v32, v33
v_add_f32 v34, v34, v35
v_add_f32 v32, v32, v34
v_cmp_nge_f32 vcc, s55, v32
s_nop 0
s_cbranch_vccnz RARE1b
C_1b:
ds_read_b128 a[48:51], v9 offset:0
s_waitcnt lgkmcnt(3)
v_mfma_f32_16x16x32_bf16 v[40:43], a[56:59], a[4:7], v[40:43]
s_waitcnt lgkmcnt(2)
ds_read_b128 a[52:55], v9 offset:12288
v_add_f32 v16, v16, v32
v_mfma_f32_16x16x32_bf16 v[36:39], a[60:63], a[8:11], v[36:39]
s_waitcnt lgkmcnt(2)
ds_read_b128 a[56:59], v9 offset:256
v_mul_f32 v84, v76, v84
v_mul_f32 v85, v77, v85
v_mfma_f32_16x16x32_bf16 v[40:43], a[64:67], a[8:11], v[40:43]
s_waitcnt lgkmcnt(2)
ds_read_b128 a[60:63], v9 offset:12544
v_mul_f32 v86, v78, v86
v_mul_f32 v87, v79, v87
v_mul_f32 v88, v80, v88
v_mul_f32 v89, v81, v89
v_mul_f32 v90, v82, v90
v_mfma_f32_16x16x32_bf16 v[36:39], a[48:51], a[12:15], v[36:39]
ds_read_b128 a[64:67], v9 offset:512
v_mul_f32 v91, v83, v91
s_waitcnt lgkmcnt(3)
v_mfma_f32_16x16x32_bf16 v[40:43], a[52:55], a[12:15], v[40:43]
s_waitcnt lgkmcnt(2)
ds_read_b128 a[48:51], v9 offset:12800
v_cvt_pk_bf16_f32 v60, v84, v85
v_cvt_pk_bf16_f32 v61, v86, v87
v_mfma_f32_16x16x32_bf16 v[36:39], a[56:59], a[16:19], v[36:39]
s_waitcnt lgkmcnt(2)
ds_read_b128 a[52:55], v10 offset:0
v_cvt_pk_bf16_f32 v62, v88, v89
v_cvt_pk_bf16_f32 v63, v90, v91
v_mfma_f32_16x16x32_bf16 v[40:43], a[60:63], a[16:19], v[40:43]
s_waitcnt lgkmcnt(2)
ds_read2_b64 v[76:79], v19 offset0:1 offset1:3
v_add_f32 v68, v68, v84
v_add_f32 v68, v68, v88
v_mfma_f32_16x16x32_bf16 v[36:39], a[64:67], a[20:23], v[36:39]
v_add_f32 v69, v69, v85
v_add_f32 v69, v69, v89
v_add_f32 v70, v70, v86
s_waitcnt lgkmcnt(2)
v_mfma_f32_16x16x32_bf16 v[40:43], a[48:51], a[20:23], v[40:43]
s_waitcnt lgkmcnt(1)
ds_read2_b64 v[80:83], v19 offset0:5 offset1:7
v_add_f32 v70, v70, v90
v_add_f32 v71, v71, v87
v_add_f32 v71, v71, v91
v_mfma_f32_16x16x32_bf16 v[36:39], a[52:55], a[24:27], v[36:39]
s_waitcnt lgkmcnt(1)
ds_write_b128 v13, v[60:63] offset:4096
v_add_f32 v76, v76, v78
v_add_f32 v77, v77, v79
ds_read_b128 a[56:59], v10 offset:12288
s_waitcnt lgkmcnt(2)
v_add_f32 v80, v80, v82
v_add_f32 v81, v81, v83
v_add_f32 v22, v76, v80
v_add_f32 v23, v77, v81
ds_read_b128 a[60:63], v10 offset:256
ds_read_b128 a[64:67], v10 offset:12544
ds_read_b128 a[48:51], v10 offset:512
ds_read2_b64 v[76:79], v19 offset0:160 offset1:162
s_waitcnt lgkmcnt(4)
v_mfma_f32_16x16x32_bf16 v[40:43], a[56:59], a[24:27], v[40:43]
s_waitcnt lgkmcnt(3)
v_mfma_f32_16x16x32_bf16 v[36:39], a[60:63], a[28:31], v[36:39]
s_waitcnt lgkmcnt(0)
ds_read2_b64 v[80:83], v19 offset0:164 offset1:166
v_mfma_f32_16x16x32_bf16 v[40:43], a[64:67], a[28:31], v[40:43]
v_mfma_f32_16x16x32_bf16 v[36:39], a[48:51], a[32:35], v[36:39]
ds_read_b128 a[52:55], v10 offset:12800
ds_read_b128 a[56:59], v11 offset:0
v_add_f32 v76, v76, v78
v_add_f32 v77, v77, v79
ds_read_b128 a[60:63], v11 offset:12288
ds_read_b128 a[64:67], v11 offset:256
s_waitcnt lgkmcnt(4)
v_add_f32 v80, v80, v82
v_add_f32 v81, v81, v83
v_add_f32 v24, v76, v80
v_add_f32 v25, v77, v81
s_waitcnt lgkmcnt(3)
v_mfma_f32_16x16x32_bf16 v[40:43], a[52:55], a[32:35], v[40:43]
s_waitcnt lgkmcnt(2)
ds_read_b128 a[48:51], v11 offset:12544
ds_read_b128 a[52:55], v11 offset:512
v_mfma_f32_16x16x32_bf16 v[36:39], a[56:59], a[36:39], v[36:39]
s_waitcnt lgkmcnt(2)
ds_read_b128 a[56:59], v11 offset:12800
v_mfma_f32_16x16x32_bf16 v[40:43], a[60:63], a[36:39], v[40:43]
v_mfma_f32_16x16x32_bf16 v[36:39], a[64:67], a[40:43], v[36:39]
s_waitcnt lgkmcnt(2)
v_mfma_f32_16x16x32_bf16 v[40:43], a[48:51], a[40:43], v[40:43]
s_waitcnt lgkmcnt(0)
s_barrier
ds_read2_b64 v[28:31], v12 offset0:0 offset1:2
v_mfma_f32_16x16x32_bf16 v[36:39], a[52:55], a[44:47], v[36:39]
v_mfma_f32_16x16x32_bf16 v[40:43], a[56:59], a[44:47], v[40:43]
ds_read2_b64 v[32:35], v12 offset0:4 offset1:6
ds_read_b128 a[60:63], v8 offset:24576
ds_read_b128 a[64:67], v8 offset:36864
s_waitcnt lgkmcnt(3)
v_add_f32 v28, v28, v30
v_add_f32 v29, v29, v31
v_add_f32 v28, v28, v22
v_add_f32 v29, v29, v23
ds_read_b128 a[48:51], v8 offset:24832
ds_read_b128 a[52:55], v8 offset:37120
s_waitcnt lgkmcnt(4)
v_add_f32 v32, v32, v34
v_add_f32 v33, v33, v35
v_add_f32 v28, v28, v32
v_add_f32 v29, v29, v33
s_waitcnt lgkmcnt(2)
v_mfma_f32_16x16x32_bf16 v[44:47], a[60:63], a[0:3], v[56:59]
ds_read_b128 a[56:59], v8 offset:25088
v_mul_f32 v29, s53, v29
v_mfma_f32_16x16x32_bf16 v[48:51], a[64:67], a[0:3], v[56:59]
ds_read_b128 a[60:63], v8 offset:37376
v_mul_f32 v28, s53, v28
v_fma_f32 v28, -v29, v29, v28
v_max_f32 v28, 0, v28
s_waitcnt lgkmcnt(3)
v_mfma_f32_16x16x32_bf16 v[44:47], a[48:51], a[4:7], v[44:47]
ds_read_b128 a[64:67], v9 offset:24576
v_add_f32 v28, s54, v28
v_rsq_f32 v28, v28
v_fmac_f32_dpp v36, v29, v17 row_newbcast:0 row_mask:0xf bank_mask:0xf
s_waitcnt lgkmcnt(3)
v_mfma_f32_16x16x32_bf16 v[48:51], a[52:55], a[4:7], v[48:51]
ds_read_b128 a[48:51], v9 offset:36864
v_fmac_f32_dpp v37, v29, v17 row_newbcast:1 row_mask:0xf bank_mask:0xf
v_fmac_f32_dpp v38, v29, v17 row_newbcast:2 row_mask:0xf bank_mask:0xf
v_fmac_f32_dpp v39, v29, v17 row_newbcast:3 row_mask:0xf bank_mask:0xf
v_fmac_f32_dpp v40, v29, v17 row_newbcast:4 row_mask:0xf bank_mask:0xf
s_waitcnt lgkmcnt(2)
v_mfma_f32_16x16x32_bf16 v[44:47], a[56:59], a[8:11], v[44:47]
ds_read_b128 a[52:55], v9 offset:24832
v_fmac_f32_dpp v41, v29, v17 row_newbcast:5 row_mask:0xf bank_mask:0xf
v_fmac_f32_dpp v42, v29, v17 row_newbcast:6 row_mask:0xf bank_mask:0xf
v_fmac_f32_dpp v43, v29, v17 row_newbcast:7 row_mask:0xf bank_mask:0xf
v_mov_b32_dpp v84, v28 row_newbcast:0 row_mask:0xf bank_mask:0xf
v_mfma_f32_16x16x32_bf16 v[48:51], a[60:63], a[8:11], v[48:51]
ds_read_b128 a[56:59], v9 offset:37120
v_mov_b32_dpp v85, v28 row_newbcast:1 row_mask:0xf bank_mask:0xf
v_mov_b32_dpp v86, v28 row_newbcast:2 row_mask:0xf bank_mask:0xf
v_mov_b32_dpp v87, v28 row_newbcast:3 row_mask:0xf bank_mask:0xf
v_mov_b32_dpp v88, v28 row_newbcast:4 row_mask:0xf bank_mask:0xf
s_waitcnt lgkmcnt(3)
v_mfma_f32_16x16x32_bf16 v[44:47], a[64:67], a[12:15], v[44:47]
ds_read_b128 a[60:63], v9 offset:25088
v_mov_b32_dpp v89, v28 row_newbcast:5 row_mask:0xf bank_mask:0xf
v_mov_b32_dpp v90, v28 row_newbcast:6 row_mask:0xf bank_mask:0xf
v_mov_b32_dpp v91, v28 row_newbcast:7 row_mask:0xf bank_mask:0xf
v_fma_f32 v36, v36, v84, v15
s_waitcnt lgkmcnt(3)
v_mfma_f32_16x16x32_bf16 v[48:51], a[48:51], a[12:15], v[48:51]
s_waitcnt lgkmcnt(2)
ds_read_b128 a[64:67], v9 offset:37376
v_fma_f32 v37, v37, v85, v15
v_fma_f32 v38, v38, v86, v15
v_fma_f32 v39, v39, v87, v15
v_fma_f32 v40, v40, v88, v15
v_mfma_f32_16x16x32_bf16 v[44:47], a[52:55], a[16:19], v[44:47]
s_waitcnt lgkmcnt(2)
ds_read_b128 a[48:51], v10 offset:24576
v_fma_f32 v41, v41, v89, v15
v_fma_f32 v42, v42, v90, v15
v_fma_f32 v43, v43, v91, v15
v_exp_f32 v76, v36
v_mfma_f32_16x16x32_bf16 v[48:51], a[56:59], a[16:19], v[48:51]
s_waitcnt lgkmcnt(2)
ds_read_b128 a[52:55], v10 offset:36864
v_exp_f32 v77, v37
v_exp_f32 v78, v38
v_exp_f32 v79, v39
v_mfma_f32_16x16x32_bf16 v[44:47], a[60:63], a[20:23], v[44:47]
s_waitcnt lgkmcnt(2)
ds_read_b128 a[56:59], v10 offset:24832
v_exp_f32 v80, v40
v_exp_f32 v81, v41
v_exp_f32 v82, v42
v_exp_f32 v83, v43
v_mfma_f32_16x16x32_bf16 v[48:51], a[64:67], a[20:23], v[48:51]
s_waitcnt lgkmcnt(2)
ds_read_b128 a[60:63], v10 offset:37120
v_add_f32 v32, v76, v77
v_add_f32 v33, v78, v79
v_add_f32 v34, v80, v81
v_add_f32 v35, v82, v83
v_mfma_f32_16x16x32_bf16 v[44:47], a[48:51], a[24:27], v[44:47]
s_waitcnt lgkmcnt(2)
ds_read_b128 a[64:67], v10 offset:25088
v_add_f32 v32, v32, v33
v_add_f32 v34, v34, v35
v_add_f32 v32, v32, v34
v_cmp_nge_f32 vcc, s55, v32
v_mfma_f32_16x16x32_bf16 v[48:51], a[52:55], a[24:27], v[48:51]
s_cbranch_vccnz RARE2b
C_2b:
ds_read_b128 a[48:51], v10 offset:37376
v_add_f32 v16, v16, v32
v_mul_f32 v84, v76, v84
v_mul_f32 v85, v77, v85
s_waitcnt lgkmcnt(3)
v_mfma_f32_16x16x32_bf16 v[44:47], a[56:59], a[28:31], v[44:47]
s_waitcnt lgkmcnt(2)
ds_read_b128 a[52:55], v11 offset:24576
v_mul_f32 v86, v78, v86
v_mul_f32 v87, v79, v87
v_mul_f32 v88, v80, v88
v_mul_f32 v89, v81, v89
v_mfma_f32_16x16x32_bf16 v[48:51], a[60:63], a[28:31], v[48:51]
s_waitcnt lgkmcnt(2)
ds_read2_b64 v[76:79], v19 offset0:161 offset1:163
v_mul_f32 v90, v82, v90
v_mul_f32 v91, v83, v91
v_cvt_pk_bf16_f32 v60, v84, v85
v_cvt_pk_bf16_f32 v61, v86, v87
v_mfma_f32_16x16x32_bf16 v[44:47], a[64:67], a[32:35], v[44:47]
s_waitcnt lgkmcnt(2)
ds_read2_b64 v[80:83], v19 offset0:165 offset1:167
v_cvt_pk_bf16_f32 v62, v88, v89
v_cvt_pk_bf16_f32 v63, v90, v91
v_add_f32 v72, v84, v88
v_mfma_f32_16x16x32_bf16 v[48:51], a[48:51], a[32:35], v[48:51]
s_waitcnt lgkmcnt(2)
v_add_f32 v73, v85, v89
v_add_f32 v74, v86, v90
v_add_f32 v75, v87, v91
v_mfma_f32_16x16x32_bf16 v[44:47], a[52:55], a[36:39], v[44:47]
s_waitcnt lgkmcnt(1)
ds_write_b128 v13, v[60:63] offset:0
v_add_u32 v8, 0xfffe8000, v8
v_add_u32 v9, 0xfffe8000, v9
v_add_u32 v10, 0xfffe8000, v10
v_add_f32 v76, v76, v78
v_add_f32 v77, v77, v79
ds_read_b128 a[56:59], v11 offset:36864
s_waitcnt lgkmcnt(2)
v_add_f32 v80, v80, v82
v_add_f32 v81, v81, v83
v_add_f32 v26, v76, v80
v_add_f32 v27, v77, v81
ds_read_b128 a[60:63], v11 offset:24832
ds_read_b128 a[64:67], v11 offset:37120
ds_read_b128 a[48:51], v11 offset:25088
ds_read_b128 a[52:55], v11 offset:37376
v_add_u32 v11, 0xfffe8000, v11
s_waitcnt lgkmcnt(4)
v_mfma_f32_16x16x32_bf16 v[48:51], a[56:59], a[36:39], v[48:51]
s_waitcnt lgkmcnt(3)
v_mfma_f32_16x16x32_bf16 v[44:47], a[60:63], a[40:43], v[44:47]
s_waitcnt lgkmcnt(0)
v_mfma_f32_16x16x32_bf16 v[48:51], a[64:67], a[40:43], v[48:51]
s_barrier
ds_read2_b64 v[28:31], v12 offset0:160 offset1:162
v_mfma_f32_16x16x32_bf16 v[44:47], a[48:51], a[44:47], v[44:47]
v_mfma_f32_16x16x32_bf16 v[48:51], a[52:55], a[44:47], v[48:51]
ds_read2_b64 v[32:35], v12 offset0:164 offset1:166
ds_read_b128 a[56:59], v8 offset:36864
ds_read_b128 a[60:63], v8 offset:37120
s_waitcnt lgkmcnt(3)
v_add_f32 v28, v28, v30
v_add_f32 v29, v29, v31
v_add_f32 v28, v28, v22
v_add_f32 v29, v29, v23
ds_read_b128 a[64:67], v8 offset:37376
ds_read_b128 a[48:51], v9 offset:36864
s_waitcnt lgkmcnt(4)
v_add_f32 v32, v32, v34
v_add_f32 v33, v33, v35
v_add_f32 v28, v28, v32
v_add_f32 v29, v29, v33
s_waitcnt lgkmcnt(2)
v_mfma_f32_16x16x32_bf16 v[56:59], a[56:59], a[0:3], 0
ds_read_b128 a[52:55], v9 offset:37120
v_mul_f32 v29, s53, v29
v_mul_f32 v28, s53, v28
v_mfma_f32_16x16x32_bf16 v[56:59], a[60:63], a[4:7], v[56:59]
ds_read_b128 a[56:59], v9 offset:37376
v_fma_f32 v28, -v29, v29, v28
v_max_f32 v28, 0, v28
s_waitcnt lgkmcnt(3)
v_mfma_f32_16x16x32_bf16 v[56:59], a[64:67], a[8:11], v[56:59]
ds_read_b128 a[60:63], v10 offset:36864
v_add_f32 v28, s54, v28
v_rsq_f32 v28, v28
v_fmac_f32_dpp v44, v29, v17 row_newbcast:0 row_mask:0xf bank_mask:0xf
s_waitcnt lgkmcnt(3)
v_mfma_f32_16x16x32_bf16 v[56:59], a[48:51], a[12:15], v[56:59]
ds_read_b128 a[64:67], v10 offset:37120
v_fmac_f32_dpp v45, v29, v17 row_newbcast:1 row_mask:0xf bank_mask:0xf
v_fmac_f32_dpp v46, v29, v17 row_newbcast:2 row_mask:0xf bank_mask:0xf
s_waitcnt lgkmcnt(3)
v_mfma_f32_16x16x32_bf16 v[56:59], a[52:55], a[16:19], v[56:59]
ds_read_b128 a[48:51], v10 offset:37376
v_fmac_f32_dpp v47, v29, v17 row_newbcast:3 row_mask:0xf bank_mask:0xf
v_fmac_f32_dpp v48, v29, v17 row_newbcast:4 row_mask:0xf bank_mask:0xf
v_fmac_f32_dpp v49, v29, v17 row_newbcast:5 row_mask:0xf bank_mask:0xf
s_waitcnt lgkmcnt(3)
v_mfma_f32_16x16x32_bf16 v[56:59], a[56:59], a[20:23], v[56:59]
ds_read_b128 a[52:55], v11 offset:36864
v_fmac_f32_dpp v50, v29, v17 row_newbcast:6 row_mask:0xf bank_mask:0xf
v_fmac_f32_dpp v51, v29, v17 row_newbcast:7 row_mask:0xf bank_mask:0xf
s_waitcnt lgkmcnt(3)
v_mfma_f32_16x16x32_bf16 v[56:59], a[60:63], a[24:27], v[56:59]
ds_read_b128 a[56:59], v11 offset:37120
v_mov_b32_dpp v84, v28 row_newbcast:0 row_mask:0xf bank_mask:0xf
v_mov_b32_dpp v85, v28 row_newbcast:1 row_mask:0xf bank_mask:0xf
v_mov_b32_dpp v86, v28 row_newbcast:2 row_mask:0xf bank_mask:0xf
s_waitcnt lgkmcnt(3)
v_mfma_f32_16x16x32_bf16 v[56:59], a[64:67], a[28:31], v[56:59]
ds_read_b128 a[60:63], v11 offset:37376
v_mov_b32_dpp v87, v28 row_newbcast:3 row_mask:0xf bank_mask:0xf
v_mov_b32_dpp v88, v28 row_newbcast:4 row_mask:0xf bank_mask:0xf
s_waitcnt lgkmcnt(3)
v_mfma_f32_16x16x32_bf16 v[56:59], a[48:51], a[32:35], v[56:59]
ds_read_b128 a[64:67], v8 offset:0
v_mov_b32_dpp v89, v28 row_newbcast:5 row_mask:0xf bank_mask:0xf
v_mov_b32_dpp v90, v28 row_newbcast:6 row_mask:0xf bank_mask:0xf
s_waitcnt lgkmcnt(3)
v_mfma_f32_16x16x32_bf16 v[56:59], a[52:55], a[36:39], v[56:59]
ds_read_b128 a[48:51], v8 offset:12288
v_mov_b32_dpp v91, v28 row_newbcast:7 row_mask:0xf bank_mask:0xf
v_fma_f32 v44, v44, v84, v15
v_fma_f32 v45, v45, v85, v15
s_waitcnt lgkmcnt(3)
v_mfma_f32_16x16x32_bf16 v[56:59], a[56:59], a[40:43], v[56:59]
s_waitcnt lgkmcnt(2)
ds_read_b128 a[52:55], v8 offset:256
v_fma_f32 v46, v46, v86, v15
v_fma_f32 v47, v47, v87, v15
v_mfma_f32_16x16x32_bf16 v[56:59], a[60:63], a[44:47], v[56:59]
s_waitcnt lgkmcnt(2)
ds_read_b128 a[56:59], v8 offset:12544
v_fma_f32 v48, v48, v88, v15
v_fma_f32 v49, v49, v89, v15
v_fma_f32 v50, v50, v90, v15
v_mfma_f32_16x16x32_bf16 v[36:39], a[64:67], a[0:3], v[52:55]
s_waitcnt lgkmcnt(2)
ds_read_b128 a[60:63], v8 offset:512
v_fma_f32 v51, v51, v91, v15
v_exp_f32 v76, v44
v_mfma_f32_16x16x32_bf16 v[40:43], a[48:51], a[0:3], v[52:55]
s_waitcnt lgkmcnt(2)
ds_read_b128 a[64:67], v8 offset:12800
v_exp_f32 v77, v45
v_exp_f32 v78, v46
v_exp_f32 v79, v47
v_mfma_f32_16x16x32_bf16 v[36:39], a[52:55], a[4:7], v[36:39]
s_waitcnt lgkmcnt(2)
ds_read_b128 a[48:51], v9 offset:0
v_exp_f32 v80, v48
v_exp_f32 v81, v49
v_mfma_f32_16x16x32_bf16 v[40:43], a[56:59], a[4:7], v[40:43]
s_waitcnt lgkmcnt(2)
ds_read_b128 a[52:55], v9 offset:12288
v_exp_f32 v82, v50
v_exp_f32 v83, v51
v_add_f32 v32, v76, v77
v_mfma_f32_16x16x32_bf16 v[36:39], a[60:63], a[8:11], v[36:39]
s_waitcnt lgkmcnt(2)
ds_read_b128 a[56:59], v9 offset:256
v_add_f32 v33, v78, v79
v_add_f32 v34, v80, v81
v_mfma_f32_16x16x32_bf16 v[40:43], a[64:67], a[8:11], v[40:43]
s_waitcnt lgkmcnt(2)
ds_read_b128 a[60:63], v9 offset:12544
v_add_f32 v35, v82, v83
v_add_f32 v32, v32, v33
v_add_f32 v34, v34, v35
v_mfma_f32_16x16x32_bf16 v[36:39], a[48:51], a[12:15], v[36:39]
s_waitcnt lgkmcnt(2)
ds_read_b128 a[64:67], v9 offset:512
v_add_f32 v32, v32, v34
v_cmp_nge_f32 vcc, s55, v32
v_mfma_f32_16x16x32_bf16 v[40:43], a[52:55], a[12:15], v[40:43]
s_cbranch_vccnz RARE3b
C_3b:
ds_read_b128 a[48:51], v9 offset:12800
v_add_f32 v16, v16, v32
s_waitcnt lgkmcnt(3)
v_mfma_f32_16x16x32_bf16 v[36:39], a[56:59], a[16:19], v[36:39]
s_waitcnt lgkmcnt(2)
s_add_u32 s52, s27, 0
ds_read_b128 a[52:55], v10 offset:0
v_mul_f32 v84, v76, v84
v_mul_f32 v85, v77, v85
v_mul_f32 v86, v78, v86
v_mfma_f32_16x16x32_bf16 v[40:43], a[60:63], a[16:19], v[40:43]
s_waitcnt lgkmcnt(2)
ds_read_b128 a[56:59], v10 offset:12288
v_mul_f32 v87, v79, v87
v_mul_f32 v88, v80, v88
v_mfma_f32_16x16x32_bf16 v[36:39], a[64:67], a[20:23], v[36:39]
s_waitcnt lgkmcnt(2)
ds_read_b128 a[60:63], v10 offset:256
v_mul_f32 v89, v81, v89
v_mul_f32 v90, v82, v90
v_mul_f32 v91, v83, v91
v_mfma_f32_16x16x32_bf16 v[40:43], a[48:51], a[20:23], v[40:43]
ds_read_b128 a[64:67], v10 offset:12544
v_cvt_pk_bf16_f32 v60, v84, v85
v_cvt_pk_bf16_f32 v61, v86, v87
s_waitcnt lgkmcnt(3)
v_mfma_f32_16x16x32_bf16 v[36:39], a[52:55], a[24:27], v[36:39]
s_waitcnt lgkmcnt(2)
ds_read_b128 a[48:51], v10 offset:512
v_cvt_pk_bf16_f32 v62, v88, v89
v_cvt_pk_bf16_f32 v63, v90, v91
v_mfma_f32_16x16x32_bf16 v[40:43], a[56:59], a[24:27], v[40:43]
s_waitcnt lgkmcnt(2)
ds_write_b128 v13, v[60:63] offset:4096
v_add_f32 v72, v72, v84
v_add_f32 v72, v72, v88
v_mfma_f32_16x16x32_bf16 v[36:39], a[60:63], a[28:31], v[36:39]
s_waitcnt lgkmcnt(2)
v_add_f32 v73, v73, v85
v_add_f32 v73, v73, v89
v_add_f32 v74, v74, v86
v_mfma_f32_16x16x32_bf16 v[40:43], a[64:67], a[28:31], v[40:43]
v_add_f32 v74, v74, v90
v_add_f32 v75, v75, v87
v_add_f32 v75, v75, v91
s_waitcnt lgkmcnt(1)
v_mfma_f32_16x16x32_bf16 v[36:39], a[48:51], a[32:35], v[36:39]
ds_read_b128 a[52:55], v10 offset:12800
v_cvt_pk_bf16_f32 v64, v68, v69
v_cvt_pk_bf16_f32 v65, v70, v71
v_cvt_pk_bf16_f32 v66, v72, v73
v_cvt_pk_bf16_f32 v67, v74, v75
v_add_u32 v8, 0xc000, v8
v_add_u32 v9, 0xc000, v9
v_add_u32 v10, 0xc000, v10
ds_read_b128 a[56:59], v11 offset:0
ds_read_b128 a[60:63], v11 offset:12288
ds_read_b128 a[64:67], v11 offset:256
s_waitcnt lgkmcnt(3)
v_mfma_f32_16x16x32_bf16 v[40:43], a[52:55], a[32:35], v[40:43]
s_waitcnt lgkmcnt(2)
ds_read_b128 a[48:51], v11 offset:12544
ds_write_b128 v13, v[64:67] offset:8192
v_mfma_f32_16x16x32_bf16 v[36:39], a[56:59], a[36:39], v[36:39]
s_waitcnt lgkmcnt(3)
v_mfma_f32_16x16x32_bf16 v[40:43], a[60:63], a[36:39], v[40:43]
s_waitcnt lgkmcnt(2)
v_mfma_f32_16x16x32_bf16 v[36:39], a[64:67], a[40:43], v[36:39]
ds_read_b128 a[52:55], v11 offset:512
s_waitcnt lgkmcnt(2)
v_mfma_f32_16x16x32_bf16 v[40:43], a[48:51], a[40:43], v[40:43]
ds_read_b128 a[56:59], v11 offset:12800
v_add_u32 v11, 0xc000, v11
s_waitcnt lgkmcnt(0)
s_barrier
buffer_load_dwordx4 v[92:95], v1, s[28:31], s52 offen offset:0 sc1
ds_read2_b64 v[28:31], v12 offset0:0 offset1:2
v_mfma_f32_16x16x32_bf16 v[36:39], a[52:55], a[44:47], v[36:39]
v_mfma_f32_16x16x32_bf16 v[40:43], a[56:59], a[44:47], v[40:43]
ds_read2_b64 v[32:35], v12 offset0:4 offset1:6
buffer_load_dwordx4 v[96:99], v1, s[28:31], s52 offen offset:1024 sc1
ds_read_b128 a[60:63], v8 offset:0
ds_read_b128 a[64:67], v8 offset:12288
s_waitcnt lgkmcnt(3)
v_add_f32 v28, v28, v30
v_add_f32 v29, v29, v31
v_add_f32 v28, v28, v24
v_add_f32 v29, v29, v25
ds_read_b128 a[48:51], v8 offset:256
buffer_load_dwordx4 v[100:103], v1, s[28:31], s52 offen offset:2048 sc1
ds_read_b128 a[52:55], v8 offset:12544
s_waitcnt lgkmcnt(4)
v_add_f32 v32, v32, v34
v_add_f32 v33, v33, v35
v_add_f32 v28, v28, v32
v_add_f32 v29, v29, v33
v_mul_f32 v29, s53, v29
s_waitcnt lgkmcnt(2)
v_mfma_f32_16x16x32_bf16 v[44:47], a[60:63], a[0:3], v[52:55]
ds_read_b128 a[56:59], v8 offset:512
v_mul_f32 v28, s53, v28
v_fma_f32 v28, -v29, v29, v28
v_max_f32 v28, 0, v28
v_mfma_f32_16x16x32_bf16 v[48:51], a[64:67], a[0:3], v[52:55]
ds_read_b128 a[60:63], v8 offset:12800
buffer_load_dwordx4 v[104:107], v1, s[28:31], s52 offen offset:3072 sc1
ds_read_b128 a[64:67], v9 offset:0
v_add_f32 v28, s54, v28
v_rsq_f32 v28, v28
v_fmac_f32_dpp v36, v29, v17 row_newbcast:0 row_mask:0xf bank_mask:0xf
v_fmac_f32_dpp v37, v29, v17 row_newbcast:1 row_mask:0xf bank_mask:0xf
s_waitcnt lgkmcnt(4)
v_mfma_f32_16x16x32_bf16 v[44:47], a[48:51], a[4:7], v[44:47]
s_add_u32 s52, s52, 4096
ds_read_b128 a[48:51], v9 offset:12288
v_fmac_f32_dpp v38, v29, v17 row_newbcast:2 row_mask:0xf bank_mask:0xf
v_fmac_f32_dpp v39, v29, v17 row_newbcast:3 row_mask:0xf bank_mask:0xf
v_fmac_f32_dpp v40, v29, v17 row_newbcast:4 row_mask:0xf bank_mask:0xf
s_waitcnt lgkmcnt(4)
v_mfma_f32_16x16x32_bf16 v[48:51], a[52:55], a[4:7], v[48:51]
ds_read_b128 a[52:55], v9 offset:256
buffer_load_dwordx4 v[108:111], v1, s[28:31], s52 offen offset:0 sc1
v_fmac_f32_dpp v41, v29, v17 row_newbcast:5 row_mask:0xf bank_mask:0xf
v_fmac_f32_dpp v42, v29, v17 row_newbcast:6 row_mask:0xf bank_mask:0xf
v_fmac_f32_dpp v43, v29, v17 row_newbcast:7 row_mask:0xf bank_mask:0xf
s_waitcnt lgkmcnt(4)
v_mfma_f32_16x16x32_bf16 v[44:47], a[56:59], a[8:11], v[44:47]
ds_read_b128 a[56:59], v9 offset:12544
v_mov_b32_dpp v84, v28 row_newbcast:0 row_mask:0xf bank_mask:0xf
v_mov_b32_dpp v85, v28 row_newbcast:1 row_mask:0xf bank_mask:0xf
v_mov_b32_dpp v86, v28 row_newbcast:2 row_mask:0xf bank_mask:0xf
s_waitcnt lgkmcnt(3)
v_mfma_f32_16x16x32_bf16 v[48:51], a[60:63], a[8:11], v[48:51]
ds_read_b128 a[60:63], v9 offset:512
v_mov_b32_dpp v87, v28 row_newbcast:3 row_mask:0xf bank_mask:0xf
v_mov_b32_dpp v88, v28 row_newbcast:4 row_mask:0xf bank_mask:0xf
v_mov_b32_dpp v89, v28 row_newbcast:5 row_mask:0xf bank_mask:0xf
v_mov_b32_dpp v90, v28 row_newbcast:6 row_mask:0xf bank_mask:0xf
v_mfma_f32_16x16x32_bf16 v[44:47], a[64:67], a[12:15], v[44:47]
ds_read_b128 a[64:67], v9 offset:12800
buffer_load_dwordx4 v[112:115], v1, s[28:31], s52 offen offset:1024 sc1
v_mov_b32_dpp v91, v28 row_newbcast:7 row_mask:0xf bank_mask:0xf
v_fma_f32 v36, v36, v84, v15
v_fma_f32 v37, v37, v85, v15
s_waitcnt lgkmcnt(3)
v_mfma_f32_16x16x32_bf16 v[48:51], a[48:51], a[12:15], v[48:51]
ds_read_b128 a[48:51], v10 offset:0
v_fma_f32 v38, v38, v86, v15
v_fma_f32 v39, v39, v87, v15
v_fma_f32 v40, v40, v88, v15
v_mfma_f32_16x16x32_bf16 v[44:47], a[52:55], a[16:19], v[44:47]
s_waitcnt lgkmcnt(3)
ds_read_b128 a[52:55], v10 offset:12288
v_fma_f32 v41, v41, v89, v15
v_fma_f32 v42, v42, v90, v15
v_fma_f32 v43, v43, v91, v15
v_mfma_f32_16x16x32_bf16 v[48:51], a[56:59], a[16:19], v[48:51]
s_waitcnt lgkmcnt(3)
ds_read_b128 a[56:59], v10 offset:256
v_exp_f32 v76, v36
v_exp_f32 v77, v37
v_exp_f32 v78, v38
v_exp_f32 v79, v39
v_mfma_f32_16x16x32_bf16 v[44:47], a[60:63], a[20:23], v[44:47]
s_waitcnt lgkmcnt(2)
ds_read_b128 a[60:63], v10 offset:12544
v_exp_f32 v80, v40
v_exp_f32 v81, v41
v_exp_f32 v82, v42
v_mfma_f32_16x16x32_bf16 v[48:51], a[64:67], a[20:23], v[48:51]
ds_read_b128 a[64:67], v10 offset:512
v_exp_f32 v83, v43
v_add_f32 v32, v76, v77
v_add_f32 v33, v78, v79
v_mfma_f32_16x16x32_bf16 v[44:47], a[48:51], a[24:27], v[44:47]
s_waitcnt lgkmcnt(2)
ds_read_b128 a[48:51], v10 offset:12800
v_add_f32 v34, v80, v81
v_add_f32 v35, v82, v83
v_add_f32 v32, v32, v33
v_mfma_f32_16x16x32_bf16 v[48:51], a[52:55], a[24:27], v[48:51]
ds_read_b128 a[52:55], v11 offset:0
v_add_f32 v34, v34, v35
v_add_f32 v32, v32, v34
v_cmp_nge_f32 vcc, s55, v32
s_nop 0
s_cbranch_vccnz RARE4b
C_4b:
v_mfma_f32_16x16x32_bf16 v[44:47], a[56:59], a[28:31], v[44:47]
s_waitcnt lgkmcnt(3)
s_add_u32 s52, s27, 18432
ds_read_b128 a[56:59], v11 offset:12288
v_add_f32 v16, v16, v32
v_mul_f32 v84, v76, v84
v_mul_f32 v85, v77, v85
v_mfma_f32_16x16x32_bf16 v[48:51], a[60:63], a[28:31], v[48:51]
s_waitcnt lgkmcnt(3)
ds_read_b128 a[60:63], v11 offset:256
v_mul_f32 v86, v78, v86
v_mul_f32 v87, v79, v87
v_mul_f32 v88, v80, v88
v_mfma_f32_16x16x32_bf16 v[44:47], a[64:67], a[32:35], v[44:47]
s_waitcnt lgkmcnt(3)
ds_read_b128 a[64:67], v11 offset:12544
v_mul_f32 v89, v81, v89
v_mul_f32 v90, v82, v90
v_mul_f32 v91, v83, v91
v_mfma_f32_16x16x32_bf16 v[48:51], a[48:51], a[32:35], v[48:51]
s_waitcnt lgkmcnt(3)
ds_read_b128 a[48:51], v11 offset:512
v_cvt_pk_bf16_f32 v60, v84, v85
v_cvt_pk_bf16_f32 v61, v86, v87
v_cvt_pk_bf16_f32 v62, v88, v89
v_cvt_pk_bf16_f32 v63, v90, v91
v_mfma_f32_16x16x32_bf16 v[44:47], a[52:55], a[36:39], v[44:47]
s_waitcnt lgkmcnt(3)
ds_write_b128 v13, v[60:63] offset:0
v_add_f32 v68, v84, v88
v_add_f32 v69, v85, v89
v_mfma_f32_16x16x32_bf16 v[48:51], a[56:59], a[36:39], v[48:51]
s_waitcnt lgkmcnt(3)
v_add_f32 v70, v86, v90
v_add_f32 v71, v87, v91
v_mfma_f32_16x16x32_bf16 v[44:47], a[60:63], a[40:43], v[44:47]
s_waitcnt lgkmcnt(2)
v_mfma_f32_16x16x32_bf16 v[48:51], a[64:67], a[40:43], v[48:51]
ds_read_b128 a[52:55], v11 offset:12800
s_waitcnt lgkmcnt(0)
s_barrier
buffer_load_dwordx4 v[116:119], v1, s[28:31], s52 offen offset:0 sc1
ds_read2_b64 v[28:31], v12 offset0:160 offset1:162
v_mfma_f32_16x16x32_bf16 v[44:47], a[48:51], a[44:47], v[44:47]
v_mfma_f32_16x16x32_bf16 v[48:51], a[52:55], a[44:47], v[48:51]
ds_read2_b64 v[32:35], v12 offset0:164 offset1:166
buffer_load_dwordx4 v[120:123], v1, s[28:31], s52 offen offset:1024 sc1
ds_read_b128 a[56:59], v8 offset:24576
ds_read_b128 a[60:63], v8 offset:36864
s_waitcnt lgkmcnt(3)
v_add_f32 v28, v28, v30
v_add_f32 v29, v29, v31
v_add_f32 v28, v28, v24
v_add_f32 v29, v29, v25
ds_read_b128 a[64:67], v8 offset:24832
buffer_load_dwordx4 v[124:127], v1, s[28:31], s52 offen offset:2048 sc1
ds_read_b128 a[48:51], v8 offset:37120
s_waitcnt lgkmcnt(4)
v_add_f32 v32, v32, v34
v_add_f32 v33, v33, v35
v_add_f32 v28, v28, v32
v_add_f32 v29, v29, v33
s_waitcnt lgkmcnt(2)
v_mfma_f32_16x16x32_bf16 v[36:39], a[56:59], a[0:3], v[56:59]
ds_read_b128 a[52:55], v8 offset:25088
v_mul_f32 v29, s53, v29
v_mfma_f32_16x16x32_bf16 v[40:43], a[60:63], a[0:3], v[56:59]
ds_read_b128 a[56:59], v8 offset:37376
v_mul_f32 v28, s53, v28
v_fma_f32 v28, -v29, v29, v28
v_max_f32 v28, 0, v28
s_waitcnt lgkmcnt(3)
v_mfma_f32_16x16x32_bf16 v[36:39], a[64:67], a[4:7], v[36:39]
s_waitcnt lgkmcnt(2)
buffer_load_dwordx4 v[128:131], v1, s[28:31], s52 offen offset:3072 sc1
ds_read_b128 a[60:63], v9 offset:24576
v_add_f32 v28, s54, v28
v_rsq_f32 v28, v28
v_mfma_f32_16x16x32_bf16 v[40:43], a[48:51], a[4:7], v[40:43]
s_add_u32 s52, s52, 4096
ds_read_b128 a[64:67], v9 offset:36864
v_fmac_f32_dpp v44, v29, v17 row_newbcast:0 row_mask:0xf bank_mask:0xf
v_fmac_f32_dpp v45, v29, v17 row_newbcast:1 row_mask:0xf bank_mask:0xf
v_fmac_f32_dpp v46, v29, v17 row_newbcast:2 row_mask:0xf bank_mask:0xf
v_fmac_f32_dpp v47, v29, v17 row_newbcast:3 row_mask:0xf bank_mask:0xf
s_waitcnt lgkmcnt(2)
v_mfma_f32_16x16x32_bf16 v[36:39], a[52:55], a[8:11], v[36:39]
ds_read_b128 a[48:51], v9 offset:24832
v_fmac_f32_dpp v48, v29, v17 row_newbcast:4 row_mask:0xf bank_mask:0xf
v_fmac_f32_dpp v49, v29, v17 row_newbcast:5 row_mask:0xf bank_mask:0xf
v_fmac_f32_dpp v50, v29, v17 row_newbcast:6 row_mask:0xf bank_mask:0xf
v_fmac_f32_dpp v51, v29, v17 row_newbcast:7 row_mask:0xf bank_mask:0xf
v_mfma_f32_16x16x32_bf16 v[40:43], a[56:59], a[8:11], v[40:43]
buffer_load_dwordx4 v[132:135], v1, s[28:31], s52 offen offset:0 sc1
ds_read_b128 a[52:55], v9 offset:37120
v_mov_b32_dpp v84, v28 row_newbcast:0 row_mask:0xf bank_mask:0xf
v_mov_b32_dpp v85, v28 row_newbcast:1 row_mask:0xf bank_mask:0xf
v_mov_b32_dpp v86, v28 row_newbcast:2 row_mask:0xf bank_mask:0xf
s_waitcnt lgkmcnt(3)
v_mfma_f32_16x16x32_bf16 v[36:39], a[60:63], a[12:15], v[36:39]
ds_read_b128 a[56:59], v9 offset:25088
v_mov_b32_dpp v87, v28 row_newbcast:3 row_mask:0xf bank_mask:0xf
v_mov_b32_dpp v88, v28 row_newbcast:4 row_mask:0xf bank_mask:0xf
v_mov_b32_dpp v89, v28 row_newbcast:5 row_mask:0xf bank_mask:0xf
v_mov_b32_dpp v90, v28 row_newbcast:6 row_mask:0xf bank_mask:0xf
s_waitcnt lgkmcnt(3)
v_mfma_f32_16x16x32_bf16 v[40:43], a[64:67], a[12:15], v[40:43]
ds_read_b128 a[60:63], v9 offset:37376
v_mov_b32_dpp v91, v28 row_newbcast:7 row_mask:0xf bank_mask:0xf
v_fma_f32 v44, v44, v84, v15
v_fma_f32 v45, v45, v85, v15
v_fma_f32 v46, v46, v86, v15
s_waitcnt lgkmcnt(3)
v_mfma_f32_16x16x32_bf16 v[36:39], a[48:51], a[16:19], v[36:39]
s_waitcnt lgkmcnt(2)
buffer_load_dwordx4 v[136:139], v1, s[28:31], s52 offen offset:1024 sc1
ds_read_b128 a[64:67], v10 offset:24576
v_fma_f32 v47, v47, v87, v15
v_fma_f32 v48, v48, v88, v15
s_add_u32 s52, s27, 36864
v_fma_f32 v49, v49, v89, v15
v_fma_f32 v50, v50, v90, v15
v_mfma_f32_16x16x32_bf16 v[40:43], a[52:55], a[16:19], v[40:43]
s_waitcnt lgkmcnt(2)
ds_read_b128 a[48:51], v10 offset:36864
v_fma_f32 v51, v51, v91, v15
v_exp_f32 v76, v44
v_exp_f32 v77, v45
v_mfma_f32_16x16x32_bf16 v[36:39], a[56:59], a[20:23], v[36:39]
s_waitcnt lgkmcnt(2)
buffer_load_dwordx4 a[68:71], v1, s[28:31], s52 offen offset:0 sc1
ds_read_b128 a[52:55], v10 offset:24832
v_exp_f32 v78, v46
v_exp_f32 v79, v47
v_exp_f32 v80, v48
v_exp_f32 v81, v49
v_mfma_f32_16x16x32_bf16 v[40:43], a[60:63], a[20:23], v[40:43]
s_waitcnt lgkmcnt(2)
ds_read_b128 a[56:59], v10 offset:37120
v_exp_f32 v82, v50
v_exp_f32 v83, v51
v_add_f32 v32, v76, v77
v_add_f32 v33, v78, v79
v_mfma_f32_16x16x32_bf16 v[36:39], a[64:67], a[24:27], v[36:39]
s_waitcnt lgkmcnt(2)
buffer_load_dwordx4 a[72:75], v1, s[28:31], s52 offen offset:1024 sc1
ds_read_b128 a[60:63], v10 offset:25088
v_add_f32 v34, v80, v81
v_add_f32 v35, v82, v83
v_add_f32 v32, v32, v33
v_add_f32 v34, v34, v35
v_mfma_f32_16x16x32_bf16 v[40:43], a[48:51], a[24:27], v[40:43]
s_waitcnt lgkmcnt(2)
ds_read_b128 a[64:67], v10 offset:37376
v_add_f32 v32, v32, v34
v_cmp_nge_f32 vcc, s55, v32
v_mfma_f32_16x16x32_bf16 v[36:39], a[52:55], a[28:31], v[36:39]
s_waitcnt lgkmcnt(2)
ds_read_b128 a[48:51], v11 offset:24576
v_add_u32 v8, 0xc000, v8
v_mfma_f32_16x16x32_bf16 v[40:43], a[56:59], a[28:31], v[40:43]
buffer_load_dwordx4 a[76:79], v1, s[28:31], s52 offen offset:2048 sc1
ds_read_b128 a[52:55], v11 offset:36864
s_waitcnt lgkmcnt(3)
v_mfma_f32_16x16x32_bf16 v[36:39], a[60:63], a[32:35], v[36:39]
s_waitcnt lgkmcnt(2)
ds_read_b128 a[56:59], v11 offset:24832
v_add_u32 v9, 0xc000, v9
v_add_u32 v10, 0xc000, v10
v_mfma_f32_16x16x32_bf16 v[40:43], a[64:67], a[32:35], v[40:43]
s_waitcnt lgkmcnt(2)
ds_read_b128 a[60:63], v11 offset:37120
ds_read_b128 a[64:67], v11 offset:25088
v_mfma_f32_16x16x32_bf16 v[36:39], a[48:51], a[36:39], v[36:39]
buffer_load_dwordx4 a[80:83], v1, s[28:31], s52 offen offset:3072 sc1
ds_read_b128 a[48:51], v11 offset:37376
s_add_u32 s52, s52, 4096
s_cbranch_vccnz RARE5b
C_5b:
v_add_f32 v16, v16, v32
v_mul_f32 v84, v76, v84
v_mul_f32 v85, v77, v85
v_mul_f32 v86, v78, v86
v_mul_f32 v87, v79, v87
v_mul_f32 v88, v80, v88
v_mul_f32 v89, v81, v89
v_mul_f32 v90, v82, v90
v_mul_f32 v91, v83, v91
v_cvt_pk_bf16_f32 v60, v84, v85
v_cvt_pk_bf16_f32 v61, v86, v87
v_cvt_pk_bf16_f32 v62, v88, v89
v_cvt_pk_bf16_f32 v63, v90, v91
v_add_f32 v68, v68, v84
v_add_f32 v68, v68, v88
v_add_f32 v69, v69, v85
v_add_f32 v69, v69, v89
v_add_f32 v70, v70, v86
s_waitcnt lgkmcnt(1)
v_mfma_f32_16x16x32_bf16 v[40:43], a[52:55], a[36:39], v[40:43]
buffer_load_dwordx4 a[84:87], v1, s[28:31], s52 offen offset:0 sc1
ds_write_b128 v13, v[60:63] offset:4096
v_add_f32 v70, v70, v90
v_add_f32 v71, v71, v87
v_add_f32 v71, v71, v91
v_mfma_f32_16x16x32_bf16 v[36:39], a[56:59], a[40:43], v[36:39]
v_add_u32 v11, 0xc000, v11
v_mfma_f32_16x16x32_bf16 v[40:43], a[60:63], a[40:43], v[40:43]
buffer_load_dwordx4 a[88:91], v1, s[28:31], s52 offen offset:1024 sc1
s_add_u32 s52, s27, 55296
s_waitcnt lgkmcnt(0)
s_barrier
buffer_load_dwordx4 v[140:143], v1, s[28:31], s52 offen offset:0 sc1
ds_read2_b64 v[28:31], v12 offset0:0 offset1:2
v_mfma_f32_16x16x32_bf16 v[36:39], a[64:67], a[44:47], v[36:39]
v_mfma_f32_16x16x32_bf16 v[40:43], a[48:51], a[44:47], v[40:43]
ds_read2_b64 v[32:35], v12 offset0:4 offset1:6
buffer_load_dwordx4 v[144:147], v1, s[28:31], s52 offen offset:1024 sc1
ds_read_b128 a[52:55], v8 offset:0
ds_read_b128 a[56:59], v8 offset:12288
s_waitcnt lgkmcnt(3)
v_add_f32 v28, v28, v30
v_add_f32 v29, v29, v31
v_add_f32 v28, v28, v26
v_add_f32 v29, v29, v27
ds_read_b128 a[60:63], v8 offset:256
buffer_load_dwordx4 v[148:151], v1, s[28:31], s52 offen offset:2048 sc1
ds_read_b128 a[64:67], v8 offset:12544
s_waitcnt lgkmcnt(4)
v_add_f32 v32, v32, v34
v_add_f32 v33, v33, v35
v_add_f32 v28, v28, v32
v_add_f32 v29, v29, v33
v_mul_f32 v29, s53, v29
s_waitcnt lgkmcnt(2)
v_mfma_f32_16x16x32_bf16 v[44:47], a[52:55], a[0:3], v[56:59]
ds_read_b128 a[48:51], v8 offset:512
v_mul_f32 v28, s53, v28
v_fma_f32 v28, -v29, v29, v28
v_max_f32 v28, 0, v28
v_mfma_f32_16x16x32_bf16 v[48:51], a[56:59], a[0:3], v[56:59]
ds_read_b128 a[52:55], v8 offset:12800
buffer_load_dwordx4 v[152:155], v1, s[28:31], s52 offen offset:3072 sc1
ds_read_b128 a[56:59], v9 offset:0
v_add_f32 v28, s54, v28
v_rsq_f32 v28, v28
v_fmac_f32_dpp v36, v29, v17 row_newbcast:0 row_mask:0xf bank_mask:0xf
v_fmac_f32_dpp v37, v29, v17 row_newbcast:1 row_mask:0xf bank_mask:0xf
s_waitcnt lgkmcnt(4)
v_mfma_f32_16x16x32_bf16 v[44:47], a[60:63], a[4:7], v[44:47]
s_add_u32 s52, s52, 4096
ds_read_b128 a[60:63], v9 offset:12288
v_fmac_f32_dpp v38, v29, v17 row_newbcast:2 row_mask:0xf bank_mask:0xf
v_fmac_f32_dpp v39, v29, v17 row_newbcast:3 row_mask:0xf bank_mask:0xf
v_fmac_f32_dpp v40, v29, v17 row_newbcast:4 row_mask:0xf bank_mask:0xf
s_waitcnt lgkmcnt(4)
v_mfma_f32_16x16x32_bf16 v[48:51], a[64:67], a[4:7], v[48:51]
ds_read_b128 a[64:67], v9 offset:256
buffer_load_dwordx4 v[156:159], v1, s[28:31], s52 offen offset:0 sc1
v_fmac_f32_dpp v41, v29, v17 row_newbcast:5 row_mask:0xf bank_mask:0xf
v_fmac_f32_dpp v42, v29, v17 row_newbcast:6 row_mask:0xf bank_mask:0xf
v_fmac_f32_dpp v43, v29, v17 row_newbcast:7 row_mask:0xf bank_mask:0xf
s_waitcnt lgkmcnt(4)
v_mfma_f32_16x16x32_bf16 v[44:47], a[48:51], a[8:11], v[44:47]
ds_read_b128 a[48:51], v9 offset:12544
v_mov_b32_dpp v84, v28 row_newbcast:0 row_mask:0xf bank_mask:0xf
v_mov_b32_dpp v85, v28 row_newbcast:1 row_mask:0xf bank_mask:0xf
v_mov_b32_dpp v86, v28 row_newbcast:2 row_mask:0xf bank_mask:0xf
s_waitcnt lgkmcnt(3)
v_mfma_f32_16x16x32_bf16 v[48:51], a[52:55], a[8:11], v[48:51]
ds_read_b128 a[52:55], v9 offset:512
v_mov_b32_dpp v87, v28 row_newbcast:3 row_mask:0xf bank_mask:0xf
v_mov_b32_dpp v88, v28 row_newbcast:4 row_mask:0xf bank_mask:0xf
v_mov_b32_dpp v89, v28 row_newbcast:5 row_mask:0xf bank_mask:0xf
v_mov_b32_dpp v90, v28 row_newbcast:6 row_mask:0xf bank_mask:0xf
v_mfma_f32_16x16x32_bf16 v[44:47], a[56:59], a[12:15], v[44:47]
ds_read_b128 a[56:59], v9 offset:12800
buffer_load_dwordx4 a[92:95], v1, s[28:31], s52 offen offset:1024 sc1
v_mov_b32_dpp v91, v28 row_newbcast:7 row_mask:0xf bank_mask:0xf
v_fma_f32 v36, v36, v84, v15
v_fma_f32 v37, v37, v85, v15
s_waitcnt lgkmcnt(3)
v_mfma_f32_16x16x32_bf16 v[48:51], a[60:63], a[12:15], v[48:51]
ds_read_b128 a[60:63], v10 offset:0
v_fma_f32 v38, v38, v86, v15
v_fma_f32 v39, v39, v87, v15
v_fma_f32 v40, v40, v88, v15
v_mfma_f32_16x16x32_bf16 v[44:47], a[64:67], a[16:19], v[44:47]
s_waitcnt lgkmcnt(3)
ds_read_b128 a[64:67], v10 offset:12288
v_fma_f32 v41, v41, v89, v15
v_fma_f32 v42, v42, v90, v15
v_fma_f32 v43, v43, v91, v15
v_mfma_f32_16x16x32_bf16 v[48:51], a[48:51], a[16:19], v[48:51]
s_waitcnt lgkmcnt(3)
ds_read_b128 a[48:51], v10 offset:256
v_exp_f32 v76, v36
v_exp_f32 v77, v37
v_exp_f32 v78, v38
v_exp_f32 v79, v39
v_mfma_f32_16x16x32_bf16 v[44:47], a[52:55], a[20:23], v[44:47]
s_waitcnt lgkmcnt(2)
ds_read_b128 a[52:55], v10 offset:12544
v_exp_f32 v80, v40
v_exp_f32 v81, v41
v_exp_f32 v82, v42
v_mfma_f32_16x16x32_bf16 v[48:51], a[56:59], a[20:23], v[48:51]
ds_read_b128 a[56:59], v10 offset:512
v_exp_f32 v83, v43
v_add_f32 v32, v76, v77
v_add_f32 v33, v78, v79
v_mfma_f32_16x16x32_bf16 v[44:47], a[60:63], a[24:27], v[44:47]
s_waitcnt lgkmcnt(2)
ds_read_b128 a[60:63], v10 offset:12800
v_add_f32 v34, v80, v81
v_add_f32 v35, v82, v83
v_add_f32 v32, v32, v33
v_mfma_f32_16x16x32_bf16 v[48:51], a[64:67], a[24:27], v[48:51]
ds_read_b128 a[64:67], v11 offset:0
v_add_f32 v34, v34, v35
v_add_f32 v32, v32, v34
v_cmp_nge_f32 vcc, s55, v32
s_nop 0
s_cbranch_vccnz RARE6b
C_6b:
v_mfma_f32_16x16x32_bf16 v[44:47], a[48:51], a[28:31], v[44:47]
s_waitcnt lgkmcnt(3)
s_add_u32 s52, s27, 61440
ds_read_b128 a[48:51], v11 offset:12288
v_add_f32 v16, v16, v32
v_mul_f32 v84, v76, v84
v_mul_f32 v85, v77, v85
v_mfma_f32_16x16x32_bf16 v[48:51], a[52:55], a[28:31], v[48:51]
s_waitcnt lgkmcnt(3)
ds_read_b128 a[52:55], v11 offset:256
v_mul_f32 v86, v78, v86
v_mul_f32 v87, v79, v87
v_mul_f32 v88, v80, v88
v_mfma_f32_16x16x32_bf16 v[44:47], a[56:59], a[32:35], v[44:47]
s_waitcnt lgkmcnt(3)
ds_read_b128 a[56:59], v11 offset:12544
v_mul_f32 v89, v81, v89
v_mul_f32 v90, v82, v90
v_mul_f32 v91, v83, v91
v_mfma_f32_16x16x32_bf16 v[48:51], a[60:63], a[32:35], v[48:51]
s_waitcnt lgkmcnt(3)
ds_read_b128 a[60:63], v11 offset:512
v_cvt_pk_bf16_f32 v60, v84, v85
v_cvt_pk_bf16_f32 v61, v86, v87
v_cvt_pk_bf16_f32 v62, v88, v89
v_cvt_pk_bf16_f32 v63, v90, v91
v_mfma_f32_16x16x32_bf16 v[44:47], a[64:67], a[36:39], v[44:47]
s_waitcnt lgkmcnt(3)
ds_write_b128 v13, v[60:63] offset:0
v_add_f32 v72, v84, v88
v_add_f32 v73, v85, v89
v_mfma_f32_16x16x32_bf16 v[48:51], a[48:51], a[36:39], v[48:51]
s_waitcnt lgkmcnt(3)
v_add_f32 v74, v86, v90
v_add_f32 v75, v87, v91
v_mfma_f32_16x16x32_bf16 v[44:47], a[52:55], a[40:43], v[44:47]
s_waitcnt lgkmcnt(2)
v_mfma_f32_16x16x32_bf16 v[48:51], a[56:59], a[40:43], v[48:51]
ds_read_b128 a[64:67], v11 offset:12800
s_waitcnt lgkmcnt(0)
s_barrier
buffer_load_dwordx4 a[0:3], v1, s[28:31], s52 offen offset:0 sc1
ds_read2_b64 v[28:31], v12 offset0:160 offset1:162
v_mfma_f32_16x16x32_bf16 v[44:47], a[60:63], a[44:47], v[44:47]
v_mfma_f32_16x16x32_bf16 v[48:51], a[64:67], a[44:47], v[48:51]
ds_read2_b64 v[32:35], v12 offset0:164 offset1:166
v_and_b32 v12, 15, v0
v_lshlrev_b32 v14, 4, v12
v_lshlrev_b32 v12, 8, v12
buffer_load_dwordx4 a[4:7], v1, s[28:31], s52 offen offset:1024 sc1
s_waitcnt lgkmcnt(1)
v_add_f32 v28, v28, v30
v_add_f32 v29, v29, v31
v_add_f32 v28, v28, v26
v_add_f32 v29, v29, v27
buffer_load_dwordx4 a[8:11], v1, s[28:31], s52 offen offset:2048 sc1
s_waitcnt lgkmcnt(0)
v_add_f32 v32, v32, v34
v_add_f32 v33, v33, v35
v_add_f32 v28, v28, v32
v_add_f32 v29, v29, v33
v_mul_f32 v29, s53, v29
v_mul_f32 v28, s53, v28
v_fma_f32 v28, -v29, v29, v28
v_max_f32 v28, 0, v28
v_add_f32 v28, s54, v28
v_rsq_f32 v28, v28
v_fmac_f32_dpp v44, v29, v17 row_newbcast:0 row_mask:0xf bank_mask:0xf
v_fmac_f32_dpp v45, v29, v17 row_newbcast:1 row_mask:0xf bank_mask:0xf
v_fmac_f32_dpp v46, v29, v17 row_newbcast:2 row_mask:0xf bank_mask:0xf
v_fmac_f32_dpp v47, v29, v17 row_newbcast:3 row_mask:0xf bank_mask:0xf
v_fmac_f32_dpp v48, v29, v17 row_newbcast:4 row_mask:0xf bank_mask:0xf
v_fmac_f32_dpp v49, v29, v17 row_newbcast:5 row_mask:0xf bank_mask:0xf
v_fmac_f32_dpp v50, v29, v17 row_newbcast:6 row_mask:0xf bank_mask:0xf
v_fmac_f32_dpp v51, v29, v17 row_newbcast:7 row_mask:0xf bank_mask:0xf
v_mov_b32_dpp v84, v28 row_newbcast:0 row_mask:0xf bank_mask:0xf
v_mov_b32_dpp v85, v28 row_newbcast:1 row_mask:0xf bank_mask:0xf
v_mov_b32_dpp v86, v28 row_newbcast:2 row_mask:0xf bank_mask:0xf
v_mov_b32_dpp v87, v28 row_newbcast:3 row_mask:0xf bank_mask:0xf
v_mov_b32_dpp v88, v28 row_newbcast:4 row_mask:0xf bank_mask:0xf
v_mov_b32_dpp v89, v28 row_newbcast:5 row_mask:0xf bank_mask:0xf
v_mov_b32_dpp v90, v28 row_newbcast:6 row_mask:0xf bank_mask:0xf
v_mov_b32_dpp v91, v28 row_newbcast:7 row_mask:0xf bank_mask:0xf
v_fma_f32 v44, v44, v84, v15
v_fma_f32 v45, v45, v85, v15
v_fma_f32 v46, v46, v86, v15
v_fma_f32 v47, v47, v87, v15
v_fma_f32 v48, v48, v88, v15
v_fma_f32 v49, v49, v89, v15
v_fma_f32 v50, v50, v90, v15
v_fma_f32 v51, v51, v91, v15
v_exp_f32 v76, v44
v_exp_f32 v77, v45
v_exp_f32 v78, v46
v_exp_f32 v79, v47
v_exp_f32 v80, v48
v_exp_f32 v81, v49
v_exp_f32 v82, v50
v_exp_f32 v83, v51
v_add_f32 v32, v76, v77
v_add_f32 v33, v78, v79
v_add_f32 v34, v80, v81
v_add_f32 v35, v82, v83
v_add_f32 v32, v32, v33
v_add_f32 v34, v34, v35
v_add_f32 v32, v32, v34
v_cmp_nge_f32 vcc, s55, v32
buffer_load_dwordx4 a[12:15], v1, s[28:31], s52 offen offset:3072 sc1
s_add_u32 s52, s52, 4096
s_cbranch_vccnz RARE7b
C_7b:
v_add_f32 v16, v16, v32
v_mul_f32 v84, v76, v84
v_mul_f32 v85, v77, v85
v_mul_f32 v86, v78, v86
v_mul_f32 v87, v79, v87
v_mul_f32 v88, v80, v88
v_mul_f32 v89, v81, v89
v_mul_f32 v90, v82, v90
v_mul_f32 v91, v83, v91
v_cvt_pk_bf16_f32 v60, v84, v85
v_cvt_pk_bf16_f32 v61, v86, v87
v_cvt_pk_bf16_f32 v62, v88, v89
v_cvt_pk_bf16_f32 v63, v90, v91
v_add_f32 v72, v72, v84
v_add_f32 v72, v72, v88
v_add_f32 v73, v73, v85
v_add_f32 v73, v73, v89
v_add_f32 v74, v74, v86
v_add_f32 v74, v74, v90
v_add_f32 v75, v75, v87
v_add_f32 v75, v75, v91
v_cvt_pk_bf16_f32 v64, v68, v69
v_cvt_pk_bf16_f32 v65, v70, v71
v_cvt_pk_bf16_f32 v66, v72, v73
v_cvt_pk_bf16_f32 v67, v74, v75
v_mov_b32 v28, v16
buffer_load_dwordx4 a[16:19], v1, s[28:31], s52 offen offset:0 sc1
ds_write_b128 v13, v[60:63] offset:4096
v_permlane32_swap_b32 v16, v28
v_add_f32 v16, v16, v28
v_mov_b32 v28, v16
s_nop 1
v_permlane16_swap_b32 v16, v28
v_add_f32 v16, v16, v28
ds_write_b128 v13, v[64:67] offset:8192
v_and_b32 v13, 48, v0
v_add_u32 v12, v12, v13
buffer_load_dwordx4 a[20:23], v1, s[28:31], s52 offen offset:1024 sc1
s_add_u32 s52, s27, 12288
s_waitcnt lgkmcnt(0)
s_barrier
buffer_load_dwordx4 a[24:27], v1, s[28:31], s52 offen offset:0 sc1
buffer_load_dwordx4 a[28:31], v1, s[28:31], s52 offen offset:1024 sc1
buffer_load_dwordx4 a[32:35], v1, s[28:31], s52 offen offset:2048 sc1
buffer_load_dwordx4 a[36:39], v1, s[28:31], s52 offen offset:3072 sc1
s_add_u32 s52, s52, 4096
buffer_load_dwordx4 a[40:43], v1, s[28:31], s52 offen offset:0 sc1
buffer_load_dwordx4 a[44:47], v1, s[28:31], s52 offen offset:1024 sc1
s_add_u32 s52, s27, 30720
buffer_load_dwordx4 a[48:51], v1, s[28:31], s52 offen offset:0 sc1
buffer_load_dwordx4 a[52:55], v1, s[28:31], s52 offen offset:1024 sc1
buffer_load_dwordx4 a[56:59], v1, s[28:31], s52 offen offset:2048 sc1
buffer_load_dwordx4 a[60:63], v1, s[28:31], s52 offen offset:3072 sc1
s_add_u32 s52, s52, 4096
buffer_load_dwordx4 a[64:67], v1, s[28:31], s52 offen offset:0 sc1
buffer_load_dwordx4 v[20:23], v1, s[28:31], s52 offen offset:1024 sc1
s_add_u32 s52, s27, 49152
buffer_load_dwordx4 v[68:71], v1, s[28:31], s52 offen offset:0 sc1
buffer_load_dwordx4 v[72:75], v1, s[28:31], s52 offen offset:1024 sc1
buffer_load_dwordx4 v[76:79], v1, s[28:31], s52 offen offset:2048 sc1
buffer_load_dwordx4 v[80:83], v1, s[28:31], s52 offen offset:3072 sc1
s_add_u32 s52, s52, 4096
s_add_u32 s50, s50, 49152
v_add_u32 v8, s50, v1
s_add_u32 s50, s24, 24576
v_add_u32 v9, s50, v1
s_add_u32 s50, s24, 122880
v_add_u32 v10, s50, v1
s_add_u32 s50, s24, 0
v_add_u32 v11, s50, v1
s_lshl_b32 s50, s2, 14
s_lshl_b32 s51, s3, 12
s_add_u32 s50, s50, s51
s_lshr_b32 s51, s50, 4
s_add_u32 s50, s50, 524288
s_add_u32 s51, s51, 4718592
buffer_load_dwordx4 v[84:87], v1, s[28:31], s52 offen offset:0 sc1
buffer_load_dwordx4 v[88:91], v1, s[28:31], s52 offen offset:1024 sc1
s_barrier
s_add_u32 s52, s27, 67584
ds_read_b128 v[28:31], v8 offset:0
ds_read_b128 v[32:35], v8 offset:3072
ds_read_b128 v[60:63], v8 offset:6144
ds_read_b128 v[64:67], v8 offset:9216
s_waitcnt vmcnt(42) lgkmcnt(3)
v_mfma_f32_16x16x32_bf16 v[36:39], v[92:95], v[28:31], 0
buffer_load_dwordx4 v[92:95], v1, s[28:31], s52 offen offset:0 sc1
v_mfma_f32_16x16x32_bf16 v[40:43], v[96:99], v[28:31], 0
v_mfma_f32_16x16x32_bf16 v[44:47], v[100:103], v[28:31], 0
v_mfma_f32_16x16x32_bf16 v[48:51], v[104:107], v[28:31], 0
v_mfma_f32_16x16x32_bf16 v[52:55], v[108:111], v[28:31], 0
buffer_load_dwordx4 v[96:99], v1, s[28:31], s52 offen offset:1024 sc1
v_mfma_f32_16x16x32_bf16 v[56:59], v[112:115], v[28:31], 0
s_waitcnt vmcnt(38) lgkmcnt(0)
v_mfma_f32_16x16x32_bf16 v[36:39], v[116:119], v[32:35], v[36:39]
ds_read_b128 v[116:119], v9 offset:0
v_mfma_f32_16x16x32_bf16 v[40:43], v[120:123], v[32:35], v[40:43]
ds_read_b128 v[120:123], v9 offset:1024
v_mfma_f32_16x16x32_bf16 v[44:47], v[124:127], v[32:35], v[44:47]
buffer_load_dwordx4 v[100:103], v1, s[28:31], s52 offen offset:2048 sc1
ds_read_b128 v[124:127], v9 offset:2048
v_mfma_f32_16x16x32_bf16 v[48:51], v[128:131], v[32:35], v[48:51]
ds_read_b128 v[128:131], v9 offset:3072
v_mfma_f32_16x16x32_bf16 v[52:55], v[132:135], v[32:35], v[52:55]
ds_read_b128 v[132:135], v9 offset:4096
v_mfma_f32_16x16x32_bf16 v[56:59], v[136:139], v[32:35], v[56:59]
ds_read_b128 v[136:139], v9 offset:5120
s_waitcnt vmcnt(33)
v_mfma_f32_16x16x32_bf16 v[36:39], a[68:71], v[60:63], v[36:39]
buffer_load_dwordx4 v[104:107], v1, s[28:31], s52 offen offset:3072 sc1
ds_read_b128 a[68:71], v10 offset:0
s_add_u32 s52, s52, 4096
v_mfma_f32_16x16x32_bf16 v[40:43], a[72:75], v[60:63], v[40:43]
ds_read_b128 a[72:75], v10 offset:1024
v_mfma_f32_16x16x32_bf16 v[44:47], a[76:79], v[60:63], v[44:47]
ds_read_b128 a[76:79], v10 offset:2048
v_mfma_f32_16x16x32_bf16 v[48:51], a[80:83], v[60:63], v[48:51]
ds_read_b128 a[80:83], v10 offset:3072
v_mfma_f32_16x16x32_bf16 v[52:55], a[84:87], v[60:63], v[52:55]
buffer_load_dwordx4 v[108:111], v1, s[28:31], s52 offen offset:0 sc1
ds_read_b128 a[84:87], v10 offset:4096
v_mfma_f32_16x16x32_bf16 v[56:59], a[88:91], v[60:63], v[56:59]
ds_read_b128 a[88:91], v10 offset:5120
s_waitcnt vmcnt(29)
v_mfma_f32_16x16x32_bf16 v[36:39], v[140:143], v[64:67], v[36:39]
ds_read_b128 v[140:143], v11 offset:0
v_mfma_f32_16x16x32_bf16 v[40:43], v[144:147], v[64:67], v[40:43]
ds_read_b128 v[144:147], v11 offset:1024
buffer_load_dwordx4 v[112:115], v1, s[28:31], s52 offen offset:1024 sc1
v_mfma_f32_16x16x32_bf16 v[44:47], v[148:151], v[64:67], v[44:47]
ds_read_b128 v[148:151], v11 offset:2048
v_mfma_f32_16x16x32_bf16 v[48:51], v[152:155], v[64:67], v[48:51]
s_barrier
ds_read_b128 v[152:155], v11 offset:3072
v_mfma_f32_16x16x32_bf16 v[52:55], v[156:159], v[64:67], v[52:55]
ds_read_b128 v[156:159], v11 offset:4096
v_mfma_f32_16x16x32_bf16 v[56:59], a[92:95], v[64:67], v[56:59]
ds_read_b128 a[92:95], v11 offset:5120
ds_read_b128 v[28:31], v8 offset:1024
ds_read_b128 v[32:35], v8 offset:4096
ds_read_b128 v[60:63], v8 offset:7168
ds_read_b128 v[64:67], v8 offset:10240
s_waitcnt lgkmcnt(3)
v_mfma_f32_16x16x32_bf16 v[36:39], v[116:119], v[28:31], v[36:39]
v_mfma_f32_16x16x32_bf16 v[40:43], v[120:123], v[28:31], v[40:43]
v_mfma_f32_16x16x32_bf16 v[44:47], v[124:127], v[28:31], v[44:47]
v_mfma_f32_16x16x32_bf16 v[48:51], v[128:131], v[28:31], v[48:51]
s_waitcnt lgkmcnt(0)
s_barrier
v_mfma_f32_16x16x32_bf16 v[52:55], v[132:135], v[28:31], v[52:55]
v_mfma_f32_16x16x32_bf16 v[56:59], v[136:139], v[28:31], v[56:59]
ds_read_b128 v[28:31], v8 offset:2048
v_mfma_f32_16x16x32_bf16 v[36:39], a[68:71], v[32:35], v[36:39]
v_mfma_f32_16x16x32_bf16 v[40:43], a[72:75], v[32:35], v[40:43]
v_mfma_f32_16x16x32_bf16 v[44:47], a[76:79], v[32:35], v[44:47]
v_mfma_f32_16x16x32_bf16 v[48:51], a[80:83], v[32:35], v[48:51]
v_mfma_f32_16x16x32_bf16 v[52:55], a[84:87], v[32:35], v[52:55]
v_mfma_f32_16x16x32_bf16 v[56:59], a[88:91], v[32:35], v[56:59]
ds_read_b128 v[32:35], v8 offset:5120
v_mfma_f32_16x16x32_bf16 v[36:39], v[140:143], v[60:63], v[36:39]
v_mov_b32 v143, s38
v_mfma_f32_16x16x32_bf16 v[40:43], v[144:147], v[60:63], v[40:43]
v_mov_b32 v147, s38
v_mfma_f32_16x16x32_bf16 v[44:47], v[148:151], v[60:63], v[44:47]
v_mov_b32 v151, s38
v_mfma_f32_16x16x32_bf16 v[48:51], v[152:155], v[60:63], v[48:51]
v_mov_b32 v155, s38
v_mfma_f32_16x16x32_bf16 v[52:55], v[156:159], v[60:63], v[52:55]
v_sub_f32 v156, 0, v15
v_mov_b32 v157, v16
v_mfma_f32_16x16x32_bf16 v[56:59], a[92:95], v[60:63], v[56:59]
ds_read_b128 v[60:63], v8 offset:8192
v_mov_b32 v158, s38
s_waitcnt vmcnt(24)
v_mfma_f32_16x16x32_bf16 v[36:39], a[0:3], v[64:67], v[36:39]
v_mov_b32 v159, s38
v_mfma_f32_16x16x32_bf16 v[40:43], a[4:7], v[64:67], v[40:43]
v_mfma_f32_16x16x32_bf16 v[44:47], a[8:11], v[64:67], v[44:47]
v_mfma_f32_16x16x32_bf16 v[48:51], a[12:15], v[64:67], v[48:51]
v_mfma_f32_16x16x32_bf16 v[52:55], a[16:19], v[64:67], v[52:55]
v_mfma_f32_16x16x32_bf16 v[56:59], a[20:23], v[64:67], v[56:59]
ds_read_b128 v[64:67], v8 offset:11264
s_waitcnt vmcnt(18) lgkmcnt(1)
v_mfma_f32_16x16x32_bf16 v[36:39], a[24:27], v[28:31], v[36:39]
v_mfma_f32_16x16x32_bf16 v[40:43], a[28:31], v[28:31], v[40:43]
s_waitcnt vmcnt(12)
v_mfma_f32_16x16x32_bf16 v[36:39], a[48:51], v[32:35], v[36:39]
v_mfma_f32_16x16x32_bf16 v[40:43], a[52:55], v[32:35], v[40:43]
s_waitcnt vmcnt(6)
v_mfma_f32_16x16x32_bf16 v[36:39], v[68:71], v[60:63], v[36:39]
v_mfma_f32_16x16x32_bf16 v[40:43], v[72:75], v[60:63], v[40:43]
s_waitcnt vmcnt(0) lgkmcnt(0)
v_mfma_f32_16x16x32_bf16 v[36:39], v[92:95], v[64:67], v[36:39]
v_mfma_f32_16x16x32_bf16 v[40:43], v[96:99], v[64:67], v[40:43]
v_mfma_f32_16x16x32_bf16 v[44:47], a[32:35], v[28:31], v[44:47]
s_nop 5
v_cvt_pk_bf16_f32 v140, v36, v37
v_mfma_f32_16x16x32_bf16 v[44:47], a[56:59], v[32:35], v[44:47]
v_cvt_pk_bf16_f32 v141, v38, v39
v_cvt_pk_bf16_f32 v142, v40, v41
v_mfma_f32_16x16x32_bf16 v[44:47], v[76:79], v[60:63], v[44:47]
buffer_store_dwordx4 v[140:143], v12, s[28:31], s50 offen offset:0 sc0 sc1
v_cvt_pk_bf16_f32 v144, v42, v43
v_mfma_f32_16x16x32_bf16 v[44:47], v[100:103], v[64:67], v[44:47]
v_mfma_f32_16x16x32_bf16 v[48:51], a[36:39], v[28:31], v[48:51]
v_mfma_f32_16x16x32_bf16 v[52:55], a[40:43], v[28:31], v[52:55]
s_nop 5
v_cvt_pk_bf16_f32 v145, v44, v45
v_mfma_f32_16x16x32_bf16 v[48:51], a[60:63], v[32:35], v[48:51]
v_cvt_pk_bf16_f32 v146, v46, v47
v_mfma_f32_16x16x32_bf16 v[52:55], a[64:67], v[32:35], v[52:55]
buffer_store_dwordx4 v[144:147], v12, s[28:31], s50 offen offset:64 sc0 sc1
v_mfma_f32_16x16x32_bf16 v[48:51], v[80:83], v[60:63], v[48:51]
v_mfma_f32_16x16x32_bf16 v[52:55], v[84:87], v[60:63], v[52:55]
v_mfma_f32_16x16x32_bf16 v[48:51], v[104:107], v[64:67], v[48:51]
v_mfma_f32_16x16x32_bf16 v[52:55], v[108:111], v[64:67], v[52:55]
v_mfma_f32_16x16x32_bf16 v[56:59], a[44:47], v[28:31], v[56:59]
s_nop 5
v_cvt_pk_bf16_f32 v148, v48, v49
v_mfma_f32_16x16x32_bf16 v[56:59], v[20:23], v[32:35], v[56:59]
v_cvt_pk_bf16_f32 v149, v50, v51
v_cvt_pk_bf16_f32 v150, v52, v53
v_mfma_f32_16x16x32_bf16 v[56:59], v[88:91], v[60:63], v[56:59]
buffer_store_dwordx4 v[148:151], v12, s[28:31], s50 offen offset:128 sc0 sc1
v_cvt_pk_bf16_f32 v152, v54, v55
v_mfma_f32_16x16x32_bf16 v[56:59], v[112:115], v[64:67], v[56:59]
s_nop 7
v_cvt_pk_bf16_f32 v153, v56, v57
v_cvt_pk_bf16_f32 v154, v58, v59
buffer_store_dwordx4 v[152:155], v12, s[28:31], s50 offen offset:192 sc0 sc1
buffer_store_dwordx4 v[156:159], v14, s[28:31], s51 offen sc0 sc1
s_branch K_fin
T_red:
s_cmp_lt_u32 s57, 64
s_cbranch_scc0 K_fin
s_load_dwordx2 s[4:5], s[0:1], 0
s_load_dwordx2 s[8:9], s[0:1], 72
s_lshr_b32 s40, s57, 2
s_and_b32 s41, s57, 3
v_mov_b32 v1, s39
v_mov_b32 v2, v0
v_lshl_add_u32 v0, v1, 6, v2
v_mul_u32_u24 v5, 12, v2
s_mul_i32 s42, s41, 73728
s_mul_i32 s43, s39, 9216
s_add_u32 s42, s42, s43
buffer_load_dwordx3 v[96:98], v5, s[16:19], s42 offen offset:0
buffer_load_dwordx3 v[100:102], v5, s[16:19], s42 offen offset:768
buffer_load_dwordx3 v[104:106], v5, s[16:19], s42 offen offset:1536
buffer_load_dwordx3 v[108:110], v5, s[16:19], s42 offen offset:2304
s_add_u32 s42, s42, 3072
buffer_load_dwordx3 v[112:114], v5, s[16:19], s42 offen offset:0
buffer_load_dwordx3 v[116:118], v5, s[16:19], s42 offen offset:768
buffer_load_dwordx3 v[120:122], v5, s[16:19], s42 offen offset:1536
buffer_load_dwordx3 v[124:126], v5, s[16:19], s42 offen offset:2304
s_add_u32 s42, s42, 3072
buffer_load_dwordx3 v[128:130], v5, s[16:19], s42 offen offset:0
buffer_load_dwordx3 v[132:134], v5, s[16:19], s42 offen offset:768
buffer_load_dwordx3 v[136:138], v5, s[16:19], s42 offen offset:1536
buffer_load_dwordx3 v[140:142], v5, s[16:19], s42 offen offset:2304
s_add_u32 s42, s42, 3072
v_lshrrev_b32 v10, 4, v2
v_and_b32 v4, 15, v2
v_lshlrev_b32 v3, 14, v10
v_lshl_add_u32 v3, v4, 4, v3
v_and_b32 v8, 7, v2
v_lshl_add_u32 v8, v8, 2, v10
v_lshlrev_b32 v8, 10, v8
s_mov_b32 s46, 0x05040100
s_mov_b32 s47, 0x07060302
s_mov_b32 s48, 0x00ff00ff
s_mov_b32 s49, 0x00ff00ff
s_waitcnt lgkmcnt(0)
s_mov_b32 s12, s4
s_mov_b32 s13, s5
s_mov_b32 s14, 12288
s_mov_b32 s15, 0x20000
s_mov_b32 s20, s8
s_mov_b32 s21, s9
s_mov_b32 s22, 12288
s_mov_b32 s23, 0x20000
v_lshlrev_b32 v6, 2, v0
s_mul_i32 s44, s40, 768
s_mul_i32 s43, s41, 192
s_add_u32 s44, s44, s43
buffer_load_dword v7, v6, s[12:15], s44 offen
v_lshrrev_b32 v11, 2, v4
v_mul_u32_u24 v11, 3, v11
v_and_b32 v12, 3, v4
v_and_b32 v13, 1, v10
v_lshrrev_b32 v14, 1, v10
v_add_u32 v17, v11, v13
v_lshrrev_b32 v15, 1, v17
v_lshlrev_b32 v15, 4, v15
v_and_b32 v16, 1, v17
v_lshl_add_u32 v15, v16, 1, v15
v_lshl_add_u32 v15, v12, 2, v15
v_add_u32 v15, v15, v14
v_lshlrev_b32 v15, 5, v15
v_lshl_add_u32 v18, v1, 2, v15
v_add_u32 v17, 2, v11
v_lshrrev_b32 v15, 1, v17
v_lshlrev_b32 v15, 4, v15
v_and_b32 v16, 1, v17
v_lshl_add_u32 v15, v16, 1, v15
v_lshl_add_u32 v15, v12, 2, v15
v_add_u32 v15, v15, v14
v_lshlrev_b32 v15, 5, v15
v_lshl_add_u32 v19, v1, 2, v15
v_lshlrev_b32 v20, 2, v1
v_add_u32 v20, 3072, v20
v_cmp_eq_u32 vcc, 1, v13
s_nop 1
v_cndmask_b32 v19, v19, v20, vcc
v_mul_u32_u24 v21, 12, v1
v_lshrrev_b32 v22, 3, v2
v_and_b32 v23, 7, v2
v_lshlrev_b32 v23, 2, v23
v_add_u32 v9, v21, v22
v_lshl_add_u32 v9, v9, 5, v23
v_and_b32 v22, 3, v22
v_add3_u32 v21, v21, v22, 8
v_lshl_add_u32 v21, v21, 5, v23
v_add_u32 v22, 3072, v23
s_waitcnt vmcnt(11)
v_perm_b32 v99, v100, v96, s46
v_perm_b32 v103, v100, v96, s47
v_perm_b32 v96, v101, v97, s46
v_perm_b32 v100, v101, v97, s47
v_perm_b32 v97, v102, v98, s46
v_perm_b32 v101, v102, v98, s47
s_waitcnt vmcnt(9)
v_perm_b32 v107, v108, v104, s46
v_perm_b32 v111, v108, v104, s47
v_perm_b32 v104, v109, v105, s46
v_perm_b32 v108, v109, v105, s47
v_perm_b32 v105, v110, v106, s46
v_perm_b32 v109, v110, v106, s47
s_waitcnt vmcnt(7)
v_perm_b32 v115, v116, v112, s46
v_perm_b32 v119, v116, v112, s47
v_perm_b32 v112, v117, v113, s46
v_perm_b32 v116, v117, v113, s47
v_perm_b32 v113, v118, v114, s46
v_perm_b32 v117, v118, v114, s47
s_waitcnt vmcnt(5)
v_perm_b32 v123, v124, v120, s46
v_perm_b32 v127, v124, v120, s47
v_perm_b32 v120, v125, v121, s46
v_perm_b32 v124, v125, v121, s47
v_perm_b32 v121, v126, v122, s46
v_perm_b32 v125, v126, v122, s47
s_waitcnt vmcnt(3)
v_perm_b32 v131, v132, v128, s46
v_perm_b32 v135, v132, v128, s47
v_perm_b32 v128, v133, v129, s46
v_perm_b32 v132, v133, v129, s47
v_perm_b32 v129, v134, v130, s46
v_perm_b32 v133, v134, v130, s47
s_waitcnt vmcnt(1)
v_perm_b32 v139, v140, v136, s46
v_perm_b32 v143, v140, v136, s47
v_perm_b32 v136, v141, v137, s46
v_perm_b32 v140, v141, v137, s47
v_perm_b32 v137, v142, v138, s46
v_perm_b32 v141, v142, v138, s47
s_barrier
s_lshl_b32 s42, s39, 19
s_lshl_b32 s43, s41, 12
s_add_u32 s42, s42, s43
s_lshl_b32 s43, s40, 8
s_add_u32 s42, s42, s43
s_lshr_b32 s43, s42, 4
s_add_u32 s42, s42, 524288
s_add_u32 s43, s43, 4718592
s_mov_b32 s58, 1048576
T_re:
T_poll:
buffer_load_dwordx4 v[64:67], v8, s[28:31], s43 offen sc1
s_waitcnt vmcnt(0)
v_cmp_ne_u32 vcc, s38, v66
s_nop 0
s_cbranch_vccz T_ok0
s_sub_u32 s58, s58, 1
s_cbranch_scc0 T_poll
s_branch T_pd
T_ok0:
v_mov_b32 v80, v64
v_mov_b32 v81, v65
T_go:
s_add_u32 s45, s42, 0
buffer_load_dwordx4 v[32:35], v3, s[28:31], s45 offen sc1
s_add_u32 s45, s42, 65536
buffer_load_dwordx4 v[36:39], v3, s[28:31], s45 offen sc1
s_add_u32 s45, s42, 131072
buffer_load_dwordx4 v[40:43], v3, s[28:31], s45 offen sc1
s_add_u32 s45, s42, 196608
buffer_load_dwordx4 v[44:47], v3, s[28:31], s45 offen sc1
s_add_u32 s45, s42, 262144
buffer_load_dwordx4 v[48:51], v3, s[28:31], s45 offen sc1
s_add_u32 s45, s42, 327680
buffer_load_dwordx4 v[52:55], v3, s[28:31], s45 offen sc1
s_add_u32 s45, s42, 393216
buffer_load_dwordx4 v[56:59], v3, s[28:31], s45 offen sc1
s_add_u32 s45, s42, 458752
buffer_load_dwordx4 v[60:63], v3, s[28:31], s45 offen sc1
v_mov_b32 v13, v80
s_nop 1
v_max_f32_dpp v13, v13, v13 row_ror:4 row_mask:0xf bank_mask:0xf
s_nop 1
v_max_f32_dpp v13, v13, v13 row_ror:2 row_mask:0xf bank_mask:0xf
s_nop 1
v_max_f32_dpp v13, v13, v13 row_ror:1 row_mask:0xf bank_mask:0xf
v_mov_b32 v15, v13
s_nop 1
v_permlane32_swap_b32 v13, v15
v_max_f32 v13, v13, v15
v_mov_b32 v15, v13
s_nop 1
v_permlane16_swap_b32 v13, v15
v_max_f32 v13, v13, v15
v_sub_f32 v80, v80, v13
v_exp_f32 v80, v80
ds_write_b32 v20, v13 offset:32
v_cvt_pk_bf16_f32 v82, v80, 0
v_lshlrev_b32 v83, 16, v82
v_mul_f32 v30, v83, v81
s_nop 1
v_add_f32_dpp v30, v30, v30 row_ror:4 row_mask:0xf bank_mask:0xf
s_nop 1
v_add_f32_dpp v30, v30, v30 row_ror:2 row_mask:0xf bank_mask:0xf
s_nop 1
v_add_f32_dpp v30, v30, v30 row_ror:1 row_mask:0xf bank_mask:0xf
v_mov_b32_dpp v144, v82 row_newbcast:0 row_mask:0xf bank_mask:0xf
v_mov_b32_dpp v145, v83 row_newbcast:0 row_mask:0xf bank_mask:0xf
v_mov_b32_dpp v146, v82 row_newbcast:1 row_mask:0xf bank_mask:0xf
v_mov_b32_dpp v147, v83 row_newbcast:1 row_mask:0xf bank_mask:0xf
v_mov_b32_dpp v148, v82 row_newbcast:2 row_mask:0xf bank_mask:0xf
v_mov_b32_dpp v149, v83 row_newbcast:2 row_mask:0xf bank_mask:0xf
v_mov_b32_dpp v150, v82 row_newbcast:3 row_mask:0xf bank_mask:0xf
v_mov_b32_dpp v151, v83 row_newbcast:3 row_mask:0xf bank_mask:0xf
v_mov_b32_dpp v152, v82 row_newbcast:4 row_mask:0xf bank_mask:0xf
v_mov_b32_dpp v153, v83 row_newbcast:4 row_mask:0xf bank_mask:0xf
v_mov_b32_dpp v154, v82 row_newbcast:5 row_mask:0xf bank_mask:0xf
v_mov_b32_dpp v155, v83 row_newbcast:5 row_mask:0xf bank_mask:0xf
v_mov_b32_dpp v156, v82 row_newbcast:6 row_mask:0xf bank_mask:0xf
v_mov_b32_dpp v157, v83 row_newbcast:6 row_mask:0xf bank_mask:0xf
v_mov_b32_dpp v158, v82 row_newbcast:7 row_mask:0xf bank_mask:0xf
v_mov_b32_dpp v159, v83 row_newbcast:7 row_mask:0xf bank_mask:0xf
v_mov_b32 v11, s38
v_mov_b32 v12, s38
v_mov_b32 v31, v30
s_waitcnt vmcnt(7)
v_dot2_f32_bf16 v24, v32, v144, 0
v_dot2_f32_bf16 v25, v32, v145, 0
v_dot2_f32_bf16 v26, v33, v144, 0
v_dot2_f32_bf16 v27, v33, v145, 0
v_dot2_f32_bf16 v28, v34, v144, 0
v_dot2_f32_bf16 v29, v34, v145, 0
s_waitcnt vmcnt(6)
v_dot2_f32_bf16 v24, v36, v146, v24
v_dot2_f32_bf16 v25, v36, v147, v25
v_dot2_f32_bf16 v26, v37, v146, v26
v_dot2_f32_bf16 v27, v37, v147, v27
v_dot2_f32_bf16 v28, v38, v146, v28
v_dot2_f32_bf16 v29, v38, v147, v29
v_min3_u32 v11, v11, v35, v39
v_max3_u32 v12, v12, v35, v39
s_waitcnt vmcnt(5)
v_dot2_f32_bf16 v24, v40, v148, v24
v_dot2_f32_bf16 v25, v40, v149, v25
v_dot2_f32_bf16 v26, v41, v148, v26
v_dot2_f32_bf16 v27, v41, v149, v27
v_dot2_f32_bf16 v28, v42, v148, v28
v_dot2_f32_bf16 v29, v42, v149, v29
s_waitcnt vmcnt(4)
v_dot2_f32_bf16 v24, v44, v150, v24
v_dot2_f32_bf16 v25, v44, v151, v25
v_dot2_f32_bf16 v26, v45, v150, v26
v_dot2_f32_bf16 v27, v45, v151, v27
v_dot2_f32_bf16 v28, v46, v150, v28
v_dot2_f32_bf16 v29, v46, v151, v29
v_min3_u32 v11, v11, v43, v47
v_max3_u32 v12, v12, v43, v47
s_waitcnt vmcnt(3)
v_dot2_f32_bf16 v24, v48, v152, v24
v_dot2_f32_bf16 v25, v48, v153, v25
v_dot2_f32_bf16 v26, v49, v152, v26
v_dot2_f32_bf16 v27, v49, v153, v27
v_dot2_f32_bf16 v28, v50, v152, v28
v_dot2_f32_bf16 v29, v50, v153, v29
s_waitcnt vmcnt(2)
v_dot2_f32_bf16 v24, v52, v154, v24
v_dot2_f32_bf16 v25, v52, v155, v25
v_dot2_f32_bf16 v26, v53, v154, v26
v_dot2_f32_bf16 v27, v53, v155, v27
v_dot2_f32_bf16 v28, v54, v154, v28
v_dot2_f32_bf16 v29, v54, v155, v29
v_min3_u32 v11, v11, v51, v55
v_max3_u32 v12, v12, v51, v55
s_waitcnt vmcnt(1)
v_dot2_f32_bf16 v24, v56, v156, v24
v_dot2_f32_bf16 v25, v56, v157, v25
v_dot2_f32_bf16 v26, v57, v156, v26
v_dot2_f32_bf16 v27, v57, v157, v27
v_dot2_f32_bf16 v28, v58, v156, v28
v_dot2_f32_bf16 v29, v58, v157, v29
s_waitcnt vmcnt(0)
v_dot2_f32_bf16 v24, v60, v158, v24
v_dot2_f32_bf16 v25, v60, v159, v25
v_dot2_f32_bf16 v26, v61, v158, v26
v_dot2_f32_bf16 v27, v61, v159, v27
v_dot2_f32_bf16 v28, v62, v158, v28
v_dot2_f32_bf16 v29, v62, v159, v29
v_min3_u32 v11, v11, v59, v63
v_max3_u32 v12, v12, v59, v63
v_cmp_ne_u32 vcc, v11, v12
s_nop 0
s_cbranch_vccnz T_rt
T_pd:
s_nop 2
v_permlane32_swap_b32 v24, v25
v_permlane32_swap_b32 v26, v27
v_permlane32_swap_b32 v28, v29
v_permlane32_swap_b32 v30, v31
v_add_f32 v24, v24, v25
v_add_f32 v26, v26, v27
v_add_f32 v28, v28, v29
v_add_f32 v30, v30, v31
v_permlane16_swap_b32 v24, v26
s_nop 0
v_permlane16_swap_b32 v28, v30
v_add_f32 v24, v24, v26
v_add_f32 v28, v28, v30
ds_write_b32 v18, v24
ds_write_b32 v19, v28
s_waitcnt lgkmcnt(0)
s_barrier
ds_read_b32 v32, v22 offset:32
ds_read_b32 v33, v22
ds_read_b32 v34, v9
ds_read_b32 v35, v21
s_waitcnt lgkmcnt(3)
v_mov_b32 v13, v32
s_nop 1
v_max_f32_dpp v13, v13, v13 quad_perm:[1,0,3,2] row_mask:0xf bank_mask:0xf
s_nop 1
v_max_f32_dpp v13, v13, v13 quad_perm:[2,3,0,1] row_mask:0xf bank_mask:0xf
s_nop 1
v_max_f32_dpp v13, v13, v13 row_half_mirror row_mask:0xf bank_mask:0xf
v_sub_f32 v32, v32, v13
v_exp_f32 v32, v32
s_waitcnt lgkmcnt(0)
v_mul_f32 v33, v32, v33
v_mul_f32 v34, v32, v34
v_mul_f32 v35, v32, v35
v_add_f32_dpp v33, v33, v33 quad_perm:[1,0,3,2] row_mask:0xf bank_mask:0xf
v_add_f32_dpp v34, v34, v34 quad_perm:[1,0,3,2] row_mask:0xf bank_mask:0xf
v_add_f32_dpp v35, v35, v35 quad_perm:[1,0,3,2] row_mask:0xf bank_mask:0xf
v_add_f32_dpp v33, v33, v33 quad_perm:[2,3,0,1] row_mask:0xf bank_mask:0xf
v_add_f32_dpp v34, v34, v34 quad_perm:[2,3,0,1] row_mask:0xf bank_mask:0xf
v_add_f32_dpp v35, v35, v35 quad_perm:[2,3,0,1] row_mask:0xf bank_mask:0xf
v_add_f32_dpp v33, v33, v33 row_half_mirror row_mask:0xf bank_mask:0xf
v_add_f32_dpp v34, v34, v34 row_half_mirror row_mask:0xf bank_mask:0xf
v_add_f32_dpp v35, v35, v35 row_half_mirror row_mask:0xf bank_mask:0xf
v_rcp_f32 v33, v33
s_nop 0
v_mul_f32 v34, v34, v33
v_mul_f32 v35, v35, v33
v_cvt_pk_bf16_f32 v15, v34, v35
s_nop 0
v_readlane_b32 s4, v15, 0
v_readlane_b32 s5, v15, 8
v_readlane_b32 s6, v15, 16
v_readlane_b32 s7, v15, 24
v_readlane_b32 s8, v15, 32
v_readlane_b32 s9, v15, 40
v_readlane_b32 s10, v15, 48
v_readlane_b32 s11, v15, 56
s_pack_ll_b32_b16 s50, s4, s5
s_pack_ll_b32_b16 s51, s6, s7
s_pack_ll_b32_b16 s52, s8, s9
s_pack_ll_b32_b16 s53, s10, s11
s_pack_hh_b32_b16 s54, s4, s5
s_pack_hh_b32_b16 s55, s6, s7
v_dot2_f32_bf16 v24, v99, s50, 0
v_dot2_f32_bf16 v25, v103, s50, 0
v_dot2_f32_bf16 v26, v96, s50, 0
v_dot2_f32_bf16 v27, v100, s50, 0
v_dot2_f32_bf16 v28, v97, s50, 0
v_dot2_f32_bf16 v29, v101, s50, 0
v_dot2_f32_bf16 v24, v107, s51, v24
v_dot2_f32_bf16 v25, v111, s51, v25
v_dot2_f32_bf16 v26, v104, s51, v26
v_dot2_f32_bf16 v27, v108, s51, v27
v_dot2_f32_bf16 v28, v105, s51, v28
v_dot2_f32_bf16 v29, v109, s51, v29
v_dot2_f32_bf16 v24, v115, s52, v24
v_dot2_f32_bf16 v25, v119, s52, v25
v_dot2_f32_bf16 v26, v112, s52, v26
v_dot2_f32_bf16 v27, v116, s52, v27
v_dot2_f32_bf16 v28, v113, s52, v28
v_dot2_f32_bf16 v29, v117, s52, v29
v_dot2_f32_bf16 v24, v123, s53, v24
v_dot2_f32_bf16 v25, v127, s53, v25
v_dot2_f32_bf16 v26, v120, s53, v26
v_dot2_f32_bf16 v27, v124, s53, v27
v_dot2_f32_bf16 v28, v121, s53, v28
v_dot2_f32_bf16 v29, v125, s53, v29
v_dot2_f32_bf16 v24, v131, s54, v24
v_dot2_f32_bf16 v25, v135, s54, v25
v_dot2_f32_bf16 v26, v128, s54, v26
v_dot2_f32_bf16 v27, v132, s54, v27
v_dot2_f32_bf16 v28, v129, s54, v28
v_dot2_f32_bf16 v29, v133, s54, v29
v_dot2_f32_bf16 v24, v139, s55, v24
v_dot2_f32_bf16 v25, v143, s55, v25
v_dot2_f32_bf16 v26, v136, s55, v26
v_dot2_f32_bf16 v27, v140, s55, v27
v_dot2_f32_bf16 v28, v137, s55, v28
v_dot2_f32_bf16 v29, v141, s55, v29
v_mul_u32_u24 v11, 24, v2
s_mul_i32 s45, s39, 1536
v_add_u32 v11, s45, v11
ds_write_b64 v11, v[24:25] offset:8192
ds_write_b64 v11, v[26:27] offset:8200
ds_write_b64 v11, v[28:29] offset:8208
s_waitcnt lgkmcnt(0)
s_barrier
v_cmp_gt_u32 vcc, 192, v0
s_nop 0
s_and_saveexec_b64 s[46:47], vcc
s_cbranch_execz K_fin
v_lshlrev_b32 v25, 3, v0
ds_read_b64 v[32:33], v25 offset:8192
ds_read_b64 v[34:35], v25 offset:9728
ds_read_b64 v[36:37], v25 offset:11264
ds_read_b64 v[38:39], v25 offset:12800
ds_read_b64 v[40:41], v25 offset:14336
ds_read_b64 v[42:43], v25 offset:15872
ds_read_b64 v[44:45], v25 offset:17408
ds_read_b64 v[46:47], v25 offset:18944
s_mov_b32 s45, 0x7fc00000
v_mov_b32 v27, s45
s_waitcnt lgkmcnt(6)
v_add_f32 v32, v32, v34
s_waitcnt lgkmcnt(4)
v_add_f32 v36, v36, v38
s_waitcnt lgkmcnt(2)
v_add_f32 v40, v40, v42
s_waitcnt lgkmcnt(0)
v_add_f32 v44, v44, v46
v_add_f32 v32, v32, v36
v_add_f32 v40, v40, v44
v_add_f32 v32, v32, v40
v_cmp_eq_u32 vcc, -1, v32
s_nop 1
v_cndmask_b32 v32, v32, v27, vcc
v_add_f32 v33, v33, v35
v_add_f32 v37, v37, v39
v_add_f32 v41, v41, v43
v_add_f32 v45, v45, v47
v_add_f32 v33, v33, v37
v_add_f32 v41, v41, v45
v_add_f32 v33, v33, v41
v_cmp_eq_u32 vcc, -1, v33
s_nop 1
v_cndmask_b32 v33, v33, v27, vcc
s_mul_i32 s42, s57, 1536
s_add_u32 s42, s42, 393216
buffer_store_dwordx2 v[32:33], v25, s[28:31], s42 offen sc0 sc1
v_cmp_gt_u32 vcc, 48, v0
s_nop 0
s_and_saveexec_b64 s[46:47], vcc
s_cbranch_execz K_fin
s_mov_b32 s46, 53248
s_cmp_eq_u32 s57, 0
s_cselect_b32 s45, s46, 4980736
v_mov_b32 v26, s38
v_mov_b32 v28, 0
buffer_store_dword v26, v28, s[28:31], s45 offen
s_mul_i32 s42, s40, 6144
s_mul_i32 s43, s41, 384
s_add_u32 s42, s42, s43
s_add_u32 s42, s42, 393216
s_add_u32 s43, s42, 3072
s_mov_b32 s58, 1048576
s_sleep 0
T_poll2:
buffer_load_dwordx2 v[40:41], v25, s[28:31], s42 offen sc1
buffer_load_dwordx2 v[42:43], v25, s[28:31], s42 offen offset:1536 sc1
buffer_load_dwordx2 v[44:45], v25, s[28:31], s43 offen sc1
buffer_load_dwordx2 v[46:47], v25, s[28:31], s43 offen offset:1536 sc1
s_waitcnt vmcnt(0)
s_waitcnt vmcnt(4)
v_max3_u32 v48, v40, v41, v42
v_max3_u32 v48, v48, v43, v44
v_max3_u32 v48, v48, v45, v46
v_max_u32 v48, v48, v47
v_cmp_eq_u32 vcc, -1, v48
s_nop 0
s_cbranch_vccz T_k0
s_sub_u32 s58, s58, 1
s_cbranch_scc0 T_poll2
T_k1:
v_add_f32 v60, v52, v54
v_add_f32 v62, v56, v58
v_add_f32 v61, v53, v55
v_add_f32 v63, v57, v59
s_branch T_k2
T_k0:
v_add_f32 v60, v40, v42
v_add_f32 v62, v44, v46
v_add_f32 v61, v41, v43
v_add_f32 v63, v45, v47
T_k2:
v_lshlrev_b32 v48, 16, v7
v_and_b32 v49, 0xffff0000, v7
v_add_f32 v60, v60, v62
v_add_f32 v61, v61, v63
v_add_f32 v60, v60, v48
v_add_f32 v61, v61, v49
v_cvt_pk_bf16_f32 v60, v60, v61
buffer_store_dword v60, v6, s[20:23], s44 offen
K_fin:
K_end:
s_endpgm
T_rt:
s_sub_u32 s58, s58, 1
s_cbranch_scc0 T_re
s_branch T_pd
POLLa:
s_mov_b32 s58, 1048576
POLL1a:
s_sleep 6
buffer_load_dword v19, v14, s[28:31], 0 offen sc1
s_sub_u32 s58, s58, 1
s_cbranch_scc1 C_POLLa
s_waitcnt vmcnt(0)
v_cmp_ne_u32 vcc, s38, v19
s_nop 0
s_cbranch_vccnz POLL1a
s_branch C_POLLa
RARE1a:
v_max3_f32 v30, v44, v45, v46
v_max3_f32 v31, v47, v48, v49
v_max3_f32 v30, v30, v50, v51
v_max_f32 v30, v30, v31
v_mov_b32 v31, v30
s_nop 1
v_permlane32_swap_b32 v30, v31
v_max_f32 v30, v30, v31
v_mov_b32 v31, v30
s_nop 1
v_permlane16_swap_b32 v30, v31
v_max_f32 v30, v30, v31
v_max_f32 v30, 0, v30
v_sub_f32 v44, v44, v30
v_sub_f32 v45, v45, v30
v_sub_f32 v46, v46, v30
v_sub_f32 v47, v47, v30
v_sub_f32 v48, v48, v30
v_sub_f32 v49, v49, v30
v_sub_f32 v50, v50, v30
v_sub_f32 v51, v51, v30
v_sub_f32 v15, v15, v30
v_exp_f32 v18, -v30
s_nop 0
v_mul_f32 v16, v18, v16
v_mul_f32 v68, v18, v68
v_mul_f32 v69, v18, v69
v_mul_f32 v70, v18, v70
v_mul_f32 v71, v18, v71
s_lshl_b32 s59, s3, 6
s_add_u32 s59, s59, 162560
v_and_b32 v30, 15, v0
v_lshl_add_u32 v30, v30, 2, s59
ds_write_b32 v30, v18
s_lshl_b32 s59, s3, 2
s_add_u32 s59, s59, 162832
v_mov_b32 v30, s59
v_mov_b32 v31, 2
ds_write_b32 v30, v31
v_exp_f32 v76, v44
v_exp_f32 v77, v45
v_exp_f32 v78, v46
v_exp_f32 v79, v47
v_exp_f32 v80, v48
v_exp_f32 v81, v49
v_exp_f32 v82, v50
v_exp_f32 v83, v51
v_add_f32 v32, v76, v77
v_add_f32 v33, v78, v79
v_add_f32 v34, v80, v81
v_add_f32 v35, v82, v83
v_add_f32 v32, v32, v33
v_add_f32 v34, v34, v35
v_add_f32 v32, v32, v34
s_waitcnt lgkmcnt(0)
s_branch C_1a
RARE2a:
v_max3_f32 v30, v36, v37, v38
v_max3_f32 v31, v39, v40, v41
v_max3_f32 v30, v30, v42, v43
v_max_f32 v30, v30, v31
v_mov_b32 v31, v30
s_nop 1
v_permlane32_swap_b32 v30, v31
v_max_f32 v30, v30, v31
v_mov_b32 v31, v30
s_nop 1
v_permlane16_swap_b32 v30, v31
v_max_f32 v30, v30, v31
v_max_f32 v30, 0, v30
v_sub_f32 v36, v36, v30
v_sub_f32 v37, v37, v30
v_sub_f32 v38, v38, v30
v_sub_f32 v39, v39, v30
v_sub_f32 v40, v40, v30
v_sub_f32 v41, v41, v30
v_sub_f32 v42, v42, v30
v_sub_f32 v43, v43, v30
v_sub_f32 v15, v15, v30
v_exp_f32 v18, -v30
s_nop 0
v_mul_f32 v16, v18, v16
v_mul_f32 v68, v18, v68
v_mul_f32 v69, v18, v69
v_mul_f32 v70, v18, v70
v_mul_f32 v71, v18, v71
s_lshl_b32 s59, s3, 6
s_add_u32 s59, s59, 162304
v_and_b32 v30, 15, v0
v_lshl_add_u32 v30, v30, 2, s59
ds_write_b32 v30, v18
s_lshl_b32 s59, s3, 2
s_add_u32 s59, s59, 162816
v_mov_b32 v30, s59
v_mov_b32 v31, 3
ds_write_b32 v30, v31
v_exp_f32 v76, v36
v_exp_f32 v77, v37
v_exp_f32 v78, v38
v_exp_f32 v79, v39
v_exp_f32 v80, v40
v_exp_f32 v81, v41
v_exp_f32 v82, v42
v_exp_f32 v83, v43
v_add_f32 v32, v76, v77
v_add_f32 v33, v78, v79
v_add_f32 v34, v80, v81
v_add_f32 v35, v82, v83
v_add_f32 v32, v32, v33
v_add_f32 v34, v34, v35
v_add_f32 v32, v32, v34
s_waitcnt lgkmcnt(0)
s_branch C_2a
RARE3a:
v_max3_f32 v30, v44, v45, v46
v_max3_f32 v31, v47, v48, v49
v_max3_f32 v30, v30, v50, v51
v_max_f32 v30, v30, v31
v_mov_b32 v31, v30
s_nop 1
v_permlane32_swap_b32 v30, v31
v_max_f32 v30, v30, v31
v_mov_b32 v31, v30
s_nop 1
v_permlane16_swap_b32 v30, v31
v_max_f32 v30, v30, v31
v_max_f32 v30, 0, v30
v_sub_f32 v44, v44, v30
v_sub_f32 v45, v45, v30
v_sub_f32 v46, v46, v30
v_sub_f32 v47, v47, v30
v_sub_f32 v48, v48, v30
v_sub_f32 v49, v49, v30
v_sub_f32 v50, v50, v30
v_sub_f32 v51, v51, v30
v_sub_f32 v15, v15, v30
v_exp_f32 v18, -v30
s_nop 0
v_mul_f32 v16, v18, v16
v_mul_f32 v68, v18, v68
v_mul_f32 v69, v18, v69
v_mul_f32 v70, v18, v70
v_mul_f32 v71, v18, v71
v_mul_f32 v72, v18, v72
v_mul_f32 v73, v18, v73
v_mul_f32 v74, v18, v74
v_mul_f32 v75, v18, v75
s_lshl_b32 s59, s3, 6
s_add_u32 s59, s59, 162560
v_and_b32 v30, 15, v0
v_lshl_add_u32 v30, v30, 2, s59
ds_write_b32 v30, v18
s_lshl_b32 s59, s3, 2
s_add_u32 s59, s59, 162832
v_mov_b32 v30, s59
v_mov_b32 v31, 4
ds_write_b32 v30, v31
v_exp_f32 v76, v44
v_exp_f32 v77, v45
v_exp_f32 v78, v46
v_exp_f32 v79, v47
v_exp_f32 v80, v48
v_exp_f32 v81, v49
v_exp_f32 v82, v50
v_exp_f32 v83, v51
v_add_f32 v32, v76, v77
v_add_f32 v33, v78, v79
v_add_f32 v34, v80, v81
v_add_f32 v35, v82, v83
v_add_f32 v32, v32, v33
v_add_f32 v34, v34, v35
v_add_f32 v32, v32, v34
s_waitcnt lgkmcnt(0)
s_branch C_3a
RARE4a:
v_max3_f32 v30, v36, v37, v38
v_max3_f32 v31, v39, v40, v41
v_max3_f32 v30, v30, v42, v43
v_max_f32 v30, v30, v31
v_mov_b32 v31, v30
s_nop 1
v_permlane32_swap_b32 v30, v31
v_max_f32 v30, v30, v31
v_mov_b32 v31, v30
s_nop 1
v_permlane16_swap_b32 v30, v31
v_max_f32 v30, v30, v31
v_max_f32 v30, 0, v30
v_sub_f32 v36, v36, v30
v_sub_f32 v37, v37, v30
v_sub_f32 v38, v38, v30
v_sub_f32 v39, v39, v30
v_sub_f32 v40, v40, v30
v_sub_f32 v41, v41, v30
v_sub_f32 v42, v42, v30
v_sub_f32 v43, v43, v30
v_sub_f32 v15, v15, v30
v_exp_f32 v18, -v30
s_nop 0
v_mul_f32 v16, v18, v16
s_lshl_b32 s59, s3, 6
s_add_u32 s59, s59, 162304
v_and_b32 v30, 15, v0
v_lshl_add_u32 v30, v30, 2, s59
ds_write_b32 v30, v18
s_lshl_b32 s59, s3, 2
s_add_u32 s59, s59, 162816
v_mov_b32 v30, s59
v_mov_b32 v31, 5
ds_write_b32 v30, v31
v_exp_f32 v76, v36
v_exp_f32 v77, v37
v_exp_f32 v78, v38
v_exp_f32 v79, v39
v_exp_f32 v80, v40
v_exp_f32 v81, v41
v_exp_f32 v82, v42
v_exp_f32 v83, v43
v_add_f32 v32, v76, v77
v_add_f32 v33, v78, v79
v_add_f32 v34, v80, v81
v_add_f32 v35, v82, v83
v_add_f32 v32, v32, v33
v_add_f32 v34, v34, v35
v_add_f32 v32, v32, v34
s_waitcnt lgkmcnt(0)
s_branch C_4a
RARE5a:
v_max3_f32 v30, v44, v45, v46
v_max3_f32 v31, v47, v48, v49
v_max3_f32 v30, v30, v50, v51
v_max_f32 v30, v30, v31
v_mov_b32 v31, v30
s_nop 1
v_permlane32_swap_b32 v30, v31
v_max_f32 v30, v30, v31
v_mov_b32 v31, v30
s_nop 1
v_permlane16_swap_b32 v30, v31
v_max_f32 v30, v30, v31
v_max_f32 v30, 0, v30
v_sub_f32 v44, v44, v30
v_sub_f32 v45, v45, v30
v_sub_f32 v46, v46, v30
v_sub_f32 v47, v47, v30
v_sub_f32 v48, v48, v30
v_sub_f32 v49, v49, v30
v_sub_f32 v50, v50, v30
v_sub_f32 v51, v51, v30
v_sub_f32 v15, v15, v30
v_exp_f32 v18, -v30
s_nop 0
v_mul_f32 v16, v18, v16
v_mul_f32 v68, v18, v68
v_mul_f32 v69, v18, v69
v_mul_f32 v70, v18, v70
v_mul_f32 v71, v18, v71
s_lshl_b32 s59, s3, 6
s_add_u32 s59, s59, 162560
v_and_b32 v30, 15, v0
v_lshl_add_u32 v30, v30, 2, s59
ds_write_b32 v30, v18
s_lshl_b32 s59, s3, 2
s_add_u32 s59, s59, 162832
v_mov_b32 v30, s59
v_mov_b32 v31, 6
ds_write_b32 v30, v31
v_exp_f32 v76, v44
v_exp_f32 v77, v45
v_exp_f32 v78, v46
v_exp_f32 v79, v47
v_exp_f32 v80, v48
v_exp_f32 v81, v49
v_exp_f32 v82, v50
v_exp_f32 v83, v51
v_add_f32 v32, v76, v77
v_add_f32 v33, v78, v79
v_add_f32 v34, v80, v81
v_add_f32 v35, v82, v83
v_add_f32 v32, v32, v33
v_add_f32 v34, v34, v35
v_add_f32 v32, v32, v34
s_waitcnt lgkmcnt(0)
s_branch C_5a
RARE6a:
v_max3_f32 v30, v36, v37, v38
v_max3_f32 v31, v39, v40, v41
v_max3_f32 v30, v30, v42, v43
v_max_f32 v30, v30, v31
v_mov_b32 v31, v30
s_nop 1
v_permlane32_swap_b32 v30, v31
v_max_f32 v30, v30, v31
v_mov_b32 v31, v30
s_nop 1
v_permlane16_swap_b32 v30, v31
v_max_f32 v30, v30, v31
v_max_f32 v30, 0, v30
v_sub_f32 v36, v36, v30
v_sub_f32 v37, v37, v30
v_sub_f32 v38, v38, v30
v_sub_f32 v39, v39, v30
v_sub_f32 v40, v40, v30
v_sub_f32 v41, v41, v30
v_sub_f32 v42, v42, v30
v_sub_f32 v43, v43, v30
v_sub_f32 v15, v15, v30
v_exp_f32 v18, -v30
s_nop 0
v_mul_f32 v16, v18, v16
v_mul_f32 v68, v18, v68
v_mul_f32 v69, v18, v69
v_mul_f32 v70, v18, v70
v_mul_f32 v71, v18, v71
s_lshl_b32 s59, s3, 6
s_add_u32 s59, s59, 162304
v_and_b32 v30, 15, v0
v_lshl_add_u32 v30, v30, 2, s59
ds_write_b32 v30, v18
s_lshl_b32 s59, s3, 2
s_add_u32 s59, s59, 162816
v_mov_b32 v30, s59
v_mov_b32 v31, 7
ds_write_b32 v30, v31
v_exp_f32 v76, v36
v_exp_f32 v77, v37
v_exp_f32 v78, v38
v_exp_f32 v79, v39
v_exp_f32 v80, v40
v_exp_f32 v81, v41
v_exp_f32 v82, v42
v_exp_f32 v83, v43
v_add_f32 v32, v76, v77
v_add_f32 v33, v78, v79
v_add_f32 v34, v80, v81
v_add_f32 v35, v82, v83
v_add_f32 v32, v32, v33
v_add_f32 v34, v34, v35
v_add_f32 v32, v32, v34
s_waitcnt lgkmcnt(0)
s_branch C_6a
RARE7a:
v_max3_f32 v30, v44, v45, v46
v_max3_f32 v31, v47, v48, v49
v_max3_f32 v30, v30, v50, v51
v_max_f32 v30, v30, v31
v_mov_b32 v31, v30
s_nop 1
v_permlane32_swap_b32 v30, v31
v_max_f32 v30, v30, v31
v_mov_b32 v31, v30
s_nop 1
v_permlane16_swap_b32 v30, v31
v_max_f32 v30, v30, v31
v_max_f32 v30, 0, v30
v_sub_f32 v44, v44, v30
v_sub_f32 v45, v45, v30
v_sub_f32 v46, v46, v30
v_sub_f32 v47, v47, v30
v_sub_f32 v48, v48, v30
v_sub_f32 v49, v49, v30
v_sub_f32 v50, v50, v30
v_sub_f32 v51, v51, v30
v_sub_f32 v15, v15, v30
v_exp_f32 v18, -v30
s_nop 0
v_mul_f32 v16, v18, v16
v_mul_f32 v68, v18, v68
v_mul_f32 v69, v18, v69
v_mul_f32 v70, v18, v70
v_mul_f32 v71, v18, v71
v_mul_f32 v72, v18, v72
v_mul_f32 v73, v18, v73
v_mul_f32 v74, v18, v74
v_mul_f32 v75, v18, v75
s_lshl_b32 s59, s3, 6
s_add_u32 s59, s59, 162560
v_and_b32 v30, 15, v0
v_lshl_add_u32 v30, v30, 2, s59
ds_write_b32 v30, v18
s_lshl_b32 s59, s3, 2
s_add_u32 s59, s59, 162832
v_mov_b32 v30, s59
v_mov_b32 v31, 8
ds_write_b32 v30, v31
v_exp_f32 v76, v44
v_exp_f32 v77, v45
v_exp_f32 v78, v46
v_exp_f32 v79, v47
v_exp_f32 v80, v48
v_exp_f32 v81, v49
v_exp_f32 v82, v50
v_exp_f32 v83, v51
v_add_f32 v32, v76, v77
v_add_f32 v33, v78, v79
v_add_f32 v34, v80, v81
v_add_f32 v35, v82, v83
v_add_f32 v32, v32, v33
v_add_f32 v34, v34, v35
v_add_f32 v32, v32, v34
s_waitcnt lgkmcnt(0)
s_branch C_7a
RESC1a:
s_nop 7
v_and_b32 v15, 15, v0
v_lshlrev_b32 v15, 2, v15
v_add_u32 v15, 162560, v15
ds_read_b32 v15, v15
v_cmp_eq_u32 vcc, 2, v16
s_waitcnt lgkmcnt(0)
s_nop 0
v_cndmask_b32 v15, 1.0, v15, vcc
v_mul_f32 v64, v15, v64
v_mul_f32 v65, v15, v65
v_mul_f32 v66, v15, v66
v_mul_f32 v67, v15, v67
v_mul_f32 v80, v15, v80
v_mul_f32 v81, v15, v81
v_mul_f32 v82, v15, v82
v_mul_f32 v83, v15, v83
v_mul_f32 v96, v15, v96
v_mul_f32 v97, v15, v97
v_mul_f32 v98, v15, v98
v_mul_f32 v99, v15, v99
v_mul_f32 v112, v15, v112
v_mul_f32 v113, v15, v113
v_mul_f32 v114, v15, v114
v_mul_f32 v115, v15, v115
v_mul_f32 v128, v15, v128
v_mul_f32 v129, v15, v129
v_mul_f32 v130, v15, v130
v_mul_f32 v131, v15, v131
v_mul_f32 v144, v15, v144
v_mul_f32 v145, v15, v145
v_mul_f32 v146, v15, v146
v_mul_f32 v147, v15, v147
v_and_b32 v15, 15, v0
v_lshlrev_b32 v15, 2, v15
v_add_u32 v15, 162624, v15
ds_read_b32 v15, v15
v_cmp_eq_u32 vcc, 2, v17
s_waitcnt lgkmcnt(0)
s_nop 0
v_cndmask_b32 v15, 1.0, v15, vcc
v_mul_f32 v68, v15, v68
v_mul_f32 v69, v15, v69
v_mul_f32 v70, v15, v70
v_mul_f32 v71, v15, v71
v_mul_f32 v84, v15, v84
v_mul_f32 v85, v15, v85
v_mul_f32 v86, v15, v86
v_mul_f32 v87, v15, v87
v_mul_f32 v100, v15, v100
v_mul_f32 v101, v15, v101
v_mul_f32 v102, v15, v102
v_mul_f32 v103, v15, v103
v_mul_f32 v116, v15, v116
v_mul_f32 v117, v15, v117
v_mul_f32 v118, v15, v118
v_mul_f32 v119, v15, v119
v_mul_f32 v132, v15, v132
v_mul_f32 v133, v15, v133
v_mul_f32 v134, v15, v134
v_mul_f32 v135, v15, v135
v_mul_f32 v148, v15, v148
v_mul_f32 v149, v15, v149
v_mul_f32 v150, v15, v150
v_mul_f32 v151, v15, v151
v_and_b32 v15, 15, v0
v_lshlrev_b32 v15, 2, v15
v_add_u32 v15, 162688, v15
ds_read_b32 v15, v15
v_cmp_eq_u32 vcc, 2, v18
s_waitcnt lgkmcnt(0)
s_nop 0
v_cndmask_b32 v15, 1.0, v15, vcc
v_mul_f32 v72, v15, v72
v_mul_f32 v73, v15, v73
v_mul_f32 v74, v15, v74
v_mul_f32 v75, v15, v75
v_mul_f32 v88, v15, v88
v_mul_f32 v89, v15, v89
v_mul_f32 v90, v15, v90
v_mul_f32 v91, v15, v91
v_mul_f32 v104, v15, v104
v_mul_f32 v105, v15, v105
v_mul_f32 v106, v15, v106
v_mul_f32 v107, v15, v107
v_mul_f32 v120, v15, v120
v_mul_f32 v121, v15, v121
v_mul_f32 v122, v15, v122
v_mul_f32 v123, v15, v123
v_mul_f32 v136, v15, v136
v_mul_f32 v137, v15, v137
v_mul_f32 v138, v15, v138
v_mul_f32 v139, v15, v139
v_mul_f32 v152, v15, v152
v_mul_f32 v153, v15, v153
v_mul_f32 v154, v15, v154
v_mul_f32 v155, v15, v155
v_and_b32 v15, 15, v0
v_lshlrev_b32 v15, 2, v15
v_add_u32 v15, 162752, v15
ds_read_b32 v15, v15
v_cmp_eq_u32 vcc, 2, v19
s_waitcnt lgkmcnt(0)
s_nop 0
v_cndmask_b32 v15, 1.0, v15, vcc
v_mul_f32 v76, v15, v76
v_mul_f32 v77, v15, v77
v_mul_f32 v78, v15, v78
v_mul_f32 v79, v15, v79
v_mul_f32 v92, v15, v92
v_mul_f32 v93, v15, v93
v_mul_f32 v94, v15, v94
v_mul_f32 v95, v15, v95
v_mul_f32 v108, v15, v108
v_mul_f32 v109, v15, v109
v_mul_f32 v110, v15, v110
v_mul_f32 v111, v15, v111
v_mul_f32 v124, v15, v124
v_mul_f32 v125, v15, v125
v_mul_f32 v126, v15, v126
v_mul_f32 v127, v15, v127
v_mul_f32 v140, v15, v140
v_mul_f32 v141, v15, v141
v_mul_f32 v142, v15, v142
v_mul_f32 v143, v15, v143
v_mul_f32 v156, v15, v156
v_mul_f32 v157, v15, v157
v_mul_f32 v158, v15, v158
v_mul_f32 v159, v15, v159
s_nop 1
s_branch C_R1a
RESC2a:
s_nop 7
v_and_b32 v15, 15, v0
v_lshlrev_b32 v15, 2, v15
v_add_u32 v15, 162304, v15
ds_read_b32 v15, v15
v_cmp_eq_u32 vcc, 3, v16
s_waitcnt lgkmcnt(0)
s_nop 0
v_cndmask_b32 v15, 1.0, v15, vcc
v_mul_f32 v64, v15, v64
v_mul_f32 v65, v15, v65
v_mul_f32 v66, v15, v66
v_mul_f32 v67, v15, v67
v_mul_f32 v80, v15, v80
v_mul_f32 v81, v15, v81
v_mul_f32 v82, v15, v82
v_mul_f32 v83, v15, v83
v_mul_f32 v96, v15, v96
v_mul_f32 v97, v15, v97
v_mul_f32 v98, v15, v98
v_mul_f32 v99, v15, v99
v_mul_f32 v112, v15, v112
v_mul_f32 v113, v15, v113
v_mul_f32 v114, v15, v114
v_mul_f32 v115, v15, v115
v_mul_f32 v128, v15, v128
v_mul_f32 v129, v15, v129
v_mul_f32 v130, v15, v130
v_mul_f32 v131, v15, v131
v_mul_f32 v144, v15, v144
v_mul_f32 v145, v15, v145
v_mul_f32 v146, v15, v146
v_mul_f32 v147, v15, v147
v_and_b32 v15, 15, v0
v_lshlrev_b32 v15, 2, v15
v_add_u32 v15, 162368, v15
ds_read_b32 v15, v15
v_cmp_eq_u32 vcc, 3, v17
s_waitcnt lgkmcnt(0)
s_nop 0
v_cndmask_b32 v15, 1.0, v15, vcc
v_mul_f32 v68, v15, v68
v_mul_f32 v69, v15, v69
v_mul_f32 v70, v15, v70
v_mul_f32 v71, v15, v71
v_mul_f32 v84, v15, v84
v_mul_f32 v85, v15, v85
v_mul_f32 v86, v15, v86
v_mul_f32 v87, v15, v87
v_mul_f32 v100, v15, v100
v_mul_f32 v101, v15, v101
v_mul_f32 v102, v15, v102
v_mul_f32 v103, v15, v103
v_mul_f32 v116, v15, v116
v_mul_f32 v117, v15, v117
v_mul_f32 v118, v15, v118
v_mul_f32 v119, v15, v119
v_mul_f32 v132, v15, v132
v_mul_f32 v133, v15, v133
v_mul_f32 v134, v15, v134
v_mul_f32 v135, v15, v135
v_mul_f32 v148, v15, v148
v_mul_f32 v149, v15, v149
v_mul_f32 v150, v15, v150
v_mul_f32 v151, v15, v151
v_and_b32 v15, 15, v0
v_lshlrev_b32 v15, 2, v15
v_add_u32 v15, 162432, v15
ds_read_b32 v15, v15
v_cmp_eq_u32 vcc, 3, v18
s_waitcnt lgkmcnt(0)
s_nop 0
v_cndmask_b32 v15, 1.0, v15, vcc
v_mul_f32 v72, v15, v72
v_mul_f32 v73, v15, v73
v_mul_f32 v74, v15, v74
v_mul_f32 v75, v15, v75
v_mul_f32 v88, v15, v88
v_mul_f32 v89, v15, v89
v_mul_f32 v90, v15, v90
v_mul_f32 v91, v15, v91
v_mul_f32 v104, v15, v104
v_mul_f32 v105, v15, v105
v_mul_f32 v106, v15, v106
v_mul_f32 v107, v15, v107
v_mul_f32 v120, v15, v120
v_mul_f32 v121, v15, v121
v_mul_f32 v122, v15, v122
v_mul_f32 v123, v15, v123
v_mul_f32 v136, v15, v136
v_mul_f32 v137, v15, v137
v_mul_f32 v138, v15, v138
v_mul_f32 v139, v15, v139
v_mul_f32 v152, v15, v152
v_mul_f32 v153, v15, v153
v_mul_f32 v154, v15, v154
v_mul_f32 v155, v15, v155
v_and_b32 v15, 15, v0
v_lshlrev_b32 v15, 2, v15
v_add_u32 v15, 162496, v15
ds_read_b32 v15, v15
v_cmp_eq_u32 vcc, 3, v19
s_waitcnt lgkmcnt(0)
s_nop 0
v_cndmask_b32 v15, 1.0, v15, vcc
v_mul_f32 v76, v15, v76
v_mul_f32 v77, v15, v77
v_mul_f32 v78, v15, v78
v_mul_f32 v79, v15, v79
v_mul_f32 v92, v15, v92
v_mul_f32 v93, v15, v93
v_mul_f32 v94, v15, v94
v_mul_f32 v95, v15, v95
v_mul_f32 v108, v15, v108
v_mul_f32 v109, v15, v109
v_mul_f32 v110, v15, v110
v_mul_f32 v111, v15, v111
v_mul_f32 v124, v15, v124
v_mul_f32 v125, v15, v125
v_mul_f32 v126, v15, v126
v_mul_f32 v127, v15, v127
v_mul_f32 v140, v15, v140
v_mul_f32 v141, v15, v141
v_mul_f32 v142, v15, v142
v_mul_f32 v143, v15, v143
v_mul_f32 v156, v15, v156
v_mul_f32 v157, v15, v157
v_mul_f32 v158, v15, v158
v_mul_f32 v159, v15, v159
s_nop 1
s_branch C_R2a
RESC3a:
s_nop 7
v_and_b32 v15, 15, v0
v_lshlrev_b32 v15, 2, v15
v_add_u32 v15, 162560, v15
ds_read_b32 v15, v15
v_cmp_eq_u32 vcc, 4, v16
s_waitcnt lgkmcnt(0)
s_nop 0
v_cndmask_b32 v15, 1.0, v15, vcc
v_mul_f32 v64, v15, v64
v_mul_f32 v65, v15, v65
v_mul_f32 v66, v15, v66
v_mul_f32 v67, v15, v67
v_mul_f32 v80, v15, v80
v_mul_f32 v81, v15, v81
v_mul_f32 v82, v15, v82
v_mul_f32 v83, v15, v83
v_mul_f32 v96, v15, v96
v_mul_f32 v97, v15, v97
v_mul_f32 v98, v15, v98
v_mul_f32 v99, v15, v99
v_mul_f32 v112, v15, v112
v_mul_f32 v113, v15, v113
v_mul_f32 v114, v15, v114
v_mul_f32 v115, v15, v115
v_mul_f32 v128, v15, v128
v_mul_f32 v129, v15, v129
v_mul_f32 v130, v15, v130
v_mul_f32 v131, v15, v131
v_mul_f32 v144, v15, v144
v_mul_f32 v145, v15, v145
v_mul_f32 v146, v15, v146
v_mul_f32 v147, v15, v147
v_and_b32 v15, 15, v0
v_lshlrev_b32 v15, 2, v15
v_add_u32 v15, 162624, v15
ds_read_b32 v15, v15
v_cmp_eq_u32 vcc, 4, v17
s_waitcnt lgkmcnt(0)
s_nop 0
v_cndmask_b32 v15, 1.0, v15, vcc
v_mul_f32 v68, v15, v68
v_mul_f32 v69, v15, v69
v_mul_f32 v70, v15, v70
v_mul_f32 v71, v15, v71
v_mul_f32 v84, v15, v84
v_mul_f32 v85, v15, v85
v_mul_f32 v86, v15, v86
v_mul_f32 v87, v15, v87
v_mul_f32 v100, v15, v100
v_mul_f32 v101, v15, v101
v_mul_f32 v102, v15, v102
v_mul_f32 v103, v15, v103
v_mul_f32 v116, v15, v116
v_mul_f32 v117, v15, v117
v_mul_f32 v118, v15, v118
v_mul_f32 v119, v15, v119
v_mul_f32 v132, v15, v132
v_mul_f32 v133, v15, v133
v_mul_f32 v134, v15, v134
v_mul_f32 v135, v15, v135
v_mul_f32 v148, v15, v148
v_mul_f32 v149, v15, v149
v_mul_f32 v150, v15, v150
v_mul_f32 v151, v15, v151
v_and_b32 v15, 15, v0
v_lshlrev_b32 v15, 2, v15
v_add_u32 v15, 162688, v15
ds_read_b32 v15, v15
v_cmp_eq_u32 vcc, 4, v18
s_waitcnt lgkmcnt(0)
s_nop 0
v_cndmask_b32 v15, 1.0, v15, vcc
v_mul_f32 v72, v15, v72
v_mul_f32 v73, v15, v73
v_mul_f32 v74, v15, v74
v_mul_f32 v75, v15, v75
v_mul_f32 v88, v15, v88
v_mul_f32 v89, v15, v89
v_mul_f32 v90, v15, v90
v_mul_f32 v91, v15, v91
v_mul_f32 v104, v15, v104
v_mul_f32 v105, v15, v105
v_mul_f32 v106, v15, v106
v_mul_f32 v107, v15, v107
v_mul_f32 v120, v15, v120
v_mul_f32 v121, v15, v121
v_mul_f32 v122, v15, v122
v_mul_f32 v123, v15, v123
v_mul_f32 v136, v15, v136
v_mul_f32 v137, v15, v137
v_mul_f32 v138, v15, v138
v_mul_f32 v139, v15, v139
v_mul_f32 v152, v15, v152
v_mul_f32 v153, v15, v153
v_mul_f32 v154, v15, v154
v_mul_f32 v155, v15, v155
v_and_b32 v15, 15, v0
v_lshlrev_b32 v15, 2, v15
v_add_u32 v15, 162752, v15
ds_read_b32 v15, v15
v_cmp_eq_u32 vcc, 4, v19
s_waitcnt lgkmcnt(0)
s_nop 0
v_cndmask_b32 v15, 1.0, v15, vcc
v_mul_f32 v76, v15, v76
v_mul_f32 v77, v15, v77
v_mul_f32 v78, v15, v78
v_mul_f32 v79, v15, v79
v_mul_f32 v92, v15, v92
v_mul_f32 v93, v15, v93
v_mul_f32 v94, v15, v94
v_mul_f32 v95, v15, v95
v_mul_f32 v108, v15, v108
v_mul_f32 v109, v15, v109
v_mul_f32 v110, v15, v110
v_mul_f32 v111, v15, v111
v_mul_f32 v124, v15, v124
v_mul_f32 v125, v15, v125
v_mul_f32 v126, v15, v126
v_mul_f32 v127, v15, v127
v_mul_f32 v140, v15, v140
v_mul_f32 v141, v15, v141
v_mul_f32 v142, v15, v142
v_mul_f32 v143, v15, v143
v_mul_f32 v156, v15, v156
v_mul_f32 v157, v15, v157
v_mul_f32 v158, v15, v158
v_mul_f32 v159, v15, v159
s_nop 1
s_branch C_R3a
RESC4a:
s_nop 7
v_and_b32 v15, 15, v0
v_lshlrev_b32 v15, 2, v15
v_add_u32 v15, 162304, v15
ds_read_b32 v15, v15
v_cmp_eq_u32 vcc, 5, v16
s_waitcnt lgkmcnt(0)
s_nop 0
v_cndmask_b32 v15, 1.0, v15, vcc
v_mul_f32 v64, v15, v64
v_mul_f32 v65, v15, v65
v_mul_f32 v66, v15, v66
v_mul_f32 v67, v15, v67
v_mul_f32 v80, v15, v80
v_mul_f32 v81, v15, v81
v_mul_f32 v82, v15, v82
v_mul_f32 v83, v15, v83
v_mul_f32 v96, v15, v96
v_mul_f32 v97, v15, v97
v_mul_f32 v98, v15, v98
v_mul_f32 v99, v15, v99
v_mul_f32 v112, v15, v112
v_mul_f32 v113, v15, v113
v_mul_f32 v114, v15, v114
v_mul_f32 v115, v15, v115
v_mul_f32 v128, v15, v128
v_mul_f32 v129, v15, v129
v_mul_f32 v130, v15, v130
v_mul_f32 v131, v15, v131
v_mul_f32 v144, v15, v144
v_mul_f32 v145, v15, v145
v_mul_f32 v146, v15, v146
v_mul_f32 v147, v15, v147
v_and_b32 v15, 15, v0
v_lshlrev_b32 v15, 2, v15
v_add_u32 v15, 162368, v15
ds_read_b32 v15, v15
v_cmp_eq_u32 vcc, 5, v17
s_waitcnt lgkmcnt(0)
s_nop 0
v_cndmask_b32 v15, 1.0, v15, vcc
v_mul_f32 v68, v15, v68
v_mul_f32 v69, v15, v69
v_mul_f32 v70, v15, v70
v_mul_f32 v71, v15, v71
v_mul_f32 v84, v15, v84
v_mul_f32 v85, v15, v85
v_mul_f32 v86, v15, v86
v_mul_f32 v87, v15, v87
v_mul_f32 v100, v15, v100
v_mul_f32 v101, v15, v101
v_mul_f32 v102, v15, v102
v_mul_f32 v103, v15, v103
v_mul_f32 v116, v15, v116
v_mul_f32 v117, v15, v117
v_mul_f32 v118, v15, v118
v_mul_f32 v119, v15, v119
v_mul_f32 v132, v15, v132
v_mul_f32 v133, v15, v133
v_mul_f32 v134, v15, v134
v_mul_f32 v135, v15, v135
v_mul_f32 v148, v15, v148
v_mul_f32 v149, v15, v149
v_mul_f32 v150, v15, v150
v_mul_f32 v151, v15, v151
v_and_b32 v15, 15, v0
v_lshlrev_b32 v15, 2, v15
v_add_u32 v15, 162432, v15
ds_read_b32 v15, v15
v_cmp_eq_u32 vcc, 5, v18
s_waitcnt lgkmcnt(0)
s_nop 0
v_cndmask_b32 v15, 1.0, v15, vcc
v_mul_f32 v72, v15, v72
v_mul_f32 v73, v15, v73
v_mul_f32 v74, v15, v74
v_mul_f32 v75, v15, v75
v_mul_f32 v88, v15, v88
v_mul_f32 v89, v15, v89
v_mul_f32 v90, v15, v90
v_mul_f32 v91, v15, v91
v_mul_f32 v104, v15, v104
v_mul_f32 v105, v15, v105
v_mul_f32 v106, v15, v106
v_mul_f32 v107, v15, v107
v_mul_f32 v120, v15, v120
v_mul_f32 v121, v15, v121
v_mul_f32 v122, v15, v122
v_mul_f32 v123, v15, v123
v_mul_f32 v136, v15, v136
v_mul_f32 v137, v15, v137
v_mul_f32 v138, v15, v138
v_mul_f32 v139, v15, v139
v_mul_f32 v152, v15, v152
v_mul_f32 v153, v15, v153
v_mul_f32 v154, v15, v154
v_mul_f32 v155, v15, v155
v_and_b32 v15, 15, v0
v_lshlrev_b32 v15, 2, v15
v_add_u32 v15, 162496, v15
ds_read_b32 v15, v15
v_cmp_eq_u32 vcc, 5, v19
s_waitcnt lgkmcnt(0)
s_nop 0
v_cndmask_b32 v15, 1.0, v15, vcc
v_mul_f32 v76, v15, v76
v_mul_f32 v77, v15, v77
v_mul_f32 v78, v15, v78
v_mul_f32 v79, v15, v79
v_mul_f32 v92, v15, v92
v_mul_f32 v93, v15, v93
v_mul_f32 v94, v15, v94
v_mul_f32 v95, v15, v95
v_mul_f32 v108, v15, v108
v_mul_f32 v109, v15, v109
v_mul_f32 v110, v15, v110
v_mul_f32 v111, v15, v111
v_mul_f32 v124, v15, v124
v_mul_f32 v125, v15, v125
v_mul_f32 v126, v15, v126
v_mul_f32 v127, v15, v127
v_mul_f32 v140, v15, v140
v_mul_f32 v141, v15, v141
v_mul_f32 v142, v15, v142
v_mul_f32 v143, v15, v143
v_mul_f32 v156, v15, v156
v_mul_f32 v157, v15, v157
v_mul_f32 v158, v15, v158
v_mul_f32 v159, v15, v159
s_nop 1
s_branch C_R4a
RESC5a:
s_nop 7
v_and_b32 v15, 15, v0
v_lshlrev_b32 v15, 2, v15
v_add_u32 v15, 162560, v15
ds_read_b32 v15, v15
v_cmp_eq_u32 vcc, 6, v16
s_waitcnt lgkmcnt(0)
s_nop 0
v_cndmask_b32 v15, 1.0, v15, vcc
v_mul_f32 v64, v15, v64
v_mul_f32 v65, v15, v65
v_mul_f32 v66, v15, v66
v_mul_f32 v67, v15, v67
v_mul_f32 v80, v15, v80
v_mul_f32 v81, v15, v81
v_mul_f32 v82, v15, v82
v_mul_f32 v83, v15, v83
v_mul_f32 v96, v15, v96
v_mul_f32 v97, v15, v97
v_mul_f32 v98, v15, v98
v_mul_f32 v99, v15, v99
v_mul_f32 v112, v15, v112
v_mul_f32 v113, v15, v113
v_mul_f32 v114, v15, v114
v_mul_f32 v115, v15, v115
v_mul_f32 v128, v15, v128
v_mul_f32 v129, v15, v129
v_mul_f32 v130, v15, v130
v_mul_f32 v131, v15, v131
v_mul_f32 v144, v15, v144
v_mul_f32 v145, v15, v145
v_mul_f32 v146, v15, v146
v_mul_f32 v147, v15, v147
v_and_b32 v15, 15, v0
v_lshlrev_b32 v15, 2, v15
v_add_u32 v15, 162624, v15
ds_read_b32 v15, v15
v_cmp_eq_u32 vcc, 6, v17
s_waitcnt lgkmcnt(0)
s_nop 0
v_cndmask_b32 v15, 1.0, v15, vcc
v_mul_f32 v68, v15, v68
v_mul_f32 v69, v15, v69
v_mul_f32 v70, v15, v70
v_mul_f32 v71, v15, v71
v_mul_f32 v84, v15, v84
v_mul_f32 v85, v15, v85
v_mul_f32 v86, v15, v86
v_mul_f32 v87, v15, v87
v_mul_f32 v100, v15, v100
v_mul_f32 v101, v15, v101
v_mul_f32 v102, v15, v102
v_mul_f32 v103, v15, v103
v_mul_f32 v116, v15, v116
v_mul_f32 v117, v15, v117
v_mul_f32 v118, v15, v118
v_mul_f32 v119, v15, v119
v_mul_f32 v132, v15, v132
v_mul_f32 v133, v15, v133
v_mul_f32 v134, v15, v134
v_mul_f32 v135, v15, v135
v_mul_f32 v148, v15, v148
v_mul_f32 v149, v15, v149
v_mul_f32 v150, v15, v150
v_mul_f32 v151, v15, v151
v_and_b32 v15, 15, v0
v_lshlrev_b32 v15, 2, v15
v_add_u32 v15, 162688, v15
ds_read_b32 v15, v15
v_cmp_eq_u32 vcc, 6, v18
s_waitcnt lgkmcnt(0)
s_nop 0
v_cndmask_b32 v15, 1.0, v15, vcc
v_mul_f32 v72, v15, v72
v_mul_f32 v73, v15, v73
v_mul_f32 v74, v15, v74
v_mul_f32 v75, v15, v75
v_mul_f32 v88, v15, v88
v_mul_f32 v89, v15, v89
v_mul_f32 v90, v15, v90
v_mul_f32 v91, v15, v91
v_mul_f32 v104, v15, v104
v_mul_f32 v105, v15, v105
v_mul_f32 v106, v15, v106
v_mul_f32 v107, v15, v107
v_mul_f32 v120, v15, v120
v_mul_f32 v121, v15, v121
v_mul_f32 v122, v15, v122
v_mul_f32 v123, v15, v123
v_mul_f32 v136, v15, v136
v_mul_f32 v137, v15, v137
v_mul_f32 v138, v15, v138
v_mul_f32 v139, v15, v139
v_mul_f32 v152, v15, v152
v_mul_f32 v153, v15, v153
v_mul_f32 v154, v15, v154
v_mul_f32 v155, v15, v155
v_and_b32 v15, 15, v0
v_lshlrev_b32 v15, 2, v15
v_add_u32 v15, 162752, v15
ds_read_b32 v15, v15
v_cmp_eq_u32 vcc, 6, v19
s_waitcnt lgkmcnt(0)
s_nop 0
v_cndmask_b32 v15, 1.0, v15, vcc
v_mul_f32 v76, v15, v76
v_mul_f32 v77, v15, v77
v_mul_f32 v78, v15, v78
v_mul_f32 v79, v15, v79
v_mul_f32 v92, v15, v92
v_mul_f32 v93, v15, v93
v_mul_f32 v94, v15, v94
v_mul_f32 v95, v15, v95
v_mul_f32 v108, v15, v108
v_mul_f32 v109, v15, v109
v_mul_f32 v110, v15, v110
v_mul_f32 v111, v15, v111
v_mul_f32 v124, v15, v124
v_mul_f32 v125, v15, v125
v_mul_f32 v126, v15, v126
v_mul_f32 v127, v15, v127
v_mul_f32 v140, v15, v140
v_mul_f32 v141, v15, v141
v_mul_f32 v142, v15, v142
v_mul_f32 v143, v15, v143
v_mul_f32 v156, v15, v156
v_mul_f32 v157, v15, v157
v_mul_f32 v158, v15, v158
v_mul_f32 v159, v15, v159
s_nop 1
s_branch C_R5a
RESC6a:
s_nop 7
v_and_b32 v15, 15, v0
v_lshlrev_b32 v15, 2, v15
v_add_u32 v15, 162304, v15
ds_read_b32 v15, v15
v_cmp_eq_u32 vcc, 7, v16
s_waitcnt lgkmcnt(0)
s_nop 0
v_cndmask_b32 v15, 1.0, v15, vcc
v_mul_f32 v64, v15, v64
v_mul_f32 v65, v15, v65
v_mul_f32 v66, v15, v66
v_mul_f32 v67, v15, v67
v_mul_f32 v80, v15, v80
v_mul_f32 v81, v15, v81
v_mul_f32 v82, v15, v82
v_mul_f32 v83, v15, v83
v_mul_f32 v96, v15, v96
v_mul_f32 v97, v15, v97
v_mul_f32 v98, v15, v98
v_mul_f32 v99, v15, v99
v_mul_f32 v112, v15, v112
v_mul_f32 v113, v15, v113
v_mul_f32 v114, v15, v114
v_mul_f32 v115, v15, v115
v_mul_f32 v128, v15, v128
v_mul_f32 v129, v15, v129
v_mul_f32 v130, v15, v130
v_mul_f32 v131, v15, v131
v_mul_f32 v144, v15, v144
v_mul_f32 v145, v15, v145
v_mul_f32 v146, v15, v146
v_mul_f32 v147, v15, v147
v_and_b32 v15, 15, v0
v_lshlrev_b32 v15, 2, v15
v_add_u32 v15, 162368, v15
ds_read_b32 v15, v15
v_cmp_eq_u32 vcc, 7, v17
s_waitcnt lgkmcnt(0)
s_nop 0
v_cndmask_b32 v15, 1.0, v15, vcc
v_mul_f32 v68, v15, v68
v_mul_f32 v69, v15, v69
v_mul_f32 v70, v15, v70
v_mul_f32 v71, v15, v71
v_mul_f32 v84, v15, v84
v_mul_f32 v85, v15, v85
v_mul_f32 v86, v15, v86
v_mul_f32 v87, v15, v87
v_mul_f32 v100, v15, v100
v_mul_f32 v101, v15, v101
v_mul_f32 v102, v15, v102
v_mul_f32 v103, v15, v103
v_mul_f32 v116, v15, v116
v_mul_f32 v117, v15, v117
v_mul_f32 v118, v15, v118
v_mul_f32 v119, v15, v119
v_mul_f32 v132, v15, v132
v_mul_f32 v133, v15, v133
v_mul_f32 v134, v15, v134
v_mul_f32 v135, v15, v135
v_mul_f32 v148, v15, v148
v_mul_f32 v149, v15, v149
v_mul_f32 v150, v15, v150
v_mul_f32 v151, v15, v151
v_and_b32 v15, 15, v0
v_lshlrev_b32 v15, 2, v15
v_add_u32 v15, 162432, v15
ds_read_b32 v15, v15
v_cmp_eq_u32 vcc, 7, v18
s_waitcnt lgkmcnt(0)
s_nop 0
v_cndmask_b32 v15, 1.0, v15, vcc
v_mul_f32 v72, v15, v72
v_mul_f32 v73, v15, v73
v_mul_f32 v74, v15, v74
v_mul_f32 v75, v15, v75
v_mul_f32 v88, v15, v88
v_mul_f32 v89, v15, v89
v_mul_f32 v90, v15, v90
v_mul_f32 v91, v15, v91
v_mul_f32 v104, v15, v104
v_mul_f32 v105, v15, v105
v_mul_f32 v106, v15, v106
v_mul_f32 v107, v15, v107
v_mul_f32 v120, v15, v120
v_mul_f32 v121, v15, v121
v_mul_f32 v122, v15, v122
v_mul_f32 v123, v15, v123
v_mul_f32 v136, v15, v136
v_mul_f32 v137, v15, v137
v_mul_f32 v138, v15, v138
v_mul_f32 v139, v15, v139
v_mul_f32 v152, v15, v152
v_mul_f32 v153, v15, v153
v_mul_f32 v154, v15, v154
v_mul_f32 v155, v15, v155
v_and_b32 v15, 15, v0
v_lshlrev_b32 v15, 2, v15
v_add_u32 v15, 162496, v15
ds_read_b32 v15, v15
v_cmp_eq_u32 vcc, 7, v19
s_waitcnt lgkmcnt(0)
s_nop 0
v_cndmask_b32 v15, 1.0, v15, vcc
v_mul_f32 v76, v15, v76
v_mul_f32 v77, v15, v77
v_mul_f32 v78, v15, v78
v_mul_f32 v79, v15, v79
v_mul_f32 v92, v15, v92
v_mul_f32 v93, v15, v93
v_mul_f32 v94, v15, v94
v_mul_f32 v95, v15, v95
v_mul_f32 v108, v15, v108
v_mul_f32 v109, v15, v109
v_mul_f32 v110, v15, v110
v_mul_f32 v111, v15, v111
v_mul_f32 v124, v15, v124
v_mul_f32 v125, v15, v125
v_mul_f32 v126, v15, v126
v_mul_f32 v127, v15, v127
v_mul_f32 v140, v15, v140
v_mul_f32 v141, v15, v141
v_mul_f32 v142, v15, v142
v_mul_f32 v143, v15, v143
v_mul_f32 v156, v15, v156
v_mul_f32 v157, v15, v157
v_mul_f32 v158, v15, v158
v_mul_f32 v159, v15, v159
s_nop 1
s_branch C_R6a
RESC7a:
s_nop 7
v_and_b32 v15, 15, v0
v_lshlrev_b32 v15, 2, v15
v_add_u32 v15, 162560, v15
ds_read_b32 v15, v15
v_cmp_eq_u32 vcc, 8, v16
s_waitcnt lgkmcnt(0)
s_nop 0
v_cndmask_b32 v15, 1.0, v15, vcc
v_mul_f32 v64, v15, v64
v_mul_f32 v65, v15, v65
v_mul_f32 v66, v15, v66
v_mul_f32 v67, v15, v67
v_mul_f32 v80, v15, v80
v_mul_f32 v81, v15, v81
v_mul_f32 v82, v15, v82
v_mul_f32 v83, v15, v83
v_mul_f32 v96, v15, v96
v_mul_f32 v97, v15, v97
v_mul_f32 v98, v15, v98
v_mul_f32 v99, v15, v99
v_mul_f32 v112, v15, v112
v_mul_f32 v113, v15, v113
v_mul_f32 v114, v15, v114
v_mul_f32 v115, v15, v115
v_mul_f32 v128, v15, v128
v_mul_f32 v129, v15, v129
v_mul_f32 v130, v15, v130
v_mul_f32 v131, v15, v131
v_mul_f32 v144, v15, v144
v_mul_f32 v145, v15, v145
v_mul_f32 v146, v15, v146
v_mul_f32 v147, v15, v147
v_and_b32 v15, 15, v0
v_lshlrev_b32 v15, 2, v15
v_add_u32 v15, 162624, v15
ds_read_b32 v15, v15
v_cmp_eq_u32 vcc, 8, v17
s_waitcnt lgkmcnt(0)
s_nop 0
v_cndmask_b32 v15, 1.0, v15, vcc
v_mul_f32 v68, v15, v68
v_mul_f32 v69, v15, v69
v_mul_f32 v70, v15, v70
v_mul_f32 v71, v15, v71
v_mul_f32 v84, v15, v84
v_mul_f32 v85, v15, v85
v_mul_f32 v86, v15, v86
v_mul_f32 v87, v15, v87
v_mul_f32 v100, v15, v100
v_mul_f32 v101, v15, v101
v_mul_f32 v102, v15, v102
v_mul_f32 v103, v15, v103
v_mul_f32 v116, v15, v116
v_mul_f32 v117, v15, v117
v_mul_f32 v118, v15, v118
v_mul_f32 v119, v15, v119
v_mul_f32 v132, v15, v132
v_mul_f32 v133, v15, v133
v_mul_f32 v134, v15, v134
v_mul_f32 v135, v15, v135
v_mul_f32 v148, v15, v148
v_mul_f32 v149, v15, v149
v_mul_f32 v150, v15, v150
v_mul_f32 v151, v15, v151
v_and_b32 v15, 15, v0
v_lshlrev_b32 v15, 2, v15
v_add_u32 v15, 162688, v15
ds_read_b32 v15, v15
v_cmp_eq_u32 vcc, 8, v18
s_waitcnt lgkmcnt(0)
s_nop 0
v_cndmask_b32 v15, 1.0, v15, vcc
v_mul_f32 v72, v15, v72
v_mul_f32 v73, v15, v73
v_mul_f32 v74, v15, v74
v_mul_f32 v75, v15, v75
v_mul_f32 v88, v15, v88
v_mul_f32 v89, v15, v89
v_mul_f32 v90, v15, v90
v_mul_f32 v91, v15, v91
v_mul_f32 v104, v15, v104
v_mul_f32 v105, v15, v105
v_mul_f32 v106, v15, v106
v_mul_f32 v107, v15, v107
v_mul_f32 v120, v15, v120
v_mul_f32 v121, v15, v121
v_mul_f32 v122, v15, v122
v_mul_f32 v123, v15, v123
v_mul_f32 v136, v15, v136
v_mul_f32 v137, v15, v137
v_mul_f32 v138, v15, v138
v_mul_f32 v139, v15, v139
v_mul_f32 v152, v15, v152
v_mul_f32 v153, v15, v153
v_mul_f32 v154, v15, v154
v_mul_f32 v155, v15, v155
v_and_b32 v15, 15, v0
v_lshlrev_b32 v15, 2, v15
v_add_u32 v15, 162752, v15
ds_read_b32 v15, v15
v_cmp_eq_u32 vcc, 8, v19
s_waitcnt lgkmcnt(0)
s_nop 0
v_cndmask_b32 v15, 1.0, v15, vcc
v_mul_f32 v76, v15, v76
v_mul_f32 v77, v15, v77
v_mul_f32 v78, v15, v78
v_mul_f32 v79, v15, v79
v_mul_f32 v92, v15, v92
v_mul_f32 v93, v15, v93
v_mul_f32 v94, v15, v94
v_mul_f32 v95, v15, v95
v_mul_f32 v108, v15, v108
v_mul_f32 v109, v15, v109
v_mul_f32 v110, v15, v110
v_mul_f32 v111, v15, v111
v_mul_f32 v124, v15, v124
v_mul_f32 v125, v15, v125
v_mul_f32 v126, v15, v126
v_mul_f32 v127, v15, v127
v_mul_f32 v140, v15, v140
v_mul_f32 v141, v15, v141
v_mul_f32 v142, v15, v142
v_mul_f32 v143, v15, v143
v_mul_f32 v156, v15, v156
v_mul_f32 v157, v15, v157
v_mul_f32 v158, v15, v158
v_mul_f32 v159, v15, v159
s_nop 1
s_branch C_R7a
POLLb:
s_mov_b32 s58, 1048576
POLL1b:
s_sleep 6
buffer_load_dword v19, v14, s[28:31], 0 offen sc1
s_sub_u32 s58, s58, 1
s_cbranch_scc1 C_POLLb
s_waitcnt vmcnt(0)
v_cmp_ne_u32 vcc, s38, v19
s_nop 0
s_cbranch_vccnz POLL1b
s_branch C_POLLb
RARE1b:
v_max3_f32 v30, v44, v45, v46
v_max3_f32 v31, v47, v48, v49
v_max3_f32 v30, v30, v50, v51
v_max_f32 v30, v30, v31
v_mov_b32 v31, v30
s_nop 1
v_permlane32_swap_b32 v30, v31
v_max_f32 v30, v30, v31
v_mov_b32 v31, v30
s_nop 1
v_permlane16_swap_b32 v30, v31
v_max_f32 v30, v30, v31
v_max_f32 v30, 0, v30
v_sub_f32 v44, v44, v30
v_sub_f32 v45, v45, v30
v_sub_f32 v46, v46, v30
v_sub_f32 v47, v47, v30
v_sub_f32 v48, v48, v30
v_sub_f32 v49, v49, v30
v_sub_f32 v50, v50, v30
v_sub_f32 v51, v51, v30
v_sub_f32 v15, v15, v30
v_exp_f32 v18, -v30
s_nop 0
v_mul_f32 v16, v18, v16
v_mul_f32 v68, v18, v68
v_mul_f32 v69, v18, v69
v_mul_f32 v70, v18, v70
v_mul_f32 v71, v18, v71
s_lshl_b32 s59, s3, 6
s_add_u32 s59, s59, 162560
v_and_b32 v30, 15, v0
v_lshl_add_u32 v30, v30, 2, s59
ds_write_b32 v30, v18
s_lshl_b32 s59, s3, 2
s_add_u32 s59, s59, 162832
v_mov_b32 v30, s59
v_mov_b32 v31, 2
ds_write_b32 v30, v31
v_exp_f32 v76, v44
v_exp_f32 v77, v45
v_exp_f32 v78, v46
v_exp_f32 v79, v47
v_exp_f32 v80, v48
v_exp_f32 v81, v49
v_exp_f32 v82, v50
v_exp_f32 v83, v51
v_add_f32 v32, v76, v77
v_add_f32 v33, v78, v79
v_add_f32 v34, v80, v81
v_add_f32 v35, v82, v83
v_add_f32 v32, v32, v33
v_add_f32 v34, v34, v35
v_add_f32 v32, v32, v34
s_waitcnt lgkmcnt(0)
s_branch C_1b
RARE2b:
v_max3_f32 v30, v36, v37, v38
v_max3_f32 v31, v39, v40, v41
v_max3_f32 v30, v30, v42, v43
v_max_f32 v30, v30, v31
v_mov_b32 v31, v30
s_nop 1
v_permlane32_swap_b32 v30, v31
v_max_f32 v30, v30, v31
v_mov_b32 v31, v30
s_nop 1
v_permlane16_swap_b32 v30, v31
v_max_f32 v30, v30, v31
v_max_f32 v30, 0, v30
v_sub_f32 v36, v36, v30
v_sub_f32 v37, v37, v30
v_sub_f32 v38, v38, v30
v_sub_f32 v39, v39, v30
v_sub_f32 v40, v40, v30
v_sub_f32 v41, v41, v30
v_sub_f32 v42, v42, v30
v_sub_f32 v43, v43, v30
v_sub_f32 v15, v15, v30
v_exp_f32 v18, -v30
s_nop 0
v_mul_f32 v16, v18, v16
v_mul_f32 v68, v18, v68
v_mul_f32 v69, v18, v69
v_mul_f32 v70, v18, v70
v_mul_f32 v71, v18, v71
s_lshl_b32 s59, s3, 6
s_add_u32 s59, s59, 162304
v_and_b32 v30, 15, v0
v_lshl_add_u32 v30, v30, 2, s59
ds_write_b32 v30, v18
s_lshl_b32 s59, s3, 2
s_add_u32 s59, s59, 162816
v_mov_b32 v30, s59
v_mov_b32 v31, 3
ds_write_b32 v30, v31
v_exp_f32 v76, v36
v_exp_f32 v77, v37
v_exp_f32 v78, v38
v_exp_f32 v79, v39
v_exp_f32 v80, v40
v_exp_f32 v81, v41
v_exp_f32 v82, v42
v_exp_f32 v83, v43
v_add_f32 v32, v76, v77
v_add_f32 v33, v78, v79
v_add_f32 v34, v80, v81
v_add_f32 v35, v82, v83
v_add_f32 v32, v32, v33
v_add_f32 v34, v34, v35
v_add_f32 v32, v32, v34
s_waitcnt lgkmcnt(0)
s_branch C_2b
RARE3b:
v_max3_f32 v30, v44, v45, v46
v_max3_f32 v31, v47, v48, v49
v_max3_f32 v30, v30, v50, v51
v_max_f32 v30, v30, v31
v_mov_b32 v31, v30
s_nop 1
v_permlane32_swap_b32 v30, v31
v_max_f32 v30, v30, v31
v_mov_b32 v31, v30
s_nop 1
v_permlane16_swap_b32 v30, v31
v_max_f32 v30, v30, v31
v_max_f32 v30, 0, v30
v_sub_f32 v44, v44, v30
v_sub_f32 v45, v45, v30
v_sub_f32 v46, v46, v30
v_sub_f32 v47, v47, v30
v_sub_f32 v48, v48, v30
v_sub_f32 v49, v49, v30
v_sub_f32 v50, v50, v30
v_sub_f32 v51, v51, v30
v_sub_f32 v15, v15, v30
v_exp_f32 v18, -v30
s_nop 0
v_mul_f32 v16, v18, v16
v_mul_f32 v68, v18, v68
v_mul_f32 v69, v18, v69
v_mul_f32 v70, v18, v70
v_mul_f32 v71, v18, v71
v_mul_f32 v72, v18, v72
v_mul_f32 v73, v18, v73
v_mul_f32 v74, v18, v74
v_mul_f32 v75, v18, v75
s_lshl_b32 s59, s3, 6
s_add_u32 s59, s59, 162560
v_and_b32 v30, 15, v0
v_lshl_add_u32 v30, v30, 2, s59
ds_write_b32 v30, v18
s_lshl_b32 s59, s3, 2
s_add_u32 s59, s59, 162832
v_mov_b32 v30, s59
v_mov_b32 v31, 4
ds_write_b32 v30, v31
v_exp_f32 v76, v44
v_exp_f32 v77, v45
v_exp_f32 v78, v46
v_exp_f32 v79, v47
v_exp_f32 v80, v48
v_exp_f32 v81, v49
v_exp_f32 v82, v50
v_exp_f32 v83, v51
v_add_f32 v32, v76, v77
v_add_f32 v33, v78, v79
v_add_f32 v34, v80, v81
v_add_f32 v35, v82, v83
v_add_f32 v32, v32, v33
v_add_f32 v34, v34, v35
v_add_f32 v32, v32, v34
s_waitcnt lgkmcnt(0)
s_branch C_3b
RARE4b:
v_max3_f32 v30, v36, v37, v38
v_max3_f32 v31, v39, v40, v41
v_max3_f32 v30, v30, v42, v43
v_max_f32 v30, v30, v31
v_mov_b32 v31, v30
s_nop 1
v_permlane32_swap_b32 v30, v31
v_max_f32 v30, v30, v31
v_mov_b32 v31, v30
s_nop 1
v_permlane16_swap_b32 v30, v31
v_max_f32 v30, v30, v31
v_max_f32 v30, 0, v30
v_sub_f32 v36, v36, v30
v_sub_f32 v37, v37, v30
v_sub_f32 v38, v38, v30
v_sub_f32 v39, v39, v30
v_sub_f32 v40, v40, v30
v_sub_f32 v41, v41, v30
v_sub_f32 v42, v42, v30
v_sub_f32 v43, v43, v30
v_sub_f32 v15, v15, v30
v_exp_f32 v18, -v30
s_nop 0
v_mul_f32 v16, v18, v16
s_lshl_b32 s59, s3, 6
s_add_u32 s59, s59, 162304
v_and_b32 v30, 15, v0
v_lshl_add_u32 v30, v30, 2, s59
ds_write_b32 v30, v18
s_lshl_b32 s59, s3, 2
s_add_u32 s59, s59, 162816
v_mov_b32 v30, s59
v_mov_b32 v31, 5
ds_write_b32 v30, v31
v_exp_f32 v76, v36
v_exp_f32 v77, v37
v_exp_f32 v78, v38
v_exp_f32 v79, v39
v_exp_f32 v80, v40
v_exp_f32 v81, v41
v_exp_f32 v82, v42
v_exp_f32 v83, v43
v_add_f32 v32, v76, v77
v_add_f32 v33, v78, v79
v_add_f32 v34, v80, v81
v_add_f32 v35, v82, v83
v_add_f32 v32, v32, v33
v_add_f32 v34, v34, v35
v_add_f32 v32, v32, v34
s_waitcnt lgkmcnt(0)
s_branch C_4b
RARE5b:
v_max3_f32 v30, v44, v45, v46
v_max3_f32 v31, v47, v48, v49
v_max3_f32 v30, v30, v50, v51
v_max_f32 v30, v30, v31
v_mov_b32 v31, v30
s_nop 1
v_permlane32_swap_b32 v30, v31
v_max_f32 v30, v30, v31
v_mov_b32 v31, v30
s_nop 1
v_permlane16_swap_b32 v30, v31
v_max_f32 v30, v30, v31
v_max_f32 v30, 0, v30
v_sub_f32 v44, v44, v30
v_sub_f32 v45, v45, v30
v_sub_f32 v46, v46, v30
v_sub_f32 v47, v47, v30
v_sub_f32 v48, v48, v30
v_sub_f32 v49, v49, v30
v_sub_f32 v50, v50, v30
v_sub_f32 v51, v51, v30
v_sub_f32 v15, v15, v30
v_exp_f32 v18, -v30
s_nop 0
v_mul_f32 v16, v18, v16
v_mul_f32 v68, v18, v68
v_mul_f32 v69, v18, v69
v_mul_f32 v70, v18, v70
v_mul_f32 v71, v18, v71
s_lshl_b32 s59, s3, 6
s_add_u32 s59, s59, 162560
v_and_b32 v30, 15, v0
v_lshl_add_u32 v30, v30, 2, s59
ds_write_b32 v30, v18
s_lshl_b32 s59, s3, 2
s_add_u32 s59, s59, 162832
v_mov_b32 v30, s59
v_mov_b32 v31, 6
ds_write_b32 v30, v31
v_exp_f32 v76, v44
v_exp_f32 v77, v45
v_exp_f32 v78, v46
v_exp_f32 v79, v47
v_exp_f32 v80, v48
v_exp_f32 v81, v49
v_exp_f32 v82, v50
v_exp_f32 v83, v51
v_add_f32 v32, v76, v77
v_add_f32 v33, v78, v79
v_add_f32 v34, v80, v81
v_add_f32 v35, v82, v83
v_add_f32 v32, v32, v33
v_add_f32 v34, v34, v35
v_add_f32 v32, v32, v34
s_waitcnt lgkmcnt(0)
s_branch C_5b
RARE6b:
v_max3_f32 v30, v36, v37, v38
v_max3_f32 v31, v39, v40, v41
v_max3_f32 v30, v30, v42, v43
v_max_f32 v30, v30, v31
v_mov_b32 v31, v30
s_nop 1
v_permlane32_swap_b32 v30, v31
v_max_f32 v30, v30, v31
v_mov_b32 v31, v30
s_nop 1
v_permlane16_swap_b32 v30, v31
v_max_f32 v30, v30, v31
v_max_f32 v30, 0, v30
v_sub_f32 v36, v36, v30
v_sub_f32 v37, v37, v30
v_sub_f32 v38, v38, v30
v_sub_f32 v39, v39, v30
v_sub_f32 v40, v40, v30
v_sub_f32 v41, v41, v30
v_sub_f32 v42, v42, v30
v_sub_f32 v43, v43, v30
v_sub_f32 v15, v15, v30
v_exp_f32 v18, -v30
s_nop 0
v_mul_f32 v16, v18, v16
v_mul_f32 v68, v18, v68
v_mul_f32 v69, v18, v69
v_mul_f32 v70, v18, v70
v_mul_f32 v71, v18, v71
s_lshl_b32 s59, s3, 6
s_add_u32 s59, s59, 162304
v_and_b32 v30, 15, v0
v_lshl_add_u32 v30, v30, 2, s59
ds_write_b32 v30, v18
s_lshl_b32 s59, s3, 2
s_add_u32 s59, s59, 162816
v_mov_b32 v30, s59
v_mov_b32 v31, 7
ds_write_b32 v30, v31
v_exp_f32 v76, v36
v_exp_f32 v77, v37
v_exp_f32 v78, v38
v_exp_f32 v79, v39
v_exp_f32 v80, v40
v_exp_f32 v81, v41
v_exp_f32 v82, v42
v_exp_f32 v83, v43
v_add_f32 v32, v76, v77
v_add_f32 v33, v78, v79
v_add_f32 v34, v80, v81
v_add_f32 v35, v82, v83
v_add_f32 v32, v32, v33
v_add_f32 v34, v34, v35
v_add_f32 v32, v32, v34
s_waitcnt lgkmcnt(0)
s_branch C_6b
RARE7b:
v_max3_f32 v30, v44, v45, v46
v_max3_f32 v31, v47, v48, v49
v_max3_f32 v30, v30, v50, v51
v_max_f32 v30, v30, v31
v_mov_b32 v31, v30
s_nop 1
v_permlane32_swap_b32 v30, v31
v_max_f32 v30, v30, v31
v_mov_b32 v31, v30
s_nop 1
v_permlane16_swap_b32 v30, v31
v_max_f32 v30, v30, v31
v_max_f32 v30, 0, v30
v_sub_f32 v44, v44, v30
v_sub_f32 v45, v45, v30
v_sub_f32 v46, v46, v30
v_sub_f32 v47, v47, v30
v_sub_f32 v48, v48, v30
v_sub_f32 v49, v49, v30
v_sub_f32 v50, v50, v30
v_sub_f32 v51, v51, v30
v_sub_f32 v15, v15, v30
v_exp_f32 v18, -v30
s_nop 0
v_mul_f32 v16, v18, v16
v_mul_f32 v68, v18, v68
v_mul_f32 v69, v18, v69
v_mul_f32 v70, v18, v70
v_mul_f32 v71, v18, v71
v_mul_f32 v72, v18, v72
v_mul_f32 v73, v18, v73
v_mul_f32 v74, v18, v74
v_mul_f32 v75, v18, v75
s_lshl_b32 s59, s3, 6
s_add_u32 s59, s59, 162560
v_and_b32 v30, 15, v0
v_lshl_add_u32 v30, v30, 2, s59
ds_write_b32 v30, v18
s_lshl_b32 s59, s3, 2
s_add_u32 s59, s59, 162832
v_mov_b32 v30, s59
v_mov_b32 v31, 8
ds_write_b32 v30, v31
v_exp_f32 v76, v44
v_exp_f32 v77, v45
v_exp_f32 v78, v46
v_exp_f32 v79, v47
v_exp_f32 v80, v48
v_exp_f32 v81, v49
v_exp_f32 v82, v50
v_exp_f32 v83, v51
v_add_f32 v32, v76, v77
v_add_f32 v33, v78, v79
v_add_f32 v34, v80, v81
v_add_f32 v35, v82, v83
v_add_f32 v32, v32, v33
v_add_f32 v34, v34, v35
v_add_f32 v32, v32, v34
s_waitcnt lgkmcnt(0)
s_branch C_7b
RESC1b:
s_nop 7
v_and_b32 v15, 15, v0
v_lshlrev_b32 v15, 2, v15
v_add_u32 v15, 162560, v15
ds_read_b32 v15, v15
v_cmp_eq_u32 vcc, 2, v16
s_waitcnt lgkmcnt(0)
s_nop 0
v_cndmask_b32 v15, 1.0, v15, vcc
v_mul_f32 v64, v15, v64
v_mul_f32 v65, v15, v65
v_mul_f32 v66, v15, v66
v_mul_f32 v67, v15, v67
v_mul_f32 v80, v15, v80
v_mul_f32 v81, v15, v81
v_mul_f32 v82, v15, v82
v_mul_f32 v83, v15, v83
v_mul_f32 v96, v15, v96
v_mul_f32 v97, v15, v97
v_mul_f32 v98, v15, v98
v_mul_f32 v99, v15, v99
v_mul_f32 v112, v15, v112
v_mul_f32 v113, v15, v113
v_mul_f32 v114, v15, v114
v_mul_f32 v115, v15, v115
v_mul_f32 v128, v15, v128
v_mul_f32 v129, v15, v129
v_mul_f32 v130, v15, v130
v_mul_f32 v131, v15, v131
v_mul_f32 v144, v15, v144
v_mul_f32 v145, v15, v145
v_mul_f32 v146, v15, v146
v_mul_f32 v147, v15, v147
v_and_b32 v15, 15, v0
v_lshlrev_b32 v15, 2, v15
v_add_u32 v15, 162624, v15
ds_read_b32 v15, v15
v_cmp_eq_u32 vcc, 2, v17
s_waitcnt lgkmcnt(0)
s_nop 0
v_cndmask_b32 v15, 1.0, v15, vcc
v_mul_f32 v68, v15, v68
v_mul_f32 v69, v15, v69
v_mul_f32 v70, v15, v70
v_mul_f32 v71, v15, v71
v_mul_f32 v84, v15, v84
v_mul_f32 v85, v15, v85
v_mul_f32 v86, v15, v86
v_mul_f32 v87, v15, v87
v_mul_f32 v100, v15, v100
v_mul_f32 v101, v15, v101
v_mul_f32 v102, v15, v102
v_mul_f32 v103, v15, v103
v_mul_f32 v116, v15, v116
v_mul_f32 v117, v15, v117
v_mul_f32 v118, v15, v118
v_mul_f32 v119, v15, v119
v_mul_f32 v132, v15, v132
v_mul_f32 v133, v15, v133
v_mul_f32 v134, v15, v134
v_mul_f32 v135, v15, v135
v_mul_f32 v148, v15, v148
v_mul_f32 v149, v15, v149
v_mul_f32 v150, v15, v150
v_mul_f32 v151, v15, v151
v_and_b32 v15, 15, v0
v_lshlrev_b32 v15, 2, v15
v_add_u32 v15, 162688, v15
ds_read_b32 v15, v15
v_cmp_eq_u32 vcc, 2, v18
s_waitcnt lgkmcnt(0)
s_nop 0
v_cndmask_b32 v15, 1.0, v15, vcc
v_mul_f32 v72, v15, v72
v_mul_f32 v73, v15, v73
v_mul_f32 v74, v15, v74
v_mul_f32 v75, v15, v75
v_mul_f32 v88, v15, v88
v_mul_f32 v89, v15, v89
v_mul_f32 v90, v15, v90
v_mul_f32 v91, v15, v91
v_mul_f32 v104, v15, v104
v_mul_f32 v105, v15, v105
v_mul_f32 v106, v15, v106
v_mul_f32 v107, v15, v107
v_mul_f32 v120, v15, v120
v_mul_f32 v121, v15, v121
v_mul_f32 v122, v15, v122
v_mul_f32 v123, v15, v123
v_mul_f32 v136, v15, v136
v_mul_f32 v137, v15, v137
v_mul_f32 v138, v15, v138
v_mul_f32 v139, v15, v139
v_mul_f32 v152, v15, v152
v_mul_f32 v153, v15, v153
v_mul_f32 v154, v15, v154
v_mul_f32 v155, v15, v155
v_and_b32 v15, 15, v0
v_lshlrev_b32 v15, 2, v15
v_add_u32 v15, 162752, v15
ds_read_b32 v15, v15
v_cmp_eq_u32 vcc, 2, v19
s_waitcnt lgkmcnt(0)
s_nop 0
v_cndmask_b32 v15, 1.0, v15, vcc
v_mul_f32 v76, v15, v76
v_mul_f32 v77, v15, v77
v_mul_f32 v78, v15, v78
v_mul_f32 v79, v15, v79
v_mul_f32 v92, v15, v92
v_mul_f32 v93, v15, v93
v_mul_f32 v94, v15, v94
v_mul_f32 v95, v15, v95
v_mul_f32 v108, v15, v108
v_mul_f32 v109, v15, v109
v_mul_f32 v110, v15, v110
v_mul_f32 v111, v15, v111
v_mul_f32 v124, v15, v124
v_mul_f32 v125, v15, v125
v_mul_f32 v126, v15, v126
v_mul_f32 v127, v15, v127
v_mul_f32 v140, v15, v140
v_mul_f32 v141, v15, v141
v_mul_f32 v142, v15, v142
v_mul_f32 v143, v15, v143
v_mul_f32 v156, v15, v156
v_mul_f32 v157, v15, v157
v_mul_f32 v158, v15, v158
v_mul_f32 v159, v15, v159
s_nop 1
s_branch C_R1b
RESC2b:
s_nop 7
v_and_b32 v15, 15, v0
v_lshlrev_b32 v15, 2, v15
v_add_u32 v15, 162304, v15
ds_read_b32 v15, v15
v_cmp_eq_u32 vcc, 3, v16
s_waitcnt lgkmcnt(0)
s_nop 0
v_cndmask_b32 v15, 1.0, v15, vcc
v_mul_f32 v64, v15, v64
v_mul_f32 v65, v15, v65
v_mul_f32 v66, v15, v66
v_mul_f32 v67, v15, v67
v_mul_f32 v80, v15, v80
v_mul_f32 v81, v15, v81
v_mul_f32 v82, v15, v82
v_mul_f32 v83, v15, v83
v_mul_f32 v96, v15, v96
v_mul_f32 v97, v15, v97
v_mul_f32 v98, v15, v98
v_mul_f32 v99, v15, v99
v_mul_f32 v112, v15, v112
v_mul_f32 v113, v15, v113
v_mul_f32 v114, v15, v114
v_mul_f32 v115, v15, v115
v_mul_f32 v128, v15, v128
v_mul_f32 v129, v15, v129
v_mul_f32 v130, v15, v130
v_mul_f32 v131, v15, v131
v_mul_f32 v144, v15, v144
v_mul_f32 v145, v15, v145
v_mul_f32 v146, v15, v146
v_mul_f32 v147, v15, v147
v_and_b32 v15, 15, v0
v_lshlrev_b32 v15, 2, v15
v_add_u32 v15, 162368, v15
ds_read_b32 v15, v15
v_cmp_eq_u32 vcc, 3, v17
s_waitcnt lgkmcnt(0)
s_nop 0
v_cndmask_b32 v15, 1.0, v15, vcc
v_mul_f32 v68, v15, v68
v_mul_f32 v69, v15, v69
v_mul_f32 v70, v15, v70
v_mul_f32 v71, v15, v71
v_mul_f32 v84, v15, v84
v_mul_f32 v85, v15, v85
v_mul_f32 v86, v15, v86
v_mul_f32 v87, v15, v87
v_mul_f32 v100, v15, v100
v_mul_f32 v101, v15, v101
v_mul_f32 v102, v15, v102
v_mul_f32 v103, v15, v103
v_mul_f32 v116, v15, v116
v_mul_f32 v117, v15, v117
v_mul_f32 v118, v15, v118
v_mul_f32 v119, v15, v119
v_mul_f32 v132, v15, v132
v_mul_f32 v133, v15, v133
v_mul_f32 v134, v15, v134
v_mul_f32 v135, v15, v135
v_mul_f32 v148, v15, v148
v_mul_f32 v149, v15, v149
v_mul_f32 v150, v15, v150
v_mul_f32 v151, v15, v151
v_and_b32 v15, 15, v0
v_lshlrev_b32 v15, 2, v15
v_add_u32 v15, 162432, v15
ds_read_b32 v15, v15
v_cmp_eq_u32 vcc, 3, v18
s_waitcnt lgkmcnt(0)
s_nop 0
v_cndmask_b32 v15, 1.0, v15, vcc
v_mul_f32 v72, v15, v72
v_mul_f32 v73, v15, v73
v_mul_f32 v74, v15, v74
v_mul_f32 v75, v15, v75
v_mul_f32 v88, v15, v88
v_mul_f32 v89, v15, v89
v_mul_f32 v90, v15, v90
v_mul_f32 v91, v15, v91
v_mul_f32 v104, v15, v104
v_mul_f32 v105, v15, v105
v_mul_f32 v106, v15, v106
v_mul_f32 v107, v15, v107
v_mul_f32 v120, v15, v120
v_mul_f32 v121, v15, v121
v_mul_f32 v122, v15, v122
v_mul_f32 v123, v15, v123
v_mul_f32 v136, v15, v136
v_mul_f32 v137, v15, v137
v_mul_f32 v138, v15, v138
v_mul_f32 v139, v15, v139
v_mul_f32 v152, v15, v152
v_mul_f32 v153, v15, v153
v_mul_f32 v154, v15, v154
v_mul_f32 v155, v15, v155
v_and_b32 v15, 15, v0
v_lshlrev_b32 v15, 2, v15
v_add_u32 v15, 162496, v15
ds_read_b32 v15, v15
v_cmp_eq_u32 vcc, 3, v19
s_waitcnt lgkmcnt(0)
s_nop 0
v_cndmask_b32 v15, 1.0, v15, vcc
v_mul_f32 v76, v15, v76
v_mul_f32 v77, v15, v77
v_mul_f32 v78, v15, v78
v_mul_f32 v79, v15, v79
v_mul_f32 v92, v15, v92
v_mul_f32 v93, v15, v93
v_mul_f32 v94, v15, v94
v_mul_f32 v95, v15, v95
v_mul_f32 v108, v15, v108
v_mul_f32 v109, v15, v109
v_mul_f32 v110, v15, v110
v_mul_f32 v111, v15, v111
v_mul_f32 v124, v15, v124
v_mul_f32 v125, v15, v125
v_mul_f32 v126, v15, v126
v_mul_f32 v127, v15, v127
v_mul_f32 v140, v15, v140
v_mul_f32 v141, v15, v141
v_mul_f32 v142, v15, v142
v_mul_f32 v143, v15, v143
v_mul_f32 v156, v15, v156
v_mul_f32 v157, v15, v157
v_mul_f32 v158, v15, v158
v_mul_f32 v159, v15, v159
s_nop 1
s_branch C_R2b
RESC3b:
s_nop 7
v_and_b32 v15, 15, v0
v_lshlrev_b32 v15, 2, v15
v_add_u32 v15, 162560, v15
ds_read_b32 v15, v15
v_cmp_eq_u32 vcc, 4, v16
s_waitcnt lgkmcnt(0)
s_nop 0
v_cndmask_b32 v15, 1.0, v15, vcc
v_mul_f32 v64, v15, v64
v_mul_f32 v65, v15, v65
v_mul_f32 v66, v15, v66
v_mul_f32 v67, v15, v67
v_mul_f32 v80, v15, v80
v_mul_f32 v81, v15, v81
v_mul_f32 v82, v15, v82
v_mul_f32 v83, v15, v83
v_mul_f32 v96, v15, v96
v_mul_f32 v97, v15, v97
v_mul_f32 v98, v15, v98
v_mul_f32 v99, v15, v99
v_mul_f32 v112, v15, v112
v_mul_f32 v113, v15, v113
v_mul_f32 v114, v15, v114
v_mul_f32 v115, v15, v115
v_mul_f32 v128, v15, v128
v_mul_f32 v129, v15, v129
v_mul_f32 v130, v15, v130
v_mul_f32 v131, v15, v131
v_mul_f32 v144, v15, v144
v_mul_f32 v145, v15, v145
v_mul_f32 v146, v15, v146
v_mul_f32 v147, v15, v147
v_and_b32 v15, 15, v0
v_lshlrev_b32 v15, 2, v15
v_add_u32 v15, 162624, v15
ds_read_b32 v15, v15
v_cmp_eq_u32 vcc, 4, v17
s_waitcnt lgkmcnt(0)
s_nop 0
v_cndmask_b32 v15, 1.0, v15, vcc
v_mul_f32 v68, v15, v68
v_mul_f32 v69, v15, v69
v_mul_f32 v70, v15, v70
v_mul_f32 v71, v15, v71
v_mul_f32 v84, v15, v84
v_mul_f32 v85, v15, v85
v_mul_f32 v86, v15, v86
v_mul_f32 v87, v15, v87
v_mul_f32 v100, v15, v100
v_mul_f32 v101, v15, v101
v_mul_f32 v102, v15, v102
v_mul_f32 v103, v15, v103
v_mul_f32 v116, v15, v116
v_mul_f32 v117, v15, v117
v_mul_f32 v118, v15, v118
v_mul_f32 v119, v15, v119
v_mul_f32 v132, v15, v132
v_mul_f32 v133, v15, v133
v_mul_f32 v134, v15, v134
v_mul_f32 v135, v15, v135
v_mul_f32 v148, v15, v148
v_mul_f32 v149, v15, v149
v_mul_f32 v150, v15, v150
v_mul_f32 v151, v15, v151
v_and_b32 v15, 15, v0
v_lshlrev_b32 v15, 2, v15
v_add_u32 v15, 162688, v15
ds_read_b32 v15, v15
v_cmp_eq_u32 vcc, 4, v18
s_waitcnt lgkmcnt(0)
s_nop 0
v_cndmask_b32 v15, 1.0, v15, vcc
v_mul_f32 v72, v15, v72
v_mul_f32 v73, v15, v73
v_mul_f32 v74, v15, v74
v_mul_f32 v75, v15, v75
v_mul_f32 v88, v15, v88
v_mul_f32 v89, v15, v89
v_mul_f32 v90, v15, v90
v_mul_f32 v91, v15, v91
v_mul_f32 v104, v15, v104
v_mul_f32 v105, v15, v105
v_mul_f32 v106, v15, v106
v_mul_f32 v107, v15, v107
v_mul_f32 v120, v15, v120
v_mul_f32 v121, v15, v121
v_mul_f32 v122, v15, v122
v_mul_f32 v123, v15, v123
v_mul_f32 v136, v15, v136
v_mul_f32 v137, v15, v137
v_mul_f32 v138, v15, v138
v_mul_f32 v139, v15, v139
v_mul_f32 v152, v15, v152
v_mul_f32 v153, v15, v153
v_mul_f32 v154, v15, v154
v_mul_f32 v155, v15, v155
v_and_b32 v15, 15, v0
v_lshlrev_b32 v15, 2, v15
v_add_u32 v15, 162752, v15
ds_read_b32 v15, v15
v_cmp_eq_u32 vcc, 4, v19
s_waitcnt lgkmcnt(0)
s_nop 0
v_cndmask_b32 v15, 1.0, v15, vcc
v_mul_f32 v76, v15, v76
v_mul_f32 v77, v15, v77
v_mul_f32 v78, v15, v78
v_mul_f32 v79, v15, v79
v_mul_f32 v92, v15, v92
v_mul_f32 v93, v15, v93
v_mul_f32 v94, v15, v94
v_mul_f32 v95, v15, v95
v_mul_f32 v108, v15, v108
v_mul_f32 v109, v15, v109
v_mul_f32 v110, v15, v110
v_mul_f32 v111, v15, v111
v_mul_f32 v124, v15, v124
v_mul_f32 v125, v15, v125
v_mul_f32 v126, v15, v126
v_mul_f32 v127, v15, v127
v_mul_f32 v140, v15, v140
v_mul_f32 v141, v15, v141
v_mul_f32 v142, v15, v142
v_mul_f32 v143, v15, v143
v_mul_f32 v156, v15, v156
v_mul_f32 v157, v15, v157
v_mul_f32 v158, v15, v158
v_mul_f32 v159, v15, v159
s_nop 1
s_branch C_R3b
RESC4b:
s_nop 7
v_and_b32 v15, 15, v0
v_lshlrev_b32 v15, 2, v15
v_add_u32 v15, 162304, v15
ds_read_b32 v15, v15
v_cmp_eq_u32 vcc, 5, v16
s_waitcnt lgkmcnt(0)
s_nop 0
v_cndmask_b32 v15, 1.0, v15, vcc
v_mul_f32 v64, v15, v64
v_mul_f32 v65, v15, v65
v_mul_f32 v66, v15, v66
v_mul_f32 v67, v15, v67
v_mul_f32 v80, v15, v80
v_mul_f32 v81, v15, v81
v_mul_f32 v82, v15, v82
v_mul_f32 v83, v15, v83
v_mul_f32 v96, v15, v96
v_mul_f32 v97, v15, v97
v_mul_f32 v98, v15, v98
v_mul_f32 v99, v15, v99
v_mul_f32 v112, v15, v112
v_mul_f32 v113, v15, v113
v_mul_f32 v114, v15, v114
v_mul_f32 v115, v15, v115
v_mul_f32 v128, v15, v128
v_mul_f32 v129, v15, v129
v_mul_f32 v130, v15, v130
v_mul_f32 v131, v15, v131
v_mul_f32 v144, v15, v144
v_mul_f32 v145, v15, v145
v_mul_f32 v146, v15, v146
v_mul_f32 v147, v15, v147
v_and_b32 v15, 15, v0
v_lshlrev_b32 v15, 2, v15
v_add_u32 v15, 162368, v15
ds_read_b32 v15, v15
v_cmp_eq_u32 vcc, 5, v17
s_waitcnt lgkmcnt(0)
s_nop 0
v_cndmask_b32 v15, 1.0, v15, vcc
v_mul_f32 v68, v15, v68
v_mul_f32 v69, v15, v69
v_mul_f32 v70, v15, v70
v_mul_f32 v71, v15, v71
v_mul_f32 v84, v15, v84
v_mul_f32 v85, v15, v85
v_mul_f32 v86, v15, v86
v_mul_f32 v87, v15, v87
v_mul_f32 v100, v15, v100
v_mul_f32 v101, v15, v101
v_mul_f32 v102, v15, v102
v_mul_f32 v103, v15, v103
v_mul_f32 v116, v15, v116
v_mul_f32 v117, v15, v117
v_mul_f32 v118, v15, v118
v_mul_f32 v119, v15, v119
v_mul_f32 v132, v15, v132
v_mul_f32 v133, v15, v133
v_mul_f32 v134, v15, v134
v_mul_f32 v135, v15, v135
v_mul_f32 v148, v15, v148
v_mul_f32 v149, v15, v149
v_mul_f32 v150, v15, v150
v_mul_f32 v151, v15, v151
v_and_b32 v15, 15, v0
v_lshlrev_b32 v15, 2, v15
v_add_u32 v15, 162432, v15
ds_read_b32 v15, v15
v_cmp_eq_u32 vcc, 5, v18
s_waitcnt lgkmcnt(0)
s_nop 0
v_cndmask_b32 v15, 1.0, v15, vcc
v_mul_f32 v72, v15, v72
v_mul_f32 v73, v15, v73
v_mul_f32 v74, v15, v74
v_mul_f32 v75, v15, v75
v_mul_f32 v88, v15, v88
v_mul_f32 v89, v15, v89
v_mul_f32 v90, v15, v90
v_mul_f32 v91, v15, v91
v_mul_f32 v104, v15, v104
v_mul_f32 v105, v15, v105
v_mul_f32 v106, v15, v106
v_mul_f32 v107, v15, v107
v_mul_f32 v120, v15, v120
v_mul_f32 v121, v15, v121
v_mul_f32 v122, v15, v122
v_mul_f32 v123, v15, v123
v_mul_f32 v136, v15, v136
v_mul_f32 v137, v15, v137
v_mul_f32 v138, v15, v138
v_mul_f32 v139, v15, v139
v_mul_f32 v152, v15, v152
v_mul_f32 v153, v15, v153
v_mul_f32 v154, v15, v154
v_mul_f32 v155, v15, v155
v_and_b32 v15, 15, v0
v_lshlrev_b32 v15, 2, v15
v_add_u32 v15, 162496, v15
ds_read_b32 v15, v15
v_cmp_eq_u32 vcc, 5, v19
s_waitcnt lgkmcnt(0)
s_nop 0
v_cndmask_b32 v15, 1.0, v15, vcc
v_mul_f32 v76, v15, v76
v_mul_f32 v77, v15, v77
v_mul_f32 v78, v15, v78
v_mul_f32 v79, v15, v79
v_mul_f32 v92, v15, v92
v_mul_f32 v93, v15, v93
v_mul_f32 v94, v15, v94
v_mul_f32 v95, v15, v95
v_mul_f32 v108, v15, v108
v_mul_f32 v109, v15, v109
v_mul_f32 v110, v15, v110
v_mul_f32 v111, v15, v111
v_mul_f32 v124, v15, v124
v_mul_f32 v125, v15, v125
v_mul_f32 v126, v15, v126
v_mul_f32 v127, v15, v127
v_mul_f32 v140, v15, v140
v_mul_f32 v141, v15, v141
v_mul_f32 v142, v15, v142
v_mul_f32 v143, v15, v143
v_mul_f32 v156, v15, v156
v_mul_f32 v157, v15, v157
v_mul_f32 v158, v15, v158
v_mul_f32 v159, v15, v159
s_nop 1
s_branch C_R4b
RESC5b:
s_nop 7
v_and_b32 v15, 15, v0
v_lshlrev_b32 v15, 2, v15
v_add_u32 v15, 162560, v15
ds_read_b32 v15, v15
v_cmp_eq_u32 vcc, 6, v16
s_waitcnt lgkmcnt(0)
s_nop 0
v_cndmask_b32 v15, 1.0, v15, vcc
v_mul_f32 v64, v15, v64
v_mul_f32 v65, v15, v65
v_mul_f32 v66, v15, v66
v_mul_f32 v67, v15, v67
v_mul_f32 v80, v15, v80
v_mul_f32 v81, v15, v81
v_mul_f32 v82, v15, v82
v_mul_f32 v83, v15, v83
v_mul_f32 v96, v15, v96
v_mul_f32 v97, v15, v97
v_mul_f32 v98, v15, v98
v_mul_f32 v99, v15, v99
v_mul_f32 v112, v15, v112
v_mul_f32 v113, v15, v113
v_mul_f32 v114, v15, v114
v_mul_f32 v115, v15, v115
v_mul_f32 v128, v15, v128
v_mul_f32 v129, v15, v129
v_mul_f32 v130, v15, v130
v_mul_f32 v131, v15, v131
v_mul_f32 v144, v15, v144
v_mul_f32 v145, v15, v145
v_mul_f32 v146, v15, v146
v_mul_f32 v147, v15, v147
v_and_b32 v15, 15, v0
v_lshlrev_b32 v15, 2, v15
v_add_u32 v15, 162624, v15
ds_read_b32 v15, v15
v_cmp_eq_u32 vcc, 6, v17
s_waitcnt lgkmcnt(0)
s_nop 0
v_cndmask_b32 v15, 1.0, v15, vcc
v_mul_f32 v68, v15, v68
v_mul_f32 v69, v15, v69
v_mul_f32 v70, v15, v70
v_mul_f32 v71, v15, v71
v_mul_f32 v84, v15, v84
v_mul_f32 v85, v15, v85
v_mul_f32 v86, v15, v86
v_mul_f32 v87, v15, v87
v_mul_f32 v100, v15, v100
v_mul_f32 v101, v15, v101
v_mul_f32 v102, v15, v102
v_mul_f32 v103, v15, v103
v_mul_f32 v116, v15, v116
v_mul_f32 v117, v15, v117
v_mul_f32 v118, v15, v118
v_mul_f32 v119, v15, v119
v_mul_f32 v132, v15, v132
v_mul_f32 v133, v15, v133
v_mul_f32 v134, v15, v134
v_mul_f32 v135, v15, v135
v_mul_f32 v148, v15, v148
v_mul_f32 v149, v15, v149
v_mul_f32 v150, v15, v150
v_mul_f32 v151, v15, v151
v_and_b32 v15, 15, v0
v_lshlrev_b32 v15, 2, v15
v_add_u32 v15, 162688, v15
ds_read_b32 v15, v15
v_cmp_eq_u32 vcc, 6, v18
s_waitcnt lgkmcnt(0)
s_nop 0
v_cndmask_b32 v15, 1.0, v15, vcc
v_mul_f32 v72, v15, v72
v_mul_f32 v73, v15, v73
v_mul_f32 v74, v15, v74
v_mul_f32 v75, v15, v75
v_mul_f32 v88, v15, v88
v_mul_f32 v89, v15, v89
v_mul_f32 v90, v15, v90
v_mul_f32 v91, v15, v91
v_mul_f32 v104, v15, v104
v_mul_f32 v105, v15, v105
v_mul_f32 v106, v15, v106
v_mul_f32 v107, v15, v107
v_mul_f32 v120, v15, v120
v_mul_f32 v121, v15, v121
v_mul_f32 v122, v15, v122
v_mul_f32 v123, v15, v123
v_mul_f32 v136, v15, v136
v_mul_f32 v137, v15, v137
v_mul_f32 v138, v15, v138
v_mul_f32 v139, v15, v139
v_mul_f32 v152, v15, v152
v_mul_f32 v153, v15, v153
v_mul_f32 v154, v15, v154
v_mul_f32 v155, v15, v155
v_and_b32 v15, 15, v0
v_lshlrev_b32 v15, 2, v15
v_add_u32 v15, 162752, v15
ds_read_b32 v15, v15
v_cmp_eq_u32 vcc, 6, v19
s_waitcnt lgkmcnt(0)
s_nop 0
v_cndmask_b32 v15, 1.0, v15, vcc
v_mul_f32 v76, v15, v76
v_mul_f32 v77, v15, v77
v_mul_f32 v78, v15, v78
v_mul_f32 v79, v15, v79
v_mul_f32 v92, v15, v92
v_mul_f32 v93, v15, v93
v_mul_f32 v94, v15, v94
v_mul_f32 v95, v15, v95
v_mul_f32 v108, v15, v108
v_mul_f32 v109, v15, v109
v_mul_f32 v110, v15, v110
v_mul_f32 v111, v15, v111
v_mul_f32 v124, v15, v124
v_mul_f32 v125, v15, v125
v_mul_f32 v126, v15, v126
v_mul_f32 v127, v15, v127
v_mul_f32 v140, v15, v140
v_mul_f32 v141, v15, v141
v_mul_f32 v142, v15, v142
v_mul_f32 v143, v15, v143
v_mul_f32 v156, v15, v156
v_mul_f32 v157, v15, v157
v_mul_f32 v158, v15, v158
v_mul_f32 v159, v15, v159
s_nop 1
s_branch C_R5b
RESC6b:
s_nop 7
v_and_b32 v15, 15, v0
v_lshlrev_b32 v15, 2, v15
v_add_u32 v15, 162304, v15
ds_read_b32 v15, v15
v_cmp_eq_u32 vcc, 7, v16
s_waitcnt lgkmcnt(0)
s_nop 0
v_cndmask_b32 v15, 1.0, v15, vcc
v_mul_f32 v64, v15, v64
v_mul_f32 v65, v15, v65
v_mul_f32 v66, v15, v66
v_mul_f32 v67, v15, v67
v_mul_f32 v80, v15, v80
v_mul_f32 v81, v15, v81
v_mul_f32 v82, v15, v82
v_mul_f32 v83, v15, v83
v_mul_f32 v96, v15, v96
v_mul_f32 v97, v15, v97
v_mul_f32 v98, v15, v98
v_mul_f32 v99, v15, v99
v_mul_f32 v112, v15, v112
v_mul_f32 v113, v15, v113
v_mul_f32 v114, v15, v114
v_mul_f32 v115, v15, v115
v_mul_f32 v128, v15, v128
v_mul_f32 v129, v15, v129
v_mul_f32 v130, v15, v130
v_mul_f32 v131, v15, v131
v_mul_f32 v144, v15, v144
v_mul_f32 v145, v15, v145
v_mul_f32 v146, v15, v146
v_mul_f32 v147, v15, v147
v_and_b32 v15, 15, v0
v_lshlrev_b32 v15, 2, v15
v_add_u32 v15, 162368, v15
ds_read_b32 v15, v15
v_cmp_eq_u32 vcc, 7, v17
s_waitcnt lgkmcnt(0)
s_nop 0
v_cndmask_b32 v15, 1.0, v15, vcc
v_mul_f32 v68, v15, v68
v_mul_f32 v69, v15, v69
v_mul_f32 v70, v15, v70
v_mul_f32 v71, v15, v71
v_mul_f32 v84, v15, v84
v_mul_f32 v85, v15, v85
v_mul_f32 v86, v15, v86
v_mul_f32 v87, v15, v87
v_mul_f32 v100, v15, v100
v_mul_f32 v101, v15, v101
v_mul_f32 v102, v15, v102
v_mul_f32 v103, v15, v103
v_mul_f32 v116, v15, v116
v_mul_f32 v117, v15, v117
v_mul_f32 v118, v15, v118
v_mul_f32 v119, v15, v119
v_mul_f32 v132, v15, v132
v_mul_f32 v133, v15, v133
v_mul_f32 v134, v15, v134
v_mul_f32 v135, v15, v135
v_mul_f32 v148, v15, v148
v_mul_f32 v149, v15, v149
v_mul_f32 v150, v15, v150
v_mul_f32 v151, v15, v151
v_and_b32 v15, 15, v0
v_lshlrev_b32 v15, 2, v15
v_add_u32 v15, 162432, v15
ds_read_b32 v15, v15
v_cmp_eq_u32 vcc, 7, v18
s_waitcnt lgkmcnt(0)
s_nop 0
v_cndmask_b32 v15, 1.0, v15, vcc
v_mul_f32 v72, v15, v72
v_mul_f32 v73, v15, v73
v_mul_f32 v74, v15, v74
v_mul_f32 v75, v15, v75
v_mul_f32 v88, v15, v88
v_mul_f32 v89, v15, v89
v_mul_f32 v90, v15, v90
v_mul_f32 v91, v15, v91
v_mul_f32 v104, v15, v104
v_mul_f32 v105, v15, v105
v_mul_f32 v106, v15, v106
v_mul_f32 v107, v15, v107
v_mul_f32 v120, v15, v120
v_mul_f32 v121, v15, v121
v_mul_f32 v122, v15, v122
v_mul_f32 v123, v15, v123
v_mul_f32 v136, v15, v136
v_mul_f32 v137, v15, v137
v_mul_f32 v138, v15, v138
v_mul_f32 v139, v15, v139
v_mul_f32 v152, v15, v152
v_mul_f32 v153, v15, v153
v_mul_f32 v154, v15, v154
v_mul_f32 v155, v15, v155
v_and_b32 v15, 15, v0
v_lshlrev_b32 v15, 2, v15
v_add_u32 v15, 162496, v15
ds_read_b32 v15, v15
v_cmp_eq_u32 vcc, 7, v19
s_waitcnt lgkmcnt(0)
s_nop 0
v_cndmask_b32 v15, 1.0, v15, vcc
v_mul_f32 v76, v15, v76
v_mul_f32 v77, v15, v77
v_mul_f32 v78, v15, v78
v_mul_f32 v79, v15, v79
v_mul_f32 v92, v15, v92
v_mul_f32 v93, v15, v93
v_mul_f32 v94, v15, v94
v_mul_f32 v95, v15, v95
v_mul_f32 v108, v15, v108
v_mul_f32 v109, v15, v109
v_mul_f32 v110, v15, v110
v_mul_f32 v111, v15, v111
v_mul_f32 v124, v15, v124
v_mul_f32 v125, v15, v125
v_mul_f32 v126, v15, v126
v_mul_f32 v127, v15, v127
v_mul_f32 v140, v15, v140
v_mul_f32 v141, v15, v141
v_mul_f32 v142, v15, v142
v_mul_f32 v143, v15, v143
v_mul_f32 v156, v15, v156
v_mul_f32 v157, v15, v157
v_mul_f32 v158, v15, v158
v_mul_f32 v159, v15, v159
s_nop 1
s_branch C_R6b
RESC7b:
s_nop 7
v_and_b32 v15, 15, v0
v_lshlrev_b32 v15, 2, v15
v_add_u32 v15, 162560, v15
ds_read_b32 v15, v15
v_cmp_eq_u32 vcc, 8, v16
s_waitcnt lgkmcnt(0)
s_nop 0
v_cndmask_b32 v15, 1.0, v15, vcc
v_mul_f32 v64, v15, v64
v_mul_f32 v65, v15, v65
v_mul_f32 v66, v15, v66
v_mul_f32 v67, v15, v67
v_mul_f32 v80, v15, v80
v_mul_f32 v81, v15, v81
v_mul_f32 v82, v15, v82
v_mul_f32 v83, v15, v83
v_mul_f32 v96, v15, v96
v_mul_f32 v97, v15, v97
v_mul_f32 v98, v15, v98
v_mul_f32 v99, v15, v99
v_mul_f32 v112, v15, v112
v_mul_f32 v113, v15, v113
v_mul_f32 v114, v15, v114
v_mul_f32 v115, v15, v115
v_mul_f32 v128, v15, v128
v_mul_f32 v129, v15, v129
v_mul_f32 v130, v15, v130
v_mul_f32 v131, v15, v131
v_mul_f32 v144, v15, v144
v_mul_f32 v145, v15, v145
v_mul_f32 v146, v15, v146
v_mul_f32 v147, v15, v147
v_and_b32 v15, 15, v0
v_lshlrev_b32 v15, 2, v15
v_add_u32 v15, 162624, v15
ds_read_b32 v15, v15
v_cmp_eq_u32 vcc, 8, v17
s_waitcnt lgkmcnt(0)
s_nop 0
v_cndmask_b32 v15, 1.0, v15, vcc
v_mul_f32 v68, v15, v68
v_mul_f32 v69, v15, v69
v_mul_f32 v70, v15, v70
v_mul_f32 v71, v15, v71
v_mul_f32 v84, v15, v84
v_mul_f32 v85, v15, v85
v_mul_f32 v86, v15, v86
v_mul_f32 v87, v15, v87
v_mul_f32 v100, v15, v100
v_mul_f32 v101, v15, v101
v_mul_f32 v102, v15, v102
v_mul_f32 v103, v15, v103
v_mul_f32 v116, v15, v116
v_mul_f32 v117, v15, v117
v_mul_f32 v118, v15, v118
v_mul_f32 v119, v15, v119
v_mul_f32 v132, v15, v132
v_mul_f32 v133, v15, v133
v_mul_f32 v134, v15, v134
v_mul_f32 v135, v15, v135
v_mul_f32 v148, v15, v148
v_mul_f32 v149, v15, v149
v_mul_f32 v150, v15, v150
v_mul_f32 v151, v15, v151
v_and_b32 v15, 15, v0
v_lshlrev_b32 v15, 2, v15
v_add_u32 v15, 162688, v15
ds_read_b32 v15, v15
v_cmp_eq_u32 vcc, 8, v18
s_waitcnt lgkmcnt(0)
s_nop 0
v_cndmask_b32 v15, 1.0, v15, vcc
v_mul_f32 v72, v15, v72
v_mul_f32 v73, v15, v73
v_mul_f32 v74, v15, v74
v_mul_f32 v75, v15, v75
v_mul_f32 v88, v15, v88
v_mul_f32 v89, v15, v89
v_mul_f32 v90, v15, v90
v_mul_f32 v91, v15, v91
v_mul_f32 v104, v15, v104
v_mul_f32 v105, v15, v105
v_mul_f32 v106, v15, v106
v_mul_f32 v107, v15, v107
v_mul_f32 v120, v15, v120
v_mul_f32 v121, v15, v121
v_mul_f32 v122, v15, v122
v_mul_f32 v123, v15, v123
v_mul_f32 v136, v15, v136
v_mul_f32 v137, v15, v137
v_mul_f32 v138, v15, v138
v_mul_f32 v139, v15, v139
v_mul_f32 v152, v15, v152
v_mul_f32 v153, v15, v153
v_mul_f32 v154, v15, v154
v_mul_f32 v155, v15, v155
v_and_b32 v15, 15, v0
v_lshlrev_b32 v15, 2, v15
v_add_u32 v15, 162752, v15
ds_read_b32 v15, v15
v_cmp_eq_u32 vcc, 8, v19
s_waitcnt lgkmcnt(0)
s_nop 0
v_cndmask_b32 v15, 1.0, v15, vcc
v_mul_f32 v76, v15, v76
v_mul_f32 v77, v15, v77
v_mul_f32 v78, v15, v78
v_mul_f32 v79, v15, v79
v_mul_f32 v92, v15, v92
v_mul_f32 v93, v15, v93
v_mul_f32 v94, v15, v94
v_mul_f32 v95, v15, v95
v_mul_f32 v108, v15, v108
v_mul_f32 v109, v15, v109
v_mul_f32 v110, v15, v110
v_mul_f32 v111, v15, v111
v_mul_f32 v124, v15, v124
v_mul_f32 v125, v15, v125
v_mul_f32 v126, v15, v126
v_mul_f32 v127, v15, v127
v_mul_f32 v140, v15, v140
v_mul_f32 v141, v15, v141
v_mul_f32 v142, v15, v142
v_mul_f32 v143, v15, v143
v_mul_f32 v156, v15, v156
v_mul_f32 v157, v15, v157
v_mul_f32 v158, v15, v158
v_mul_f32 v159, v15, v159
s_nop 1
s_branch C_R7b
CODE_END:
.section .rodata,"a"
.p2align 6
.amdhsa_kernel standalone__detection_seg_mask2former__vision_kernel
  .amdhsa_next_free_vgpr 256
  .amdhsa_next_free_sgpr 102
  .amdhsa_accum_offset 160
  .amdhsa_group_segment_fixed_size 0
  .amdhsa_kernarg_size 96
  .amdhsa_user_sgpr_count 2
  .amdhsa_user_sgpr_kernarg_segment_ptr 1
  .amdhsa_system_sgpr_workgroup_id_x 1
.end_amdhsa_kernel
```
